```python
import torch

def _softmax(x, axis=-1):
    return torch.softmax(x, dim=axis)
def _gelu(x):
    return torch.nn.functional.gelu(x, approximate="tanh")
def _silu(x):
    return torch.nn.functional.silu(x)
def _sigmoid(x):
    return torch.sigmoid(x)
def _layernorm(x, axis=-1, eps=1e-5):
    m = x.mean(dim=axis, keepdim=True)
    v = x.var(dim=axis, keepdim=True, unbiased=False)
    return (x - m) / torch.sqrt(v + eps)
def _scatter_add(tgt, idx, src, axis=0):
    return tgt.clone().index_add_(axis, idx, src)
def _segment_sum(src, seg, n):
    out = torch.zeros((n,) + src.shape[1:], dtype=src.dtype)
    return out.index_add_(0, seg, src)
def _pad(x, pw):
    flat = tuple(v for pair in reversed(pw) for v in pair)
    return torch.nn.functional.pad(x, flat)

kernel_name = 'gated_mix__sliding_block__spectral_fnet__prompt'

def setup_inputs():

    _w = (lambda a: (lambda t: t.to(torch.bfloat16) if t.is_floating_point() else t)(torch.as_tensor(a)))
    def _A_setup():
        B, S, D = 1, 2048, 512
        return {
            "x": _w((lambda *s: torch.randn(*s, dtype=torch.bfloat16) * 0.05)(B, S, D)),
            "wqkv": _w((lambda *s: torch.randn(*s, dtype=torch.bfloat16) * 1.6)(D, 3 * D)),
            "wo": _w((lambda *s: torch.randn(*s, dtype=torch.bfloat16) * 1.6)(D, D)),
        }
    _A_in = _A_setup()

    def _B_setup():
        B, S, D = 1, 2048, 512
        ns = torch.arange(S)[:, None] * torch.arange(S)[None, :]
        nd = torch.arange(D)[:, None] * torch.arange(D)[None, :]
        Ws_re = torch.cos(-2.0 * torch.pi * ns / S).to(float)
        Ws_im = torch.sin(-2.0 * torch.pi * ns / S).to(float)
        Wd_re = torch.cos(-2.0 * torch.pi * nd / D).to(float)
        Wd_im = torch.sin(-2.0 * torch.pi * nd / D).to(float)
        return {
            "x": _w((lambda *s: torch.randn(*s, dtype=torch.bfloat16) * 0.05)(B, S, D)),
            "dft_seq_re": _w(Ws_re),
            "dft_seq_im": _w(Ws_im),
            "dft_hid_re": _w(Wd_re),
            "dft_hid_im": _w(Wd_im),
        }
    _B_in = _B_setup()

    return {
        "A_x": _A_in["x"],
        "A_wqkv": _A_in["wqkv"],
        "A_wo": _A_in["wo"],
        "B_x": _B_in["x"],
        "B_dft_seq_re": _B_in["dft_seq_re"],
        "B_dft_seq_im": _B_in["dft_seq_im"],
        "B_dft_hid_re": _B_in["dft_hid_re"],
        "B_dft_hid_im": _B_in["dft_hid_im"],
        "gate_w": _w((lambda *s: torch.randn(*s, dtype=torch.bfloat16) * 0.05)(512) * 16.0),
    }

def reference(A_x, A_wqkv, A_wo, B_x, B_dft_seq_re, B_dft_seq_im, B_dft_hid_re, B_dft_hid_im, gate_w):
    def _A_ref(x, wqkv, wo):
        B, S, D = x.shape
        H = 32; Dh = D // H; W = 256
        qkv = (lambda x, *d: x.permute(*d))((x @ wqkv).reshape(B, S, 3, H, Dh), 2, 0, 3, 1, 4)
        q, k, v = qkv[0], qkv[1], qkv[2]
        scores = torch.einsum("bhqd,bhkd->bhqk", q, k) * (Dh ** -0.5)
        idx = torch.arange(S)
        mask = (idx[:, None] - idx[None, :] >= 0) & (idx[:, None] - idx[None, :] < W)
        scores = torch.where(mask[None, None], scores, -1e9)
        p = _softmax(scores, axis=-1)
        o = torch.einsum("bhqk,bhkd->bhqd", p, v)
        return (lambda x, *d: x.permute(*d))(o, 0, 2, 1, 3).reshape(B, S, D) @ wo

    def _B_ref(x, dft_seq_re, dft_seq_im, dft_hid_re, dft_hid_im):
        a = torch.einsum("bsd,ed->bse", x, dft_hid_re)
        b = torch.einsum("bsd,ed->bse", x, dft_hid_im)
        y = torch.einsum("ts,bse->bte", dft_seq_re, a) - torch.einsum("ts,bse->bte", dft_seq_im, b)
        return y

    x = A_x
    g = _sigmoid((x * gate_w).sum(-1, keepdims=True))
    a = _A_ref(x, A_wqkv, A_wo)
    b = _B_ref(x, B_dft_seq_re, B_dft_seq_im, B_dft_hid_re, B_dft_hid_im)
    return g * a + (1 - g) * b
```

```asm
; @launch grid=(256,1,1) block=(768,1,1) lds=163840
.amdgcn_target "amdgcn-amd-amdhsa--gfx950"
.text
.p2align 8
CODE_START:
.globl gated_mix__sliding_block__spectral_fnet__prompt_kernel
.type gated_mix__sliding_block__spectral_fnet__prompt_kernel,@function
gated_mix__sliding_block__spectral_fnet__prompt_kernel:
  s_cmp_ge_u32 s2, 256
  s_cbranch_scc1 gm_end
  s_load_dwordx16 s[8:23], s[0:1], 0
  s_load_dwordx8 s[24:31], s[0:1], 64
  v_lshrrev_b32 v1, 6, v0
  v_and_b32 v0, 63, v0
  v_readfirstlane_b32 s3, v1
  s_and_b32 s4, s2, 7
  s_lshr_b32 s5, s2, 3
  s_lshr_b32 s6, s2, 4
  v_lshlrev_b32 v1, 4, v0
  s_bitcmp1_b32 s2, 3
  s_cbranch_scc1 gm_typeA
  s_cmp_ge_u32 s3, 8
  s_cbranch_scc1 gm_BL
gm_BC:
  s_and_b32 s77, s4, 3
  s_lshr_b32 s78, s4, 2
  s_mov_b32 s63, 0x20000
  s_mov_b64 s[60:61], 0
  s_mov_b32 s62, 0
  s_mov_b32 s75, 0
  v_and_b32 v150, 15, v0
  v_lshrrev_b32 v151, 4, v0
  s_cmp_eq_u32 s3, 4
  s_cbranch_scc1 gm_BC_t4
  s_cmp_gt_u32 s3, 4
  s_cbranch_scc1 gm_BC_tj
  v_lshlrev_b32 v150, 10, v150
  v_lshl_add_u32 v150, v151, 7, v150
  s_lshl_b32 s75, s5, 14
  s_and_b32 s33, s3, 2
  s_lshl_b32 s33, s33, 8
  s_add_u32 s75, s75, s33
  s_lshl_b32 s34, s77, 19
  s_bitcmp1_b32 s3, 0
  s_cselect_b32 s34, 0, s34
  s_add_u32 s75, s75, s34
  s_waitcnt lgkmcnt(0)
  s_cmp_eq_u32 s78, 0
  s_cselect_b32 s60, s20, s22
  s_cselect_b32 s61, s21, s23
  s_bitcmp1_b32 s3, 0
  s_cselect_b32 s60, s60, s8
  s_cselect_b32 s61, s61, s9
  s_cselect_b32 s62, 0x80000, s63
  s_cselect_b32 s33, 0, 0x1e0000
  s_add_u32 s62, s62, s33
  s_cmp_ge_u32 s3, 2
  s_cbranch_scc1 gm_BC_tj
  buffer_load_dword v152, v150, s[60:63], s75 offen
  s_branch gm_BC_tj
gm_BC_t4:
  s_getpc_b64 s[60:61]
gm_BC_pc:
  s_sub_u32 s60, s60, gm_BC_pc-CODE_START
  s_subb_u32 s61, s61, 0
  s_mov_b32 s62, CODE_END-CODE_START
  v_lshlrev_b32 v150, 12, v0
  s_lshl_b32 s75, s5, 7
  s_mov_b64 exec, 0xffffffff
  s_waitcnt vmcnt(0)
  buffer_load_dword v152, v150, s[60:63], s75 offen
  s_mov_b64 exec, -1
gm_BC_tj:
  v_lshrrev_b32 v144, 5, v0
  v_bfe_u32 v145, v0, 1, 3
  v_xor_b32 v145, v144, v145
  v_and_b32 v146, 31, v0
  v_lshlrev_b32 v146, 7, v146
  v_xor_b32 v144, 0, v145
  v_lshl_add_u32 v140, v144, 4, v146
  v_xor_b32 v144, 2, v145
  v_lshl_add_u32 v141, v144, 4, v146
  v_xor_b32 v144, 4, v145
  v_lshl_add_u32 v142, v144, 4, v146
  v_xor_b32 v144, 6, v145
  v_lshl_add_u32 v143, v144, 4, v146
  s_lshr_b32 s33, s3, 1
  s_lshl_b32 s33, s33, 12
  s_and_b32 s34, s3, 1
  s_lshl_b32 s34, s34, 13
  s_add_u32 s34, s34, 16384
  v_add_u32 v2, s33, v140
  v_add_u32 v6, 0x10000, v2
  v_add_u32 v10, s34, v140
  v_add_u32 v14, 0x10000, v10
  v_add_u32 v3, s33, v141
  v_add_u32 v7, 0x10000, v3
  v_add_u32 v11, s34, v141
  v_add_u32 v15, 0x10000, v11
  v_add_u32 v4, s33, v142
  v_add_u32 v8, 0x10000, v4
  v_add_u32 v12, s34, v142
  v_add_u32 v16, 0x10000, v12
  v_add_u32 v5, s33, v143
  v_add_u32 v9, 0x10000, v5
  v_add_u32 v13, s34, v143
  v_add_u32 v17, 0x10000, v13
  s_waitcnt lgkmcnt(0)
  s_mov_b32 s36, s30
  s_mov_b32 s37, s31
  s_mov_b32 s38, 0x1700000
  s_mov_b32 s39, 0x20000
  s_add_u32 s84, s30, 0x1600000
  s_addc_u32 s85, s31, 0
  s_load_dword s90, s[84:85], 0
  s_lshl_b32 s40, s77, 2
  s_and_b32 s33, s6, 3
  s_add_u32 s40, s40, s33
  s_lshr_b32 s41, s6, 2
  s_lshl_b32 s33, s40, 2
  s_lshr_b32 s34, s3, 1
  s_add_u32 s33, s33, s34
  s_lshl_b32 s33, s33, 1
  s_lshl_b32 s34, s78, 7
  s_add_u32 s33, s33, s34
  s_lshl_b32 s33, s33, 4
  s_lshl_b32 s34, s41, 2
  s_add_u32 s33, s33, s34
  s_and_b32 s34, s3, 1
  s_lshl_b32 s34, s34, 1
  s_add_u32 s33, s33, s34
  s_lshl_b32 s33, s33, 10
  s_add_u32 s42, s33, 0x600000
  s_add_u32 s43, s42, 16384
  s_lshl_b32 s33, s78, 2
  s_add_u32 s33, s33, s41
  s_lshl_b32 s33, s33, 4
  s_add_u32 s33, s33, s40
  s_lshl_b32 s33, s33, 3
  s_add_u32 s33, s33, s3
  s_lshl_b32 s33, s33, 7
  s_add_u32 s44, s33, 0x1620000
  s_cmp_eq_u32 s78, 0
  s_cselect_b32 s45, 0, 0x80008000
  s_waitcnt lgkmcnt(0)
  s_add_u32 s90, s90, 1
  s_barrier
  s_and_b32 s33, s3, 6
  s_cmp_lg_u32 s33, 2
  s_cbranch_scc1 gm_BC_f1x
  buffer_load_dword v152, v150, s[60:63], s75 offen
gm_BC_f1x:
  ds_read_b128 v[20:23], v2 offset:0
  ds_read_b128 v[24:27], v10 offset:0
  ds_read_b128 v[28:31], v10 offset:4096
  s_waitcnt lgkmcnt(1)
  v_mfma_f32_32x32x16_bf16 v[44:59], v[20:23], v[24:27], 0
  ds_read_b128 v[32:35], v3 offset:0
  ds_read_b128 v[36:39], v11 offset:0
  s_waitcnt lgkmcnt(2)
  v_mfma_f32_32x32x16_bf16 v[60:75], v[20:23], v[28:31], 0
  ds_read_b128 v[40:43], v11 offset:4096
  s_waitcnt lgkmcnt(1)
  v_mfma_f32_32x32x16_bf16 v[44:59], v[32:35], v[36:39], v[44:59]
  ds_read_b128 v[20:23], v4 offset:0
  ds_read_b128 v[24:27], v12 offset:0
  s_waitcnt lgkmcnt(2)
  v_mfma_f32_32x32x16_bf16 v[60:75], v[32:35], v[40:43], v[60:75]
  ds_read_b128 v[28:31], v12 offset:4096
  s_waitcnt lgkmcnt(1)
  v_mfma_f32_32x32x16_bf16 v[44:59], v[20:23], v[24:27], v[44:59]
  ds_read_b128 v[32:35], v5 offset:0
  ds_read_b128 v[36:39], v13 offset:0
  s_waitcnt lgkmcnt(2)
  v_mfma_f32_32x32x16_bf16 v[60:75], v[20:23], v[28:31], v[60:75]
  ds_read_b128 v[40:43], v13 offset:4096
  s_waitcnt lgkmcnt(0)
  s_barrier
  v_mfma_f32_32x32x16_bf16 v[44:59], v[32:35], v[36:39], v[44:59]
  ds_read_b128 v[20:23], v2 offset:32768
  ds_read_b128 v[24:27], v10 offset:32768
  v_mfma_f32_32x32x16_bf16 v[60:75], v[32:35], v[40:43], v[60:75]
  ds_read_b128 v[28:31], v10 offset:36864
  s_waitcnt lgkmcnt(1)
  v_mfma_f32_32x32x16_bf16 v[44:59], v[20:23], v[24:27], v[44:59]
  ds_read_b128 v[32:35], v3 offset:32768
  ds_read_b128 v[36:39], v11 offset:32768
  s_waitcnt lgkmcnt(2)
  v_mfma_f32_32x32x16_bf16 v[60:75], v[20:23], v[28:31], v[60:75]
  ds_read_b128 v[40:43], v11 offset:36864
  s_waitcnt lgkmcnt(1)
  v_mfma_f32_32x32x16_bf16 v[44:59], v[32:35], v[36:39], v[44:59]
  ds_read_b128 v[20:23], v4 offset:32768
  ds_read_b128 v[24:27], v12 offset:32768
  s_waitcnt lgkmcnt(2)
  v_mfma_f32_32x32x16_bf16 v[60:75], v[32:35], v[40:43], v[60:75]
  ds_read_b128 v[28:31], v12 offset:36864
  s_waitcnt lgkmcnt(1)
  v_mfma_f32_32x32x16_bf16 v[44:59], v[20:23], v[24:27], v[44:59]
  ds_read_b128 v[32:35], v5 offset:32768
  ds_read_b128 v[36:39], v13 offset:32768
  s_waitcnt lgkmcnt(2)
  v_mfma_f32_32x32x16_bf16 v[60:75], v[20:23], v[28:31], v[60:75]
  ds_read_b128 v[40:43], v13 offset:36864
  s_waitcnt lgkmcnt(0)
  s_barrier
  v_mfma_f32_32x32x16_bf16 v[44:59], v[32:35], v[36:39], v[44:59]
  ds_read_b128 v[20:23], v6 offset:0
  ds_read_b128 v[24:27], v14 offset:0
  v_mfma_f32_32x32x16_bf16 v[60:75], v[32:35], v[40:43], v[60:75]
  ds_read_b128 v[28:31], v14 offset:4096
  s_waitcnt lgkmcnt(1)
  v_mfma_f32_32x32x16_bf16 v[44:59], v[20:23], v[24:27], v[44:59]
  ds_read_b128 v[32:35], v7 offset:0
  ds_read_b128 v[36:39], v15 offset:0
  s_waitcnt lgkmcnt(2)
  v_mfma_f32_32x32x16_bf16 v[60:75], v[20:23], v[28:31], v[60:75]
  ds_read_b128 v[40:43], v15 offset:4096
  s_waitcnt lgkmcnt(1)
  v_mfma_f32_32x32x16_bf16 v[44:59], v[32:35], v[36:39], v[44:59]
  ds_read_b128 v[20:23], v8 offset:0
  ds_read_b128 v[24:27], v16 offset:0
  s_waitcnt lgkmcnt(2)
  v_mfma_f32_32x32x16_bf16 v[60:75], v[32:35], v[40:43], v[60:75]
  ds_read_b128 v[28:31], v16 offset:4096
  s_waitcnt lgkmcnt(1)
  v_mfma_f32_32x32x16_bf16 v[44:59], v[20:23], v[24:27], v[44:59]
  ds_read_b128 v[32:35], v9 offset:0
  ds_read_b128 v[36:39], v17 offset:0
  s_waitcnt lgkmcnt(2)
  v_mfma_f32_32x32x16_bf16 v[60:75], v[20:23], v[28:31], v[60:75]
  ds_read_b128 v[40:43], v17 offset:4096
  s_waitcnt lgkmcnt(0)
  s_barrier
  v_mfma_f32_32x32x16_bf16 v[44:59], v[32:35], v[36:39], v[44:59]
  ds_read_b128 v[20:23], v6 offset:32768
  ds_read_b128 v[24:27], v14 offset:32768
  v_mfma_f32_32x32x16_bf16 v[60:75], v[32:35], v[40:43], v[60:75]
  ds_read_b128 v[28:31], v14 offset:36864
  s_waitcnt lgkmcnt(1)
  v_mfma_f32_32x32x16_bf16 v[44:59], v[20:23], v[24:27], v[44:59]
  ds_read_b128 v[32:35], v7 offset:32768
  ds_read_b128 v[36:39], v15 offset:32768
  s_waitcnt lgkmcnt(2)
  v_mfma_f32_32x32x16_bf16 v[60:75], v[20:23], v[28:31], v[60:75]
  ds_read_b128 v[40:43], v15 offset:36864
  s_waitcnt lgkmcnt(1)
  v_mfma_f32_32x32x16_bf16 v[44:59], v[32:35], v[36:39], v[44:59]
  ds_read_b128 v[20:23], v8 offset:32768
  ds_read_b128 v[24:27], v16 offset:32768
  s_waitcnt lgkmcnt(2)
  v_mfma_f32_32x32x16_bf16 v[60:75], v[32:35], v[40:43], v[60:75]
  ds_read_b128 v[28:31], v16 offset:36864
  s_waitcnt lgkmcnt(1)
  v_mfma_f32_32x32x16_bf16 v[44:59], v[20:23], v[24:27], v[44:59]
  ds_read_b128 v[32:35], v9 offset:32768
  ds_read_b128 v[36:39], v17 offset:32768
  s_waitcnt lgkmcnt(2)
  v_mfma_f32_32x32x16_bf16 v[60:75], v[20:23], v[28:31], v[60:75]
  ds_read_b128 v[40:43], v17 offset:36864
  s_waitcnt lgkmcnt(0)
  s_barrier
  v_mfma_f32_32x32x16_bf16 v[44:59], v[32:35], v[36:39], v[44:59]
  ds_read_b128 v[20:23], v2 offset:0
  ds_read_b128 v[24:27], v10 offset:0
  v_mfma_f32_32x32x16_bf16 v[60:75], v[32:35], v[40:43], v[60:75]
  ds_read_b128 v[28:31], v10 offset:4096
  s_waitcnt lgkmcnt(1)
  v_mfma_f32_32x32x16_bf16 v[44:59], v[20:23], v[24:27], v[44:59]
  ds_read_b128 v[32:35], v3 offset:0
  ds_read_b128 v[36:39], v11 offset:0
  s_waitcnt lgkmcnt(2)
  v_mfma_f32_32x32x16_bf16 v[60:75], v[20:23], v[28:31], v[60:75]
  ds_read_b128 v[40:43], v11 offset:4096
  s_waitcnt lgkmcnt(1)
  v_mfma_f32_32x32x16_bf16 v[44:59], v[32:35], v[36:39], v[44:59]
  ds_read_b128 v[20:23], v4 offset:0
  ds_read_b128 v[24:27], v12 offset:0
  s_waitcnt lgkmcnt(2)
  v_mfma_f32_32x32x16_bf16 v[60:75], v[32:35], v[40:43], v[60:75]
  ds_read_b128 v[28:31], v12 offset:4096
  s_waitcnt lgkmcnt(1)
  v_mfma_f32_32x32x16_bf16 v[44:59], v[20:23], v[24:27], v[44:59]
  ds_read_b128 v[32:35], v5 offset:0
  ds_read_b128 v[36:39], v13 offset:0
  s_waitcnt lgkmcnt(2)
  v_mfma_f32_32x32x16_bf16 v[60:75], v[20:23], v[28:31], v[60:75]
  ds_read_b128 v[40:43], v13 offset:4096
  s_waitcnt lgkmcnt(0)
  s_barrier
  v_mfma_f32_32x32x16_bf16 v[44:59], v[32:35], v[36:39], v[44:59]
  ds_read_b128 v[20:23], v2 offset:32768
  ds_read_b128 v[24:27], v10 offset:32768
  v_mfma_f32_32x32x16_bf16 v[60:75], v[32:35], v[40:43], v[60:75]
  ds_read_b128 v[28:31], v10 offset:36864
  s_waitcnt lgkmcnt(1)
  v_mfma_f32_32x32x16_bf16 v[44:59], v[20:23], v[24:27], v[44:59]
  ds_read_b128 v[32:35], v3 offset:32768
  ds_read_b128 v[36:39], v11 offset:32768
  s_waitcnt lgkmcnt(2)
  v_mfma_f32_32x32x16_bf16 v[60:75], v[20:23], v[28:31], v[60:75]
  ds_read_b128 v[40:43], v11 offset:36864
  s_waitcnt lgkmcnt(1)
  v_mfma_f32_32x32x16_bf16 v[44:59], v[32:35], v[36:39], v[44:59]
  ds_read_b128 v[20:23], v4 offset:32768
  ds_read_b128 v[24:27], v12 offset:32768
  s_waitcnt lgkmcnt(2)
  v_mfma_f32_32x32x16_bf16 v[60:75], v[32:35], v[40:43], v[60:75]
  ds_read_b128 v[28:31], v12 offset:36864
  s_waitcnt lgkmcnt(1)
  v_mfma_f32_32x32x16_bf16 v[44:59], v[20:23], v[24:27], v[44:59]
  ds_read_b128 v[32:35], v5 offset:32768
  ds_read_b128 v[36:39], v13 offset:32768
  s_waitcnt lgkmcnt(2)
  v_mfma_f32_32x32x16_bf16 v[60:75], v[20:23], v[28:31], v[60:75]
  ds_read_b128 v[40:43], v13 offset:36864
  s_waitcnt lgkmcnt(0)
  s_barrier
  v_mfma_f32_32x32x16_bf16 v[44:59], v[32:35], v[36:39], v[44:59]
  ds_read_b128 v[20:23], v6 offset:0
  ds_read_b128 v[24:27], v14 offset:0
  v_mfma_f32_32x32x16_bf16 v[60:75], v[32:35], v[40:43], v[60:75]
  ds_read_b128 v[28:31], v14 offset:4096
  s_waitcnt lgkmcnt(1)
  v_mfma_f32_32x32x16_bf16 v[44:59], v[20:23], v[24:27], v[44:59]
  ds_read_b128 v[32:35], v7 offset:0
  ds_read_b128 v[36:39], v15 offset:0
  s_waitcnt lgkmcnt(2)
  v_mfma_f32_32x32x16_bf16 v[60:75], v[20:23], v[28:31], v[60:75]
  ds_read_b128 v[40:43], v15 offset:4096
  s_waitcnt lgkmcnt(1)
  v_mfma_f32_32x32x16_bf16 v[44:59], v[32:35], v[36:39], v[44:59]
  ds_read_b128 v[20:23], v8 offset:0
  ds_read_b128 v[24:27], v16 offset:0
  s_waitcnt lgkmcnt(2)
  v_mfma_f32_32x32x16_bf16 v[60:75], v[32:35], v[40:43], v[60:75]
  ds_read_b128 v[28:31], v16 offset:4096
  s_waitcnt lgkmcnt(1)
  v_mfma_f32_32x32x16_bf16 v[44:59], v[20:23], v[24:27], v[44:59]
  ds_read_b128 v[32:35], v9 offset:0
  ds_read_b128 v[36:39], v17 offset:0
  s_waitcnt lgkmcnt(2)
  v_mfma_f32_32x32x16_bf16 v[60:75], v[20:23], v[28:31], v[60:75]
  ds_read_b128 v[40:43], v17 offset:4096
  s_waitcnt lgkmcnt(0)
  s_barrier
  v_mfma_f32_32x32x16_bf16 v[44:59], v[32:35], v[36:39], v[44:59]
  ds_read_b128 v[20:23], v6 offset:32768
  ds_read_b128 v[24:27], v14 offset:32768
  v_mfma_f32_32x32x16_bf16 v[60:75], v[32:35], v[40:43], v[60:75]
  ds_read_b128 v[28:31], v14 offset:36864
  s_waitcnt lgkmcnt(1)
  v_mfma_f32_32x32x16_bf16 v[44:59], v[20:23], v[24:27], v[44:59]
  ds_read_b128 v[32:35], v7 offset:32768
  ds_read_b128 v[36:39], v15 offset:32768
  s_waitcnt lgkmcnt(2)
  v_mfma_f32_32x32x16_bf16 v[60:75], v[20:23], v[28:31], v[60:75]
  ds_read_b128 v[40:43], v15 offset:36864
  s_waitcnt lgkmcnt(1)
  v_mfma_f32_32x32x16_bf16 v[44:59], v[32:35], v[36:39], v[44:59]
  ds_read_b128 v[20:23], v8 offset:32768
  ds_read_b128 v[24:27], v16 offset:32768
  s_waitcnt lgkmcnt(2)
  v_mfma_f32_32x32x16_bf16 v[60:75], v[32:35], v[40:43], v[60:75]
  ds_read_b128 v[28:31], v16 offset:36864
  s_waitcnt lgkmcnt(1)
  v_mfma_f32_32x32x16_bf16 v[44:59], v[20:23], v[24:27], v[44:59]
  ds_read_b128 v[32:35], v9 offset:32768
  ds_read_b128 v[36:39], v17 offset:32768
  s_waitcnt lgkmcnt(2)
  v_mfma_f32_32x32x16_bf16 v[60:75], v[20:23], v[28:31], v[60:75]
  ds_read_b128 v[40:43], v17 offset:36864
  s_waitcnt lgkmcnt(0)
  s_barrier
  v_mfma_f32_32x32x16_bf16 v[44:59], v[32:35], v[36:39], v[44:59]
  v_mfma_f32_32x32x16_bf16 v[60:75], v[32:35], v[40:43], v[60:75]
  s_nop 10
  v_cvt_pk_bf16_f32 v44, v44, v45
  v_cvt_pk_bf16_f32 v45, v46, v47
  v_cvt_pk_bf16_f32 v46, v48, v49
  v_cvt_pk_bf16_f32 v47, v50, v51
  v_cvt_pk_bf16_f32 v48, v52, v53
  v_cvt_pk_bf16_f32 v49, v54, v55
  v_cvt_pk_bf16_f32 v50, v56, v57
  v_cvt_pk_bf16_f32 v51, v58, v59
  v_xor_b32 v44, s45, v44
  v_xor_b32 v45, s45, v45
  v_xor_b32 v46, s45, v46
  v_xor_b32 v47, s45, v47
  v_xor_b32 v48, s45, v48
  v_xor_b32 v49, s45, v49
  v_xor_b32 v50, s45, v50
  v_xor_b32 v51, s45, v51
  v_permlane32_swap_b32 v44, v46
  v_permlane32_swap_b32 v45, v47
  v_permlane32_swap_b32 v48, v50
  v_permlane32_swap_b32 v49, v51
  buffer_store_dwordx4 v[44:47], v1, s[36:39], s42 offen offset:0 sc1
  buffer_store_dwordx4 v[48:51], v1, s[36:39], s43 offen offset:0 sc1
  v_cvt_pk_bf16_f32 v60, v60, v61
  v_cvt_pk_bf16_f32 v61, v62, v63
  v_cvt_pk_bf16_f32 v62, v64, v65
  v_cvt_pk_bf16_f32 v63, v66, v67
  v_cvt_pk_bf16_f32 v64, v68, v69
  v_cvt_pk_bf16_f32 v65, v70, v71
  v_cvt_pk_bf16_f32 v66, v72, v73
  v_cvt_pk_bf16_f32 v67, v74, v75
  v_xor_b32 v60, s45, v60
  v_xor_b32 v61, s45, v61
  v_xor_b32 v62, s45, v62
  v_xor_b32 v63, s45, v63
  v_xor_b32 v64, s45, v64
  v_xor_b32 v65, s45, v65
  v_xor_b32 v66, s45, v66
  v_xor_b32 v67, s45, v67
  v_permlane32_swap_b32 v60, v62
  v_permlane32_swap_b32 v61, v63
  v_permlane32_swap_b32 v64, v66
  v_permlane32_swap_b32 v65, v67
  buffer_store_dwordx4 v[60:63], v1, s[36:39], s42 offen offset:1024 sc1
  buffer_store_dwordx4 v[64:67], v1, s[36:39], s43 offen offset:1024 sc1
  s_lshr_b32 s33, s3, 2
  s_mul_i32 s33, s33, 49152
  s_bfe_u32 s34, s3, 0x10001
  s_lshl_b32 s34, s34, 13
  s_add_u32 s33, s33, s34
  s_and_b32 s34, s3, 1
  s_lshl_b32 s34, s34, 11
  s_add_u32 s33, s33, s34
  v_add_u32 v2, s33, v1
  ds_write_b128 v2, v[44:47] offset:0
  ds_write_b128 v2, v[48:51] offset:4096
  ds_write_b128 v2, v[60:63] offset:1024
  ds_write_b128 v2, v[64:67] offset:5120
  s_lshr_b32 s80, s4, 1
  v_and_b32 v144, 15, v0
  v_lshlrev_b32 v3, 4, v144
  v_bfe_u32 v145, v0, 4, 1
  v_lshl_add_u32 v3, v145, 9, v3
  v_lshrrev_b32 v146, 5, v0
  v_lshl_add_u32 v3, v146, 12, v3
  s_and_b32 s33, s3, 1
  s_lshl_b32 s33, s33, 11
  v_add_u32 v3, s33, v3
  v_lshl_add_u32 v9, v146, 4, v144
  v_lshl_add_u32 v9, v145, 5, v9
  v_lshlrev_b32 v9, 4, v9
  s_lshr_b32 s33, s3, 1
  s_lshl_b32 s33, s33, 13
  s_add_u32 s33, s33, 16384
  v_lshrrev_b32 v145, 4, v0
  v_lshrrev_b32 v146, 1, v144
  v_xor_b32 v145, v145, v146
  v_lshlrev_b32 v144, 7, v144
  v_add_u32 v144, s33, v144
  v_lshl_add_u32 v4, v145, 4, v144
  v_xor_b32 v145, 4, v145
  v_lshl_add_u32 v5, v145, 4, v144
  s_and_b32 s40, s40, 7
  s_lshl_b32 s33, s80, 6
  s_lshl_b32 s34, s40, 3
  s_add_u32 s33, s33, s34
  s_lshr_b32 s34, s3, 1
  s_lshl_b32 s34, s34, 1
  s_add_u32 s33, s33, s34
  s_lshl_b32 s33, s33, 4
  s_lshl_b32 s34, s41, 2
  s_add_u32 s33, s33, s34
  s_and_b32 s34, s3, 1
  s_lshl_b32 s34, s34, 1
  s_add_u32 s33, s33, s34
  s_lshl_b32 s33, s33, 11
  s_add_u32 s46, s33, 0xd00000
  s_add_u32 s47, s46, 0x8000
  s_lshl_b32 s33, s40, 2
  s_add_u32 s33, s33, s41
  s_lshl_b32 s33, s33, 3
  s_add_u32 s33, s33, s3
  s_lshl_b32 s33, s33, 2
  s_add_u32 s33, s33, s80
  s_lshl_b32 s33, s33, 7
  s_add_u32 s48, s33, 0x1640000
  s_waitcnt lgkmcnt(0)
  v_add_u32 v6, 0x0, v3
  v_add_u32 v7, 0x0, v4
  v_add_u32 v8, 0x0, v5
  s_barrier
  ds_read_b128 v[12:15], v6 offset:0
  ds_read_b128 v[28:31], v7 offset:0
  ds_read_b128 v[32:35], v7 offset:2048
  ds_read_b128 v[36:39], v7 offset:4096
  ds_read_b128 v[40:43], v7 offset:6144
  ds_read_b128 v[16:19], v6 offset:256
  ds_read_b128 v[20:23], v6 offset:1024
  ds_read_b128 v[24:27], v6 offset:1280
  s_waitcnt lgkmcnt(6)
  v_mfma_f32_16x16x32_bf16 v[76:79], v[12:15], v[28:31], 0
  ds_read_b128 v[44:47], v6 offset:8192
  s_waitcnt lgkmcnt(6)
  v_mfma_f32_16x16x32_bf16 v[80:83], v[12:15], v[32:35], 0
  s_waitcnt lgkmcnt(5)
  v_mfma_f32_16x16x32_bf16 v[84:87], v[12:15], v[36:39], 0
  ds_read_b128 v[60:63], v8 offset:0
  s_waitcnt lgkmcnt(5)
  v_mfma_f32_16x16x32_bf16 v[88:91], v[12:15], v[40:43], 0
  s_waitcnt lgkmcnt(4)
  v_mfma_f32_16x16x32_bf16 v[92:95], v[16:19], v[28:31], 0
  ds_read_b128 v[64:67], v8 offset:2048
  v_mfma_f32_16x16x32_bf16 v[96:99], v[16:19], v[32:35], 0
  v_mfma_f32_16x16x32_bf16 v[100:103], v[16:19], v[36:39], 0
  ds_read_b128 v[68:71], v8 offset:4096
  v_mfma_f32_16x16x32_bf16 v[104:107], v[16:19], v[40:43], 0
  s_waitcnt lgkmcnt(5)
  v_mfma_f32_16x16x32_bf16 v[108:111], v[20:23], v[28:31], 0
  ds_read_b128 v[72:75], v8 offset:6144
  v_mfma_f32_16x16x32_bf16 v[112:115], v[20:23], v[32:35], 0
  v_mfma_f32_16x16x32_bf16 v[116:119], v[20:23], v[36:39], 0
  ds_read_b128 v[48:51], v6 offset:8448
  v_mfma_f32_16x16x32_bf16 v[120:123], v[20:23], v[40:43], 0
  s_waitcnt lgkmcnt(6)
  v_mfma_f32_16x16x32_bf16 v[124:127], v[24:27], v[28:31], 0
  ds_read_b128 v[52:55], v6 offset:9216
  v_mfma_f32_16x16x32_bf16 v[128:131], v[24:27], v[32:35], 0
  v_mfma_f32_16x16x32_bf16 v[132:135], v[24:27], v[36:39], 0
  ds_read_b128 v[56:59], v6 offset:9472
  v_mfma_f32_16x16x32_bf16 v[136:139], v[24:27], v[40:43], 0
  v_add_u32 v6, 0xc000, v3
  v_add_u32 v7, 0xc000, v4
  v_add_u32 v8, 0xc000, v5
  s_waitcnt vmcnt(0)
  s_waitcnt lgkmcnt(0)
  s_barrier
  v_mfma_f32_16x16x32_bf16 v[76:79], v[44:47], v[60:63], v[76:79]
  ds_read_b128 v[12:15], v6 offset:0
  v_mfma_f32_16x16x32_bf16 v[80:83], v[44:47], v[64:67], v[80:83]
  v_mfma_f32_16x16x32_bf16 v[84:87], v[44:47], v[68:71], v[84:87]
  ds_read_b128 v[28:31], v7 offset:0
  v_mfma_f32_16x16x32_bf16 v[88:91], v[44:47], v[72:75], v[88:91]
  v_mfma_f32_16x16x32_bf16 v[92:95], v[48:51], v[60:63], v[92:95]
  ds_read_b128 v[32:35], v7 offset:2048
  v_mfma_f32_16x16x32_bf16 v[96:99], v[48:51], v[64:67], v[96:99]
  v_mfma_f32_16x16x32_bf16 v[100:103], v[48:51], v[68:71], v[100:103]
  ds_read_b128 v[36:39], v7 offset:4096
  v_mfma_f32_16x16x32_bf16 v[104:107], v[48:51], v[72:75], v[104:107]
  v_mfma_f32_16x16x32_bf16 v[108:111], v[52:55], v[60:63], v[108:111]
  ds_read_b128 v[40:43], v7 offset:6144
  v_mfma_f32_16x16x32_bf16 v[112:115], v[52:55], v[64:67], v[112:115]
  v_mfma_f32_16x16x32_bf16 v[116:119], v[52:55], v[68:71], v[116:119]
  ds_read_b128 v[16:19], v6 offset:256
  v_mfma_f32_16x16x32_bf16 v[120:123], v[52:55], v[72:75], v[120:123]
  v_mfma_f32_16x16x32_bf16 v[124:127], v[56:59], v[60:63], v[124:127]
  ds_read_b128 v[20:23], v6 offset:1024
  v_mfma_f32_16x16x32_bf16 v[128:131], v[56:59], v[64:67], v[128:131]
  v_mfma_f32_16x16x32_bf16 v[132:135], v[56:59], v[68:71], v[132:135]
  ds_read_b128 v[24:27], v6 offset:1280
  v_mfma_f32_16x16x32_bf16 v[136:139], v[56:59], v[72:75], v[136:139]
  s_waitcnt lgkmcnt(6)
  v_mfma_f32_16x16x32_bf16 v[76:79], v[12:15], v[28:31], v[76:79]
  ds_read_b128 v[44:47], v6 offset:8192
  s_waitcnt lgkmcnt(6)
  v_mfma_f32_16x16x32_bf16 v[80:83], v[12:15], v[32:35], v[80:83]
  s_waitcnt lgkmcnt(5)
  v_mfma_f32_16x16x32_bf16 v[84:87], v[12:15], v[36:39], v[84:87]
  ds_read_b128 v[60:63], v8 offset:0
  s_waitcnt lgkmcnt(5)
  v_mfma_f32_16x16x32_bf16 v[88:91], v[12:15], v[40:43], v[88:91]
  s_waitcnt lgkmcnt(4)
  v_mfma_f32_16x16x32_bf16 v[92:95], v[16:19], v[28:31], v[92:95]
  ds_read_b128 v[64:67], v8 offset:2048
  v_mfma_f32_16x16x32_bf16 v[96:99], v[16:19], v[32:35], v[96:99]
  v_mfma_f32_16x16x32_bf16 v[100:103], v[16:19], v[36:39], v[100:103]
  ds_read_b128 v[68:71], v8 offset:4096
  v_mfma_f32_16x16x32_bf16 v[104:107], v[16:19], v[40:43], v[104:107]
  s_waitcnt lgkmcnt(5)
  v_mfma_f32_16x16x32_bf16 v[108:111], v[20:23], v[28:31], v[108:111]
  ds_read_b128 v[72:75], v8 offset:6144
  v_mfma_f32_16x16x32_bf16 v[112:115], v[20:23], v[32:35], v[112:115]
  v_mfma_f32_16x16x32_bf16 v[116:119], v[20:23], v[36:39], v[116:119]
  ds_read_b128 v[48:51], v6 offset:8448
  v_mfma_f32_16x16x32_bf16 v[120:123], v[20:23], v[40:43], v[120:123]
  s_waitcnt lgkmcnt(6)
  v_mfma_f32_16x16x32_bf16 v[124:127], v[24:27], v[28:31], v[124:127]
  ds_read_b128 v[52:55], v6 offset:9216
  v_mfma_f32_16x16x32_bf16 v[128:131], v[24:27], v[32:35], v[128:131]
  v_mfma_f32_16x16x32_bf16 v[132:135], v[24:27], v[36:39], v[132:135]
  ds_read_b128 v[56:59], v6 offset:9472
  v_mfma_f32_16x16x32_bf16 v[136:139], v[24:27], v[40:43], v[136:139]
  v_add_u32 v6, 0x18000, v3
  v_add_u32 v7, 0x18000, v4
  v_add_u32 v8, 0x18000, v5
  s_waitcnt lgkmcnt(0)
  s_barrier
  s_barrier
  v_mfma_f32_16x16x32_bf16 v[76:79], v[44:47], v[60:63], v[76:79]
  ds_read_b128 v[12:15], v6 offset:0
  v_mfma_f32_16x16x32_bf16 v[80:83], v[44:47], v[64:67], v[80:83]
  v_mfma_f32_16x16x32_bf16 v[84:87], v[44:47], v[68:71], v[84:87]
  ds_read_b128 v[28:31], v7 offset:0
  v_mfma_f32_16x16x32_bf16 v[88:91], v[44:47], v[72:75], v[88:91]
  v_mfma_f32_16x16x32_bf16 v[92:95], v[48:51], v[60:63], v[92:95]
  ds_read_b128 v[32:35], v7 offset:2048
  v_mfma_f32_16x16x32_bf16 v[96:99], v[48:51], v[64:67], v[96:99]
  v_mfma_f32_16x16x32_bf16 v[100:103], v[48:51], v[68:71], v[100:103]
  ds_read_b128 v[36:39], v7 offset:4096
  v_mfma_f32_16x16x32_bf16 v[104:107], v[48:51], v[72:75], v[104:107]
  v_mfma_f32_16x16x32_bf16 v[108:111], v[52:55], v[60:63], v[108:111]
  ds_read_b128 v[40:43], v7 offset:6144
  v_mfma_f32_16x16x32_bf16 v[112:115], v[52:55], v[64:67], v[112:115]
  v_mfma_f32_16x16x32_bf16 v[116:119], v[52:55], v[68:71], v[116:119]
  ds_read_b128 v[16:19], v6 offset:256
  v_mfma_f32_16x16x32_bf16 v[120:123], v[52:55], v[72:75], v[120:123]
  v_mfma_f32_16x16x32_bf16 v[124:127], v[56:59], v[60:63], v[124:127]
  ds_read_b128 v[20:23], v6 offset:1024
  v_mfma_f32_16x16x32_bf16 v[128:131], v[56:59], v[64:67], v[128:131]
  v_mfma_f32_16x16x32_bf16 v[132:135], v[56:59], v[68:71], v[132:135]
  ds_read_b128 v[24:27], v6 offset:1280
  v_mfma_f32_16x16x32_bf16 v[136:139], v[56:59], v[72:75], v[136:139]
  s_waitcnt lgkmcnt(6)
  v_mfma_f32_16x16x32_bf16 v[76:79], v[12:15], v[28:31], v[76:79]
  ds_read_b128 v[44:47], v6 offset:8192
  s_waitcnt lgkmcnt(6)
  v_mfma_f32_16x16x32_bf16 v[80:83], v[12:15], v[32:35], v[80:83]
  s_waitcnt lgkmcnt(5)
  v_mfma_f32_16x16x32_bf16 v[84:87], v[12:15], v[36:39], v[84:87]
  ds_read_b128 v[60:63], v8 offset:0
  s_waitcnt lgkmcnt(5)
  v_mfma_f32_16x16x32_bf16 v[88:91], v[12:15], v[40:43], v[88:91]
  s_waitcnt lgkmcnt(4)
  v_mfma_f32_16x16x32_bf16 v[92:95], v[16:19], v[28:31], v[92:95]
  ds_read_b128 v[64:67], v8 offset:2048
  v_mfma_f32_16x16x32_bf16 v[96:99], v[16:19], v[32:35], v[96:99]
  v_mfma_f32_16x16x32_bf16 v[100:103], v[16:19], v[36:39], v[100:103]
  ds_read_b128 v[68:71], v8 offset:4096
  v_mfma_f32_16x16x32_bf16 v[104:107], v[16:19], v[40:43], v[104:107]
  s_waitcnt lgkmcnt(5)
  v_mfma_f32_16x16x32_bf16 v[108:111], v[20:23], v[28:31], v[108:111]
  ds_read_b128 v[72:75], v8 offset:6144
  v_mfma_f32_16x16x32_bf16 v[112:115], v[20:23], v[32:35], v[112:115]
  v_mfma_f32_16x16x32_bf16 v[116:119], v[20:23], v[36:39], v[116:119]
  ds_read_b128 v[48:51], v6 offset:8448
  v_mfma_f32_16x16x32_bf16 v[120:123], v[20:23], v[40:43], v[120:123]
  s_waitcnt lgkmcnt(6)
  v_mfma_f32_16x16x32_bf16 v[124:127], v[24:27], v[28:31], v[124:127]
  ds_read_b128 v[52:55], v6 offset:9216
  v_mfma_f32_16x16x32_bf16 v[128:131], v[24:27], v[32:35], v[128:131]
  v_mfma_f32_16x16x32_bf16 v[132:135], v[24:27], v[36:39], v[132:135]
  ds_read_b128 v[56:59], v6 offset:9472
  v_mfma_f32_16x16x32_bf16 v[136:139], v[24:27], v[40:43], v[136:139]
  v_add_u32 v6, 0x0, v3
  v_add_u32 v7, 0x0, v4
  v_add_u32 v8, 0x0, v5
  s_waitcnt lgkmcnt(0)
  s_barrier
  v_mfma_f32_16x16x32_bf16 v[76:79], v[44:47], v[60:63], v[76:79]
  ds_read_b128 v[12:15], v6 offset:0
  v_mfma_f32_16x16x32_bf16 v[80:83], v[44:47], v[64:67], v[80:83]
  v_mfma_f32_16x16x32_bf16 v[84:87], v[44:47], v[68:71], v[84:87]
  ds_read_b128 v[28:31], v7 offset:0
  v_mfma_f32_16x16x32_bf16 v[88:91], v[44:47], v[72:75], v[88:91]
  v_mfma_f32_16x16x32_bf16 v[92:95], v[48:51], v[60:63], v[92:95]
  ds_read_b128 v[32:35], v7 offset:2048
  v_mfma_f32_16x16x32_bf16 v[96:99], v[48:51], v[64:67], v[96:99]
  v_mfma_f32_16x16x32_bf16 v[100:103], v[48:51], v[68:71], v[100:103]
  ds_read_b128 v[36:39], v7 offset:4096
  v_mfma_f32_16x16x32_bf16 v[104:107], v[48:51], v[72:75], v[104:107]
  v_mfma_f32_16x16x32_bf16 v[108:111], v[52:55], v[60:63], v[108:111]
  ds_read_b128 v[40:43], v7 offset:6144
  v_mfma_f32_16x16x32_bf16 v[112:115], v[52:55], v[64:67], v[112:115]
  v_mfma_f32_16x16x32_bf16 v[116:119], v[52:55], v[68:71], v[116:119]
  ds_read_b128 v[16:19], v6 offset:256
  v_mfma_f32_16x16x32_bf16 v[120:123], v[52:55], v[72:75], v[120:123]
  v_mfma_f32_16x16x32_bf16 v[124:127], v[56:59], v[60:63], v[124:127]
  ds_read_b128 v[20:23], v6 offset:1024
  v_mfma_f32_16x16x32_bf16 v[128:131], v[56:59], v[64:67], v[128:131]
  v_mfma_f32_16x16x32_bf16 v[132:135], v[56:59], v[68:71], v[132:135]
  ds_read_b128 v[24:27], v6 offset:1280
  v_mfma_f32_16x16x32_bf16 v[136:139], v[56:59], v[72:75], v[136:139]
  s_waitcnt lgkmcnt(6)
  v_mfma_f32_16x16x32_bf16 v[76:79], v[12:15], v[28:31], v[76:79]
  ds_read_b128 v[44:47], v6 offset:8192
  s_waitcnt lgkmcnt(6)
  v_mfma_f32_16x16x32_bf16 v[80:83], v[12:15], v[32:35], v[80:83]
  s_waitcnt lgkmcnt(5)
  v_mfma_f32_16x16x32_bf16 v[84:87], v[12:15], v[36:39], v[84:87]
  ds_read_b128 v[60:63], v8 offset:0
  s_waitcnt lgkmcnt(5)
  v_mfma_f32_16x16x32_bf16 v[88:91], v[12:15], v[40:43], v[88:91]
  s_waitcnt lgkmcnt(4)
  v_mfma_f32_16x16x32_bf16 v[92:95], v[16:19], v[28:31], v[92:95]
  ds_read_b128 v[64:67], v8 offset:2048
  v_mfma_f32_16x16x32_bf16 v[96:99], v[16:19], v[32:35], v[96:99]
  v_mfma_f32_16x16x32_bf16 v[100:103], v[16:19], v[36:39], v[100:103]
  ds_read_b128 v[68:71], v8 offset:4096
  v_mfma_f32_16x16x32_bf16 v[104:107], v[16:19], v[40:43], v[104:107]
  s_waitcnt lgkmcnt(5)
  v_mfma_f32_16x16x32_bf16 v[108:111], v[20:23], v[28:31], v[108:111]
  ds_read_b128 v[72:75], v8 offset:6144
  v_mfma_f32_16x16x32_bf16 v[112:115], v[20:23], v[32:35], v[112:115]
  v_mfma_f32_16x16x32_bf16 v[116:119], v[20:23], v[36:39], v[116:119]
  ds_read_b128 v[48:51], v6 offset:8448
  v_mfma_f32_16x16x32_bf16 v[120:123], v[20:23], v[40:43], v[120:123]
  s_waitcnt lgkmcnt(6)
  v_mfma_f32_16x16x32_bf16 v[124:127], v[24:27], v[28:31], v[124:127]
  ds_read_b128 v[52:55], v6 offset:9216
  v_mfma_f32_16x16x32_bf16 v[128:131], v[24:27], v[32:35], v[128:131]
  v_mfma_f32_16x16x32_bf16 v[132:135], v[24:27], v[36:39], v[132:135]
  ds_read_b128 v[56:59], v6 offset:9472
  v_mfma_f32_16x16x32_bf16 v[136:139], v[24:27], v[40:43], v[136:139]
  v_add_u32 v6, 0xc000, v3
  v_add_u32 v7, 0xc000, v4
  v_add_u32 v8, 0xc000, v5
  s_waitcnt lgkmcnt(0)
  s_barrier
  v_mfma_f32_16x16x32_bf16 v[76:79], v[44:47], v[60:63], v[76:79]
  ds_read_b128 v[12:15], v6 offset:0
  v_mfma_f32_16x16x32_bf16 v[80:83], v[44:47], v[64:67], v[80:83]
  v_mfma_f32_16x16x32_bf16 v[84:87], v[44:47], v[68:71], v[84:87]
  ds_read_b128 v[28:31], v7 offset:0
  v_mfma_f32_16x16x32_bf16 v[88:91], v[44:47], v[72:75], v[88:91]
  v_mfma_f32_16x16x32_bf16 v[92:95], v[48:51], v[60:63], v[92:95]
  ds_read_b128 v[32:35], v7 offset:2048
  v_mfma_f32_16x16x32_bf16 v[96:99], v[48:51], v[64:67], v[96:99]
  v_mfma_f32_16x16x32_bf16 v[100:103], v[48:51], v[68:71], v[100:103]
  ds_read_b128 v[36:39], v7 offset:4096
  v_mfma_f32_16x16x32_bf16 v[104:107], v[48:51], v[72:75], v[104:107]
  v_mfma_f32_16x16x32_bf16 v[108:111], v[52:55], v[60:63], v[108:111]
  ds_read_b128 v[40:43], v7 offset:6144
  v_mfma_f32_16x16x32_bf16 v[112:115], v[52:55], v[64:67], v[112:115]
  v_mfma_f32_16x16x32_bf16 v[116:119], v[52:55], v[68:71], v[116:119]
  ds_read_b128 v[16:19], v6 offset:256
  v_mfma_f32_16x16x32_bf16 v[120:123], v[52:55], v[72:75], v[120:123]
  v_mfma_f32_16x16x32_bf16 v[124:127], v[56:59], v[60:63], v[124:127]
  ds_read_b128 v[20:23], v6 offset:1024
  v_mfma_f32_16x16x32_bf16 v[128:131], v[56:59], v[64:67], v[128:131]
  v_mfma_f32_16x16x32_bf16 v[132:135], v[56:59], v[68:71], v[132:135]
  ds_read_b128 v[24:27], v6 offset:1280
  v_mfma_f32_16x16x32_bf16 v[136:139], v[56:59], v[72:75], v[136:139]
  s_waitcnt lgkmcnt(6)
  v_mfma_f32_16x16x32_bf16 v[76:79], v[12:15], v[28:31], v[76:79]
  ds_read_b128 v[44:47], v6 offset:8192
  s_waitcnt lgkmcnt(6)
  v_mfma_f32_16x16x32_bf16 v[80:83], v[12:15], v[32:35], v[80:83]
  s_waitcnt lgkmcnt(5)
  v_mfma_f32_16x16x32_bf16 v[84:87], v[12:15], v[36:39], v[84:87]
  ds_read_b128 v[60:63], v8 offset:0
  s_waitcnt lgkmcnt(5)
  v_mfma_f32_16x16x32_bf16 v[88:91], v[12:15], v[40:43], v[88:91]
  s_waitcnt lgkmcnt(4)
  v_mfma_f32_16x16x32_bf16 v[92:95], v[16:19], v[28:31], v[92:95]
  ds_read_b128 v[64:67], v8 offset:2048
  v_mfma_f32_16x16x32_bf16 v[96:99], v[16:19], v[32:35], v[96:99]
  v_mfma_f32_16x16x32_bf16 v[100:103], v[16:19], v[36:39], v[100:103]
  ds_read_b128 v[68:71], v8 offset:4096
  v_mfma_f32_16x16x32_bf16 v[104:107], v[16:19], v[40:43], v[104:107]
  s_waitcnt lgkmcnt(5)
  v_mfma_f32_16x16x32_bf16 v[108:111], v[20:23], v[28:31], v[108:111]
  ds_read_b128 v[72:75], v8 offset:6144
  v_mfma_f32_16x16x32_bf16 v[112:115], v[20:23], v[32:35], v[112:115]
  v_mfma_f32_16x16x32_bf16 v[116:119], v[20:23], v[36:39], v[116:119]
  ds_read_b128 v[48:51], v6 offset:8448
  v_mfma_f32_16x16x32_bf16 v[120:123], v[20:23], v[40:43], v[120:123]
  s_waitcnt lgkmcnt(6)
  v_mfma_f32_16x16x32_bf16 v[124:127], v[24:27], v[28:31], v[124:127]
  ds_read_b128 v[52:55], v6 offset:9216
  v_mfma_f32_16x16x32_bf16 v[128:131], v[24:27], v[32:35], v[128:131]
  v_mfma_f32_16x16x32_bf16 v[132:135], v[24:27], v[36:39], v[132:135]
  ds_read_b128 v[56:59], v6 offset:9472
  v_mfma_f32_16x16x32_bf16 v[136:139], v[24:27], v[40:43], v[136:139]
  v_add_u32 v6, 0x18000, v3
  v_add_u32 v7, 0x18000, v4
  v_add_u32 v8, 0x18000, v5
  s_waitcnt lgkmcnt(0)
  s_barrier
  v_mfma_f32_16x16x32_bf16 v[76:79], v[44:47], v[60:63], v[76:79]
  ds_read_b128 v[12:15], v6 offset:0
  v_mfma_f32_16x16x32_bf16 v[80:83], v[44:47], v[64:67], v[80:83]
  v_mfma_f32_16x16x32_bf16 v[84:87], v[44:47], v[68:71], v[84:87]
  ds_read_b128 v[28:31], v7 offset:0
  v_mfma_f32_16x16x32_bf16 v[88:91], v[44:47], v[72:75], v[88:91]
  v_mfma_f32_16x16x32_bf16 v[92:95], v[48:51], v[60:63], v[92:95]
  ds_read_b128 v[32:35], v7 offset:2048
  v_mfma_f32_16x16x32_bf16 v[96:99], v[48:51], v[64:67], v[96:99]
  v_mfma_f32_16x16x32_bf16 v[100:103], v[48:51], v[68:71], v[100:103]
  ds_read_b128 v[36:39], v7 offset:4096
  v_mfma_f32_16x16x32_bf16 v[104:107], v[48:51], v[72:75], v[104:107]
  v_mfma_f32_16x16x32_bf16 v[108:111], v[52:55], v[60:63], v[108:111]
  ds_read_b128 v[40:43], v7 offset:6144
  v_mfma_f32_16x16x32_bf16 v[112:115], v[52:55], v[64:67], v[112:115]
  v_mfma_f32_16x16x32_bf16 v[116:119], v[52:55], v[68:71], v[116:119]
  ds_read_b128 v[16:19], v6 offset:256
  v_mfma_f32_16x16x32_bf16 v[120:123], v[52:55], v[72:75], v[120:123]
  v_mfma_f32_16x16x32_bf16 v[124:127], v[56:59], v[60:63], v[124:127]
  ds_read_b128 v[20:23], v6 offset:1024
  v_mfma_f32_16x16x32_bf16 v[128:131], v[56:59], v[64:67], v[128:131]
  v_mfma_f32_16x16x32_bf16 v[132:135], v[56:59], v[68:71], v[132:135]
  ds_read_b128 v[24:27], v6 offset:1280
  v_mfma_f32_16x16x32_bf16 v[136:139], v[56:59], v[72:75], v[136:139]
  s_waitcnt lgkmcnt(6)
  v_mfma_f32_16x16x32_bf16 v[76:79], v[12:15], v[28:31], v[76:79]
  ds_read_b128 v[44:47], v6 offset:8192
  s_waitcnt lgkmcnt(6)
  v_mfma_f32_16x16x32_bf16 v[80:83], v[12:15], v[32:35], v[80:83]
  s_waitcnt lgkmcnt(5)
  v_mfma_f32_16x16x32_bf16 v[84:87], v[12:15], v[36:39], v[84:87]
  ds_read_b128 v[60:63], v8 offset:0
  s_waitcnt lgkmcnt(5)
  v_mfma_f32_16x16x32_bf16 v[88:91], v[12:15], v[40:43], v[88:91]
  s_waitcnt lgkmcnt(4)
  v_mfma_f32_16x16x32_bf16 v[92:95], v[16:19], v[28:31], v[92:95]
  ds_read_b128 v[64:67], v8 offset:2048
  v_mfma_f32_16x16x32_bf16 v[96:99], v[16:19], v[32:35], v[96:99]
  v_mfma_f32_16x16x32_bf16 v[100:103], v[16:19], v[36:39], v[100:103]
  ds_read_b128 v[68:71], v8 offset:4096
  v_mfma_f32_16x16x32_bf16 v[104:107], v[16:19], v[40:43], v[104:107]
  s_waitcnt lgkmcnt(5)
  v_mfma_f32_16x16x32_bf16 v[108:111], v[20:23], v[28:31], v[108:111]
  ds_read_b128 v[72:75], v8 offset:6144
  v_mfma_f32_16x16x32_bf16 v[112:115], v[20:23], v[32:35], v[112:115]
  v_mfma_f32_16x16x32_bf16 v[116:119], v[20:23], v[36:39], v[116:119]
  ds_read_b128 v[48:51], v6 offset:8448
  v_mfma_f32_16x16x32_bf16 v[120:123], v[20:23], v[40:43], v[120:123]
  s_waitcnt lgkmcnt(6)
  v_mfma_f32_16x16x32_bf16 v[124:127], v[24:27], v[28:31], v[124:127]
  ds_read_b128 v[52:55], v6 offset:9216
  v_mfma_f32_16x16x32_bf16 v[128:131], v[24:27], v[32:35], v[128:131]
  v_mfma_f32_16x16x32_bf16 v[132:135], v[24:27], v[36:39], v[132:135]
  ds_read_b128 v[56:59], v6 offset:9472
  v_mfma_f32_16x16x32_bf16 v[136:139], v[24:27], v[40:43], v[136:139]
  v_add_u32 v6, 0x0, v3
  v_add_u32 v7, 0x0, v4
  v_add_u32 v8, 0x0, v5
  s_waitcnt lgkmcnt(0)
  s_barrier
  v_mfma_f32_16x16x32_bf16 v[76:79], v[44:47], v[60:63], v[76:79]
  ds_read_b128 v[12:15], v6 offset:0
  v_mfma_f32_16x16x32_bf16 v[80:83], v[44:47], v[64:67], v[80:83]
  v_mfma_f32_16x16x32_bf16 v[84:87], v[44:47], v[68:71], v[84:87]
  ds_read_b128 v[28:31], v7 offset:0
  v_mfma_f32_16x16x32_bf16 v[88:91], v[44:47], v[72:75], v[88:91]
  v_mfma_f32_16x16x32_bf16 v[92:95], v[48:51], v[60:63], v[92:95]
  ds_read_b128 v[32:35], v7 offset:2048
  v_mfma_f32_16x16x32_bf16 v[96:99], v[48:51], v[64:67], v[96:99]
  v_mfma_f32_16x16x32_bf16 v[100:103], v[48:51], v[68:71], v[100:103]
  ds_read_b128 v[36:39], v7 offset:4096
  v_mfma_f32_16x16x32_bf16 v[104:107], v[48:51], v[72:75], v[104:107]
  v_mfma_f32_16x16x32_bf16 v[108:111], v[52:55], v[60:63], v[108:111]
  ds_read_b128 v[40:43], v7 offset:6144
  v_mfma_f32_16x16x32_bf16 v[112:115], v[52:55], v[64:67], v[112:115]
  v_mfma_f32_16x16x32_bf16 v[116:119], v[52:55], v[68:71], v[116:119]
  ds_read_b128 v[16:19], v6 offset:256
  v_mfma_f32_16x16x32_bf16 v[120:123], v[52:55], v[72:75], v[120:123]
  v_mfma_f32_16x16x32_bf16 v[124:127], v[56:59], v[60:63], v[124:127]
  ds_read_b128 v[20:23], v6 offset:1024
  v_mfma_f32_16x16x32_bf16 v[128:131], v[56:59], v[64:67], v[128:131]
  v_mfma_f32_16x16x32_bf16 v[132:135], v[56:59], v[68:71], v[132:135]
  ds_read_b128 v[24:27], v6 offset:1280
  v_mfma_f32_16x16x32_bf16 v[136:139], v[56:59], v[72:75], v[136:139]
  s_waitcnt lgkmcnt(6)
  v_mfma_f32_16x16x32_bf16 v[76:79], v[12:15], v[28:31], v[76:79]
  ds_read_b128 v[44:47], v6 offset:8192
  s_waitcnt lgkmcnt(6)
  v_mfma_f32_16x16x32_bf16 v[80:83], v[12:15], v[32:35], v[80:83]
  s_waitcnt lgkmcnt(5)
  v_mfma_f32_16x16x32_bf16 v[84:87], v[12:15], v[36:39], v[84:87]
  ds_read_b128 v[60:63], v8 offset:0
  s_waitcnt lgkmcnt(5)
  v_mfma_f32_16x16x32_bf16 v[88:91], v[12:15], v[40:43], v[88:91]
  s_waitcnt lgkmcnt(4)
  v_mfma_f32_16x16x32_bf16 v[92:95], v[16:19], v[28:31], v[92:95]
  ds_read_b128 v[64:67], v8 offset:2048
  v_mfma_f32_16x16x32_bf16 v[96:99], v[16:19], v[32:35], v[96:99]
  v_mfma_f32_16x16x32_bf16 v[100:103], v[16:19], v[36:39], v[100:103]
  ds_read_b128 v[68:71], v8 offset:4096
  v_mfma_f32_16x16x32_bf16 v[104:107], v[16:19], v[40:43], v[104:107]
  s_waitcnt lgkmcnt(5)
  v_mfma_f32_16x16x32_bf16 v[108:111], v[20:23], v[28:31], v[108:111]
  ds_read_b128 v[72:75], v8 offset:6144
  v_mfma_f32_16x16x32_bf16 v[112:115], v[20:23], v[32:35], v[112:115]
  v_mfma_f32_16x16x32_bf16 v[116:119], v[20:23], v[36:39], v[116:119]
  ds_read_b128 v[48:51], v6 offset:8448
  v_mfma_f32_16x16x32_bf16 v[120:123], v[20:23], v[40:43], v[120:123]
  s_waitcnt lgkmcnt(6)
  v_mfma_f32_16x16x32_bf16 v[124:127], v[24:27], v[28:31], v[124:127]
  ds_read_b128 v[52:55], v6 offset:9216
  v_mfma_f32_16x16x32_bf16 v[128:131], v[24:27], v[32:35], v[128:131]
  v_mfma_f32_16x16x32_bf16 v[132:135], v[24:27], v[36:39], v[132:135]
  ds_read_b128 v[56:59], v6 offset:9472
  v_mfma_f32_16x16x32_bf16 v[136:139], v[24:27], v[40:43], v[136:139]
  v_add_u32 v6, 0xc000, v3
  v_add_u32 v7, 0xc000, v4
  v_add_u32 v8, 0xc000, v5
  s_waitcnt lgkmcnt(0)
  s_barrier
  v_mfma_f32_16x16x32_bf16 v[76:79], v[44:47], v[60:63], v[76:79]
  ds_read_b128 v[12:15], v6 offset:0
  v_mfma_f32_16x16x32_bf16 v[80:83], v[44:47], v[64:67], v[80:83]
  v_mfma_f32_16x16x32_bf16 v[84:87], v[44:47], v[68:71], v[84:87]
  ds_read_b128 v[28:31], v7 offset:0
  v_mfma_f32_16x16x32_bf16 v[88:91], v[44:47], v[72:75], v[88:91]
  v_mfma_f32_16x16x32_bf16 v[92:95], v[48:51], v[60:63], v[92:95]
  ds_read_b128 v[32:35], v7 offset:2048
  v_mfma_f32_16x16x32_bf16 v[96:99], v[48:51], v[64:67], v[96:99]
  v_mfma_f32_16x16x32_bf16 v[100:103], v[48:51], v[68:71], v[100:103]
  ds_read_b128 v[36:39], v7 offset:4096
  v_mfma_f32_16x16x32_bf16 v[104:107], v[48:51], v[72:75], v[104:107]
  v_mfma_f32_16x16x32_bf16 v[108:111], v[52:55], v[60:63], v[108:111]
  ds_read_b128 v[40:43], v7 offset:6144
  v_mfma_f32_16x16x32_bf16 v[112:115], v[52:55], v[64:67], v[112:115]
  v_mfma_f32_16x16x32_bf16 v[116:119], v[52:55], v[68:71], v[116:119]
  ds_read_b128 v[16:19], v6 offset:256
  v_mfma_f32_16x16x32_bf16 v[120:123], v[52:55], v[72:75], v[120:123]
  v_mfma_f32_16x16x32_bf16 v[124:127], v[56:59], v[60:63], v[124:127]
  ds_read_b128 v[20:23], v6 offset:1024
  v_mfma_f32_16x16x32_bf16 v[128:131], v[56:59], v[64:67], v[128:131]
  v_mfma_f32_16x16x32_bf16 v[132:135], v[56:59], v[68:71], v[132:135]
  ds_read_b128 v[24:27], v6 offset:1280
  v_mfma_f32_16x16x32_bf16 v[136:139], v[56:59], v[72:75], v[136:139]
  s_waitcnt lgkmcnt(6)
  v_mfma_f32_16x16x32_bf16 v[76:79], v[12:15], v[28:31], v[76:79]
  ds_read_b128 v[44:47], v6 offset:8192
  s_waitcnt lgkmcnt(6)
  v_mfma_f32_16x16x32_bf16 v[80:83], v[12:15], v[32:35], v[80:83]
  s_waitcnt lgkmcnt(5)
  v_mfma_f32_16x16x32_bf16 v[84:87], v[12:15], v[36:39], v[84:87]
  ds_read_b128 v[60:63], v8 offset:0
  s_waitcnt lgkmcnt(5)
  v_mfma_f32_16x16x32_bf16 v[88:91], v[12:15], v[40:43], v[88:91]
  s_waitcnt lgkmcnt(4)
  v_mfma_f32_16x16x32_bf16 v[92:95], v[16:19], v[28:31], v[92:95]
  ds_read_b128 v[64:67], v8 offset:2048
  v_mfma_f32_16x16x32_bf16 v[96:99], v[16:19], v[32:35], v[96:99]
  v_mfma_f32_16x16x32_bf16 v[100:103], v[16:19], v[36:39], v[100:103]
  ds_read_b128 v[68:71], v8 offset:4096
  v_mfma_f32_16x16x32_bf16 v[104:107], v[16:19], v[40:43], v[104:107]
  s_waitcnt lgkmcnt(5)
  v_mfma_f32_16x16x32_bf16 v[108:111], v[20:23], v[28:31], v[108:111]
  ds_read_b128 v[72:75], v8 offset:6144
  v_mfma_f32_16x16x32_bf16 v[112:115], v[20:23], v[32:35], v[112:115]
  v_mfma_f32_16x16x32_bf16 v[116:119], v[20:23], v[36:39], v[116:119]
  ds_read_b128 v[48:51], v6 offset:8448
  v_mfma_f32_16x16x32_bf16 v[120:123], v[20:23], v[40:43], v[120:123]
  s_waitcnt lgkmcnt(6)
  v_mfma_f32_16x16x32_bf16 v[124:127], v[24:27], v[28:31], v[124:127]
  ds_read_b128 v[52:55], v6 offset:9216
  v_mfma_f32_16x16x32_bf16 v[128:131], v[24:27], v[32:35], v[128:131]
  v_mfma_f32_16x16x32_bf16 v[132:135], v[24:27], v[36:39], v[132:135]
  ds_read_b128 v[56:59], v6 offset:9472
  v_mfma_f32_16x16x32_bf16 v[136:139], v[24:27], v[40:43], v[136:139]
  v_add_u32 v6, 0x18000, v3
  v_add_u32 v7, 0x18000, v4
  v_add_u32 v8, 0x18000, v5
  s_waitcnt lgkmcnt(0)
  s_barrier
  v_mfma_f32_16x16x32_bf16 v[76:79], v[44:47], v[60:63], v[76:79]
  ds_read_b128 v[12:15], v6 offset:0
  v_mfma_f32_16x16x32_bf16 v[80:83], v[44:47], v[64:67], v[80:83]
  v_mfma_f32_16x16x32_bf16 v[84:87], v[44:47], v[68:71], v[84:87]
  ds_read_b128 v[28:31], v7 offset:0
  v_mfma_f32_16x16x32_bf16 v[88:91], v[44:47], v[72:75], v[88:91]
  v_mfma_f32_16x16x32_bf16 v[92:95], v[48:51], v[60:63], v[92:95]
  ds_read_b128 v[32:35], v7 offset:2048
  v_mfma_f32_16x16x32_bf16 v[96:99], v[48:51], v[64:67], v[96:99]
  v_mfma_f32_16x16x32_bf16 v[100:103], v[48:51], v[68:71], v[100:103]
  ds_read_b128 v[36:39], v7 offset:4096
  v_mfma_f32_16x16x32_bf16 v[104:107], v[48:51], v[72:75], v[104:107]
  v_mfma_f32_16x16x32_bf16 v[108:111], v[52:55], v[60:63], v[108:111]
  ds_read_b128 v[40:43], v7 offset:6144
  v_mfma_f32_16x16x32_bf16 v[112:115], v[52:55], v[64:67], v[112:115]
  v_mfma_f32_16x16x32_bf16 v[116:119], v[52:55], v[68:71], v[116:119]
  ds_read_b128 v[16:19], v6 offset:256
  v_mfma_f32_16x16x32_bf16 v[120:123], v[52:55], v[72:75], v[120:123]
  v_mfma_f32_16x16x32_bf16 v[124:127], v[56:59], v[60:63], v[124:127]
  ds_read_b128 v[20:23], v6 offset:1024
  v_mfma_f32_16x16x32_bf16 v[128:131], v[56:59], v[64:67], v[128:131]
  v_mfma_f32_16x16x32_bf16 v[132:135], v[56:59], v[68:71], v[132:135]
  ds_read_b128 v[24:27], v6 offset:1280
  v_mfma_f32_16x16x32_bf16 v[136:139], v[56:59], v[72:75], v[136:139]
  s_waitcnt lgkmcnt(6)
  v_mfma_f32_16x16x32_bf16 v[76:79], v[12:15], v[28:31], v[76:79]
  ds_read_b128 v[44:47], v6 offset:8192
  s_waitcnt lgkmcnt(6)
  v_mfma_f32_16x16x32_bf16 v[80:83], v[12:15], v[32:35], v[80:83]
  s_waitcnt lgkmcnt(5)
  v_mfma_f32_16x16x32_bf16 v[84:87], v[12:15], v[36:39], v[84:87]
  ds_read_b128 v[60:63], v8 offset:0
  s_waitcnt lgkmcnt(5)
  v_mfma_f32_16x16x32_bf16 v[88:91], v[12:15], v[40:43], v[88:91]
  s_waitcnt lgkmcnt(4)
  v_mfma_f32_16x16x32_bf16 v[92:95], v[16:19], v[28:31], v[92:95]
  ds_read_b128 v[64:67], v8 offset:2048
  v_mfma_f32_16x16x32_bf16 v[96:99], v[16:19], v[32:35], v[96:99]
  v_mfma_f32_16x16x32_bf16 v[100:103], v[16:19], v[36:39], v[100:103]
  ds_read_b128 v[68:71], v8 offset:4096
  v_mfma_f32_16x16x32_bf16 v[104:107], v[16:19], v[40:43], v[104:107]
  s_waitcnt lgkmcnt(5)
  v_mfma_f32_16x16x32_bf16 v[108:111], v[20:23], v[28:31], v[108:111]
  ds_read_b128 v[72:75], v8 offset:6144
  v_mfma_f32_16x16x32_bf16 v[112:115], v[20:23], v[32:35], v[112:115]
  v_mfma_f32_16x16x32_bf16 v[116:119], v[20:23], v[36:39], v[116:119]
  ds_read_b128 v[48:51], v6 offset:8448
  v_mfma_f32_16x16x32_bf16 v[120:123], v[20:23], v[40:43], v[120:123]
  s_waitcnt lgkmcnt(6)
  v_mfma_f32_16x16x32_bf16 v[124:127], v[24:27], v[28:31], v[124:127]
  ds_read_b128 v[52:55], v6 offset:9216
  v_mfma_f32_16x16x32_bf16 v[128:131], v[24:27], v[32:35], v[128:131]
  v_mfma_f32_16x16x32_bf16 v[132:135], v[24:27], v[36:39], v[132:135]
  ds_read_b128 v[56:59], v6 offset:9472
  v_mfma_f32_16x16x32_bf16 v[136:139], v[24:27], v[40:43], v[136:139]
  v_add_u32 v6, 0x0, v3
  v_add_u32 v7, 0x0, v4
  v_add_u32 v8, 0x0, v5
  s_waitcnt lgkmcnt(0)
  s_barrier
  v_mfma_f32_16x16x32_bf16 v[76:79], v[44:47], v[60:63], v[76:79]
  ds_read_b128 v[12:15], v6 offset:0
  v_mfma_f32_16x16x32_bf16 v[80:83], v[44:47], v[64:67], v[80:83]
  v_mfma_f32_16x16x32_bf16 v[84:87], v[44:47], v[68:71], v[84:87]
  ds_read_b128 v[28:31], v7 offset:0
  v_mfma_f32_16x16x32_bf16 v[88:91], v[44:47], v[72:75], v[88:91]
  v_mfma_f32_16x16x32_bf16 v[92:95], v[48:51], v[60:63], v[92:95]
  ds_read_b128 v[32:35], v7 offset:2048
  v_mfma_f32_16x16x32_bf16 v[96:99], v[48:51], v[64:67], v[96:99]
  v_mfma_f32_16x16x32_bf16 v[100:103], v[48:51], v[68:71], v[100:103]
  ds_read_b128 v[36:39], v7 offset:4096
  v_mfma_f32_16x16x32_bf16 v[104:107], v[48:51], v[72:75], v[104:107]
  v_mfma_f32_16x16x32_bf16 v[108:111], v[52:55], v[60:63], v[108:111]
  ds_read_b128 v[40:43], v7 offset:6144
  v_mfma_f32_16x16x32_bf16 v[112:115], v[52:55], v[64:67], v[112:115]
  v_mfma_f32_16x16x32_bf16 v[116:119], v[52:55], v[68:71], v[116:119]
  ds_read_b128 v[16:19], v6 offset:256
  v_mfma_f32_16x16x32_bf16 v[120:123], v[52:55], v[72:75], v[120:123]
  v_mfma_f32_16x16x32_bf16 v[124:127], v[56:59], v[60:63], v[124:127]
  ds_read_b128 v[20:23], v6 offset:1024
  v_mfma_f32_16x16x32_bf16 v[128:131], v[56:59], v[64:67], v[128:131]
  v_mfma_f32_16x16x32_bf16 v[132:135], v[56:59], v[68:71], v[132:135]
  ds_read_b128 v[24:27], v6 offset:1280
  v_mfma_f32_16x16x32_bf16 v[136:139], v[56:59], v[72:75], v[136:139]
  s_waitcnt lgkmcnt(6)
  v_mfma_f32_16x16x32_bf16 v[76:79], v[12:15], v[28:31], v[76:79]
  ds_read_b128 v[44:47], v6 offset:8192
  s_waitcnt lgkmcnt(6)
  v_mfma_f32_16x16x32_bf16 v[80:83], v[12:15], v[32:35], v[80:83]
  s_waitcnt lgkmcnt(5)
  v_mfma_f32_16x16x32_bf16 v[84:87], v[12:15], v[36:39], v[84:87]
  ds_read_b128 v[60:63], v8 offset:0
  s_waitcnt lgkmcnt(5)
  v_mfma_f32_16x16x32_bf16 v[88:91], v[12:15], v[40:43], v[88:91]
  s_waitcnt lgkmcnt(4)
  v_mfma_f32_16x16x32_bf16 v[92:95], v[16:19], v[28:31], v[92:95]
  ds_read_b128 v[64:67], v8 offset:2048
  v_mfma_f32_16x16x32_bf16 v[96:99], v[16:19], v[32:35], v[96:99]
  v_mfma_f32_16x16x32_bf16 v[100:103], v[16:19], v[36:39], v[100:103]
  ds_read_b128 v[68:71], v8 offset:4096
  v_mfma_f32_16x16x32_bf16 v[104:107], v[16:19], v[40:43], v[104:107]
  s_waitcnt lgkmcnt(5)
  v_mfma_f32_16x16x32_bf16 v[108:111], v[20:23], v[28:31], v[108:111]
  ds_read_b128 v[72:75], v8 offset:6144
  v_mfma_f32_16x16x32_bf16 v[112:115], v[20:23], v[32:35], v[112:115]
  v_mfma_f32_16x16x32_bf16 v[116:119], v[20:23], v[36:39], v[116:119]
  ds_read_b128 v[48:51], v6 offset:8448
  v_mfma_f32_16x16x32_bf16 v[120:123], v[20:23], v[40:43], v[120:123]
  s_waitcnt lgkmcnt(6)
  v_mfma_f32_16x16x32_bf16 v[124:127], v[24:27], v[28:31], v[124:127]
  ds_read_b128 v[52:55], v6 offset:9216
  v_mfma_f32_16x16x32_bf16 v[128:131], v[24:27], v[32:35], v[128:131]
  v_mfma_f32_16x16x32_bf16 v[132:135], v[24:27], v[36:39], v[132:135]
  ds_read_b128 v[56:59], v6 offset:9472
  v_mfma_f32_16x16x32_bf16 v[136:139], v[24:27], v[40:43], v[136:139]
  v_add_u32 v6, 0xc000, v3
  v_add_u32 v7, 0xc000, v4
  v_add_u32 v8, 0xc000, v5
  s_waitcnt lgkmcnt(0)
  s_barrier
  v_mfma_f32_16x16x32_bf16 v[76:79], v[44:47], v[60:63], v[76:79]
  ds_read_b128 v[12:15], v6 offset:0
  v_mfma_f32_16x16x32_bf16 v[80:83], v[44:47], v[64:67], v[80:83]
  v_mfma_f32_16x16x32_bf16 v[84:87], v[44:47], v[68:71], v[84:87]
  ds_read_b128 v[28:31], v7 offset:0
  v_mfma_f32_16x16x32_bf16 v[88:91], v[44:47], v[72:75], v[88:91]
  v_mfma_f32_16x16x32_bf16 v[92:95], v[48:51], v[60:63], v[92:95]
  ds_read_b128 v[32:35], v7 offset:2048
  v_mfma_f32_16x16x32_bf16 v[96:99], v[48:51], v[64:67], v[96:99]
  v_mfma_f32_16x16x32_bf16 v[100:103], v[48:51], v[68:71], v[100:103]
  ds_read_b128 v[36:39], v7 offset:4096
  v_mfma_f32_16x16x32_bf16 v[104:107], v[48:51], v[72:75], v[104:107]
  v_mfma_f32_16x16x32_bf16 v[108:111], v[52:55], v[60:63], v[108:111]
  ds_read_b128 v[40:43], v7 offset:6144
  v_mfma_f32_16x16x32_bf16 v[112:115], v[52:55], v[64:67], v[112:115]
  v_mfma_f32_16x16x32_bf16 v[116:119], v[52:55], v[68:71], v[116:119]
  ds_read_b128 v[16:19], v6 offset:256
  v_mfma_f32_16x16x32_bf16 v[120:123], v[52:55], v[72:75], v[120:123]
  v_mfma_f32_16x16x32_bf16 v[124:127], v[56:59], v[60:63], v[124:127]
  ds_read_b128 v[20:23], v6 offset:1024
  v_mfma_f32_16x16x32_bf16 v[128:131], v[56:59], v[64:67], v[128:131]
  v_mfma_f32_16x16x32_bf16 v[132:135], v[56:59], v[68:71], v[132:135]
  ds_read_b128 v[24:27], v6 offset:1280
  v_mfma_f32_16x16x32_bf16 v[136:139], v[56:59], v[72:75], v[136:139]
  s_waitcnt lgkmcnt(6)
  v_mfma_f32_16x16x32_bf16 v[76:79], v[12:15], v[28:31], v[76:79]
  ds_read_b128 v[44:47], v6 offset:8192
  s_waitcnt lgkmcnt(6)
  v_mfma_f32_16x16x32_bf16 v[80:83], v[12:15], v[32:35], v[80:83]
  s_waitcnt lgkmcnt(5)
  v_mfma_f32_16x16x32_bf16 v[84:87], v[12:15], v[36:39], v[84:87]
  ds_read_b128 v[60:63], v8 offset:0
  s_waitcnt lgkmcnt(5)
  v_mfma_f32_16x16x32_bf16 v[88:91], v[12:15], v[40:43], v[88:91]
  s_waitcnt lgkmcnt(4)
  v_mfma_f32_16x16x32_bf16 v[92:95], v[16:19], v[28:31], v[92:95]
  ds_read_b128 v[64:67], v8 offset:2048
  v_mfma_f32_16x16x32_bf16 v[96:99], v[16:19], v[32:35], v[96:99]
  v_mfma_f32_16x16x32_bf16 v[100:103], v[16:19], v[36:39], v[100:103]
  ds_read_b128 v[68:71], v8 offset:4096
  v_mfma_f32_16x16x32_bf16 v[104:107], v[16:19], v[40:43], v[104:107]
  s_waitcnt lgkmcnt(5)
  v_mfma_f32_16x16x32_bf16 v[108:111], v[20:23], v[28:31], v[108:111]
  ds_read_b128 v[72:75], v8 offset:6144
  v_mfma_f32_16x16x32_bf16 v[112:115], v[20:23], v[32:35], v[112:115]
  v_mfma_f32_16x16x32_bf16 v[116:119], v[20:23], v[36:39], v[116:119]
  ds_read_b128 v[48:51], v6 offset:8448
  v_mfma_f32_16x16x32_bf16 v[120:123], v[20:23], v[40:43], v[120:123]
  s_waitcnt lgkmcnt(6)
  v_mfma_f32_16x16x32_bf16 v[124:127], v[24:27], v[28:31], v[124:127]
  ds_read_b128 v[52:55], v6 offset:9216
  v_mfma_f32_16x16x32_bf16 v[128:131], v[24:27], v[32:35], v[128:131]
  v_mfma_f32_16x16x32_bf16 v[132:135], v[24:27], v[36:39], v[132:135]
  ds_read_b128 v[56:59], v6 offset:9472
  v_mfma_f32_16x16x32_bf16 v[136:139], v[24:27], v[40:43], v[136:139]
  v_add_u32 v6, 0x18000, v3
  v_add_u32 v7, 0x18000, v4
  v_add_u32 v8, 0x18000, v5
  s_waitcnt lgkmcnt(0)
  s_barrier
  v_mfma_f32_16x16x32_bf16 v[76:79], v[44:47], v[60:63], v[76:79]
  ds_read_b128 v[12:15], v6 offset:0
  v_mfma_f32_16x16x32_bf16 v[80:83], v[44:47], v[64:67], v[80:83]
  v_mfma_f32_16x16x32_bf16 v[84:87], v[44:47], v[68:71], v[84:87]
  ds_read_b128 v[28:31], v7 offset:0
  v_mfma_f32_16x16x32_bf16 v[88:91], v[44:47], v[72:75], v[88:91]
  v_mfma_f32_16x16x32_bf16 v[92:95], v[48:51], v[60:63], v[92:95]
  ds_read_b128 v[32:35], v7 offset:2048
  v_mfma_f32_16x16x32_bf16 v[96:99], v[48:51], v[64:67], v[96:99]
  v_mfma_f32_16x16x32_bf16 v[100:103], v[48:51], v[68:71], v[100:103]
  ds_read_b128 v[36:39], v7 offset:4096
  v_mfma_f32_16x16x32_bf16 v[104:107], v[48:51], v[72:75], v[104:107]
  v_mfma_f32_16x16x32_bf16 v[108:111], v[52:55], v[60:63], v[108:111]
  ds_read_b128 v[40:43], v7 offset:6144
  v_mfma_f32_16x16x32_bf16 v[112:115], v[52:55], v[64:67], v[112:115]
  v_mfma_f32_16x16x32_bf16 v[116:119], v[52:55], v[68:71], v[116:119]
  ds_read_b128 v[16:19], v6 offset:256
  v_mfma_f32_16x16x32_bf16 v[120:123], v[52:55], v[72:75], v[120:123]
  v_mfma_f32_16x16x32_bf16 v[124:127], v[56:59], v[60:63], v[124:127]
  ds_read_b128 v[20:23], v6 offset:1024
  v_mfma_f32_16x16x32_bf16 v[128:131], v[56:59], v[64:67], v[128:131]
  v_mfma_f32_16x16x32_bf16 v[132:135], v[56:59], v[68:71], v[132:135]
  ds_read_b128 v[24:27], v6 offset:1280
  v_mfma_f32_16x16x32_bf16 v[136:139], v[56:59], v[72:75], v[136:139]
  s_waitcnt lgkmcnt(6)
  v_mfma_f32_16x16x32_bf16 v[76:79], v[12:15], v[28:31], v[76:79]
  ds_read_b128 v[44:47], v6 offset:8192
  s_waitcnt lgkmcnt(6)
  v_mfma_f32_16x16x32_bf16 v[80:83], v[12:15], v[32:35], v[80:83]
  s_waitcnt lgkmcnt(5)
  v_mfma_f32_16x16x32_bf16 v[84:87], v[12:15], v[36:39], v[84:87]
  ds_read_b128 v[60:63], v8 offset:0
  s_waitcnt lgkmcnt(5)
  v_mfma_f32_16x16x32_bf16 v[88:91], v[12:15], v[40:43], v[88:91]
  s_waitcnt lgkmcnt(4)
  v_mfma_f32_16x16x32_bf16 v[92:95], v[16:19], v[28:31], v[92:95]
  ds_read_b128 v[64:67], v8 offset:2048
  v_mfma_f32_16x16x32_bf16 v[96:99], v[16:19], v[32:35], v[96:99]
  v_mfma_f32_16x16x32_bf16 v[100:103], v[16:19], v[36:39], v[100:103]
  ds_read_b128 v[68:71], v8 offset:4096
  v_mfma_f32_16x16x32_bf16 v[104:107], v[16:19], v[40:43], v[104:107]
  s_waitcnt lgkmcnt(5)
  v_mfma_f32_16x16x32_bf16 v[108:111], v[20:23], v[28:31], v[108:111]
  ds_read_b128 v[72:75], v8 offset:6144
  v_mfma_f32_16x16x32_bf16 v[112:115], v[20:23], v[32:35], v[112:115]
  v_mfma_f32_16x16x32_bf16 v[116:119], v[20:23], v[36:39], v[116:119]
  ds_read_b128 v[48:51], v6 offset:8448
  v_mfma_f32_16x16x32_bf16 v[120:123], v[20:23], v[40:43], v[120:123]
  s_waitcnt lgkmcnt(6)
  v_mfma_f32_16x16x32_bf16 v[124:127], v[24:27], v[28:31], v[124:127]
  ds_read_b128 v[52:55], v6 offset:9216
  v_mfma_f32_16x16x32_bf16 v[128:131], v[24:27], v[32:35], v[128:131]
  v_mfma_f32_16x16x32_bf16 v[132:135], v[24:27], v[36:39], v[132:135]
  ds_read_b128 v[56:59], v6 offset:9472
  v_mfma_f32_16x16x32_bf16 v[136:139], v[24:27], v[40:43], v[136:139]
  v_add_u32 v6, 0x0, v3
  v_add_u32 v7, 0x0, v4
  v_add_u32 v8, 0x0, v5
  s_waitcnt lgkmcnt(0)
  s_barrier
  v_mfma_f32_16x16x32_bf16 v[76:79], v[44:47], v[60:63], v[76:79]
  ds_read_b128 v[12:15], v6 offset:0
  v_mfma_f32_16x16x32_bf16 v[80:83], v[44:47], v[64:67], v[80:83]
  v_mfma_f32_16x16x32_bf16 v[84:87], v[44:47], v[68:71], v[84:87]
  ds_read_b128 v[28:31], v7 offset:0
  v_mfma_f32_16x16x32_bf16 v[88:91], v[44:47], v[72:75], v[88:91]
  v_mfma_f32_16x16x32_bf16 v[92:95], v[48:51], v[60:63], v[92:95]
  ds_read_b128 v[32:35], v7 offset:2048
  v_mfma_f32_16x16x32_bf16 v[96:99], v[48:51], v[64:67], v[96:99]
  v_mfma_f32_16x16x32_bf16 v[100:103], v[48:51], v[68:71], v[100:103]
  ds_read_b128 v[36:39], v7 offset:4096
  v_mfma_f32_16x16x32_bf16 v[104:107], v[48:51], v[72:75], v[104:107]
  v_mfma_f32_16x16x32_bf16 v[108:111], v[52:55], v[60:63], v[108:111]
  ds_read_b128 v[40:43], v7 offset:6144
  v_mfma_f32_16x16x32_bf16 v[112:115], v[52:55], v[64:67], v[112:115]
  v_mfma_f32_16x16x32_bf16 v[116:119], v[52:55], v[68:71], v[116:119]
  ds_read_b128 v[16:19], v6 offset:256
  v_mfma_f32_16x16x32_bf16 v[120:123], v[52:55], v[72:75], v[120:123]
  v_mfma_f32_16x16x32_bf16 v[124:127], v[56:59], v[60:63], v[124:127]
  ds_read_b128 v[20:23], v6 offset:1024
  v_mfma_f32_16x16x32_bf16 v[128:131], v[56:59], v[64:67], v[128:131]
  v_mfma_f32_16x16x32_bf16 v[132:135], v[56:59], v[68:71], v[132:135]
  ds_read_b128 v[24:27], v6 offset:1280
  v_mfma_f32_16x16x32_bf16 v[136:139], v[56:59], v[72:75], v[136:139]
  s_waitcnt lgkmcnt(6)
  v_mfma_f32_16x16x32_bf16 v[76:79], v[12:15], v[28:31], v[76:79]
  ds_read_b128 v[44:47], v6 offset:8192
  s_waitcnt lgkmcnt(6)
  v_mfma_f32_16x16x32_bf16 v[80:83], v[12:15], v[32:35], v[80:83]
  s_waitcnt lgkmcnt(5)
  v_mfma_f32_16x16x32_bf16 v[84:87], v[12:15], v[36:39], v[84:87]
  ds_read_b128 v[60:63], v8 offset:0
  s_waitcnt lgkmcnt(5)
  v_mfma_f32_16x16x32_bf16 v[88:91], v[12:15], v[40:43], v[88:91]
  s_waitcnt lgkmcnt(4)
  v_mfma_f32_16x16x32_bf16 v[92:95], v[16:19], v[28:31], v[92:95]
  ds_read_b128 v[64:67], v8 offset:2048
  v_mfma_f32_16x16x32_bf16 v[96:99], v[16:19], v[32:35], v[96:99]
  v_mfma_f32_16x16x32_bf16 v[100:103], v[16:19], v[36:39], v[100:103]
  ds_read_b128 v[68:71], v8 offset:4096
  v_mfma_f32_16x16x32_bf16 v[104:107], v[16:19], v[40:43], v[104:107]
  s_waitcnt lgkmcnt(5)
  v_mfma_f32_16x16x32_bf16 v[108:111], v[20:23], v[28:31], v[108:111]
  ds_read_b128 v[72:75], v8 offset:6144
  v_mfma_f32_16x16x32_bf16 v[112:115], v[20:23], v[32:35], v[112:115]
  v_mfma_f32_16x16x32_bf16 v[116:119], v[20:23], v[36:39], v[116:119]
  ds_read_b128 v[48:51], v6 offset:8448
  v_mfma_f32_16x16x32_bf16 v[120:123], v[20:23], v[40:43], v[120:123]
  s_waitcnt lgkmcnt(6)
  v_mfma_f32_16x16x32_bf16 v[124:127], v[24:27], v[28:31], v[124:127]
  ds_read_b128 v[52:55], v6 offset:9216
  v_mfma_f32_16x16x32_bf16 v[128:131], v[24:27], v[32:35], v[128:131]
  v_mfma_f32_16x16x32_bf16 v[132:135], v[24:27], v[36:39], v[132:135]
  ds_read_b128 v[56:59], v6 offset:9472
  v_mfma_f32_16x16x32_bf16 v[136:139], v[24:27], v[40:43], v[136:139]
  v_add_u32 v6, 0xc000, v3
  v_add_u32 v7, 0xc000, v4
  v_add_u32 v8, 0xc000, v5
  s_waitcnt lgkmcnt(0)
  s_barrier
  v_mfma_f32_16x16x32_bf16 v[76:79], v[44:47], v[60:63], v[76:79]
  v_mfma_f32_16x16x32_bf16 v[80:83], v[44:47], v[64:67], v[80:83]
  v_mfma_f32_16x16x32_bf16 v[84:87], v[44:47], v[68:71], v[84:87]
  v_mfma_f32_16x16x32_bf16 v[88:91], v[44:47], v[72:75], v[88:91]
  v_mfma_f32_16x16x32_bf16 v[92:95], v[48:51], v[60:63], v[92:95]
  v_mfma_f32_16x16x32_bf16 v[96:99], v[48:51], v[64:67], v[96:99]
  v_mfma_f32_16x16x32_bf16 v[100:103], v[48:51], v[68:71], v[100:103]
  v_mfma_f32_16x16x32_bf16 v[104:107], v[48:51], v[72:75], v[104:107]
  v_mfma_f32_16x16x32_bf16 v[108:111], v[52:55], v[60:63], v[108:111]
  v_mfma_f32_16x16x32_bf16 v[112:115], v[52:55], v[64:67], v[112:115]
  v_mfma_f32_16x16x32_bf16 v[116:119], v[52:55], v[68:71], v[116:119]
  v_mfma_f32_16x16x32_bf16 v[120:123], v[52:55], v[72:75], v[120:123]
  v_mfma_f32_16x16x32_bf16 v[124:127], v[56:59], v[60:63], v[124:127]
  v_mfma_f32_16x16x32_bf16 v[128:131], v[56:59], v[64:67], v[128:131]
  v_mfma_f32_16x16x32_bf16 v[132:135], v[56:59], v[68:71], v[132:135]
  v_mfma_f32_16x16x32_bf16 v[136:139], v[56:59], v[72:75], v[136:139]
  ds_read_b128 v[12:15], v6 offset:0
  ds_read_b128 v[28:31], v7 offset:0
  ds_read_b128 v[32:35], v7 offset:2048
  ds_read_b128 v[36:39], v7 offset:4096
  ds_read_b128 v[40:43], v7 offset:6144
  ds_read_b128 v[16:19], v6 offset:256
  s_waitcnt lgkmcnt(4)
  v_mfma_f32_16x16x32_bf16 v[76:79], v[12:15], v[28:31], v[76:79]
  ds_read_b128 v[44:47], v6 offset:8192
  s_waitcnt lgkmcnt(4)
  v_mfma_f32_16x16x32_bf16 v[80:83], v[12:15], v[32:35], v[80:83]
  ds_read_b128 v[60:63], v8 offset:0
  s_waitcnt lgkmcnt(4)
  v_mfma_f32_16x16x32_bf16 v[84:87], v[12:15], v[36:39], v[84:87]
  ds_read_b128 v[64:67], v8 offset:2048
  s_waitcnt lgkmcnt(4)
  v_mfma_f32_16x16x32_bf16 v[88:91], v[12:15], v[40:43], v[88:91]
  ds_read_b128 v[68:71], v8 offset:4096
  s_waitcnt lgkmcnt(4)
  v_mfma_f32_16x16x32_bf16 v[92:95], v[16:19], v[28:31], v[92:95]
  ds_read_b128 v[72:75], v8 offset:6144
  v_mfma_f32_16x16x32_bf16 v[96:99], v[16:19], v[32:35], v[96:99]
  ds_read_b128 v[48:51], v6 offset:8448
  v_mfma_f32_16x16x32_bf16 v[100:103], v[16:19], v[36:39], v[100:103]
  v_mfma_f32_16x16x32_bf16 v[104:107], v[16:19], v[40:43], v[104:107]
  s_waitcnt lgkmcnt(0)
  v_add_u32 v6, 0x18000, v3
  v_add_u32 v7, 0x18000, v4
  v_add_u32 v8, 0x18000, v5
  s_barrier
  v_mfma_f32_16x16x32_bf16 v[76:79], v[44:47], v[60:63], v[76:79]
  ds_read_b128 v[12:15], v6 offset:0
  v_mfma_f32_16x16x32_bf16 v[80:83], v[44:47], v[64:67], v[80:83]
  ds_read_b128 v[28:31], v7 offset:0
  v_mfma_f32_16x16x32_bf16 v[84:87], v[44:47], v[68:71], v[84:87]
  ds_read_b128 v[32:35], v7 offset:2048
  v_mfma_f32_16x16x32_bf16 v[88:91], v[44:47], v[72:75], v[88:91]
  ds_read_b128 v[36:39], v7 offset:4096
  v_mfma_f32_16x16x32_bf16 v[92:95], v[48:51], v[60:63], v[92:95]
  ds_read_b128 v[40:43], v7 offset:6144
  v_mfma_f32_16x16x32_bf16 v[96:99], v[48:51], v[64:67], v[96:99]
  ds_read_b128 v[16:19], v6 offset:256
  v_mfma_f32_16x16x32_bf16 v[100:103], v[48:51], v[68:71], v[100:103]
  v_mfma_f32_16x16x32_bf16 v[104:107], v[48:51], v[72:75], v[104:107]
  s_waitcnt lgkmcnt(4)
  v_mfma_f32_16x16x32_bf16 v[76:79], v[12:15], v[28:31], v[76:79]
  ds_read_b128 v[44:47], v6 offset:8192
  s_waitcnt lgkmcnt(4)
  v_mfma_f32_16x16x32_bf16 v[80:83], v[12:15], v[32:35], v[80:83]
  ds_read_b128 v[60:63], v8 offset:0
  s_waitcnt lgkmcnt(4)
  v_mfma_f32_16x16x32_bf16 v[84:87], v[12:15], v[36:39], v[84:87]
  ds_read_b128 v[64:67], v8 offset:2048
  s_waitcnt lgkmcnt(4)
  v_mfma_f32_16x16x32_bf16 v[88:91], v[12:15], v[40:43], v[88:91]
  ds_read_b128 v[68:71], v8 offset:4096
  s_waitcnt lgkmcnt(4)
  v_mfma_f32_16x16x32_bf16 v[92:95], v[16:19], v[28:31], v[92:95]
  ds_read_b128 v[72:75], v8 offset:6144
  v_mfma_f32_16x16x32_bf16 v[96:99], v[16:19], v[32:35], v[96:99]
  ds_read_b128 v[48:51], v6 offset:8448
  v_mfma_f32_16x16x32_bf16 v[100:103], v[16:19], v[36:39], v[100:103]
  v_mfma_f32_16x16x32_bf16 v[104:107], v[16:19], v[40:43], v[104:107]
  s_waitcnt lgkmcnt(0)
  v_add_u32 v6, 0x0, v3
  v_add_u32 v7, 0x0, v4
  v_add_u32 v8, 0x0, v5
  s_barrier
  v_mfma_f32_16x16x32_bf16 v[76:79], v[44:47], v[60:63], v[76:79]
  ds_read_b128 v[12:15], v6 offset:0
  v_mfma_f32_16x16x32_bf16 v[80:83], v[44:47], v[64:67], v[80:83]
  ds_read_b128 v[28:31], v7 offset:0
  v_mfma_f32_16x16x32_bf16 v[84:87], v[44:47], v[68:71], v[84:87]
  ds_read_b128 v[32:35], v7 offset:2048
  v_mfma_f32_16x16x32_bf16 v[88:91], v[44:47], v[72:75], v[88:91]
  ds_read_b128 v[36:39], v7 offset:4096
  v_mfma_f32_16x16x32_bf16 v[92:95], v[48:51], v[60:63], v[92:95]
  ds_read_b128 v[40:43], v7 offset:6144
  v_mfma_f32_16x16x32_bf16 v[96:99], v[48:51], v[64:67], v[96:99]
  ds_read_b128 v[16:19], v6 offset:256
  v_mfma_f32_16x16x32_bf16 v[100:103], v[48:51], v[68:71], v[100:103]
  v_mfma_f32_16x16x32_bf16 v[104:107], v[48:51], v[72:75], v[104:107]
  s_waitcnt lgkmcnt(4)
  v_mfma_f32_16x16x32_bf16 v[76:79], v[12:15], v[28:31], v[76:79]
  ds_read_b128 v[44:47], v6 offset:8192
  s_waitcnt lgkmcnt(4)
  v_mfma_f32_16x16x32_bf16 v[80:83], v[12:15], v[32:35], v[80:83]
  ds_read_b128 v[60:63], v8 offset:0
  s_waitcnt lgkmcnt(4)
  v_mfma_f32_16x16x32_bf16 v[84:87], v[12:15], v[36:39], v[84:87]
  ds_read_b128 v[64:67], v8 offset:2048
  s_waitcnt lgkmcnt(4)
  v_mfma_f32_16x16x32_bf16 v[88:91], v[12:15], v[40:43], v[88:91]
  ds_read_b128 v[68:71], v8 offset:4096
  s_waitcnt lgkmcnt(4)
  v_mfma_f32_16x16x32_bf16 v[92:95], v[16:19], v[28:31], v[92:95]
  ds_read_b128 v[72:75], v8 offset:6144
  v_mfma_f32_16x16x32_bf16 v[96:99], v[16:19], v[32:35], v[96:99]
  ds_read_b128 v[48:51], v6 offset:8448
  v_mfma_f32_16x16x32_bf16 v[100:103], v[16:19], v[36:39], v[100:103]
  v_mfma_f32_16x16x32_bf16 v[104:107], v[16:19], v[40:43], v[104:107]
  s_waitcnt lgkmcnt(0)
  v_add_u32 v6, 0xc000, v3
  v_add_u32 v7, 0xc000, v4
  v_add_u32 v8, 0xc000, v5
  v_mfma_f32_16x16x32_bf16 v[76:79], v[44:47], v[60:63], v[76:79]
  ds_read_b128 v[20:23], v6 offset:1024
  v_mfma_f32_16x16x32_bf16 v[80:83], v[44:47], v[64:67], v[80:83]
  ds_read_b128 v[28:31], v7 offset:0
  v_mfma_f32_16x16x32_bf16 v[84:87], v[44:47], v[68:71], v[84:87]
  ds_read_b128 v[32:35], v7 offset:2048
  v_mfma_f32_16x16x32_bf16 v[88:91], v[44:47], v[72:75], v[88:91]
  ds_read_b128 v[36:39], v7 offset:4096
  v_mfma_f32_16x16x32_bf16 v[92:95], v[48:51], v[60:63], v[92:95]
  ds_read_b128 v[40:43], v7 offset:6144
  v_mfma_f32_16x16x32_bf16 v[96:99], v[48:51], v[64:67], v[96:99]
  ds_read_b128 v[24:27], v6 offset:1280
  v_mfma_f32_16x16x32_bf16 v[100:103], v[48:51], v[68:71], v[100:103]
  v_mfma_f32_16x16x32_bf16 v[104:107], v[48:51], v[72:75], v[104:107]
  s_waitcnt lgkmcnt(4)
  v_mfma_f32_16x16x32_bf16 v[108:111], v[20:23], v[28:31], v[108:111]
  ds_read_b128 v[52:55], v6 offset:9216
  s_waitcnt lgkmcnt(4)
  v_mfma_f32_16x16x32_bf16 v[112:115], v[20:23], v[32:35], v[112:115]
  ds_read_b128 v[60:63], v8 offset:0
  s_waitcnt lgkmcnt(4)
  v_mfma_f32_16x16x32_bf16 v[116:119], v[20:23], v[36:39], v[116:119]
  ds_read_b128 v[64:67], v8 offset:2048
  s_waitcnt lgkmcnt(4)
  v_mfma_f32_16x16x32_bf16 v[120:123], v[20:23], v[40:43], v[120:123]
  ds_read_b128 v[68:71], v8 offset:4096
  s_waitcnt lgkmcnt(4)
  v_mfma_f32_16x16x32_bf16 v[124:127], v[24:27], v[28:31], v[124:127]
  ds_read_b128 v[72:75], v8 offset:6144
  v_mfma_f32_16x16x32_bf16 v[128:131], v[24:27], v[32:35], v[128:131]
  ds_read_b128 v[56:59], v6 offset:9472
  v_mfma_f32_16x16x32_bf16 v[132:135], v[24:27], v[36:39], v[132:135]
  v_mfma_f32_16x16x32_bf16 v[136:139], v[24:27], v[40:43], v[136:139]
  v_cvt_pk_bf16_f32 v76, v76, v77
  v_cvt_pk_bf16_f32 v77, v78, v79
  v_cvt_pk_bf16_f32 v78, v80, v81
  v_cvt_pk_bf16_f32 v79, v82, v83
  s_nop 0
  v_permlane32_swap_b32 v76, v78
  v_permlane32_swap_b32 v77, v79
  buffer_store_dwordx4 v[76:79], v9, s[36:39], s46 offen offset:0 sc1
  v_cvt_pk_bf16_f32 v84, v84, v85
  v_cvt_pk_bf16_f32 v85, v86, v87
  v_cvt_pk_bf16_f32 v86, v88, v89
  v_cvt_pk_bf16_f32 v87, v90, v91
  s_nop 0
  v_permlane32_swap_b32 v84, v86
  v_permlane32_swap_b32 v85, v87
  buffer_store_dwordx4 v[84:87], v9, s[36:39], s47 offen offset:0 sc1
  v_cvt_pk_bf16_f32 v92, v92, v93
  v_cvt_pk_bf16_f32 v93, v94, v95
  v_cvt_pk_bf16_f32 v94, v96, v97
  v_cvt_pk_bf16_f32 v95, v98, v99
  s_nop 0
  v_permlane32_swap_b32 v92, v94
  v_permlane32_swap_b32 v93, v95
  buffer_store_dwordx4 v[92:95], v9, s[36:39], s46 offen offset:1024 sc1
  v_cvt_pk_bf16_f32 v100, v100, v101
  v_cvt_pk_bf16_f32 v101, v102, v103
  v_cvt_pk_bf16_f32 v102, v104, v105
  v_cvt_pk_bf16_f32 v103, v106, v107
  s_nop 0
  v_permlane32_swap_b32 v100, v102
  v_permlane32_swap_b32 v101, v103
  buffer_store_dwordx4 v[100:103], v9, s[36:39], s47 offen offset:1024 sc1
  s_waitcnt lgkmcnt(0)
  v_add_u32 v6, 0x18000, v3
  v_add_u32 v7, 0x18000, v4
  v_add_u32 v8, 0x18000, v5
  v_mfma_f32_16x16x32_bf16 v[108:111], v[52:55], v[60:63], v[108:111]
  ds_read_b128 v[20:23], v6 offset:1024
  v_mfma_f32_16x16x32_bf16 v[112:115], v[52:55], v[64:67], v[112:115]
  ds_read_b128 v[28:31], v7 offset:0
  v_mfma_f32_16x16x32_bf16 v[116:119], v[52:55], v[68:71], v[116:119]
  ds_read_b128 v[32:35], v7 offset:2048
  v_mfma_f32_16x16x32_bf16 v[120:123], v[52:55], v[72:75], v[120:123]
  ds_read_b128 v[36:39], v7 offset:4096
  v_mfma_f32_16x16x32_bf16 v[124:127], v[56:59], v[60:63], v[124:127]
  ds_read_b128 v[40:43], v7 offset:6144
  v_mfma_f32_16x16x32_bf16 v[128:131], v[56:59], v[64:67], v[128:131]
  ds_read_b128 v[24:27], v6 offset:1280
  v_mfma_f32_16x16x32_bf16 v[132:135], v[56:59], v[68:71], v[132:135]
  v_mfma_f32_16x16x32_bf16 v[136:139], v[56:59], v[72:75], v[136:139]
  s_waitcnt lgkmcnt(4)
  v_mfma_f32_16x16x32_bf16 v[108:111], v[20:23], v[28:31], v[108:111]
  ds_read_b128 v[52:55], v6 offset:9216
  s_waitcnt lgkmcnt(4)
  v_mfma_f32_16x16x32_bf16 v[112:115], v[20:23], v[32:35], v[112:115]
  ds_read_b128 v[60:63], v8 offset:0
  s_waitcnt lgkmcnt(4)
  v_mfma_f32_16x16x32_bf16 v[116:119], v[20:23], v[36:39], v[116:119]
  ds_read_b128 v[64:67], v8 offset:2048
  s_waitcnt lgkmcnt(4)
  v_mfma_f32_16x16x32_bf16 v[120:123], v[20:23], v[40:43], v[120:123]
  ds_read_b128 v[68:71], v8 offset:4096
  s_waitcnt lgkmcnt(4)
  v_mfma_f32_16x16x32_bf16 v[124:127], v[24:27], v[28:31], v[124:127]
  ds_read_b128 v[72:75], v8 offset:6144
  v_mfma_f32_16x16x32_bf16 v[128:131], v[24:27], v[32:35], v[128:131]
  ds_read_b128 v[56:59], v6 offset:9472
  v_mfma_f32_16x16x32_bf16 v[132:135], v[24:27], v[36:39], v[132:135]
  v_mfma_f32_16x16x32_bf16 v[136:139], v[24:27], v[40:43], v[136:139]
  s_waitcnt lgkmcnt(0)
  v_add_u32 v6, 0x0, v3
  v_add_u32 v7, 0x0, v4
  v_add_u32 v8, 0x0, v5
  v_mfma_f32_16x16x32_bf16 v[108:111], v[52:55], v[60:63], v[108:111]
  ds_read_b128 v[20:23], v6 offset:1024
  v_mfma_f32_16x16x32_bf16 v[112:115], v[52:55], v[64:67], v[112:115]
  ds_read_b128 v[28:31], v7 offset:0
  v_mfma_f32_16x16x32_bf16 v[116:119], v[52:55], v[68:71], v[116:119]
  ds_read_b128 v[32:35], v7 offset:2048
  v_mfma_f32_16x16x32_bf16 v[120:123], v[52:55], v[72:75], v[120:123]
  ds_read_b128 v[36:39], v7 offset:4096
  v_mfma_f32_16x16x32_bf16 v[124:127], v[56:59], v[60:63], v[124:127]
  ds_read_b128 v[40:43], v7 offset:6144
  v_mfma_f32_16x16x32_bf16 v[128:131], v[56:59], v[64:67], v[128:131]
  ds_read_b128 v[24:27], v6 offset:1280
  v_mfma_f32_16x16x32_bf16 v[132:135], v[56:59], v[68:71], v[132:135]
  v_mfma_f32_16x16x32_bf16 v[136:139], v[56:59], v[72:75], v[136:139]
  s_waitcnt lgkmcnt(4)
  v_mfma_f32_16x16x32_bf16 v[108:111], v[20:23], v[28:31], v[108:111]
  ds_read_b128 v[52:55], v6 offset:9216
  s_waitcnt lgkmcnt(4)
  v_mfma_f32_16x16x32_bf16 v[112:115], v[20:23], v[32:35], v[112:115]
  ds_read_b128 v[60:63], v8 offset:0
  s_waitcnt lgkmcnt(4)
  v_mfma_f32_16x16x32_bf16 v[116:119], v[20:23], v[36:39], v[116:119]
  ds_read_b128 v[64:67], v8 offset:2048
  s_waitcnt lgkmcnt(4)
  v_mfma_f32_16x16x32_bf16 v[120:123], v[20:23], v[40:43], v[120:123]
  ds_read_b128 v[68:71], v8 offset:4096
  s_waitcnt lgkmcnt(4)
  v_mfma_f32_16x16x32_bf16 v[124:127], v[24:27], v[28:31], v[124:127]
  ds_read_b128 v[72:75], v8 offset:6144
  v_mfma_f32_16x16x32_bf16 v[128:131], v[24:27], v[32:35], v[128:131]
  ds_read_b128 v[56:59], v6 offset:9472
  v_mfma_f32_16x16x32_bf16 v[132:135], v[24:27], v[36:39], v[132:135]
  v_mfma_f32_16x16x32_bf16 v[136:139], v[24:27], v[40:43], v[136:139]
  s_waitcnt lgkmcnt(4)
  v_mfma_f32_16x16x32_bf16 v[108:111], v[52:55], v[60:63], v[108:111]
  s_waitcnt lgkmcnt(3)
  v_mfma_f32_16x16x32_bf16 v[112:115], v[52:55], v[64:67], v[112:115]
  s_waitcnt lgkmcnt(2)
  v_mfma_f32_16x16x32_bf16 v[116:119], v[52:55], v[68:71], v[116:119]
  s_waitcnt lgkmcnt(1)
  v_mfma_f32_16x16x32_bf16 v[120:123], v[52:55], v[72:75], v[120:123]
  s_waitcnt lgkmcnt(0)
  v_mfma_f32_16x16x32_bf16 v[124:127], v[56:59], v[60:63], v[124:127]
  v_mfma_f32_16x16x32_bf16 v[128:131], v[56:59], v[64:67], v[128:131]
  v_mfma_f32_16x16x32_bf16 v[132:135], v[56:59], v[68:71], v[132:135]
  v_mfma_f32_16x16x32_bf16 v[136:139], v[56:59], v[72:75], v[136:139]
  v_cvt_pk_bf16_f32 v108, v108, v109
  v_cvt_pk_bf16_f32 v109, v110, v111
  v_cvt_pk_bf16_f32 v110, v112, v113
  v_cvt_pk_bf16_f32 v111, v114, v115
  s_nop 0
  v_permlane32_swap_b32 v108, v110
  v_permlane32_swap_b32 v109, v111
  buffer_store_dwordx4 v[108:111], v9, s[36:39], s46 offen offset:2048 sc1
  v_cvt_pk_bf16_f32 v116, v116, v117
  v_cvt_pk_bf16_f32 v117, v118, v119
  v_cvt_pk_bf16_f32 v118, v120, v121
  v_cvt_pk_bf16_f32 v119, v122, v123
  s_nop 0
  v_permlane32_swap_b32 v116, v118
  v_permlane32_swap_b32 v117, v119
  buffer_store_dwordx4 v[116:119], v9, s[36:39], s47 offen offset:2048 sc1
  v_cvt_pk_bf16_f32 v124, v124, v125
  v_cvt_pk_bf16_f32 v125, v126, v127
  v_cvt_pk_bf16_f32 v126, v128, v129
  v_cvt_pk_bf16_f32 v127, v130, v131
  s_nop 0
  v_permlane32_swap_b32 v124, v126
  v_permlane32_swap_b32 v125, v127
  buffer_store_dwordx4 v[124:127], v9, s[36:39], s46 offen offset:3072 sc1
  v_cvt_pk_bf16_f32 v132, v132, v133
  v_cvt_pk_bf16_f32 v133, v134, v135
  v_cvt_pk_bf16_f32 v134, v136, v137
  v_cvt_pk_bf16_f32 v135, v138, v139
  s_nop 0
  v_permlane32_swap_b32 v132, v134
  v_permlane32_swap_b32 v133, v135
  buffer_store_dwordx4 v[132:135], v9, s[36:39], s47 offen offset:3072 sc1
  s_waitcnt vmcnt(0)
  v_mov_b32 v144, s90
  v_mov_b32 v145, 0
  s_mov_b64 exec, 1
  buffer_store_dword v144, v145, s[36:39], s48 offen sc1
  s_mov_b64 exec, -1
  s_endpgm
gm_BL:
  s_sub_u32 s3, s3, 8
  s_setprio 3
  v_lshrrev_b32 v2, 3, v0
  v_lshrrev_b32 v4, 4, v0
  s_and_b32 s33, s3, 1
  s_lshl_b32 s33, s33, 2
  v_or_b32 v4, s33, v4
  v_and_b32 v5, 7, v0
  v_xor_b32 v4, v4, v5
  s_lshl_b32 s33, s3, 3
  v_add_u32 v2, s33, v2
  v_lshlrev_b32 v2, 10, v2
  v_lshl_add_u32 v2, v4, 4, v2
  s_lshl_b32 s34, s3, 10
  s_lshl_b32 s35, s3, 12
  s_and_b32 s77, s4, 3
  s_lshr_b32 s78, s4, 2
  s_lshr_b32 s80, s4, 1
  s_lshl_b32 s33, s77, 2
  s_and_b32 s32, s6, 3
  s_add_u32 s33, s33, s32
  s_and_b32 s81, s33, 7
  s_lshl_b32 s33, s33, 17
  s_waitcnt lgkmcnt(0)
  s_add_u32 s40, s8, s33
  s_addc_u32 s41, s9, 0
  s_mov_b32 s42, 0x20000
  s_mov_b32 s43, 0x20000
  s_lshr_b32 s79, s6, 2
  s_lshl_b32 s33, s79, 17
  s_cmp_eq_u32 s78, 0
  s_cselect_b32 s44, s20, s22
  s_cselect_b32 s45, s21, s23
  s_add_u32 s44, s44, s33
  s_addc_u32 s45, s45, 0
  s_mov_b32 s46, 0x20000
  s_mov_b32 s47, 0x20000
  s_mov_b32 s33, 0x0
  s_add_u32 m0, s34, 0x0
  s_nop 0
  buffer_load_dwordx4 v2, s[40:43], s33 offen lds
  s_add_u32 m0, s34, 0x4000
  s_nop 0
  buffer_load_dwordx4 v2, s[44:47], s33 offen lds
  s_mov_b32 s33, 0x8000
  s_add_u32 m0, s34, 0x1000
  s_nop 0
  buffer_load_dwordx4 v2, s[40:43], s33 offen lds
  s_add_u32 m0, s34, 0x5000
  s_nop 0
  buffer_load_dwordx4 v2, s[44:47], s33 offen lds
  s_mov_b32 s33, 0x10000
  s_add_u32 m0, s34, 0x2000
  s_nop 0
  buffer_load_dwordx4 v2, s[40:43], s33 offen lds
  s_add_u32 m0, s34, 0x6000
  s_nop 0
  buffer_load_dwordx4 v2, s[44:47], s33 offen lds
  s_mov_b32 s33, 0x18000
  s_add_u32 m0, s34, 0x3000
  s_nop 0
  buffer_load_dwordx4 v2, s[40:43], s33 offen lds
  s_add_u32 m0, s34, 0x7000
  s_nop 0
  buffer_load_dwordx4 v2, s[44:47], s33 offen lds
  s_mov_b32 s33, 0x80
  s_add_u32 m0, s34, 0x8000
  s_nop 0
  buffer_load_dwordx4 v2, s[40:43], s33 offen lds
  s_add_u32 m0, s34, 0xc000
  s_nop 0
  buffer_load_dwordx4 v2, s[44:47], s33 offen lds
  s_mov_b32 s33, 0x8080
  s_add_u32 m0, s34, 0x9000
  s_nop 0
  buffer_load_dwordx4 v2, s[40:43], s33 offen lds
  s_add_u32 m0, s34, 0xd000
  s_nop 0
  buffer_load_dwordx4 v2, s[44:47], s33 offen lds
  s_mov_b32 s33, 0x10080
  s_add_u32 m0, s34, 0xa000
  s_nop 0
  buffer_load_dwordx4 v2, s[40:43], s33 offen lds
  s_add_u32 m0, s34, 0xe000
  s_nop 0
  buffer_load_dwordx4 v2, s[44:47], s33 offen lds
  s_mov_b32 s33, 0x18080
  s_add_u32 m0, s34, 0xb000
  s_nop 0
  buffer_load_dwordx4 v2, s[40:43], s33 offen lds
  s_add_u32 m0, s34, 0xf000
  s_nop 0
  buffer_load_dwordx4 v2, s[44:47], s33 offen lds
  s_mov_b32 s36, s30
  s_mov_b32 s37, s31
  s_mov_b32 s38, 0x1700000
  s_mov_b32 s39, 0x20000
  s_add_u32 s84, s30, 0x1600000
  s_addc_u32 s85, s31, 0
  s_load_dword s90, s[84:85], 0
  v_lshrrev_b32 v5, 3, v0
  v_lshrrev_b32 v6, 4, v0
  s_and_b32 s33, s3, 1
  s_lshl_b32 s33, s33, 2
  v_or_b32 v6, s33, v6
  v_and_b32 v7, 7, v0
  v_xor_b32 v6, v6, v7
  s_lshl_b32 s33, s3, 3
  v_add_u32 v5, s33, v5
  v_lshlrev_b32 v5, 12, v5
  v_lshl_add_u32 v5, v6, 4, v5
  s_lshl_b32 s33, s81, 20
  s_and_b32 s32, s80, 1
  s_lshl_b32 s32, s32, 11
  s_add_u32 s33, s33, s32
  s_sub_u32 s58, 0x100000, s32
  s_mov_b32 s59, 0x20000
  s_cmp_eq_u32 s78, 0
  s_cselect_b32 s56, s16, s18
  s_cselect_b32 s57, s17, s19
  s_add_u32 s56, s56, s33
  s_addc_u32 s57, s57, 0
  s_lshl_b32 s33, s80, 6
  s_add_u32 s33, s33, s3
  s_lshl_b32 s33, s33, 14
  s_lshl_b32 s60, s79, 12
  s_add_u32 s60, s60, s33
  s_add_u32 s60, s60, 0x600000
  s_lshl_b32 s64, s81, 1
  v_and_b32 v8, 15, v0
  v_lshlrev_b32 v8, 12, v8
  v_lshrrev_b32 v9, 4, v0
  v_add_u32 v9, s64, v9
  s_lshl_b32 s61, s79, 2
  s_add_u32 s61, s61, s3
  s_lshl_b32 s61, s61, 16
  s_lshl_b32 s33, s78, 2
  s_add_u32 s33, s33, s79
  s_lshl_b32 s33, s33, 1
  s_and_b32 s32, s80, 1
  s_add_u32 s33, s33, s32
  s_lshl_b32 s33, s33, 6
  s_and_b32 s32, s3, 2
  s_add_u32 s33, s33, s32
  s_lshl_b32 s33, s33, 7
  s_add_u32 s33, s33, 0x1620000
  v_bfe_u32 v12, v0, 2, 3
  v_lshlrev_b32 v12, 10, v12
  v_bfe_u32 v13, v0, 1, 1
  v_lshl_add_u32 v12, v13, 9, v12
  v_and_b32 v13, 1, v0
  v_lshl_add_u32 v12, v13, 7, v12
  v_add_u32 v12, s33, v12
  v_and_b32 v15, 3, v0
  v_bfe_u32 v13, v15, 1, 1
  v_and_b32 v15, 1, v15
  v_lshlrev_b32 v15, 7, v15
  v_lshl_add_u32 v15, v13, 9, v15
  s_add_u32 s32, s81, 1
  s_and_b32 s32, s32, 7
  s_lshl_b32 s32, s32, 10
  s_add_u32 s33, s33, s32
  v_add_u32 v15, s33, v15
  s_add_u32 s33, s81, 5
  s_and_b32 s33, s33, 7
  s_lshl_b32 s33, s33, 17
  s_add_u32 s62, s60, s33
  v_and_b32 v10, 31, v0
  v_lshlrev_b32 v10, 7, v10
  v_lshrrev_b32 v13, 5, v0
  v_lshl_add_u32 v10, v13, 16, v10
  s_waitcnt lgkmcnt(0)
  s_add_u32 s90, s90, 1
  s_waitcnt vmcnt(8)
  s_barrier
  s_mov_b32 s33, 0x100
  s_add_u32 m0, s34, 0x10000
  s_nop 0
  buffer_load_dwordx4 v2, s[40:43], s33 offen lds
  s_add_u32 m0, s34, 0x14000
  s_nop 0
  buffer_load_dwordx4 v2, s[44:47], s33 offen lds
  s_mov_b32 s33, 0x8100
  s_add_u32 m0, s34, 0x11000
  s_nop 0
  buffer_load_dwordx4 v2, s[40:43], s33 offen lds
  s_add_u32 m0, s34, 0x15000
  s_nop 0
  buffer_load_dwordx4 v2, s[44:47], s33 offen lds
  s_mov_b32 s33, 0x10100
  s_add_u32 m0, s34, 0x12000
  s_nop 0
  buffer_load_dwordx4 v2, s[40:43], s33 offen lds
  s_add_u32 m0, s34, 0x16000
  s_nop 0
  buffer_load_dwordx4 v2, s[44:47], s33 offen lds
  s_mov_b32 s33, 0x18100
  s_add_u32 m0, s34, 0x13000
  s_nop 0
  buffer_load_dwordx4 v2, s[40:43], s33 offen lds
  s_add_u32 m0, s34, 0x17000
  s_nop 0
  buffer_load_dwordx4 v2, s[44:47], s33 offen lds
  s_waitcnt vmcnt(8)
  s_barrier
  s_mov_b32 s33, 0x180
  s_add_u32 m0, s34, 0x18000
  s_nop 0
  buffer_load_dwordx4 v2, s[40:43], s33 offen lds
  s_add_u32 m0, s34, 0x1c000
  s_nop 0
  buffer_load_dwordx4 v2, s[44:47], s33 offen lds
  s_mov_b32 s33, 0x8180
  s_add_u32 m0, s34, 0x19000
  s_nop 0
  buffer_load_dwordx4 v2, s[40:43], s33 offen lds
  s_add_u32 m0, s34, 0x1d000
  s_nop 0
  buffer_load_dwordx4 v2, s[44:47], s33 offen lds
  s_mov_b32 s33, 0x10180
  s_add_u32 m0, s34, 0x1a000
  s_nop 0
  buffer_load_dwordx4 v2, s[40:43], s33 offen lds
  s_add_u32 m0, s34, 0x1e000
  s_nop 0
  buffer_load_dwordx4 v2, s[44:47], s33 offen lds
  s_mov_b32 s33, 0x18180
  s_add_u32 m0, s34, 0x1b000
  s_nop 0
  buffer_load_dwordx4 v2, s[40:43], s33 offen lds
  s_add_u32 m0, s34, 0x1f000
  s_nop 0
  buffer_load_dwordx4 v2, s[44:47], s33 offen lds
  s_mov_b32 s33, 0x200
  s_add_u32 m0, s34, 0x0
  s_nop 0
  buffer_load_dwordx4 v2, s[40:43], s33 offen lds
  s_add_u32 m0, s34, 0x4000
  s_nop 0
  buffer_load_dwordx4 v2, s[44:47], s33 offen lds
  s_mov_b32 s33, 0x8200
  s_add_u32 m0, s34, 0x1000
  s_nop 0
  buffer_load_dwordx4 v2, s[40:43], s33 offen lds
  s_add_u32 m0, s34, 0x5000
  s_nop 0
  buffer_load_dwordx4 v2, s[44:47], s33 offen lds
  s_mov_b32 s33, 0x10200
  s_add_u32 m0, s34, 0x2000
  s_nop 0
  buffer_load_dwordx4 v2, s[40:43], s33 offen lds
  s_add_u32 m0, s34, 0x6000
  s_nop 0
  buffer_load_dwordx4 v2, s[44:47], s33 offen lds
  s_mov_b32 s33, 0x18200
  s_add_u32 m0, s34, 0x3000
  s_nop 0
  buffer_load_dwordx4 v2, s[40:43], s33 offen lds
  s_add_u32 m0, s34, 0x7000
  s_nop 0
  buffer_load_dwordx4 v2, s[44:47], s33 offen lds
  s_waitcnt vmcnt(16)
  s_barrier
  s_mov_b32 s33, 0x280
  s_add_u32 m0, s34, 0x8000
  s_nop 0
  buffer_load_dwordx4 v2, s[40:43], s33 offen lds
  s_add_u32 m0, s34, 0xc000
  s_nop 0
  buffer_load_dwordx4 v2, s[44:47], s33 offen lds
  s_mov_b32 s33, 0x8280
  s_add_u32 m0, s34, 0x9000
  s_nop 0
  buffer_load_dwordx4 v2, s[40:43], s33 offen lds
  s_add_u32 m0, s34, 0xd000
  s_nop 0
  buffer_load_dwordx4 v2, s[44:47], s33 offen lds
  s_mov_b32 s33, 0x10280
  s_add_u32 m0, s34, 0xa000
  s_nop 0
  buffer_load_dwordx4 v2, s[40:43], s33 offen lds
  s_add_u32 m0, s34, 0xe000
  s_nop 0
  buffer_load_dwordx4 v2, s[44:47], s33 offen lds
  s_mov_b32 s33, 0x18280
  s_add_u32 m0, s34, 0xb000
  s_nop 0
  buffer_load_dwordx4 v2, s[40:43], s33 offen lds
  s_add_u32 m0, s34, 0xf000
  s_nop 0
  buffer_load_dwordx4 v2, s[44:47], s33 offen lds
  s_waitcnt vmcnt(16)
  s_barrier
  s_mov_b32 s33, 0x300
  s_add_u32 m0, s34, 0x10000
  s_nop 0
  buffer_load_dwordx4 v2, s[40:43], s33 offen lds
  s_add_u32 m0, s34, 0x14000
  s_nop 0
  buffer_load_dwordx4 v2, s[44:47], s33 offen lds
  s_mov_b32 s33, 0x8300
  s_add_u32 m0, s34, 0x11000
  s_nop 0
  buffer_load_dwordx4 v2, s[40:43], s33 offen lds
  s_add_u32 m0, s34, 0x15000
  s_nop 0
  buffer_load_dwordx4 v2, s[44:47], s33 offen lds
  s_mov_b32 s33, 0x10300
  s_add_u32 m0, s34, 0x12000
  s_nop 0
  buffer_load_dwordx4 v2, s[40:43], s33 offen lds
  s_add_u32 m0, s34, 0x16000
  s_nop 0
  buffer_load_dwordx4 v2, s[44:47], s33 offen lds
  s_mov_b32 s33, 0x18300
  s_add_u32 m0, s34, 0x13000
  s_nop 0
  buffer_load_dwordx4 v2, s[40:43], s33 offen lds
  s_add_u32 m0, s34, 0x17000
  s_nop 0
  buffer_load_dwordx4 v2, s[44:47], s33 offen lds
  s_waitcnt vmcnt(16)
  s_barrier
  s_mov_b32 s33, 0x380
  s_add_u32 m0, s34, 0x18000
  s_nop 0
  buffer_load_dwordx4 v2, s[40:43], s33 offen lds
  s_add_u32 m0, s34, 0x1c000
  s_nop 0
  buffer_load_dwordx4 v2, s[44:47], s33 offen lds
  s_mov_b32 s33, 0x8380
  s_add_u32 m0, s34, 0x19000
  s_nop 0
  buffer_load_dwordx4 v2, s[40:43], s33 offen lds
  s_add_u32 m0, s34, 0x1d000
  s_nop 0
  buffer_load_dwordx4 v2, s[44:47], s33 offen lds
  s_mov_b32 s33, 0x10380
  s_add_u32 m0, s34, 0x1a000
  s_nop 0
  buffer_load_dwordx4 v2, s[40:43], s33 offen lds
  s_add_u32 m0, s34, 0x1e000
  s_nop 0
  buffer_load_dwordx4 v2, s[44:47], s33 offen lds
  s_mov_b32 s33, 0x18380
  s_add_u32 m0, s34, 0x1b000
  s_nop 0
  buffer_load_dwordx4 v2, s[40:43], s33 offen lds
  s_add_u32 m0, s34, 0x1f000
  s_nop 0
  buffer_load_dwordx4 v2, s[44:47], s33 offen lds
  s_add_u32 s84, s81, 0
  s_and_b32 s84, s84, 3
  s_xor_b32 s86, s81, 0
  s_and_b32 s86, s86, 4
  s_or_b32 s84, s84, s86
  s_add_u32 s85, s81, 1
  s_and_b32 s85, s85, 3
  s_xor_b32 s86, s81, 0
  s_and_b32 s86, s86, 4
  s_or_b32 s85, s85, s86
  v_mov_b32 v28, s84
  v_mov_b32 v29, s85
  s_mov_b32 s86, 0
  s_mov_b32 s87, -1
  v_cndmask_b32 v28, v28, v29, s[86:87]
  v_bfe_u32 v29, v0, 4, 1
  v_lshl_add_u32 v28, v28, 1, v29
  v_lshl_add_u32 v28, v28, 7, v8
  buffer_load_dword v20, v28, s[56:59], s61 offen
  s_waitcnt vmcnt(17)
  s_barrier
  s_waitcnt vmcnt(9)
  s_barrier
  s_waitcnt vmcnt(1)
  s_barrier
  s_add_u32 s65, s81, 0
  s_and_b32 s65, s65, 3
  s_xor_b32 s66, s81, 0
  s_and_b32 s66, s66, 4
  s_or_b32 s65, s65, s66
  s_lshl_b32 s65, s65, 1
  s_lshl_b32 s66, s65, 7
  s_add_u32 s33, s66, 0x0
  s_add_u32 m0, s34, 0x4000
  s_nop 0
  buffer_load_dwordx4 v5, s[56:59], s33 offen lds
  s_add_u32 s33, s66, 0x20000
  s_add_u32 m0, s34, 0x5000
  s_nop 0
  buffer_load_dwordx4 v5, s[56:59], s33 offen lds
  s_add_u32 s33, s66, 0x40000
  s_add_u32 m0, s34, 0x6000
  s_nop 0
  buffer_load_dwordx4 v5, s[56:59], s33 offen lds
  s_add_u32 s33, s66, 0x60000
  s_add_u32 m0, s34, 0x7000
  s_nop 0
  buffer_load_dwordx4 v5, s[56:59], s33 offen lds
  s_add_u32 s33, s66, 0x80000
  s_add_u32 m0, s34, 0x8000
  s_nop 0
  buffer_load_dwordx4 v5, s[56:59], s33 offen lds
  s_add_u32 s33, s66, 0xa0000
  s_add_u32 m0, s34, 0x9000
  s_nop 0
  buffer_load_dwordx4 v5, s[56:59], s33 offen lds
  s_add_u32 s33, s66, 0xc0000
  s_add_u32 m0, s34, 0xa000
  s_nop 0
  buffer_load_dwordx4 v5, s[56:59], s33 offen lds
  s_add_u32 s33, s66, 0xe0000
  s_add_u32 m0, s34, 0xb000
  s_nop 0
  buffer_load_dwordx4 v5, s[56:59], s33 offen lds
  s_barrier
  s_waitcnt vmcnt(0)
  s_barrier
  s_add_u32 s65, s81, 0
  s_and_b32 s65, s65, 3
  s_xor_b32 s66, s81, 0
  s_and_b32 s66, s66, 4
  s_or_b32 s65, s65, s66
  s_lshl_b32 s65, s65, 1
  s_add_u32 s65, s65, 1
  s_lshl_b32 s66, s65, 7
  s_add_u32 s33, s66, 0x0
  s_add_u32 m0, s34, 0x10000
  s_nop 0
  buffer_load_dwordx4 v5, s[56:59], s33 offen lds
  s_add_u32 s33, s66, 0x20000
  s_add_u32 m0, s34, 0x11000
  s_nop 0
  buffer_load_dwordx4 v5, s[56:59], s33 offen lds
  s_add_u32 s33, s66, 0x40000
  s_add_u32 m0, s34, 0x12000
  s_nop 0
  buffer_load_dwordx4 v5, s[56:59], s33 offen lds
  s_add_u32 s33, s66, 0x60000
  s_add_u32 m0, s34, 0x13000
  s_nop 0
  buffer_load_dwordx4 v5, s[56:59], s33 offen lds
  s_add_u32 s33, s66, 0x80000
  s_add_u32 m0, s34, 0x14000
  s_nop 0
  buffer_load_dwordx4 v5, s[56:59], s33 offen lds
  s_add_u32 s33, s66, 0xa0000
  s_add_u32 m0, s34, 0x15000
  s_nop 0
  buffer_load_dwordx4 v5, s[56:59], s33 offen lds
  s_add_u32 s33, s66, 0xc0000
  s_add_u32 m0, s34, 0x16000
  s_nop 0
  buffer_load_dwordx4 v5, s[56:59], s33 offen lds
  s_add_u32 s33, s66, 0xe0000
  s_add_u32 m0, s34, 0x17000
  s_nop 0
  buffer_load_dwordx4 v5, s[56:59], s33 offen lds
  s_add_u32 s65, s81, 1
  s_and_b32 s65, s65, 3
  s_xor_b32 s66, s81, 0
  s_and_b32 s66, s66, 4
  s_or_b32 s65, s65, s66
  s_lshl_b32 s65, s65, 1
  s_lshl_b32 s66, s65, 7
  s_add_u32 s33, s66, 0x0
  s_add_u32 m0, s34, 0x1c000
  s_nop 0
  buffer_load_dwordx4 v5, s[56:59], s33 offen lds
  s_add_u32 s33, s66, 0x20000
  s_add_u32 m0, s34, 0x1d000
  s_nop 0
  buffer_load_dwordx4 v5, s[56:59], s33 offen lds
  s_add_u32 s33, s66, 0x40000
  s_add_u32 m0, s34, 0x1e000
  s_nop 0
  buffer_load_dwordx4 v5, s[56:59], s33 offen lds
  s_add_u32 s33, s66, 0x60000
  s_add_u32 m0, s34, 0x1f000
  s_nop 0
  buffer_load_dwordx4 v5, s[56:59], s33 offen lds
  s_add_u32 s33, s66, 0x80000
  s_add_u32 m0, s34, 0x20000
  s_nop 0
  buffer_load_dwordx4 v5, s[56:59], s33 offen lds
  s_add_u32 s33, s66, 0xa0000
  s_add_u32 m0, s34, 0x21000
  s_nop 0
  buffer_load_dwordx4 v5, s[56:59], s33 offen lds
  s_add_u32 s33, s66, 0xc0000
  s_add_u32 m0, s34, 0x22000
  s_nop 0
  buffer_load_dwordx4 v5, s[56:59], s33 offen lds
  s_add_u32 s33, s66, 0xe0000
  s_add_u32 m0, s34, 0x23000
  s_nop 0
  buffer_load_dwordx4 v5, s[56:59], s33 offen lds
  s_waitcnt vmcnt(8)
  s_barrier
  s_cmp_lg_u32 s3, 0
  s_cbranch_scc1 gm_BL_w1
  s_lshl_b32 s33, s78, 2
  s_add_u32 s33, s33, s79
  s_lshl_b32 s33, s33, 1
  s_and_b32 s32, s80, 1
  s_add_u32 s33, s33, s32
  s_lshl_b32 s33, s33, 13
  s_add_u32 s33, s33, 0x1620000
  v_and_b32 v12, 7, v0
  v_lshlrev_b32 v12, 10, v12
  v_add_u32 v12, s33, v12
  s_lshl_b32 s32, s81, 10
  s_add_u32 s33, s33, s32
  v_mov_b32 v16, s90
  v_mov_b32 v17, 0
  s_mov_b64 exec, 1
  buffer_store_dword v16, v17, s[36:39], s33 offen sc1
  s_mov_b64 exec, -1
  s_sleep 8
  s_mov_b32 s88, 0x8000
poll1:
  buffer_load_dword v14, v12, s[36:39], 0 offen sc1
  s_waitcnt vmcnt(0)
  v_cmp_ne_u32 s[86:87], s90, v14
  s_nop 3
  s_cmp_eq_u64 s[86:87], 0
  s_cbranch_scc1 poll1_ok
  s_sleep 3
  s_sub_u32 s88, s88, 1
  s_cmp_lg_u32 s88, 0
  s_cbranch_scc1 poll1
poll1_ok:
gm_BL_w1:
  s_barrier
  s_add_u32 s65, s81, 1
  s_and_b32 s65, s65, 3
  s_xor_b32 s66, s81, 0
  s_and_b32 s66, s66, 4
  s_or_b32 s65, s65, s66
  s_lshl_b32 s65, s65, 1
  s_lshl_b32 s33, s65, 16
  s_add_u32 s33, s33, s60
  s_add_u32 m0, s35, 0x18000
  s_nop 0
  buffer_load_dwordx4 v1, s[36:39], s33 offen offset:0 sc1 lds
  buffer_load_dwordx4 v1, s[36:39], s33 offen offset:1024 sc1 lds
  buffer_load_dwordx4 v1, s[36:39], s33 offen offset:2048 sc1 lds
  buffer_load_dwordx4 v1, s[36:39], s33 offen offset:3072 sc1 lds
  s_add_u32 s65, s81, 1
  s_and_b32 s65, s65, 3
  s_xor_b32 s66, s81, 0
  s_and_b32 s66, s66, 4
  s_or_b32 s65, s65, s66
  s_lshl_b32 s65, s65, 1
  s_add_u32 s65, s65, 1
  s_lshl_b32 s33, s65, 16
  s_add_u32 s33, s33, s60
  s_add_u32 m0, s35, 0x0
  s_nop 0
  buffer_load_dwordx4 v1, s[36:39], s33 offen offset:0 sc1 lds
  buffer_load_dwordx4 v1, s[36:39], s33 offen offset:1024 sc1 lds
  buffer_load_dwordx4 v1, s[36:39], s33 offen offset:2048 sc1 lds
  buffer_load_dwordx4 v1, s[36:39], s33 offen offset:3072 sc1 lds
  s_add_u32 s65, s81, 1
  s_and_b32 s65, s65, 3
  s_xor_b32 s66, s81, 0
  s_and_b32 s66, s66, 4
  s_or_b32 s65, s65, s66
  s_lshl_b32 s65, s65, 1
  s_add_u32 s65, s65, 1
  s_lshl_b32 s66, s65, 7
  s_add_u32 s33, s66, 0x0
  s_add_u32 m0, s34, 0x4000
  s_nop 0
  buffer_load_dwordx4 v5, s[56:59], s33 offen lds
  s_add_u32 s33, s66, 0x20000
  s_add_u32 m0, s34, 0x5000
  s_nop 0
  buffer_load_dwordx4 v5, s[56:59], s33 offen lds
  s_add_u32 s33, s66, 0x40000
  s_add_u32 m0, s34, 0x6000
  s_nop 0
  buffer_load_dwordx4 v5, s[56:59], s33 offen lds
  s_add_u32 s33, s66, 0x60000
  s_add_u32 m0, s34, 0x7000
  s_nop 0
  buffer_load_dwordx4 v5, s[56:59], s33 offen lds
  s_add_u32 s33, s66, 0x80000
  s_add_u32 m0, s34, 0x8000
  s_nop 0
  buffer_load_dwordx4 v5, s[56:59], s33 offen lds
  s_add_u32 s33, s66, 0xa0000
  s_add_u32 m0, s34, 0x9000
  s_nop 0
  buffer_load_dwordx4 v5, s[56:59], s33 offen lds
  s_add_u32 s33, s66, 0xc0000
  s_add_u32 m0, s34, 0xa000
  s_nop 0
  buffer_load_dwordx4 v5, s[56:59], s33 offen lds
  s_add_u32 s33, s66, 0xe0000
  s_add_u32 m0, s34, 0xb000
  s_nop 0
  buffer_load_dwordx4 v5, s[56:59], s33 offen lds
  s_waitcnt vmcnt(12)
  s_barrier
  s_add_u32 s65, s81, 0
  s_and_b32 s65, s65, 3
  s_xor_b32 s66, s81, 4
  s_and_b32 s66, s66, 4
  s_or_b32 s65, s65, s66
  s_lshl_b32 s65, s65, 1
  s_lshl_b32 s33, s65, 16
  s_add_u32 s33, s33, s60
  s_add_u32 m0, s35, 0xc000
  s_nop 0
  buffer_load_dwordx4 v1, s[36:39], s33 offen offset:0 sc1 lds
  buffer_load_dwordx4 v1, s[36:39], s33 offen offset:1024 sc1 lds
  buffer_load_dwordx4 v1, s[36:39], s33 offen offset:2048 sc1 lds
  buffer_load_dwordx4 v1, s[36:39], s33 offen offset:3072 sc1 lds
  s_add_u32 s65, s81, 0
  s_and_b32 s65, s65, 3
  s_xor_b32 s66, s81, 4
  s_and_b32 s66, s66, 4
  s_or_b32 s65, s65, s66
  s_lshl_b32 s65, s65, 1
  s_lshl_b32 s66, s65, 7
  s_add_u32 s33, s66, 0x0
  s_add_u32 m0, s34, 0x10000
  s_nop 0
  buffer_load_dwordx4 v5, s[56:59], s33 offen lds
  s_add_u32 s33, s66, 0x20000
  s_add_u32 m0, s34, 0x11000
  s_nop 0
  buffer_load_dwordx4 v5, s[56:59], s33 offen lds
  s_add_u32 s33, s66, 0x40000
  s_add_u32 m0, s34, 0x12000
  s_nop 0
  buffer_load_dwordx4 v5, s[56:59], s33 offen lds
  s_add_u32 s33, s66, 0x60000
  s_add_u32 m0, s34, 0x13000
  s_nop 0
  buffer_load_dwordx4 v5, s[56:59], s33 offen lds
  s_add_u32 s33, s66, 0x80000
  s_add_u32 m0, s34, 0x14000
  s_nop 0
  buffer_load_dwordx4 v5, s[56:59], s33 offen lds
  s_add_u32 s33, s66, 0xa0000
  s_add_u32 m0, s34, 0x15000
  s_nop 0
  buffer_load_dwordx4 v5, s[56:59], s33 offen lds
  s_add_u32 s33, s66, 0xc0000
  s_add_u32 m0, s34, 0x16000
  s_nop 0
  buffer_load_dwordx4 v5, s[56:59], s33 offen lds
  s_add_u32 s33, s66, 0xe0000
  s_add_u32 m0, s34, 0x17000
  s_nop 0
  buffer_load_dwordx4 v5, s[56:59], s33 offen lds
  s_waitcnt vmcnt(12)
  s_barrier
  s_add_u32 s65, s81, 0
  s_and_b32 s65, s65, 3
  s_xor_b32 s66, s81, 4
  s_and_b32 s66, s66, 4
  s_or_b32 s65, s65, s66
  s_lshl_b32 s65, s65, 1
  s_add_u32 s65, s65, 1
  s_lshl_b32 s33, s65, 16
  s_add_u32 s33, s33, s60
  s_add_u32 m0, s35, 0x18000
  s_nop 0
  buffer_load_dwordx4 v1, s[36:39], s33 offen offset:0 sc1 lds
  buffer_load_dwordx4 v1, s[36:39], s33 offen offset:1024 sc1 lds
  buffer_load_dwordx4 v1, s[36:39], s33 offen offset:2048 sc1 lds
  buffer_load_dwordx4 v1, s[36:39], s33 offen offset:3072 sc1 lds
  s_add_u32 s65, s81, 0
  s_and_b32 s65, s65, 3
  s_xor_b32 s66, s81, 4
  s_and_b32 s66, s66, 4
  s_or_b32 s65, s65, s66
  s_lshl_b32 s65, s65, 1
  s_add_u32 s65, s65, 1
  s_lshl_b32 s66, s65, 7
  s_add_u32 s33, s66, 0x0
  s_add_u32 m0, s34, 0x1c000
  s_nop 0
  buffer_load_dwordx4 v5, s[56:59], s33 offen lds
  s_add_u32 s33, s66, 0x20000
  s_add_u32 m0, s34, 0x1d000
  s_nop 0
  buffer_load_dwordx4 v5, s[56:59], s33 offen lds
  s_add_u32 s33, s66, 0x40000
  s_add_u32 m0, s34, 0x1e000
  s_nop 0
  buffer_load_dwordx4 v5, s[56:59], s33 offen lds
  s_add_u32 s33, s66, 0x60000
  s_add_u32 m0, s34, 0x1f000
  s_nop 0
  buffer_load_dwordx4 v5, s[56:59], s33 offen lds
  s_add_u32 s33, s66, 0x80000
  s_add_u32 m0, s34, 0x20000
  s_nop 0
  buffer_load_dwordx4 v5, s[56:59], s33 offen lds
  s_add_u32 s33, s66, 0xa0000
  s_add_u32 m0, s34, 0x21000
  s_nop 0
  buffer_load_dwordx4 v5, s[56:59], s33 offen lds
  s_add_u32 s33, s66, 0xc0000
  s_add_u32 m0, s34, 0x22000
  s_nop 0
  buffer_load_dwordx4 v5, s[56:59], s33 offen lds
  s_add_u32 s33, s66, 0xe0000
  s_add_u32 m0, s34, 0x23000
  s_nop 0
  buffer_load_dwordx4 v5, s[56:59], s33 offen lds
  s_waitcnt vmcnt(12)
  s_barrier
  s_add_u32 s65, s81, 2
  s_and_b32 s65, s65, 3
  s_xor_b32 s66, s81, 0
  s_and_b32 s66, s66, 4
  s_or_b32 s65, s65, s66
  s_lshl_b32 s65, s65, 1
  s_lshl_b32 s33, s65, 16
  s_add_u32 s33, s33, s60
  s_add_u32 m0, s35, 0x0
  s_nop 0
  buffer_load_dwordx4 v1, s[36:39], s33 offen offset:0 sc1 lds
  buffer_load_dwordx4 v1, s[36:39], s33 offen offset:1024 sc1 lds
  buffer_load_dwordx4 v1, s[36:39], s33 offen offset:2048 sc1 lds
  buffer_load_dwordx4 v1, s[36:39], s33 offen offset:3072 sc1 lds
  s_add_u32 s65, s81, 2
  s_and_b32 s65, s65, 3
  s_xor_b32 s66, s81, 0
  s_and_b32 s66, s66, 4
  s_or_b32 s65, s65, s66
  s_lshl_b32 s65, s65, 1
  s_lshl_b32 s66, s65, 7
  s_add_u32 s33, s66, 0x0
  s_add_u32 m0, s34, 0x4000
  s_nop 0
  buffer_load_dwordx4 v5, s[56:59], s33 offen lds
  s_add_u32 s33, s66, 0x20000
  s_add_u32 m0, s34, 0x5000
  s_nop 0
  buffer_load_dwordx4 v5, s[56:59], s33 offen lds
  s_add_u32 s33, s66, 0x40000
  s_add_u32 m0, s34, 0x6000
  s_nop 0
  buffer_load_dwordx4 v5, s[56:59], s33 offen lds
  s_add_u32 s33, s66, 0x60000
  s_add_u32 m0, s34, 0x7000
  s_nop 0
  buffer_load_dwordx4 v5, s[56:59], s33 offen lds
  s_add_u32 s33, s66, 0x80000
  s_add_u32 m0, s34, 0x8000
  s_nop 0
  buffer_load_dwordx4 v5, s[56:59], s33 offen lds
  s_add_u32 s33, s66, 0xa0000
  s_add_u32 m0, s34, 0x9000
  s_nop 0
  buffer_load_dwordx4 v5, s[56:59], s33 offen lds
  s_add_u32 s33, s66, 0xc0000
  s_add_u32 m0, s34, 0xa000
  s_nop 0
  buffer_load_dwordx4 v5, s[56:59], s33 offen lds
  s_add_u32 s33, s66, 0xe0000
  s_add_u32 m0, s34, 0xb000
  s_nop 0
  buffer_load_dwordx4 v5, s[56:59], s33 offen lds
  s_waitcnt vmcnt(12)
  s_barrier
  s_add_u32 s65, s81, 2
  s_and_b32 s65, s65, 3
  s_xor_b32 s66, s81, 0
  s_and_b32 s66, s66, 4
  s_or_b32 s65, s65, s66
  s_lshl_b32 s65, s65, 1
  s_add_u32 s65, s65, 1
  s_lshl_b32 s33, s65, 16
  s_add_u32 s33, s33, s60
  s_add_u32 m0, s35, 0xc000
  s_nop 0
  buffer_load_dwordx4 v1, s[36:39], s33 offen offset:0 sc1 lds
  buffer_load_dwordx4 v1, s[36:39], s33 offen offset:1024 sc1 lds
  buffer_load_dwordx4 v1, s[36:39], s33 offen offset:2048 sc1 lds
  buffer_load_dwordx4 v1, s[36:39], s33 offen offset:3072 sc1 lds
  s_add_u32 s65, s81, 2
  s_and_b32 s65, s65, 3
  s_xor_b32 s66, s81, 0
  s_and_b32 s66, s66, 4
  s_or_b32 s65, s65, s66
  s_lshl_b32 s65, s65, 1
  s_add_u32 s65, s65, 1
  s_lshl_b32 s66, s65, 7
  s_add_u32 s33, s66, 0x0
  s_add_u32 m0, s34, 0x10000
  s_nop 0
  buffer_load_dwordx4 v5, s[56:59], s33 offen lds
  s_add_u32 s33, s66, 0x20000
  s_add_u32 m0, s34, 0x11000
  s_nop 0
  buffer_load_dwordx4 v5, s[56:59], s33 offen lds
  s_add_u32 s33, s66, 0x40000
  s_add_u32 m0, s34, 0x12000
  s_nop 0
  buffer_load_dwordx4 v5, s[56:59], s33 offen lds
  s_add_u32 s33, s66, 0x60000
  s_add_u32 m0, s34, 0x13000
  s_nop 0
  buffer_load_dwordx4 v5, s[56:59], s33 offen lds
  s_add_u32 s33, s66, 0x80000
  s_add_u32 m0, s34, 0x14000
  s_nop 0
  buffer_load_dwordx4 v5, s[56:59], s33 offen lds
  s_add_u32 s33, s66, 0xa0000
  s_add_u32 m0, s34, 0x15000
  s_nop 0
  buffer_load_dwordx4 v5, s[56:59], s33 offen lds
  s_add_u32 s33, s66, 0xc0000
  s_add_u32 m0, s34, 0x16000
  s_nop 0
  buffer_load_dwordx4 v5, s[56:59], s33 offen lds
  s_add_u32 s33, s66, 0xe0000
  s_add_u32 m0, s34, 0x17000
  s_nop 0
  buffer_load_dwordx4 v5, s[56:59], s33 offen lds
  s_waitcnt vmcnt(12)
  s_barrier
  s_add_u32 s65, s81, 3
  s_and_b32 s65, s65, 3
  s_xor_b32 s66, s81, 0
  s_and_b32 s66, s66, 4
  s_or_b32 s65, s65, s66
  s_lshl_b32 s65, s65, 1
  s_lshl_b32 s33, s65, 16
  s_add_u32 s33, s33, s60
  s_add_u32 m0, s35, 0x18000
  s_nop 0
  buffer_load_dwordx4 v1, s[36:39], s33 offen offset:0 sc1 lds
  buffer_load_dwordx4 v1, s[36:39], s33 offen offset:1024 sc1 lds
  buffer_load_dwordx4 v1, s[36:39], s33 offen offset:2048 sc1 lds
  buffer_load_dwordx4 v1, s[36:39], s33 offen offset:3072 sc1 lds
  s_add_u32 s65, s81, 3
  s_and_b32 s65, s65, 3
  s_xor_b32 s66, s81, 0
  s_and_b32 s66, s66, 4
  s_or_b32 s65, s65, s66
  s_lshl_b32 s65, s65, 1
  s_lshl_b32 s66, s65, 7
  s_add_u32 s33, s66, 0x0
  s_add_u32 m0, s34, 0x1c000
  s_nop 0
  buffer_load_dwordx4 v5, s[56:59], s33 offen lds
  s_add_u32 s33, s66, 0x20000
  s_add_u32 m0, s34, 0x1d000
  s_nop 0
  buffer_load_dwordx4 v5, s[56:59], s33 offen lds
  s_add_u32 s33, s66, 0x40000
  s_add_u32 m0, s34, 0x1e000
  s_nop 0
  buffer_load_dwordx4 v5, s[56:59], s33 offen lds
  s_add_u32 s33, s66, 0x60000
  s_add_u32 m0, s34, 0x1f000
  s_nop 0
  buffer_load_dwordx4 v5, s[56:59], s33 offen lds
  s_add_u32 s33, s66, 0x80000
  s_add_u32 m0, s34, 0x20000
  s_nop 0
  buffer_load_dwordx4 v5, s[56:59], s33 offen lds
  s_add_u32 s33, s66, 0xa0000
  s_add_u32 m0, s34, 0x21000
  s_nop 0
  buffer_load_dwordx4 v5, s[56:59], s33 offen lds
  s_add_u32 s33, s66, 0xc0000
  s_add_u32 m0, s34, 0x22000
  s_nop 0
  buffer_load_dwordx4 v5, s[56:59], s33 offen lds
  s_add_u32 s33, s66, 0xe0000
  s_add_u32 m0, s34, 0x23000
  s_nop 0
  buffer_load_dwordx4 v5, s[56:59], s33 offen lds
  s_waitcnt vmcnt(12)
  s_barrier
  s_add_u32 s65, s81, 3
  s_and_b32 s65, s65, 3
  s_xor_b32 s66, s81, 0
  s_and_b32 s66, s66, 4
  s_or_b32 s65, s65, s66
  s_lshl_b32 s65, s65, 1
  s_add_u32 s65, s65, 1
  s_lshl_b32 s33, s65, 16
  s_add_u32 s33, s33, s60
  s_add_u32 m0, s35, 0x0
  s_nop 0
  buffer_load_dwordx4 v1, s[36:39], s33 offen offset:0 sc1 lds
  buffer_load_dwordx4 v1, s[36:39], s33 offen offset:1024 sc1 lds
  buffer_load_dwordx4 v1, s[36:39], s33 offen offset:2048 sc1 lds
  buffer_load_dwordx4 v1, s[36:39], s33 offen offset:3072 sc1 lds
  s_add_u32 s65, s81, 3
  s_and_b32 s65, s65, 3
  s_xor_b32 s66, s81, 0
  s_and_b32 s66, s66, 4
  s_or_b32 s65, s65, s66
  s_lshl_b32 s65, s65, 1
  s_add_u32 s65, s65, 1
  s_lshl_b32 s66, s65, 7
  s_add_u32 s33, s66, 0x0
  s_add_u32 m0, s34, 0x4000
  s_nop 0
  buffer_load_dwordx4 v5, s[56:59], s33 offen lds
  s_add_u32 s33, s66, 0x20000
  s_add_u32 m0, s34, 0x5000
  s_nop 0
  buffer_load_dwordx4 v5, s[56:59], s33 offen lds
  s_add_u32 s33, s66, 0x40000
  s_add_u32 m0, s34, 0x6000
  s_nop 0
  buffer_load_dwordx4 v5, s[56:59], s33 offen lds
  s_add_u32 s33, s66, 0x60000
  s_add_u32 m0, s34, 0x7000
  s_nop 0
  buffer_load_dwordx4 v5, s[56:59], s33 offen lds
  s_add_u32 s33, s66, 0x80000
  s_add_u32 m0, s34, 0x8000
  s_nop 0
  buffer_load_dwordx4 v5, s[56:59], s33 offen lds
  s_add_u32 s33, s66, 0xa0000
  s_add_u32 m0, s34, 0x9000
  s_nop 0
  buffer_load_dwordx4 v5, s[56:59], s33 offen lds
  s_add_u32 s33, s66, 0xc0000
  s_add_u32 m0, s34, 0xa000
  s_nop 0
  buffer_load_dwordx4 v5, s[56:59], s33 offen lds
  s_add_u32 s33, s66, 0xe0000
  s_add_u32 m0, s34, 0xb000
  s_nop 0
  buffer_load_dwordx4 v5, s[56:59], s33 offen lds
  s_waitcnt vmcnt(12)
  s_barrier
  s_add_u32 s65, s81, 1
  s_and_b32 s65, s65, 3
  s_xor_b32 s66, s81, 4
  s_and_b32 s66, s66, 4
  s_or_b32 s65, s65, s66
  s_lshl_b32 s65, s65, 1
  s_lshl_b32 s33, s65, 16
  s_add_u32 s33, s33, s60
  s_add_u32 m0, s35, 0xc000
  s_nop 0
  buffer_load_dwordx4 v1, s[36:39], s33 offen offset:0 sc1 lds
  buffer_load_dwordx4 v1, s[36:39], s33 offen offset:1024 sc1 lds
  buffer_load_dwordx4 v1, s[36:39], s33 offen offset:2048 sc1 lds
  buffer_load_dwordx4 v1, s[36:39], s33 offen offset:3072 sc1 lds
  s_add_u32 s65, s81, 1
  s_and_b32 s65, s65, 3
  s_xor_b32 s66, s81, 4
  s_and_b32 s66, s66, 4
  s_or_b32 s65, s65, s66
  s_lshl_b32 s65, s65, 1
  s_lshl_b32 s66, s65, 7
  s_add_u32 s33, s66, 0x0
  s_add_u32 m0, s34, 0x10000
  s_nop 0
  buffer_load_dwordx4 v5, s[56:59], s33 offen lds
  s_add_u32 s33, s66, 0x20000
  s_add_u32 m0, s34, 0x11000
  s_nop 0
  buffer_load_dwordx4 v5, s[56:59], s33 offen lds
  s_add_u32 s33, s66, 0x40000
  s_add_u32 m0, s34, 0x12000
  s_nop 0
  buffer_load_dwordx4 v5, s[56:59], s33 offen lds
  s_add_u32 s33, s66, 0x60000
  s_add_u32 m0, s34, 0x13000
  s_nop 0
  buffer_load_dwordx4 v5, s[56:59], s33 offen lds
  s_add_u32 s33, s66, 0x80000
  s_add_u32 m0, s34, 0x14000
  s_nop 0
  buffer_load_dwordx4 v5, s[56:59], s33 offen lds
  s_add_u32 s33, s66, 0xa0000
  s_add_u32 m0, s34, 0x15000
  s_nop 0
  buffer_load_dwordx4 v5, s[56:59], s33 offen lds
  s_add_u32 s33, s66, 0xc0000
  s_add_u32 m0, s34, 0x16000
  s_nop 0
  buffer_load_dwordx4 v5, s[56:59], s33 offen lds
  s_add_u32 s33, s66, 0xe0000
  s_add_u32 m0, s34, 0x17000
  s_nop 0
  buffer_load_dwordx4 v5, s[56:59], s33 offen lds
  s_waitcnt vmcnt(12)
  s_barrier
  s_add_u32 s65, s81, 1
  s_and_b32 s65, s65, 3
  s_xor_b32 s66, s81, 4
  s_and_b32 s66, s66, 4
  s_or_b32 s65, s65, s66
  s_lshl_b32 s65, s65, 1
  s_add_u32 s65, s65, 1
  s_lshl_b32 s33, s65, 16
  s_add_u32 s33, s33, s60
  s_add_u32 m0, s35, 0x18000
  s_nop 0
  buffer_load_dwordx4 v1, s[36:39], s33 offen offset:0 sc1 lds
  buffer_load_dwordx4 v1, s[36:39], s33 offen offset:1024 sc1 lds
  buffer_load_dwordx4 v1, s[36:39], s33 offen offset:2048 sc1 lds
  buffer_load_dwordx4 v1, s[36:39], s33 offen offset:3072 sc1 lds
  s_add_u32 s65, s81, 1
  s_and_b32 s65, s65, 3
  s_xor_b32 s66, s81, 4
  s_and_b32 s66, s66, 4
  s_or_b32 s65, s65, s66
  s_lshl_b32 s65, s65, 1
  s_add_u32 s65, s65, 1
  s_lshl_b32 s66, s65, 7
  s_add_u32 s33, s66, 0x0
  s_add_u32 m0, s34, 0x1c000
  s_nop 0
  buffer_load_dwordx4 v5, s[56:59], s33 offen lds
  s_add_u32 s33, s66, 0x20000
  s_add_u32 m0, s34, 0x1d000
  s_nop 0
  buffer_load_dwordx4 v5, s[56:59], s33 offen lds
  s_add_u32 s33, s66, 0x40000
  s_add_u32 m0, s34, 0x1e000
  s_nop 0
  buffer_load_dwordx4 v5, s[56:59], s33 offen lds
  s_add_u32 s33, s66, 0x60000
  s_add_u32 m0, s34, 0x1f000
  s_nop 0
  buffer_load_dwordx4 v5, s[56:59], s33 offen lds
  s_add_u32 s33, s66, 0x80000
  s_add_u32 m0, s34, 0x20000
  s_nop 0
  buffer_load_dwordx4 v5, s[56:59], s33 offen lds
  s_add_u32 s33, s66, 0xa0000
  s_add_u32 m0, s34, 0x21000
  s_nop 0
  buffer_load_dwordx4 v5, s[56:59], s33 offen lds
  s_add_u32 s33, s66, 0xc0000
  s_add_u32 m0, s34, 0x22000
  s_nop 0
  buffer_load_dwordx4 v5, s[56:59], s33 offen lds
  s_add_u32 s33, s66, 0xe0000
  s_add_u32 m0, s34, 0x23000
  s_nop 0
  buffer_load_dwordx4 v5, s[56:59], s33 offen lds
  s_waitcnt vmcnt(12)
  s_barrier
  s_add_u32 s65, s81, 2
  s_and_b32 s65, s65, 3
  s_xor_b32 s66, s81, 4
  s_and_b32 s66, s66, 4
  s_or_b32 s65, s65, s66
  s_lshl_b32 s65, s65, 1
  s_lshl_b32 s33, s65, 16
  s_add_u32 s33, s33, s60
  s_add_u32 m0, s35, 0x0
  s_nop 0
  buffer_load_dwordx4 v1, s[36:39], s33 offen offset:0 sc1 lds
  buffer_load_dwordx4 v1, s[36:39], s33 offen offset:1024 sc1 lds
  buffer_load_dwordx4 v1, s[36:39], s33 offen offset:2048 sc1 lds
  buffer_load_dwordx4 v1, s[36:39], s33 offen offset:3072 sc1 lds
  s_add_u32 s65, s81, 2
  s_and_b32 s65, s65, 3
  s_xor_b32 s66, s81, 4
  s_and_b32 s66, s66, 4
  s_or_b32 s65, s65, s66
  s_lshl_b32 s65, s65, 1
  s_lshl_b32 s66, s65, 7
  s_add_u32 s33, s66, 0x0
  s_add_u32 m0, s34, 0x4000
  s_nop 0
  buffer_load_dwordx4 v5, s[56:59], s33 offen lds
  s_add_u32 s33, s66, 0x20000
  s_add_u32 m0, s34, 0x5000
  s_nop 0
  buffer_load_dwordx4 v5, s[56:59], s33 offen lds
  s_add_u32 s33, s66, 0x40000
  s_add_u32 m0, s34, 0x6000
  s_nop 0
  buffer_load_dwordx4 v5, s[56:59], s33 offen lds
  s_add_u32 s33, s66, 0x60000
  s_add_u32 m0, s34, 0x7000
  s_nop 0
  buffer_load_dwordx4 v5, s[56:59], s33 offen lds
  s_add_u32 s33, s66, 0x80000
  s_add_u32 m0, s34, 0x8000
  s_nop 0
  buffer_load_dwordx4 v5, s[56:59], s33 offen lds
  s_add_u32 s33, s66, 0xa0000
  s_add_u32 m0, s34, 0x9000
  s_nop 0
  buffer_load_dwordx4 v5, s[56:59], s33 offen lds
  s_add_u32 s33, s66, 0xc0000
  s_add_u32 m0, s34, 0xa000
  s_nop 0
  buffer_load_dwordx4 v5, s[56:59], s33 offen lds
  s_add_u32 s33, s66, 0xe0000
  s_add_u32 m0, s34, 0xb000
  s_nop 0
  buffer_load_dwordx4 v5, s[56:59], s33 offen lds
  s_waitcnt vmcnt(12)
  s_barrier
  s_add_u32 s65, s81, 2
  s_and_b32 s65, s65, 3
  s_xor_b32 s66, s81, 4
  s_and_b32 s66, s66, 4
  s_or_b32 s65, s65, s66
  s_lshl_b32 s65, s65, 1
  s_add_u32 s65, s65, 1
  s_lshl_b32 s33, s65, 16
  s_add_u32 s33, s33, s60
  s_add_u32 m0, s35, 0xc000
  s_nop 0
  buffer_load_dwordx4 v1, s[36:39], s33 offen offset:0 sc1 lds
  buffer_load_dwordx4 v1, s[36:39], s33 offen offset:1024 sc1 lds
  buffer_load_dwordx4 v1, s[36:39], s33 offen offset:2048 sc1 lds
  buffer_load_dwordx4 v1, s[36:39], s33 offen offset:3072 sc1 lds
  s_add_u32 s65, s81, 2
  s_and_b32 s65, s65, 3
  s_xor_b32 s66, s81, 4
  s_and_b32 s66, s66, 4
  s_or_b32 s65, s65, s66
  s_lshl_b32 s65, s65, 1
  s_add_u32 s65, s65, 1
  s_lshl_b32 s66, s65, 7
  s_add_u32 s33, s66, 0x0
  s_add_u32 m0, s34, 0x10000
  s_nop 0
  buffer_load_dwordx4 v5, s[56:59], s33 offen lds
  s_add_u32 s33, s66, 0x20000
  s_add_u32 m0, s34, 0x11000
  s_nop 0
  buffer_load_dwordx4 v5, s[56:59], s33 offen lds
  s_add_u32 s33, s66, 0x40000
  s_add_u32 m0, s34, 0x12000
  s_nop 0
  buffer_load_dwordx4 v5, s[56:59], s33 offen lds
  s_add_u32 s33, s66, 0x60000
  s_add_u32 m0, s34, 0x13000
  s_nop 0
  buffer_load_dwordx4 v5, s[56:59], s33 offen lds
  s_add_u32 s33, s66, 0x80000
  s_add_u32 m0, s34, 0x14000
  s_nop 0
  buffer_load_dwordx4 v5, s[56:59], s33 offen lds
  s_add_u32 s33, s66, 0xa0000
  s_add_u32 m0, s34, 0x15000
  s_nop 0
  buffer_load_dwordx4 v5, s[56:59], s33 offen lds
  s_add_u32 s33, s66, 0xc0000
  s_add_u32 m0, s34, 0x16000
  s_nop 0
  buffer_load_dwordx4 v5, s[56:59], s33 offen lds
  s_add_u32 s33, s66, 0xe0000
  s_add_u32 m0, s34, 0x17000
  s_nop 0
  buffer_load_dwordx4 v5, s[56:59], s33 offen lds
  s_waitcnt vmcnt(12)
  s_barrier
  s_add_u32 s65, s81, 3
  s_and_b32 s65, s65, 3
  s_xor_b32 s66, s81, 4
  s_and_b32 s66, s66, 4
  s_or_b32 s65, s65, s66
  s_lshl_b32 s65, s65, 1
  s_lshl_b32 s33, s65, 16
  s_add_u32 s33, s33, s60
  s_add_u32 m0, s35, 0x18000
  s_nop 0
  buffer_load_dwordx4 v1, s[36:39], s33 offen offset:0 sc1 lds
  buffer_load_dwordx4 v1, s[36:39], s33 offen offset:1024 sc1 lds
  buffer_load_dwordx4 v1, s[36:39], s33 offen offset:2048 sc1 lds
  buffer_load_dwordx4 v1, s[36:39], s33 offen offset:3072 sc1 lds
  s_add_u32 s65, s81, 3
  s_and_b32 s65, s65, 3
  s_xor_b32 s66, s81, 4
  s_and_b32 s66, s66, 4
  s_or_b32 s65, s65, s66
  s_lshl_b32 s65, s65, 1
  s_lshl_b32 s66, s65, 7
  s_add_u32 s33, s66, 0x0
  s_add_u32 m0, s34, 0x1c000
  s_nop 0
  buffer_load_dwordx4 v5, s[56:59], s33 offen lds
  s_add_u32 s33, s66, 0x20000
  s_add_u32 m0, s34, 0x1d000
  s_nop 0
  buffer_load_dwordx4 v5, s[56:59], s33 offen lds
  s_add_u32 s33, s66, 0x40000
  s_add_u32 m0, s34, 0x1e000
  s_nop 0
  buffer_load_dwordx4 v5, s[56:59], s33 offen lds
  s_add_u32 s33, s66, 0x60000
  s_add_u32 m0, s34, 0x1f000
  s_nop 0
  buffer_load_dwordx4 v5, s[56:59], s33 offen lds
  s_add_u32 s33, s66, 0x80000
  s_add_u32 m0, s34, 0x20000
  s_nop 0
  buffer_load_dwordx4 v5, s[56:59], s33 offen lds
  s_add_u32 s33, s66, 0xa0000
  s_add_u32 m0, s34, 0x21000
  s_nop 0
  buffer_load_dwordx4 v5, s[56:59], s33 offen lds
  s_add_u32 s33, s66, 0xc0000
  s_add_u32 m0, s34, 0x22000
  s_nop 0
  buffer_load_dwordx4 v5, s[56:59], s33 offen lds
  s_add_u32 s33, s66, 0xe0000
  s_add_u32 m0, s34, 0x23000
  s_nop 0
  buffer_load_dwordx4 v5, s[56:59], s33 offen lds
  s_waitcnt vmcnt(12)
  s_barrier
  s_add_u32 s65, s81, 3
  s_and_b32 s65, s65, 3
  s_xor_b32 s66, s81, 4
  s_and_b32 s66, s66, 4
  s_or_b32 s65, s65, s66
  s_lshl_b32 s65, s65, 1
  s_add_u32 s65, s65, 1
  s_lshl_b32 s33, s65, 16
  s_add_u32 s33, s33, s60
  s_add_u32 m0, s35, 0x0
  s_nop 0
  buffer_load_dwordx4 v1, s[36:39], s33 offen offset:0 sc1 lds
  buffer_load_dwordx4 v1, s[36:39], s33 offen offset:1024 sc1 lds
  buffer_load_dwordx4 v1, s[36:39], s33 offen offset:2048 sc1 lds
  buffer_load_dwordx4 v1, s[36:39], s33 offen offset:3072 sc1 lds
  s_add_u32 s65, s81, 3
  s_and_b32 s65, s65, 3
  s_xor_b32 s66, s81, 4
  s_and_b32 s66, s66, 4
  s_or_b32 s65, s65, s66
  s_lshl_b32 s65, s65, 1
  s_add_u32 s65, s65, 1
  s_lshl_b32 s66, s65, 7
  s_add_u32 s33, s66, 0x0
  s_add_u32 m0, s34, 0x4000
  s_nop 0
  buffer_load_dwordx4 v5, s[56:59], s33 offen lds
  s_add_u32 s33, s66, 0x20000
  s_add_u32 m0, s34, 0x5000
  s_nop 0
  buffer_load_dwordx4 v5, s[56:59], s33 offen lds
  s_add_u32 s33, s66, 0x40000
  s_add_u32 m0, s34, 0x6000
  s_nop 0
  buffer_load_dwordx4 v5, s[56:59], s33 offen lds
  s_add_u32 s33, s66, 0x60000
  s_add_u32 m0, s34, 0x7000
  s_nop 0
  buffer_load_dwordx4 v5, s[56:59], s33 offen lds
  s_add_u32 s33, s66, 0x80000
  s_add_u32 m0, s34, 0x8000
  s_nop 0
  buffer_load_dwordx4 v5, s[56:59], s33 offen lds
  s_add_u32 s33, s66, 0xa0000
  s_add_u32 m0, s34, 0x9000
  s_nop 0
  buffer_load_dwordx4 v5, s[56:59], s33 offen lds
  s_add_u32 s33, s66, 0xc0000
  s_add_u32 m0, s34, 0xa000
  s_nop 0
  buffer_load_dwordx4 v5, s[56:59], s33 offen lds
  s_add_u32 s33, s66, 0xe0000
  s_add_u32 m0, s34, 0xb000
  s_nop 0
  buffer_load_dwordx4 v5, s[56:59], s33 offen lds
  s_waitcnt vmcnt(12)
  s_barrier
  s_waitcnt vmcnt(0)
  s_barrier
  s_or_b32 s33, s2, s3
  s_cmp_lg_u32 s33, 0
  s_cbranch_scc1 gm_BL_done
  v_lshlrev_b32 v6, 10, v0
  v_add_u32 v6, 0x1620000, v6
  s_mov_b32 s88, 0x8000
poll2:
  buffer_load_dword v7, v6, s[36:39], 0 offen sc1
  s_waitcnt vmcnt(0)
  v_cmp_ne_u32 s[86:87], s90, v7
  s_nop 3
  s_cmp_eq_u64 s[86:87], 0
  s_cbranch_scc1 poll2_ok
  s_sleep 3
  s_sub_u32 s88, s88, 1
  s_cmp_lg_u32 s88, 0
  s_cbranch_scc1 poll2
poll2_ok:
  v_lshlrev_b32 v6, 10, v0
  v_add_u32 v6, 0x1630000, v6
  s_mov_b32 s88, 0x8000
poll3:
  buffer_load_dword v7, v6, s[36:39], 0 offen sc1
  s_waitcnt vmcnt(0)
  v_cmp_ne_u32 s[86:87], s90, v7
  s_nop 3
  s_cmp_eq_u64 s[86:87], 0
  s_cbranch_scc1 poll3_ok
  s_sleep 3
  s_sub_u32 s88, s88, 1
  s_cmp_lg_u32 s88, 0
  s_cbranch_scc1 poll3
poll3_ok:
  v_lshlrev_b32 v6, 10, v0
  v_add_u32 v6, 0x1660000, v6
  s_mov_b32 s88, 0x8000
poll4:
  buffer_load_dword v7, v6, s[36:39], 0 offen sc1
  s_waitcnt vmcnt(0)
  v_cmp_ne_u32 s[86:87], s90, v7
  s_nop 3
  s_cmp_eq_u64 s[86:87], 0
  s_cbranch_scc1 poll4_ok
  s_sleep 3
  s_sub_u32 s88, s88, 1
  s_cmp_lg_u32 s88, 0
  s_cbranch_scc1 poll4
poll4_ok:
  v_lshlrev_b32 v6, 10, v0
  v_add_u32 v6, 0x1670000, v6
  s_mov_b32 s88, 0x8000
poll5:
  buffer_load_dword v7, v6, s[36:39], 0 offen sc1
  s_waitcnt vmcnt(0)
  v_cmp_ne_u32 s[86:87], s90, v7
  s_nop 3
  s_cmp_eq_u64 s[86:87], 0
  s_cbranch_scc1 poll5_ok
  s_sleep 3
  s_sub_u32 s88, s88, 1
  s_cmp_lg_u32 s88, 0
  s_cbranch_scc1 poll5
poll5_ok:
  s_mov_b32 s33, 0x1600000
  s_waitcnt vmcnt(0)
  v_mov_b32 v12, s90
  v_mov_b32 v13, 0
  s_mov_b64 exec, 1
  buffer_store_dword v12, v13, s[36:39], s33 offen sc1
  s_mov_b64 exec, -1
gm_BL_done:
  s_endpgm
gm_typeA:
  s_cmp_ge_u32 s3, 8
  s_cbranch_scc1 gm_AL
gm_AC:
  s_and_b32 s77, s4, 3
  s_lshr_b32 s78, s4, 2
  s_mov_b32 s63, 0x20000
  s_mov_b64 s[60:61], 0
  s_mov_b32 s62, 0
  s_mov_b32 s75, 0
  v_and_b32 v150, 15, v0
  v_lshrrev_b32 v151, 4, v0
  s_cmp_eq_u32 s3, 4
  s_cbranch_scc1 gm_AC_t4
  s_cmp_gt_u32 s3, 5
  s_cbranch_scc1 gm_AC_t6
  s_cmp_gt_u32 s3, 4
  s_cbranch_scc1 gm_AC_tj
  v_lshlrev_b32 v150, 10, v150
  v_lshl_add_u32 v150, v151, 7, v150
  s_lshl_b32 s75, s5, 14
  s_and_b32 s33, s3, 2
  s_lshl_b32 s33, s33, 8
  s_add_u32 s75, s75, s33
  s_lshl_b32 s34, s77, 19
  s_bitcmp1_b32 s3, 0
  s_cselect_b32 s34, 0, s34
  s_add_u32 s75, s75, s34
  s_waitcnt lgkmcnt(0)
  s_cmp_eq_u32 s78, 0
  s_cselect_b32 s60, s20, s22
  s_cselect_b32 s61, s21, s23
  s_bitcmp1_b32 s3, 0
  s_cselect_b32 s60, s60, s8
  s_cselect_b32 s61, s61, s9
  s_cselect_b32 s62, 0x80000, s63
  s_cselect_b32 s33, 0, 0x1e0000
  s_add_u32 s62, s62, s33
  s_cmp_ge_u32 s3, 2
  s_cbranch_scc1 gm_AC_tj
  buffer_load_dword v152, v150, s[60:63], s75 offen
  s_branch gm_AC_tj
gm_AC_t4:
  s_getpc_b64 s[60:61]
gm_AC_pc:
  s_sub_u32 s60, s60, gm_AC_pc-CODE_START
  s_subb_u32 s61, s61, 0
  s_mov_b32 s62, CODE_END-CODE_START
  v_lshlrev_b32 v150, 12, v0
  s_lshl_b32 s75, s5, 7
  s_mov_b64 exec, 0xffffffff
  s_waitcnt vmcnt(0)
  buffer_load_dword v152, v150, s[60:63], s75 offen
  s_mov_b64 exec, -1
  s_branch gm_AC_tj
gm_AC_t6:
  v_mul_u32_u24 v150, 3072, v151
  v_bfe_u32 v151, v0, 2, 2
  v_min_u32 v151, 2, v151
  v_lshl_add_u32 v150, v151, 10, v150
  v_and_b32 v151, 3, v0
  v_lshl_add_u32 v150, v151, 7, v150
  s_mul_i32 s75, s6, 12288
  s_lshl_b32 s33, s78, 9
  s_add_u32 s75, s75, s33
  s_mov_b32 s62, 0x180000
  s_waitcnt lgkmcnt(0)
  s_mov_b32 s60, s10
  s_mov_b32 s61, s11
  s_cmp_eq_u32 s3, 7
  s_cbranch_scc1 gm_AC_t7
  s_waitcnt vmcnt(0)
  buffer_load_dword v152, v150, s[60:63], s75 offen
  s_add_u32 s75, s75, 0x30000
  buffer_load_dword v153, v150, s[60:63], s75 offen
  s_add_u32 s75, s75, 0x30000
  buffer_load_dword v154, v150, s[60:63], s75 offen
  s_add_u32 s75, s75, 0x30000
  buffer_load_dword v155, v150, s[60:63], s75 offen
  s_add_u32 s75, s75, 0x30000
  s_branch gm_AC_tj
gm_AC_t7:
  s_add_u32 s75, s75, 0xc0000
gm_AC_tj:
  v_lshrrev_b32 v144, 5, v0
  v_bfe_u32 v145, v0, 1, 3
  v_xor_b32 v145, v144, v145
  v_and_b32 v146, 31, v0
  v_lshlrev_b32 v146, 7, v146
  v_xor_b32 v144, 0, v145
  v_lshl_add_u32 v2, v144, 4, v146
  v_xor_b32 v144, 2, v145
  v_lshl_add_u32 v3, v144, 4, v146
  v_xor_b32 v144, 4, v145
  v_lshl_add_u32 v4, v144, 4, v146
  v_xor_b32 v144, 6, v145
  v_lshl_add_u32 v5, v144, 4, v146
  s_sub_u32 s81, 11, s3
  s_cmp_lt_u32 s3, 4
  s_cselect_b32 s81, s3, s81
  s_lshl_b32 s33, s81, 12
  v_add_u32 v2, s33, v2
  v_add_u32 v3, s33, v3
  v_add_u32 v4, s33, v4
  v_add_u32 v5, s33, v5
  v_lshrrev_b32 v6, 5, v0
  v_lshlrev_b32 v6, 9, v6
  v_bfe_u32 v144, v0, 2, 2
  v_lshl_add_u32 v6, v144, 6, v6
  v_bfe_u32 v144, v0, 4, 1
  v_lshl_add_u32 v6, v144, 5, v6
  v_and_b32 v144, 3, v0
  v_lshl_add_u32 v6, v144, 3, v6
  v_add_u32 v6, 0x8000, v6
  s_waitcnt lgkmcnt(0)
  s_mov_b32 s36, s30
  s_mov_b32 s37, s31
  s_mov_b32 s38, 0x1700000
  s_mov_b32 s39, 0x20000
  s_add_u32 s84, s30, 0x1600000
  s_addc_u32 s85, s31, 0
  s_load_dword s90, s[84:85], 0
  s_lshl_b32 s83, s77, 1
  s_and_b32 s33, s6, 1
  s_add_u32 s83, s83, s33
  s_lshl_b32 s82, s78, 3
  s_lshr_b32 s33, s6, 1
  s_add_u32 s82, s82, s33
  s_waitcnt lgkmcnt(0)
  s_add_u32 s90, s90, 1
  v_lshrrev_b32 v136, 5, v0
  v_lshlrev_b32 v136, 8, v136
  v_and_b32 v137, 15, v0
  v_lshl_add_u32 v136, v137, 4, v136
  v_bfe_u32 v137, v0, 4, 1
  v_lshl_add_u32 v138, v137, 13, v136
  v_lshl_add_u32 v137, v137, 14, v136
  s_lshl_b32 s33, s83, 4
  s_add_u32 s33, s33, s82
  s_lshl_b32 s40, s33, 15
  s_lshl_b32 s34, s81, 10
  s_add_u32 s40, s40, s34
  s_add_u32 s41, s40, 0x2000
  s_add_u32 s42, s40, 0x4000
  s_lshl_b32 s33, s33, 3
  s_add_u32 s33, s33, s81
  s_lshl_b32 s33, s33, 7
  s_add_u32 s43, s33, 0x1660000
  s_add_u32 s80, s33, 0x1680000
  v_add_u32 v7, 0x0, v2
  v_add_u32 v8, 0x0, v3
  v_add_u32 v9, 0x0, v4
  v_add_u32 v10, 0x0, v5
  v_add_u32 v11, 0x0, v6
  s_barrier
  s_and_b32 s33, s3, 6
  s_cmp_lg_u32 s33, 2
  s_cbranch_scc1 gm_AC_f11x
  buffer_load_dword v152, v150, s[60:63], s75 offen
gm_AC_f11x:
  s_cmp_lg_u32 s3, 7
  s_cbranch_scc1 gm_AC_f11
  buffer_load_dword v152, v150, s[60:63], s75 offen
  s_add_u32 s75, s75, 0x30000
  buffer_load_dword v153, v150, s[60:63], s75 offen
  s_add_u32 s75, s75, 0x30000
  buffer_load_dword v154, v150, s[60:63], s75 offen
  s_add_u32 s75, s75, 0x30000
  buffer_load_dword v155, v150, s[60:63], s75 offen
  s_add_u32 s75, s75, 0x30000
gm_AC_f11:
  ds_read_b128 v[12:15], v7
  ds_read_b64_tr_b16 v[16:17], v11 offset:0
  ds_read_b64_tr_b16 v[18:19], v11 offset:256
  ds_read_b64_tr_b16 v[20:21], v11 offset:4096
  ds_read_b64_tr_b16 v[22:23], v11 offset:4352
  ds_read_b64_tr_b16 v[24:25], v11 offset:8192
  ds_read_b64_tr_b16 v[26:27], v11 offset:8448
  s_waitcnt lgkmcnt(4)
  v_mfma_f32_32x32x16_bf16 v[44:59], v[16:19], v[12:15], 0
  ds_read_b128 v[28:31], v8
  ds_read_b64_tr_b16 v[32:33], v11 offset:1024
  ds_read_b64_tr_b16 v[34:35], v11 offset:1280
  s_waitcnt lgkmcnt(5)
  v_mfma_f32_32x32x16_bf16 v[60:75], v[12:15], v[20:23], 0
  ds_read_b64_tr_b16 v[36:37], v11 offset:5120
  ds_read_b64_tr_b16 v[38:39], v11 offset:5376
  s_waitcnt lgkmcnt(5)
  v_mfma_f32_32x32x16_bf16 v[76:91], v[24:27], v[12:15], 0
  ds_read_b64_tr_b16 v[40:41], v11 offset:9216
  ds_read_b64_tr_b16 v[42:43], v11 offset:9472
  s_waitcnt lgkmcnt(4)
  v_mfma_f32_32x32x16_bf16 v[44:59], v[32:35], v[28:31], v[44:59]
  ds_read_b128 v[12:15], v9
  ds_read_b64_tr_b16 v[16:17], v11 offset:2048
  ds_read_b64_tr_b16 v[18:19], v11 offset:2304
  s_waitcnt lgkmcnt(5)
  v_mfma_f32_32x32x16_bf16 v[60:75], v[28:31], v[36:39], v[60:75]
  ds_read_b64_tr_b16 v[20:21], v11 offset:6144
  ds_read_b64_tr_b16 v[22:23], v11 offset:6400
  s_waitcnt lgkmcnt(5)
  v_mfma_f32_32x32x16_bf16 v[76:91], v[40:43], v[28:31], v[76:91]
  ds_read_b64_tr_b16 v[24:25], v11 offset:10240
  ds_read_b64_tr_b16 v[26:27], v11 offset:10496
  s_waitcnt lgkmcnt(4)
  v_mfma_f32_32x32x16_bf16 v[44:59], v[16:19], v[12:15], v[44:59]
  ds_read_b128 v[28:31], v10
  ds_read_b64_tr_b16 v[32:33], v11 offset:3072
  ds_read_b64_tr_b16 v[34:35], v11 offset:3328
  s_waitcnt lgkmcnt(5)
  v_mfma_f32_32x32x16_bf16 v[60:75], v[12:15], v[20:23], v[60:75]
  ds_read_b64_tr_b16 v[36:37], v11 offset:7168
  ds_read_b64_tr_b16 v[38:39], v11 offset:7424
  s_waitcnt lgkmcnt(5)
  v_mfma_f32_32x32x16_bf16 v[76:91], v[24:27], v[12:15], v[76:91]
  ds_read_b64_tr_b16 v[40:41], v11 offset:11264
  ds_read_b64_tr_b16 v[42:43], v11 offset:11520
  v_add_u32 v7, 0xb000, v2
  v_add_u32 v8, 0xb000, v3
  v_add_u32 v9, 0xb000, v4
  v_add_u32 v10, 0xb000, v5
  v_add_u32 v11, 0xb000, v6
  s_waitcnt lgkmcnt(0)
  s_barrier
  v_mfma_f32_32x32x16_bf16 v[44:59], v[32:35], v[28:31], v[44:59]
  ds_read_b128 v[12:15], v7
  ds_read_b64_tr_b16 v[16:17], v11 offset:0
  ds_read_b64_tr_b16 v[18:19], v11 offset:256
  v_mfma_f32_32x32x16_bf16 v[60:75], v[28:31], v[36:39], v[60:75]
  ds_read_b64_tr_b16 v[20:21], v11 offset:4096
  ds_read_b64_tr_b16 v[22:23], v11 offset:4352
  v_mfma_f32_32x32x16_bf16 v[76:91], v[40:43], v[28:31], v[76:91]
  ds_read_b64_tr_b16 v[24:25], v11 offset:8192
  ds_read_b64_tr_b16 v[26:27], v11 offset:8448
  s_waitcnt lgkmcnt(4)
  v_mfma_f32_32x32x16_bf16 v[44:59], v[16:19], v[12:15], v[44:59]
  ds_read_b128 v[28:31], v8
  ds_read_b64_tr_b16 v[32:33], v11 offset:1024
  ds_read_b64_tr_b16 v[34:35], v11 offset:1280
  s_waitcnt lgkmcnt(5)
  v_mfma_f32_32x32x16_bf16 v[60:75], v[12:15], v[20:23], v[60:75]
  ds_read_b64_tr_b16 v[36:37], v11 offset:5120
  ds_read_b64_tr_b16 v[38:39], v11 offset:5376
  s_waitcnt lgkmcnt(5)
  v_mfma_f32_32x32x16_bf16 v[76:91], v[24:27], v[12:15], v[76:91]
  ds_read_b64_tr_b16 v[40:41], v11 offset:9216
  ds_read_b64_tr_b16 v[42:43], v11 offset:9472
  s_waitcnt lgkmcnt(4)
  v_mfma_f32_32x32x16_bf16 v[44:59], v[32:35], v[28:31], v[44:59]
  ds_read_b128 v[12:15], v9
  ds_read_b64_tr_b16 v[16:17], v11 offset:2048
  ds_read_b64_tr_b16 v[18:19], v11 offset:2304
  s_waitcnt lgkmcnt(5)
  v_mfma_f32_32x32x16_bf16 v[60:75], v[28:31], v[36:39], v[60:75]
  ds_read_b64_tr_b16 v[20:21], v11 offset:6144
  ds_read_b64_tr_b16 v[22:23], v11 offset:6400
  s_waitcnt lgkmcnt(5)
  v_mfma_f32_32x32x16_bf16 v[76:91], v[40:43], v[28:31], v[76:91]
  ds_read_b64_tr_b16 v[24:25], v11 offset:10240
  ds_read_b64_tr_b16 v[26:27], v11 offset:10496
  s_waitcnt lgkmcnt(4)
  v_mfma_f32_32x32x16_bf16 v[44:59], v[16:19], v[12:15], v[44:59]
  ds_read_b128 v[28:31], v10
  ds_read_b64_tr_b16 v[32:33], v11 offset:3072
  ds_read_b64_tr_b16 v[34:35], v11 offset:3328
  s_waitcnt lgkmcnt(5)
  v_mfma_f32_32x32x16_bf16 v[60:75], v[12:15], v[20:23], v[60:75]
  ds_read_b64_tr_b16 v[36:37], v11 offset:7168
  ds_read_b64_tr_b16 v[38:39], v11 offset:7424
  s_waitcnt lgkmcnt(5)
  v_mfma_f32_32x32x16_bf16 v[76:91], v[24:27], v[12:15], v[76:91]
  ds_read_b64_tr_b16 v[40:41], v11 offset:11264
  ds_read_b64_tr_b16 v[42:43], v11 offset:11520
  v_add_u32 v7, 0x16000, v2
  v_add_u32 v8, 0x16000, v3
  v_add_u32 v9, 0x16000, v4
  v_add_u32 v10, 0x16000, v5
  v_add_u32 v11, 0x16000, v6
  s_waitcnt lgkmcnt(0)
  s_barrier
  v_mfma_f32_32x32x16_bf16 v[44:59], v[32:35], v[28:31], v[44:59]
  ds_read_b128 v[12:15], v7
  ds_read_b64_tr_b16 v[16:17], v11 offset:0
  ds_read_b64_tr_b16 v[18:19], v11 offset:256
  v_mfma_f32_32x32x16_bf16 v[60:75], v[28:31], v[36:39], v[60:75]
  ds_read_b64_tr_b16 v[20:21], v11 offset:4096
  ds_read_b64_tr_b16 v[22:23], v11 offset:4352
  v_mfma_f32_32x32x16_bf16 v[76:91], v[40:43], v[28:31], v[76:91]
  ds_read_b64_tr_b16 v[24:25], v11 offset:8192
  ds_read_b64_tr_b16 v[26:27], v11 offset:8448
  s_waitcnt lgkmcnt(4)
  v_mfma_f32_32x32x16_bf16 v[44:59], v[16:19], v[12:15], v[44:59]
  ds_read_b128 v[28:31], v8
  ds_read_b64_tr_b16 v[32:33], v11 offset:1024
  ds_read_b64_tr_b16 v[34:35], v11 offset:1280
  s_waitcnt lgkmcnt(5)
  v_mfma_f32_32x32x16_bf16 v[60:75], v[12:15], v[20:23], v[60:75]
  ds_read_b64_tr_b16 v[36:37], v11 offset:5120
  ds_read_b64_tr_b16 v[38:39], v11 offset:5376
  s_waitcnt lgkmcnt(5)
  v_mfma_f32_32x32x16_bf16 v[76:91], v[24:27], v[12:15], v[76:91]
  ds_read_b64_tr_b16 v[40:41], v11 offset:9216
  ds_read_b64_tr_b16 v[42:43], v11 offset:9472
  s_waitcnt lgkmcnt(4)
  v_mfma_f32_32x32x16_bf16 v[44:59], v[32:35], v[28:31], v[44:59]
  ds_read_b128 v[12:15], v9
  ds_read_b64_tr_b16 v[16:17], v11 offset:2048
  ds_read_b64_tr_b16 v[18:19], v11 offset:2304
  s_waitcnt lgkmcnt(5)
  v_mfma_f32_32x32x16_bf16 v[60:75], v[28:31], v[36:39], v[60:75]
  ds_read_b64_tr_b16 v[20:21], v11 offset:6144
  ds_read_b64_tr_b16 v[22:23], v11 offset:6400
  s_waitcnt lgkmcnt(5)
  v_mfma_f32_32x32x16_bf16 v[76:91], v[40:43], v[28:31], v[76:91]
  ds_read_b64_tr_b16 v[24:25], v11 offset:10240
  ds_read_b64_tr_b16 v[26:27], v11 offset:10496
  s_waitcnt lgkmcnt(4)
  v_mfma_f32_32x32x16_bf16 v[44:59], v[16:19], v[12:15], v[44:59]
  ds_read_b128 v[28:31], v10
  ds_read_b64_tr_b16 v[32:33], v11 offset:3072
  ds_read_b64_tr_b16 v[34:35], v11 offset:3328
  s_waitcnt lgkmcnt(5)
  v_mfma_f32_32x32x16_bf16 v[60:75], v[12:15], v[20:23], v[60:75]
  ds_read_b64_tr_b16 v[36:37], v11 offset:7168
  ds_read_b64_tr_b16 v[38:39], v11 offset:7424
  s_waitcnt lgkmcnt(5)
  v_mfma_f32_32x32x16_bf16 v[76:91], v[24:27], v[12:15], v[76:91]
  ds_read_b64_tr_b16 v[40:41], v11 offset:11264
  ds_read_b64_tr_b16 v[42:43], v11 offset:11520
  v_add_u32 v7, 0x0, v2
  v_add_u32 v8, 0x0, v3
  v_add_u32 v9, 0x0, v4
  v_add_u32 v10, 0x0, v5
  v_add_u32 v11, 0x0, v6
  s_waitcnt lgkmcnt(0)
  s_barrier
  v_mfma_f32_32x32x16_bf16 v[44:59], v[32:35], v[28:31], v[44:59]
  ds_read_b128 v[12:15], v7
  ds_read_b64_tr_b16 v[16:17], v11 offset:0
  ds_read_b64_tr_b16 v[18:19], v11 offset:256
  v_mfma_f32_32x32x16_bf16 v[60:75], v[28:31], v[36:39], v[60:75]
  ds_read_b64_tr_b16 v[20:21], v11 offset:4096
  ds_read_b64_tr_b16 v[22:23], v11 offset:4352
  v_mfma_f32_32x32x16_bf16 v[76:91], v[40:43], v[28:31], v[76:91]
  ds_read_b64_tr_b16 v[24:25], v11 offset:8192
  ds_read_b64_tr_b16 v[26:27], v11 offset:8448
  s_waitcnt lgkmcnt(4)
  v_mfma_f32_32x32x16_bf16 v[44:59], v[16:19], v[12:15], v[44:59]
  ds_read_b128 v[28:31], v8
  ds_read_b64_tr_b16 v[32:33], v11 offset:1024
  ds_read_b64_tr_b16 v[34:35], v11 offset:1280
  s_waitcnt lgkmcnt(5)
  v_mfma_f32_32x32x16_bf16 v[60:75], v[12:15], v[20:23], v[60:75]
  ds_read_b64_tr_b16 v[36:37], v11 offset:5120
  ds_read_b64_tr_b16 v[38:39], v11 offset:5376
  s_waitcnt lgkmcnt(5)
  v_mfma_f32_32x32x16_bf16 v[76:91], v[24:27], v[12:15], v[76:91]
  ds_read_b64_tr_b16 v[40:41], v11 offset:9216
  ds_read_b64_tr_b16 v[42:43], v11 offset:9472
  s_waitcnt lgkmcnt(4)
  v_mfma_f32_32x32x16_bf16 v[44:59], v[32:35], v[28:31], v[44:59]
  ds_read_b128 v[12:15], v9
  ds_read_b64_tr_b16 v[16:17], v11 offset:2048
  ds_read_b64_tr_b16 v[18:19], v11 offset:2304
  s_waitcnt lgkmcnt(5)
  v_mfma_f32_32x32x16_bf16 v[60:75], v[28:31], v[36:39], v[60:75]
  ds_read_b64_tr_b16 v[20:21], v11 offset:6144
  ds_read_b64_tr_b16 v[22:23], v11 offset:6400
  s_waitcnt lgkmcnt(5)
  v_mfma_f32_32x32x16_bf16 v[76:91], v[40:43], v[28:31], v[76:91]
  ds_read_b64_tr_b16 v[24:25], v11 offset:10240
  ds_read_b64_tr_b16 v[26:27], v11 offset:10496
  s_waitcnt lgkmcnt(4)
  v_mfma_f32_32x32x16_bf16 v[44:59], v[16:19], v[12:15], v[44:59]
  ds_read_b128 v[28:31], v10
  ds_read_b64_tr_b16 v[32:33], v11 offset:3072
  ds_read_b64_tr_b16 v[34:35], v11 offset:3328
  s_waitcnt lgkmcnt(5)
  v_mfma_f32_32x32x16_bf16 v[60:75], v[12:15], v[20:23], v[60:75]
  ds_read_b64_tr_b16 v[36:37], v11 offset:7168
  ds_read_b64_tr_b16 v[38:39], v11 offset:7424
  s_waitcnt lgkmcnt(5)
  v_mfma_f32_32x32x16_bf16 v[76:91], v[24:27], v[12:15], v[76:91]
  ds_read_b64_tr_b16 v[40:41], v11 offset:11264
  ds_read_b64_tr_b16 v[42:43], v11 offset:11520
  v_add_u32 v7, 0xb000, v2
  v_add_u32 v8, 0xb000, v3
  v_add_u32 v9, 0xb000, v4
  v_add_u32 v10, 0xb000, v5
  v_add_u32 v11, 0xb000, v6
  s_waitcnt lgkmcnt(0)
  s_barrier
  v_mfma_f32_32x32x16_bf16 v[44:59], v[32:35], v[28:31], v[44:59]
  ds_read_b128 v[12:15], v7
  ds_read_b64_tr_b16 v[16:17], v11 offset:0
  ds_read_b64_tr_b16 v[18:19], v11 offset:256
  v_mfma_f32_32x32x16_bf16 v[60:75], v[28:31], v[36:39], v[60:75]
  ds_read_b64_tr_b16 v[20:21], v11 offset:4096
  ds_read_b64_tr_b16 v[22:23], v11 offset:4352
  v_mfma_f32_32x32x16_bf16 v[76:91], v[40:43], v[28:31], v[76:91]
  ds_read_b64_tr_b16 v[24:25], v11 offset:8192
  ds_read_b64_tr_b16 v[26:27], v11 offset:8448
  s_waitcnt lgkmcnt(4)
  v_mfma_f32_32x32x16_bf16 v[44:59], v[16:19], v[12:15], v[44:59]
  ds_read_b128 v[28:31], v8
  ds_read_b64_tr_b16 v[32:33], v11 offset:1024
  ds_read_b64_tr_b16 v[34:35], v11 offset:1280
  s_waitcnt lgkmcnt(5)
  v_mfma_f32_32x32x16_bf16 v[60:75], v[12:15], v[20:23], v[60:75]
  ds_read_b64_tr_b16 v[36:37], v11 offset:5120
  ds_read_b64_tr_b16 v[38:39], v11 offset:5376
  s_waitcnt lgkmcnt(5)
  v_mfma_f32_32x32x16_bf16 v[76:91], v[24:27], v[12:15], v[76:91]
  ds_read_b64_tr_b16 v[40:41], v11 offset:9216
  ds_read_b64_tr_b16 v[42:43], v11 offset:9472
  s_waitcnt lgkmcnt(4)
  v_mfma_f32_32x32x16_bf16 v[44:59], v[32:35], v[28:31], v[44:59]
  ds_read_b128 v[12:15], v9
  ds_read_b64_tr_b16 v[16:17], v11 offset:2048
  ds_read_b64_tr_b16 v[18:19], v11 offset:2304
  s_waitcnt lgkmcnt(5)
  v_mfma_f32_32x32x16_bf16 v[60:75], v[28:31], v[36:39], v[60:75]
  ds_read_b64_tr_b16 v[20:21], v11 offset:6144
  ds_read_b64_tr_b16 v[22:23], v11 offset:6400
  s_waitcnt lgkmcnt(5)
  v_mfma_f32_32x32x16_bf16 v[76:91], v[40:43], v[28:31], v[76:91]
  ds_read_b64_tr_b16 v[24:25], v11 offset:10240
  ds_read_b64_tr_b16 v[26:27], v11 offset:10496
  s_waitcnt lgkmcnt(4)
  v_mfma_f32_32x32x16_bf16 v[44:59], v[16:19], v[12:15], v[44:59]
  ds_read_b128 v[28:31], v10
  ds_read_b64_tr_b16 v[32:33], v11 offset:3072
  ds_read_b64_tr_b16 v[34:35], v11 offset:3328
  s_waitcnt lgkmcnt(5)
  v_mfma_f32_32x32x16_bf16 v[60:75], v[12:15], v[20:23], v[60:75]
  ds_read_b64_tr_b16 v[36:37], v11 offset:7168
  ds_read_b64_tr_b16 v[38:39], v11 offset:7424
  s_waitcnt lgkmcnt(5)
  v_mfma_f32_32x32x16_bf16 v[76:91], v[24:27], v[12:15], v[76:91]
  ds_read_b64_tr_b16 v[40:41], v11 offset:11264
  ds_read_b64_tr_b16 v[42:43], v11 offset:11520
  v_add_u32 v7, 0x16000, v2
  v_add_u32 v8, 0x16000, v3
  v_add_u32 v9, 0x16000, v4
  v_add_u32 v10, 0x16000, v5
  v_add_u32 v11, 0x16000, v6
  s_waitcnt lgkmcnt(0)
  s_barrier
  v_mfma_f32_32x32x16_bf16 v[44:59], v[32:35], v[28:31], v[44:59]
  ds_read_b128 v[12:15], v7
  ds_read_b64_tr_b16 v[16:17], v11 offset:0
  ds_read_b64_tr_b16 v[18:19], v11 offset:256
  v_mfma_f32_32x32x16_bf16 v[60:75], v[28:31], v[36:39], v[60:75]
  ds_read_b64_tr_b16 v[20:21], v11 offset:4096
  ds_read_b64_tr_b16 v[22:23], v11 offset:4352
  v_mfma_f32_32x32x16_bf16 v[76:91], v[40:43], v[28:31], v[76:91]
  ds_read_b64_tr_b16 v[24:25], v11 offset:8192
  ds_read_b64_tr_b16 v[26:27], v11 offset:8448
  s_waitcnt lgkmcnt(4)
  v_mfma_f32_32x32x16_bf16 v[44:59], v[16:19], v[12:15], v[44:59]
  ds_read_b128 v[28:31], v8
  ds_read_b64_tr_b16 v[32:33], v11 offset:1024
  ds_read_b64_tr_b16 v[34:35], v11 offset:1280
  s_waitcnt lgkmcnt(5)
  v_mfma_f32_32x32x16_bf16 v[60:75], v[12:15], v[20:23], v[60:75]
  ds_read_b64_tr_b16 v[36:37], v11 offset:5120
  ds_read_b64_tr_b16 v[38:39], v11 offset:5376
  s_waitcnt lgkmcnt(5)
  v_mfma_f32_32x32x16_bf16 v[76:91], v[24:27], v[12:15], v[76:91]
  ds_read_b64_tr_b16 v[40:41], v11 offset:9216
  ds_read_b64_tr_b16 v[42:43], v11 offset:9472
  s_waitcnt lgkmcnt(4)
  v_mfma_f32_32x32x16_bf16 v[44:59], v[32:35], v[28:31], v[44:59]
  ds_read_b128 v[12:15], v9
  ds_read_b64_tr_b16 v[16:17], v11 offset:2048
  ds_read_b64_tr_b16 v[18:19], v11 offset:2304
  s_waitcnt lgkmcnt(5)
  v_mfma_f32_32x32x16_bf16 v[60:75], v[28:31], v[36:39], v[60:75]
  ds_read_b64_tr_b16 v[20:21], v11 offset:6144
  ds_read_b64_tr_b16 v[22:23], v11 offset:6400
  s_waitcnt lgkmcnt(5)
  v_mfma_f32_32x32x16_bf16 v[76:91], v[40:43], v[28:31], v[76:91]
  ds_read_b64_tr_b16 v[24:25], v11 offset:10240
  ds_read_b64_tr_b16 v[26:27], v11 offset:10496
  s_waitcnt lgkmcnt(4)
  v_mfma_f32_32x32x16_bf16 v[44:59], v[16:19], v[12:15], v[44:59]
  ds_read_b128 v[28:31], v10
  ds_read_b64_tr_b16 v[32:33], v11 offset:3072
  ds_read_b64_tr_b16 v[34:35], v11 offset:3328
  s_waitcnt lgkmcnt(5)
  v_mfma_f32_32x32x16_bf16 v[60:75], v[12:15], v[20:23], v[60:75]
  ds_read_b64_tr_b16 v[36:37], v11 offset:7168
  ds_read_b64_tr_b16 v[38:39], v11 offset:7424
  s_waitcnt lgkmcnt(5)
  v_mfma_f32_32x32x16_bf16 v[76:91], v[24:27], v[12:15], v[76:91]
  ds_read_b64_tr_b16 v[40:41], v11 offset:11264
  ds_read_b64_tr_b16 v[42:43], v11 offset:11520
  v_add_u32 v7, 0x0, v2
  v_add_u32 v8, 0x0, v3
  v_add_u32 v9, 0x0, v4
  v_add_u32 v10, 0x0, v5
  v_add_u32 v11, 0x0, v6
  s_waitcnt lgkmcnt(0)
  s_barrier
  v_mfma_f32_32x32x16_bf16 v[44:59], v[32:35], v[28:31], v[44:59]
  ds_read_b128 v[12:15], v7
  ds_read_b64_tr_b16 v[16:17], v11 offset:0
  ds_read_b64_tr_b16 v[18:19], v11 offset:256
  v_mfma_f32_32x32x16_bf16 v[60:75], v[28:31], v[36:39], v[60:75]
  ds_read_b64_tr_b16 v[20:21], v11 offset:4096
  ds_read_b64_tr_b16 v[22:23], v11 offset:4352
  v_mfma_f32_32x32x16_bf16 v[76:91], v[40:43], v[28:31], v[76:91]
  ds_read_b64_tr_b16 v[24:25], v11 offset:8192
  ds_read_b64_tr_b16 v[26:27], v11 offset:8448
  s_waitcnt lgkmcnt(4)
  v_mfma_f32_32x32x16_bf16 v[44:59], v[16:19], v[12:15], v[44:59]
  ds_read_b128 v[28:31], v8
  ds_read_b64_tr_b16 v[32:33], v11 offset:1024
  ds_read_b64_tr_b16 v[34:35], v11 offset:1280
  s_waitcnt lgkmcnt(5)
  v_mfma_f32_32x32x16_bf16 v[60:75], v[12:15], v[20:23], v[60:75]
  ds_read_b64_tr_b16 v[36:37], v11 offset:5120
  ds_read_b64_tr_b16 v[38:39], v11 offset:5376
  s_waitcnt lgkmcnt(5)
  v_mfma_f32_32x32x16_bf16 v[76:91], v[24:27], v[12:15], v[76:91]
  ds_read_b64_tr_b16 v[40:41], v11 offset:9216
  ds_read_b64_tr_b16 v[42:43], v11 offset:9472
  s_waitcnt lgkmcnt(4)
  v_mfma_f32_32x32x16_bf16 v[44:59], v[32:35], v[28:31], v[44:59]
  ds_read_b128 v[12:15], v9
  ds_read_b64_tr_b16 v[16:17], v11 offset:2048
  ds_read_b64_tr_b16 v[18:19], v11 offset:2304
  s_waitcnt lgkmcnt(5)
  v_mfma_f32_32x32x16_bf16 v[60:75], v[28:31], v[36:39], v[60:75]
  ds_read_b64_tr_b16 v[20:21], v11 offset:6144
  ds_read_b64_tr_b16 v[22:23], v11 offset:6400
  s_waitcnt lgkmcnt(5)
  v_mfma_f32_32x32x16_bf16 v[76:91], v[40:43], v[28:31], v[76:91]
  ds_read_b64_tr_b16 v[24:25], v11 offset:10240
  ds_read_b64_tr_b16 v[26:27], v11 offset:10496
  s_waitcnt lgkmcnt(4)
  v_mfma_f32_32x32x16_bf16 v[44:59], v[16:19], v[12:15], v[44:59]
  ds_read_b128 v[28:31], v10
  ds_read_b64_tr_b16 v[32:33], v11 offset:3072
  ds_read_b64_tr_b16 v[34:35], v11 offset:3328
  s_waitcnt lgkmcnt(5)
  v_mfma_f32_32x32x16_bf16 v[60:75], v[12:15], v[20:23], v[60:75]
  ds_read_b64_tr_b16 v[36:37], v11 offset:7168
  ds_read_b64_tr_b16 v[38:39], v11 offset:7424
  s_waitcnt lgkmcnt(5)
  v_mfma_f32_32x32x16_bf16 v[76:91], v[24:27], v[12:15], v[76:91]
  ds_read_b64_tr_b16 v[40:41], v11 offset:11264
  ds_read_b64_tr_b16 v[42:43], v11 offset:11520
  v_add_u32 v7, 0xb000, v2
  v_add_u32 v8, 0xb000, v3
  v_add_u32 v9, 0xb000, v4
  v_add_u32 v10, 0xb000, v5
  v_add_u32 v11, 0xb000, v6
  s_waitcnt lgkmcnt(0)
  s_barrier
  v_mfma_f32_32x32x16_bf16 v[44:59], v[32:35], v[28:31], v[44:59]
  ds_read_b128 v[12:15], v7
  ds_read_b64_tr_b16 v[16:17], v11 offset:0
  ds_read_b64_tr_b16 v[18:19], v11 offset:256
  v_mfma_f32_32x32x16_bf16 v[60:75], v[28:31], v[36:39], v[60:75]
  ds_read_b64_tr_b16 v[20:21], v11 offset:4096
  ds_read_b64_tr_b16 v[22:23], v11 offset:4352
  v_mfma_f32_32x32x16_bf16 v[76:91], v[40:43], v[28:31], v[76:91]
  ds_read_b64_tr_b16 v[24:25], v11 offset:8192
  ds_read_b64_tr_b16 v[26:27], v11 offset:8448
  s_waitcnt lgkmcnt(4)
  v_mfma_f32_32x32x16_bf16 v[44:59], v[16:19], v[12:15], v[44:59]
  ds_read_b128 v[28:31], v8
  ds_read_b64_tr_b16 v[32:33], v11 offset:1024
  ds_read_b64_tr_b16 v[34:35], v11 offset:1280
  s_waitcnt lgkmcnt(5)
  v_mfma_f32_32x32x16_bf16 v[60:75], v[12:15], v[20:23], v[60:75]
  ds_read_b64_tr_b16 v[36:37], v11 offset:5120
  ds_read_b64_tr_b16 v[38:39], v11 offset:5376
  s_waitcnt lgkmcnt(5)
  v_mfma_f32_32x32x16_bf16 v[76:91], v[24:27], v[12:15], v[76:91]
  ds_read_b64_tr_b16 v[40:41], v11 offset:9216
  ds_read_b64_tr_b16 v[42:43], v11 offset:9472
  s_waitcnt lgkmcnt(4)
  v_mfma_f32_32x32x16_bf16 v[44:59], v[32:35], v[28:31], v[44:59]
  ds_read_b128 v[12:15], v9
  ds_read_b64_tr_b16 v[16:17], v11 offset:2048
  ds_read_b64_tr_b16 v[18:19], v11 offset:2304
  s_waitcnt lgkmcnt(5)
  v_mfma_f32_32x32x16_bf16 v[60:75], v[28:31], v[36:39], v[60:75]
  ds_read_b64_tr_b16 v[20:21], v11 offset:6144
  ds_read_b64_tr_b16 v[22:23], v11 offset:6400
  s_waitcnt lgkmcnt(5)
  v_mfma_f32_32x32x16_bf16 v[76:91], v[40:43], v[28:31], v[76:91]
  ds_read_b64_tr_b16 v[24:25], v11 offset:10240
  ds_read_b64_tr_b16 v[26:27], v11 offset:10496
  s_waitcnt lgkmcnt(4)
  v_mfma_f32_32x32x16_bf16 v[44:59], v[16:19], v[12:15], v[44:59]
  ds_read_b128 v[28:31], v10
  ds_read_b64_tr_b16 v[32:33], v11 offset:3072
  ds_read_b64_tr_b16 v[34:35], v11 offset:3328
  s_waitcnt lgkmcnt(5)
  v_mfma_f32_32x32x16_bf16 v[60:75], v[12:15], v[20:23], v[60:75]
  ds_read_b64_tr_b16 v[36:37], v11 offset:7168
  ds_read_b64_tr_b16 v[38:39], v11 offset:7424
  s_waitcnt lgkmcnt(5)
  v_mfma_f32_32x32x16_bf16 v[76:91], v[24:27], v[12:15], v[76:91]
  ds_read_b64_tr_b16 v[40:41], v11 offset:11264
  ds_read_b64_tr_b16 v[42:43], v11 offset:11520
  s_waitcnt lgkmcnt(4)
  v_mfma_f32_32x32x16_bf16 v[44:59], v[32:35], v[28:31], v[44:59]
  s_waitcnt lgkmcnt(2)
  v_mfma_f32_32x32x16_bf16 v[60:75], v[28:31], v[36:39], v[60:75]
  s_waitcnt lgkmcnt(0)
  v_mfma_f32_32x32x16_bf16 v[76:91], v[40:43], v[28:31], v[76:91]
  s_nop 7
  v_cvt_pk_bf16_f32 v112, v44, v45
  v_cvt_pk_bf16_f32 v113, v46, v47
  v_cvt_pk_bf16_f32 v114, v48, v49
  v_cvt_pk_bf16_f32 v115, v50, v51
  v_cvt_pk_bf16_f32 v116, v52, v53
  v_cvt_pk_bf16_f32 v117, v54, v55
  v_cvt_pk_bf16_f32 v118, v56, v57
  v_cvt_pk_bf16_f32 v119, v58, v59
  v_cvt_pk_bf16_f32 v120, v60, v61
  v_cvt_pk_bf16_f32 v121, v62, v63
  v_cvt_pk_bf16_f32 v122, v64, v65
  v_cvt_pk_bf16_f32 v123, v66, v67
  v_cvt_pk_bf16_f32 v124, v68, v69
  v_cvt_pk_bf16_f32 v125, v70, v71
  v_cvt_pk_bf16_f32 v126, v72, v73
  v_cvt_pk_bf16_f32 v127, v74, v75
  buffer_store_dwordx4 v[112:115], v1, s[36:39], s40 offen sc1
  buffer_store_dwordx4 v[116:119], v1, s[36:39], s41 offen sc1
  buffer_store_dwordx4 v[120:123], v138, s[36:39], s42 offen sc1
  buffer_store_dwordx4 v[124:127], v138, s[36:39], s42 offen offset:512 sc1
  v_mul_f32 v76, 0x3eb8aa3b, v76
  v_mul_f32 v77, 0x3eb8aa3b, v77
  v_mul_f32 v78, 0x3eb8aa3b, v78
  v_mul_f32 v79, 0x3eb8aa3b, v79
  v_mul_f32 v80, 0x3eb8aa3b, v80
  v_mul_f32 v81, 0x3eb8aa3b, v81
  v_mul_f32 v82, 0x3eb8aa3b, v82
  v_mul_f32 v83, 0x3eb8aa3b, v83
  v_mul_f32 v84, 0x3eb8aa3b, v84
  v_mul_f32 v85, 0x3eb8aa3b, v85
  v_mul_f32 v86, 0x3eb8aa3b, v86
  v_mul_f32 v87, 0x3eb8aa3b, v87
  v_mul_f32 v88, 0x3eb8aa3b, v88
  v_mul_f32 v89, 0x3eb8aa3b, v89
  v_mul_f32 v90, 0x3eb8aa3b, v90
  v_mul_f32 v91, 0x3eb8aa3b, v91
  v_cvt_pk_bf16_f32 v128, v76, v77
  v_cvt_pk_bf16_f32 v129, v78, v79
  v_cvt_pk_bf16_f32 v130, v80, v81
  v_cvt_pk_bf16_f32 v131, v82, v83
  v_cvt_pk_bf16_f32 v132, v84, v85
  v_cvt_pk_bf16_f32 v133, v86, v87
  v_cvt_pk_bf16_f32 v134, v88, v89
  v_cvt_pk_bf16_f32 v135, v90, v91
  s_waitcnt lgkmcnt(0)
gm_AC_att:
  s_barrier
  s_lshl_b32 s33, s81, 10
  v_add_u32 v2, s33, v1
  s_add_u32 s34, s33, 0x8000
  v_add_u32 v3, s34, v137
  ds_write_b128 v2, v[112:115] offset:8192
  ds_write_b128 v2, v[116:119] offset:24576
  ds_write_b128 v3, v[120:123] offset:8192
  ds_write_b128 v3, v[124:127] offset:8704
  v_mov_b32 v4, v128
  v_mov_b32 v5, v129
  v_mov_b32 v6, v130
  v_mov_b32 v7, v131
  v_mov_b32 v8, v132
  v_mov_b32 v9, v133
  v_mov_b32 v10, v134
  v_mov_b32 v11, v135
  s_waitcnt lgkmcnt(0)
  s_waitcnt vmcnt(0)
  s_mov_b32 s44, 0x0
  s_mov_b32 s45, 0xf
  s_mov_b32 s46, 0x1
  s_mov_b32 s47, 0x1f
  s_mov_b32 s48, 0x3
  s_mov_b32 s49, 0x3f
  s_mov_b32 s50, 0x7
  s_mov_b32 s51, 0x7f
  s_mov_b32 s52, 0xff
  s_mov_b32 s53, 0xfff
  s_mov_b32 s54, 0x1ff
  s_mov_b32 s55, 0x1fff
  s_mov_b32 s56, 0x3ff
  s_mov_b32 s57, 0x3fff
  s_mov_b32 s58, 0x7ff
  s_mov_b32 s59, 0x7fff
  s_mov_b32 s60, 0xffff
  s_mov_b32 s61, 0xfffff
  s_mov_b32 s62, 0x1ffff
  s_mov_b32 s63, 0x1fffff
  s_mov_b32 s64, 0x3ffff
  s_mov_b32 s65, 0x3fffff
  s_mov_b32 s66, 0x7ffff
  s_mov_b32 s67, 0x7fffff
  s_mov_b32 s68, 0xffffff
  s_mov_b32 s69, 0xfffffff
  s_mov_b32 s70, 0x1ffffff
  s_mov_b32 s71, 0x1fffffff
  s_mov_b32 s72, 0x3ffffff
  s_mov_b32 s73, 0x3fffffff
  s_mov_b32 s74, 0x7ffffff
  s_mov_b32 s75, 0x7fffffff
  v_mov_b32 v156, 0xffff
  v_mov_b32 v157, 0xffff0000
  v_mov_b32 v159, 0
  v_cndmask_b32 v148, v159, v156, s[44:45]
  v_cndmask_b32 v158, v159, v157, s[46:47]
  v_or_b32 v148, v148, v158
  v_cndmask_b32 v149, v159, v156, s[48:49]
  v_cndmask_b32 v158, v159, v157, s[50:51]
  v_or_b32 v149, v149, v158
  v_cndmask_b32 v150, v159, v156, s[52:53]
  v_cndmask_b32 v158, v159, v157, s[54:55]
  v_or_b32 v150, v150, v158
  v_cndmask_b32 v151, v159, v156, s[56:57]
  v_cndmask_b32 v158, v159, v157, s[58:59]
  v_or_b32 v151, v151, v158
  v_cndmask_b32 v152, v159, v156, s[60:61]
  v_cndmask_b32 v158, v159, v157, s[62:63]
  v_or_b32 v152, v152, v158
  v_cndmask_b32 v153, v159, v156, s[64:65]
  v_cndmask_b32 v158, v159, v157, s[66:67]
  v_or_b32 v153, v153, v158
  v_cndmask_b32 v154, v159, v156, s[68:69]
  v_cndmask_b32 v158, v159, v157, s[70:71]
  v_or_b32 v154, v154, v158
  v_cndmask_b32 v155, v159, v156, s[72:73]
  v_cndmask_b32 v158, v159, v157, s[74:75]
  v_or_b32 v155, v155, v158
  v_and_b32 v156, 27, v0
  v_cmp_eq_u32 s[76:77], 16, v156
  v_mov_b32 v157, 0x3f803f80
  s_nop 0
  v_cndmask_b32 v28, v159, v157, s[76:77]
  v_cndmask_b32 v29, v159, v157, s[76:77]
  v_cndmask_b32 v30, v159, v157, s[76:77]
  v_cndmask_b32 v31, v159, v157, s[76:77]
  v_cndmask_b32 v32, v159, v157, s[76:77]
  v_cndmask_b32 v33, v159, v157, s[76:77]
  v_cndmask_b32 v34, v159, v157, s[76:77]
  v_cndmask_b32 v35, v159, v157, s[76:77]
  v_cndmask_b32 v36, v159, v157, s[76:77]
  v_cndmask_b32 v37, v159, v157, s[76:77]
  v_cndmask_b32 v38, v159, v157, s[76:77]
  v_cndmask_b32 v39, v159, v157, s[76:77]
  v_cndmask_b32 v40, v159, v157, s[76:77]
  v_cndmask_b32 v41, v159, v157, s[76:77]
  v_cndmask_b32 v42, v159, v157, s[76:77]
  v_cndmask_b32 v43, v159, v157, s[76:77]
  s_mov_b32 s78, 0x0000ffff
  s_mov_b32 s79, 0x0000ffff
  v_mov_b32 v158, 0xff7fffff
  v_and_b32 v3, 0xffffbfff, v3
  s_lshl_b32 s33, s83, 3
  s_add_u32 s33, s33, s81
  s_lshl_b32 s40, s33, 5
  s_lshl_b32 s34, s82, 1
  s_add_u32 s40, s40, s34
  s_lshl_b32 s40, s40, 10
  s_add_u32 s40, s40, 0xb00000
  s_sub_i32 s41, 8, s81
  v_mov_b32 v160, s90
  v_mov_b32 v161, 0
  s_mov_b64 exec, 1
  buffer_store_dword v160, v161, s[36:39], s80 offen sc1
  s_mov_b64 exec, -1
  s_barrier
  s_lshl_b32 s33, s4, 1
  s_and_b32 s34, s6, 1
  s_add_u32 s33, s33, s34
  s_lshl_b32 s33, s33, 2
  s_lshr_b32 s34, s3, 1
  s_add_u32 s33, s33, s34
  s_lshl_b32 s33, s33, 4
  s_and_b32 s34, s6, 14
  s_add_u32 s33, s33, s34
  s_and_b32 s34, s3, 1
  s_add_u32 s33, s33, s34
  s_lshl_b32 s33, s33, 11
  s_add_u32 s42, s33, 0xd00000
  s_cmp_eq_u32 s81, 1
  s_cbranch_scc1 gm_AC_v1
  s_cmp_eq_u32 s81, 2
  s_cbranch_scc1 gm_AC_v2
  s_cmp_eq_u32 s81, 3
  s_cbranch_scc1 gm_AC_v3
  s_cmp_eq_u32 s81, 4
  s_cbranch_scc1 gm_AC_v4
  s_cmp_eq_u32 s81, 5
  s_cbranch_scc1 gm_AC_v5
  s_cmp_eq_u32 s81, 6
  s_cbranch_scc1 gm_AC_v6
  s_cmp_eq_u32 s81, 7
  s_cbranch_scc1 gm_AC_v7
  s_setprio 3
  ds_read_b128 v[12:15], v2 offset:8192
  s_mov_b64 exec, s[78:79]
  ds_read_b128 v[28:31], v3 offset:8192
  ds_read_b128 v[32:35], v3 offset:8704
  s_mov_b64 exec, -1
  s_waitcnt lgkmcnt(2)
  v_mfma_f32_32x32x16_bf16 v[44:59], v[12:15], v[4:7], 0
  s_nop 11
  v_cndmask_b32 v44, v44, v158, s[44:45]
  v_cndmask_b32 v45, v45, v158, s[46:47]
  v_cndmask_b32 v46, v46, v158, s[48:49]
  v_cndmask_b32 v47, v47, v158, s[50:51]
  v_cndmask_b32 v48, v48, v158, s[52:53]
  v_cndmask_b32 v49, v49, v158, s[54:55]
  v_cndmask_b32 v50, v50, v158, s[56:57]
  v_cndmask_b32 v51, v51, v158, s[58:59]
  v_cndmask_b32 v52, v52, v158, s[60:61]
  v_cndmask_b32 v53, v53, v158, s[62:63]
  v_cndmask_b32 v54, v54, v158, s[64:65]
  v_cndmask_b32 v55, v55, v158, s[66:67]
  v_cndmask_b32 v56, v56, v158, s[68:69]
  v_cndmask_b32 v57, v57, v158, s[70:71]
  v_cndmask_b32 v58, v58, v158, s[72:73]
  v_cndmask_b32 v59, v59, v158, s[74:75]
  v_max3_f32 v156, v44, v45, v46
  v_max3_f32 v157, v47, v48, v49
  v_max3_f32 v157, v50, v51, v157
  v_max3_f32 v156, v52, v53, v156
  v_max3_f32 v157, v54, v55, v157
  v_max3_f32 v156, v56, v57, v156
  v_max3_f32 v157, v58, v59, v157
  v_max_f32 v156, v156, v157
  v_mov_b32 v157, v156
  s_nop 1
  v_permlane32_swap_b32 v156, v157
  v_max_f32 v162, v156, v157
  v_sub_f32 v44, v44, v162
  v_sub_f32 v45, v45, v162
  v_sub_f32 v46, v46, v162
  v_sub_f32 v47, v47, v162
  v_sub_f32 v48, v48, v162
  v_sub_f32 v49, v49, v162
  v_sub_f32 v50, v50, v162
  v_sub_f32 v51, v51, v162
  v_sub_f32 v52, v52, v162
  v_sub_f32 v53, v53, v162
  v_sub_f32 v54, v54, v162
  v_sub_f32 v55, v55, v162
  v_sub_f32 v56, v56, v162
  v_sub_f32 v57, v57, v162
  v_sub_f32 v58, v58, v162
  v_sub_f32 v59, v59, v162
  v_exp_f32 v44, v44
  v_exp_f32 v45, v45
  v_exp_f32 v46, v46
  v_exp_f32 v47, v47
  v_cvt_pk_bf16_f32 v124, v44, v45
  v_exp_f32 v48, v48
  v_exp_f32 v49, v49
  v_cvt_pk_bf16_f32 v125, v46, v47
  v_exp_f32 v50, v50
  v_exp_f32 v51, v51
  v_cvt_pk_bf16_f32 v126, v48, v49
  v_exp_f32 v52, v52
  v_exp_f32 v53, v53
  v_cvt_pk_bf16_f32 v127, v50, v51
  v_exp_f32 v54, v54
  v_exp_f32 v55, v55
  v_cvt_pk_bf16_f32 v128, v52, v53
  v_exp_f32 v56, v56
  v_exp_f32 v57, v57
  v_cvt_pk_bf16_f32 v129, v54, v55
  v_exp_f32 v58, v58
  v_exp_f32 v59, v59
  v_cvt_pk_bf16_f32 v130, v56, v57
  v_cvt_pk_bf16_f32 v131, v58, v59
  s_waitcnt lgkmcnt(1)
  v_mfma_f32_32x32x16_bf16 v[76:91], v[28:31], v[124:127], 0
  s_waitcnt lgkmcnt(0)
  v_mfma_f32_32x32x16_bf16 v[76:91], v[32:35], v[128:131], v[76:91]
  s_setprio 2
  ds_read_b128 v[12:15], v2 offset:24576
  s_mov_b64 exec, s[78:79]
  ds_read_b128 v[28:31], v3 offset:24576
  ds_read_b128 v[32:35], v3 offset:25088
  s_mov_b64 exec, -1
  s_waitcnt lgkmcnt(2)
  v_mfma_f32_32x32x16_bf16 v[44:59], v[12:15], v[8:11], 0
  s_nop 11
  v_cndmask_b32 v44, v44, v158, s[44:45]
  v_cndmask_b32 v45, v45, v158, s[46:47]
  v_cndmask_b32 v46, v46, v158, s[48:49]
  v_cndmask_b32 v47, v47, v158, s[50:51]
  v_cndmask_b32 v48, v48, v158, s[52:53]
  v_cndmask_b32 v49, v49, v158, s[54:55]
  v_cndmask_b32 v50, v50, v158, s[56:57]
  v_cndmask_b32 v51, v51, v158, s[58:59]
  v_cndmask_b32 v52, v52, v158, s[60:61]
  v_cndmask_b32 v53, v53, v158, s[62:63]
  v_cndmask_b32 v54, v54, v158, s[64:65]
  v_cndmask_b32 v55, v55, v158, s[66:67]
  v_cndmask_b32 v56, v56, v158, s[68:69]
  v_cndmask_b32 v57, v57, v158, s[70:71]
  v_cndmask_b32 v58, v58, v158, s[72:73]
  v_cndmask_b32 v59, v59, v158, s[74:75]
  v_max3_f32 v156, v44, v45, v46
  v_max3_f32 v157, v47, v48, v49
  v_max3_f32 v157, v50, v51, v157
  v_max3_f32 v156, v52, v53, v156
  v_max3_f32 v157, v54, v55, v157
  v_max3_f32 v156, v56, v57, v156
  v_max3_f32 v157, v58, v59, v157
  v_max_f32 v156, v156, v157
  v_mov_b32 v157, v156
  s_nop 1
  v_permlane32_swap_b32 v156, v157
  v_max_f32 v163, v156, v157
  v_sub_f32 v44, v44, v163
  v_sub_f32 v45, v45, v163
  v_sub_f32 v46, v46, v163
  v_sub_f32 v47, v47, v163
  v_sub_f32 v48, v48, v163
  v_sub_f32 v49, v49, v163
  v_sub_f32 v50, v50, v163
  v_sub_f32 v51, v51, v163
  v_sub_f32 v52, v52, v163
  v_sub_f32 v53, v53, v163
  v_sub_f32 v54, v54, v163
  v_sub_f32 v55, v55, v163
  v_sub_f32 v56, v56, v163
  v_sub_f32 v57, v57, v163
  v_sub_f32 v58, v58, v163
  v_sub_f32 v59, v59, v163
  v_exp_f32 v44, v44
  v_exp_f32 v45, v45
  v_exp_f32 v46, v46
  v_exp_f32 v47, v47
  v_cvt_pk_bf16_f32 v124, v44, v45
  v_exp_f32 v48, v48
  v_exp_f32 v49, v49
  v_cvt_pk_bf16_f32 v125, v46, v47
  v_exp_f32 v50, v50
  v_exp_f32 v51, v51
  v_cvt_pk_bf16_f32 v126, v48, v49
  v_exp_f32 v52, v52
  v_exp_f32 v53, v53
  v_cvt_pk_bf16_f32 v127, v50, v51
  v_exp_f32 v54, v54
  v_exp_f32 v55, v55
  v_cvt_pk_bf16_f32 v128, v52, v53
  v_exp_f32 v56, v56
  v_exp_f32 v57, v57
  v_cvt_pk_bf16_f32 v129, v54, v55
  v_exp_f32 v58, v58
  v_exp_f32 v59, v59
  v_cvt_pk_bf16_f32 v130, v56, v57
  v_cvt_pk_bf16_f32 v131, v58, v59
  s_waitcnt lgkmcnt(1)
  v_mfma_f32_32x32x16_bf16 v[108:123], v[28:31], v[124:127], 0
  s_waitcnt lgkmcnt(0)
  v_mfma_f32_32x32x16_bf16 v[108:123], v[32:35], v[128:131], v[108:123]
  s_waitcnt lgkmcnt(0)
  s_barrier
  s_cmp_eq_u32 s83, 0
  s_cbranch_scc1 gm_AC_fz
  s_setprio 1
  ds_read_b128 v[12:15], v2 offset:7168
  ds_read_b128 v[16:19], v2 offset:6144
  ds_read_b128 v[20:23], v2 offset:5120
  s_mov_b64 exec, s[78:79]
  ds_read_b128 v[28:31], v3 offset:7168
  ds_read_b128 v[32:35], v3 offset:7680
  s_mov_b64 exec, -1
  s_mov_b64 exec, s[78:79]
  ds_read_b128 v[36:39], v3 offset:6144
  ds_read_b128 v[40:43], v3 offset:6656
  s_mov_b64 exec, -1
  v_sub_f32 v92, 0, v162
  v_sub_f32 v93, 0, v162
  v_sub_f32 v94, 0, v162
  v_sub_f32 v95, 0, v162
  v_sub_f32 v96, 0, v162
  v_sub_f32 v97, 0, v162
  v_sub_f32 v98, 0, v162
  v_sub_f32 v99, 0, v162
  v_sub_f32 v100, 0, v162
  v_sub_f32 v101, 0, v162
  v_sub_f32 v102, 0, v162
  v_sub_f32 v103, 0, v162
  v_sub_f32 v104, 0, v162
  v_sub_f32 v105, 0, v162
  v_sub_f32 v106, 0, v162
  v_sub_f32 v107, 0, v162
  s_waitcnt lgkmcnt(6)
  s_nop 0
  v_mfma_f32_32x32x16_bf16 v[44:59], v[12:15], v[4:7], v[92:107]
  s_waitcnt lgkmcnt(5)
  v_mfma_f32_32x32x16_bf16 v[60:75], v[16:19], v[4:7], v[92:107]
  ds_read_b128 v[24:27], v2 offset:4096
  s_nop 8
  v_exp_f32 v44, v44
  v_exp_f32 v45, v45
  v_exp_f32 v46, v46
  v_exp_f32 v47, v47
  v_cvt_pk_bf16_f32 v124, v44, v45
  v_exp_f32 v48, v48
  v_exp_f32 v49, v49
  v_cvt_pk_bf16_f32 v125, v46, v47
  v_exp_f32 v50, v50
  v_exp_f32 v51, v51
  v_cvt_pk_bf16_f32 v126, v48, v49
  v_exp_f32 v52, v52
  v_exp_f32 v53, v53
  v_cvt_pk_bf16_f32 v127, v50, v51
  v_exp_f32 v54, v54
  v_exp_f32 v55, v55
  v_cvt_pk_bf16_f32 v128, v52, v53
  v_exp_f32 v56, v56
  v_exp_f32 v57, v57
  v_cvt_pk_bf16_f32 v129, v54, v55
  v_exp_f32 v58, v58
  v_exp_f32 v59, v59
  v_cvt_pk_bf16_f32 v130, v56, v57
  v_cvt_pk_bf16_f32 v131, v58, v59
  s_waitcnt lgkmcnt(5)
  v_mfma_f32_32x32x16_bf16 v[44:59], v[20:23], v[4:7], v[92:107]
  ds_read_b128 v[12:15], v2 offset:3072
  v_exp_f32 v60, v60
  v_exp_f32 v61, v61
  v_exp_f32 v62, v62
  v_exp_f32 v63, v63
  v_cvt_pk_bf16_f32 v132, v60, v61
  v_exp_f32 v64, v64
  s_waitcnt lgkmcnt(5)
  v_mfma_f32_32x32x16_bf16 v[76:91], v[28:31], v[124:127], v[76:91]
  v_exp_f32 v65, v65
  v_cvt_pk_bf16_f32 v133, v62, v63
  v_exp_f32 v66, v66
  v_exp_f32 v67, v67
  v_cvt_pk_bf16_f32 v134, v64, v65
  v_exp_f32 v68, v68
  v_exp_f32 v69, v69
  v_cvt_pk_bf16_f32 v135, v66, v67
  v_exp_f32 v70, v70
  s_waitcnt lgkmcnt(4)
  v_mfma_f32_32x32x16_bf16 v[76:91], v[32:35], v[128:131], v[76:91]
  v_exp_f32 v71, v71
  v_cvt_pk_bf16_f32 v136, v68, v69
  s_mov_b64 exec, s[78:79]
  ds_read_b128 v[28:31], v3 offset:5120
  ds_read_b128 v[32:35], v3 offset:5632
  s_mov_b64 exec, -1
  v_exp_f32 v72, v72
  v_exp_f32 v73, v73
  v_cvt_pk_bf16_f32 v137, v70, v71
  v_exp_f32 v74, v74
  v_exp_f32 v75, v75
  v_cvt_pk_bf16_f32 v138, v72, v73
  v_cvt_pk_bf16_f32 v139, v74, v75
  s_waitcnt lgkmcnt(3)
  v_mfma_f32_32x32x16_bf16 v[60:75], v[24:27], v[4:7], v[92:107]
  ds_read_b128 v[16:19], v2 offset:2048
  v_exp_f32 v44, v44
  v_exp_f32 v45, v45
  v_exp_f32 v46, v46
  v_exp_f32 v47, v47
  v_cvt_pk_bf16_f32 v124, v44, v45
  v_exp_f32 v48, v48
  v_mfma_f32_32x32x16_bf16 v[76:91], v[36:39], v[132:135], v[76:91]
  v_exp_f32 v49, v49
  v_cvt_pk_bf16_f32 v125, v46, v47
  v_exp_f32 v50, v50
  v_exp_f32 v51, v51
  v_cvt_pk_bf16_f32 v126, v48, v49
  v_exp_f32 v52, v52
  v_exp_f32 v53, v53
  v_cvt_pk_bf16_f32 v127, v50, v51
  v_exp_f32 v54, v54
  v_mfma_f32_32x32x16_bf16 v[76:91], v[40:43], v[136:139], v[76:91]
  v_exp_f32 v55, v55
  v_cvt_pk_bf16_f32 v128, v52, v53
  s_mov_b64 exec, s[78:79]
  ds_read_b128 v[36:39], v3 offset:4096
  ds_read_b128 v[40:43], v3 offset:4608
  s_mov_b64 exec, -1
  v_exp_f32 v56, v56
  v_exp_f32 v57, v57
  v_cvt_pk_bf16_f32 v129, v54, v55
  v_exp_f32 v58, v58
  v_exp_f32 v59, v59
  v_cvt_pk_bf16_f32 v130, v56, v57
  v_cvt_pk_bf16_f32 v131, v58, v59
  s_waitcnt lgkmcnt(5)
  v_mfma_f32_32x32x16_bf16 v[44:59], v[12:15], v[4:7], v[92:107]
  ds_read_b128 v[20:23], v2 offset:1024
  v_exp_f32 v60, v60
  v_exp_f32 v61, v61
  v_exp_f32 v62, v62
  v_exp_f32 v63, v63
  v_cvt_pk_bf16_f32 v132, v60, v61
  v_exp_f32 v64, v64
  s_waitcnt lgkmcnt(5)
  v_mfma_f32_32x32x16_bf16 v[76:91], v[28:31], v[124:127], v[76:91]
  v_exp_f32 v65, v65
  v_cvt_pk_bf16_f32 v133, v62, v63
  v_exp_f32 v66, v66
  v_exp_f32 v67, v67
  v_cvt_pk_bf16_f32 v134, v64, v65
  v_exp_f32 v68, v68
  v_exp_f32 v69, v69
  v_cvt_pk_bf16_f32 v135, v66, v67
  v_exp_f32 v70, v70
  s_waitcnt lgkmcnt(4)
  v_mfma_f32_32x32x16_bf16 v[76:91], v[32:35], v[128:131], v[76:91]
  v_exp_f32 v71, v71
  v_cvt_pk_bf16_f32 v136, v68, v69
  s_mov_b64 exec, s[78:79]
  ds_read_b128 v[28:31], v3 offset:3072
  ds_read_b128 v[32:35], v3 offset:3584
  s_mov_b64 exec, -1
  v_exp_f32 v72, v72
  v_exp_f32 v73, v73
  v_cvt_pk_bf16_f32 v137, v70, v71
  v_exp_f32 v74, v74
  v_exp_f32 v75, v75
  v_cvt_pk_bf16_f32 v138, v72, v73
  v_cvt_pk_bf16_f32 v139, v74, v75
  s_waitcnt lgkmcnt(5)
  v_mfma_f32_32x32x16_bf16 v[60:75], v[16:19], v[4:7], v[92:107]
  ds_read_b128 v[24:27], v2 offset:0
  v_exp_f32 v44, v44
  v_exp_f32 v45, v45
  v_exp_f32 v46, v46
  v_exp_f32 v47, v47
  v_cvt_pk_bf16_f32 v124, v44, v45
  v_exp_f32 v48, v48
  s_waitcnt lgkmcnt(5)
  v_mfma_f32_32x32x16_bf16 v[76:91], v[36:39], v[132:135], v[76:91]
  v_exp_f32 v49, v49
  v_cvt_pk_bf16_f32 v125, v46, v47
  v_exp_f32 v50, v50
  v_exp_f32 v51, v51
  v_cvt_pk_bf16_f32 v126, v48, v49
  v_exp_f32 v52, v52
  v_exp_f32 v53, v53
  v_cvt_pk_bf16_f32 v127, v50, v51
  v_exp_f32 v54, v54
  s_waitcnt lgkmcnt(4)
  v_mfma_f32_32x32x16_bf16 v[76:91], v[40:43], v[136:139], v[76:91]
  v_exp_f32 v55, v55
  v_cvt_pk_bf16_f32 v128, v52, v53
  s_mov_b64 exec, s[78:79]
  ds_read_b128 v[36:39], v3 offset:2048
  ds_read_b128 v[40:43], v3 offset:2560
  s_mov_b64 exec, -1
  v_exp_f32 v56, v56
  v_exp_f32 v57, v57
  v_cvt_pk_bf16_f32 v129, v54, v55
  v_exp_f32 v58, v58
  v_exp_f32 v59, v59
  v_cvt_pk_bf16_f32 v130, v56, v57
  v_cvt_pk_bf16_f32 v131, v58, v59
  s_waitcnt lgkmcnt(5)
  v_mfma_f32_32x32x16_bf16 v[44:59], v[20:23], v[4:7], v[92:107]
  v_exp_f32 v60, v60
  v_exp_f32 v61, v61
  v_exp_f32 v62, v62
  v_exp_f32 v63, v63
  v_cvt_pk_bf16_f32 v132, v60, v61
  v_exp_f32 v64, v64
  s_waitcnt lgkmcnt(4)
  v_mfma_f32_32x32x16_bf16 v[76:91], v[28:31], v[124:127], v[76:91]
  v_exp_f32 v65, v65
  v_cvt_pk_bf16_f32 v133, v62, v63
  v_exp_f32 v66, v66
  v_exp_f32 v67, v67
  v_cvt_pk_bf16_f32 v134, v64, v65
  v_exp_f32 v68, v68
  v_exp_f32 v69, v69
  v_cvt_pk_bf16_f32 v135, v66, v67
  v_exp_f32 v70, v70
  s_waitcnt lgkmcnt(3)
  v_mfma_f32_32x32x16_bf16 v[76:91], v[32:35], v[128:131], v[76:91]
  v_exp_f32 v71, v71
  v_cvt_pk_bf16_f32 v136, v68, v69
  s_mov_b64 exec, s[78:79]
  ds_read_b128 v[28:31], v3 offset:1024
  ds_read_b128 v[32:35], v3 offset:1536
  s_mov_b64 exec, -1
  v_exp_f32 v72, v72
  v_exp_f32 v73, v73
  v_cvt_pk_bf16_f32 v137, v70, v71
  v_exp_f32 v74, v74
  v_exp_f32 v75, v75
  v_cvt_pk_bf16_f32 v138, v72, v73
  v_cvt_pk_bf16_f32 v139, v74, v75
  s_waitcnt lgkmcnt(4)
  v_mfma_f32_32x32x16_bf16 v[60:75], v[24:27], v[4:7], v[92:107]
  v_exp_f32 v44, v44
  v_exp_f32 v45, v45
  v_exp_f32 v46, v46
  v_exp_f32 v47, v47
  v_cvt_pk_bf16_f32 v124, v44, v45
  v_exp_f32 v48, v48
  s_waitcnt lgkmcnt(3)
  v_mfma_f32_32x32x16_bf16 v[76:91], v[36:39], v[132:135], v[76:91]
  v_exp_f32 v49, v49
  v_cvt_pk_bf16_f32 v125, v46, v47
  v_exp_f32 v50, v50
  v_exp_f32 v51, v51
  v_cvt_pk_bf16_f32 v126, v48, v49
  v_exp_f32 v52, v52
  v_exp_f32 v53, v53
  v_cvt_pk_bf16_f32 v127, v50, v51
  v_exp_f32 v54, v54
  s_waitcnt lgkmcnt(2)
  v_mfma_f32_32x32x16_bf16 v[76:91], v[40:43], v[136:139], v[76:91]
  v_exp_f32 v55, v55
  v_cvt_pk_bf16_f32 v128, v52, v53
  s_mov_b64 exec, s[78:79]
  ds_read_b128 v[36:39], v3 offset:0
  ds_read_b128 v[40:43], v3 offset:512
  s_mov_b64 exec, -1
  v_exp_f32 v56, v56
  v_exp_f32 v57, v57
  v_cvt_pk_bf16_f32 v129, v54, v55
  v_exp_f32 v58, v58
  v_exp_f32 v59, v59
  v_cvt_pk_bf16_f32 v130, v56, v57
  v_cvt_pk_bf16_f32 v131, v58, v59
  v_exp_f32 v60, v60
  v_exp_f32 v61, v61
  v_exp_f32 v62, v62
  v_exp_f32 v63, v63
  v_cvt_pk_bf16_f32 v132, v60, v61
  v_exp_f32 v64, v64
  s_waitcnt lgkmcnt(3)
  v_mfma_f32_32x32x16_bf16 v[76:91], v[28:31], v[124:127], v[76:91]
  v_exp_f32 v65, v65
  v_cvt_pk_bf16_f32 v133, v62, v63
  v_exp_f32 v66, v66
  v_exp_f32 v67, v67
  v_cvt_pk_bf16_f32 v134, v64, v65
  v_exp_f32 v68, v68
  v_exp_f32 v69, v69
  v_cvt_pk_bf16_f32 v135, v66, v67
  v_exp_f32 v70, v70
  s_waitcnt lgkmcnt(2)
  v_mfma_f32_32x32x16_bf16 v[76:91], v[32:35], v[128:131], v[76:91]
  v_exp_f32 v71, v71
  v_cvt_pk_bf16_f32 v136, v68, v69
  v_exp_f32 v72, v72
  v_exp_f32 v73, v73
  v_cvt_pk_bf16_f32 v137, v70, v71
  v_exp_f32 v74, v74
  v_exp_f32 v75, v75
  v_cvt_pk_bf16_f32 v138, v72, v73
  v_cvt_pk_bf16_f32 v139, v74, v75
  v_and_b32 v132, v132, v148
  v_and_b32 v133, v133, v149
  v_and_b32 v134, v134, v150
  v_and_b32 v135, v135, v151
  v_and_b32 v136, v136, v152
  v_and_b32 v137, v137, v153
  v_and_b32 v138, v138, v154
  v_and_b32 v139, v139, v155
  s_waitcnt lgkmcnt(1)
  v_mfma_f32_32x32x16_bf16 v[76:91], v[36:39], v[132:135], v[76:91]
  s_waitcnt lgkmcnt(0)
  v_mfma_f32_32x32x16_bf16 v[76:91], v[40:43], v[136:139], v[76:91]
  s_setprio 0
  ds_read_b128 v[12:15], v2 offset:23552
  ds_read_b128 v[16:19], v2 offset:22528
  ds_read_b128 v[20:23], v2 offset:21504
  s_mov_b64 exec, s[78:79]
  ds_read_b128 v[28:31], v3 offset:23552
  ds_read_b128 v[32:35], v3 offset:24064
  s_mov_b64 exec, -1
  s_mov_b64 exec, s[78:79]
  ds_read_b128 v[36:39], v3 offset:22528
  ds_read_b128 v[40:43], v3 offset:23040
  s_mov_b64 exec, -1
  v_sub_f32 v92, 0, v163
  v_sub_f32 v93, 0, v163
  v_sub_f32 v94, 0, v163
  v_sub_f32 v95, 0, v163
  v_sub_f32 v96, 0, v163
  v_sub_f32 v97, 0, v163
  v_sub_f32 v98, 0, v163
  v_sub_f32 v99, 0, v163
  v_sub_f32 v100, 0, v163
  v_sub_f32 v101, 0, v163
  v_sub_f32 v102, 0, v163
  v_sub_f32 v103, 0, v163
  v_sub_f32 v104, 0, v163
  v_sub_f32 v105, 0, v163
  v_sub_f32 v106, 0, v163
  v_sub_f32 v107, 0, v163
  s_waitcnt lgkmcnt(6)
  s_nop 0
  v_mfma_f32_32x32x16_bf16 v[44:59], v[12:15], v[8:11], v[92:107]
  s_waitcnt lgkmcnt(5)
  v_mfma_f32_32x32x16_bf16 v[60:75], v[16:19], v[8:11], v[92:107]
  ds_read_b128 v[24:27], v2 offset:20480
  s_nop 8
  v_exp_f32 v44, v44
  v_exp_f32 v45, v45
  v_exp_f32 v46, v46
  v_exp_f32 v47, v47
  v_cvt_pk_bf16_f32 v124, v44, v45
  v_exp_f32 v48, v48
  v_exp_f32 v49, v49
  v_cvt_pk_bf16_f32 v125, v46, v47
  v_exp_f32 v50, v50
  v_exp_f32 v51, v51
  v_cvt_pk_bf16_f32 v126, v48, v49
  v_exp_f32 v52, v52
  v_exp_f32 v53, v53
  v_cvt_pk_bf16_f32 v127, v50, v51
  v_exp_f32 v54, v54
  v_exp_f32 v55, v55
  v_cvt_pk_bf16_f32 v128, v52, v53
  v_exp_f32 v56, v56
  v_exp_f32 v57, v57
  v_cvt_pk_bf16_f32 v129, v54, v55
  v_exp_f32 v58, v58
  v_exp_f32 v59, v59
  v_cvt_pk_bf16_f32 v130, v56, v57
  v_cvt_pk_bf16_f32 v131, v58, v59
  s_waitcnt lgkmcnt(5)
  v_mfma_f32_32x32x16_bf16 v[44:59], v[20:23], v[8:11], v[92:107]
  ds_read_b128 v[12:15], v2 offset:19456
  v_exp_f32 v60, v60
  v_exp_f32 v61, v61
  v_exp_f32 v62, v62
  v_exp_f32 v63, v63
  v_cvt_pk_bf16_f32 v132, v60, v61
  v_exp_f32 v64, v64
  s_waitcnt lgkmcnt(5)
  v_mfma_f32_32x32x16_bf16 v[108:123], v[28:31], v[124:127], v[108:123]
  v_exp_f32 v65, v65
  v_cvt_pk_bf16_f32 v133, v62, v63
  v_exp_f32 v66, v66
  v_exp_f32 v67, v67
  v_cvt_pk_bf16_f32 v134, v64, v65
  v_exp_f32 v68, v68
  v_exp_f32 v69, v69
  v_cvt_pk_bf16_f32 v135, v66, v67
  v_exp_f32 v70, v70
  s_waitcnt lgkmcnt(4)
  v_mfma_f32_32x32x16_bf16 v[108:123], v[32:35], v[128:131], v[108:123]
  v_exp_f32 v71, v71
  v_cvt_pk_bf16_f32 v136, v68, v69
  s_mov_b64 exec, s[78:79]
  ds_read_b128 v[28:31], v3 offset:21504
  ds_read_b128 v[32:35], v3 offset:22016
  s_mov_b64 exec, -1
  v_exp_f32 v72, v72
  v_exp_f32 v73, v73
  v_cvt_pk_bf16_f32 v137, v70, v71
  v_exp_f32 v74, v74
  v_exp_f32 v75, v75
  v_cvt_pk_bf16_f32 v138, v72, v73
  v_cvt_pk_bf16_f32 v139, v74, v75
  s_waitcnt lgkmcnt(3)
  v_mfma_f32_32x32x16_bf16 v[60:75], v[24:27], v[8:11], v[92:107]
  ds_read_b128 v[16:19], v2 offset:18432
  v_exp_f32 v44, v44
  v_exp_f32 v45, v45
  v_exp_f32 v46, v46
  v_exp_f32 v47, v47
  v_cvt_pk_bf16_f32 v124, v44, v45
  v_exp_f32 v48, v48
  v_mfma_f32_32x32x16_bf16 v[108:123], v[36:39], v[132:135], v[108:123]
  v_exp_f32 v49, v49
  v_cvt_pk_bf16_f32 v125, v46, v47
  v_exp_f32 v50, v50
  v_exp_f32 v51, v51
  v_cvt_pk_bf16_f32 v126, v48, v49
  v_exp_f32 v52, v52
  v_exp_f32 v53, v53
  v_cvt_pk_bf16_f32 v127, v50, v51
  v_exp_f32 v54, v54
  v_mfma_f32_32x32x16_bf16 v[108:123], v[40:43], v[136:139], v[108:123]
  v_exp_f32 v55, v55
  v_cvt_pk_bf16_f32 v128, v52, v53
  s_mov_b64 exec, s[78:79]
  ds_read_b128 v[36:39], v3 offset:20480
  ds_read_b128 v[40:43], v3 offset:20992
  s_mov_b64 exec, -1
  v_exp_f32 v56, v56
  v_exp_f32 v57, v57
  v_cvt_pk_bf16_f32 v129, v54, v55
  v_exp_f32 v58, v58
  v_exp_f32 v59, v59
  v_cvt_pk_bf16_f32 v130, v56, v57
  v_cvt_pk_bf16_f32 v131, v58, v59
  s_waitcnt lgkmcnt(5)
  v_mfma_f32_32x32x16_bf16 v[44:59], v[12:15], v[8:11], v[92:107]
  ds_read_b128 v[20:23], v2 offset:17408
  v_exp_f32 v60, v60
  v_exp_f32 v61, v61
  v_exp_f32 v62, v62
  v_exp_f32 v63, v63
  v_cvt_pk_bf16_f32 v132, v60, v61
  v_exp_f32 v64, v64
  s_waitcnt lgkmcnt(5)
  v_mfma_f32_32x32x16_bf16 v[108:123], v[28:31], v[124:127], v[108:123]
  v_exp_f32 v65, v65
  v_cvt_pk_bf16_f32 v133, v62, v63
  v_exp_f32 v66, v66
  v_exp_f32 v67, v67
  v_cvt_pk_bf16_f32 v134, v64, v65
  v_exp_f32 v68, v68
  v_exp_f32 v69, v69
  v_cvt_pk_bf16_f32 v135, v66, v67
  v_exp_f32 v70, v70
  s_waitcnt lgkmcnt(4)
  v_mfma_f32_32x32x16_bf16 v[108:123], v[32:35], v[128:131], v[108:123]
  v_exp_f32 v71, v71
  v_cvt_pk_bf16_f32 v136, v68, v69
  s_mov_b64 exec, s[78:79]
  ds_read_b128 v[28:31], v3 offset:19456
  ds_read_b128 v[32:35], v3 offset:19968
  s_mov_b64 exec, -1
  v_exp_f32 v72, v72
  v_exp_f32 v73, v73
  v_cvt_pk_bf16_f32 v137, v70, v71
  v_exp_f32 v74, v74
  v_exp_f32 v75, v75
  v_cvt_pk_bf16_f32 v138, v72, v73
  v_cvt_pk_bf16_f32 v139, v74, v75
  s_waitcnt lgkmcnt(5)
  v_mfma_f32_32x32x16_bf16 v[60:75], v[16:19], v[8:11], v[92:107]
  ds_read_b128 v[24:27], v2 offset:16384
  v_exp_f32 v44, v44
  v_exp_f32 v45, v45
  v_exp_f32 v46, v46
  v_exp_f32 v47, v47
  v_cvt_pk_bf16_f32 v124, v44, v45
  v_exp_f32 v48, v48
  s_waitcnt lgkmcnt(5)
  v_mfma_f32_32x32x16_bf16 v[108:123], v[36:39], v[132:135], v[108:123]
  v_exp_f32 v49, v49
  v_cvt_pk_bf16_f32 v125, v46, v47
  v_exp_f32 v50, v50
  v_exp_f32 v51, v51
  v_cvt_pk_bf16_f32 v126, v48, v49
  v_exp_f32 v52, v52
  v_exp_f32 v53, v53
  v_cvt_pk_bf16_f32 v127, v50, v51
  v_exp_f32 v54, v54
  s_waitcnt lgkmcnt(4)
  v_mfma_f32_32x32x16_bf16 v[108:123], v[40:43], v[136:139], v[108:123]
  v_exp_f32 v55, v55
  v_cvt_pk_bf16_f32 v128, v52, v53
  s_mov_b64 exec, s[78:79]
  ds_read_b128 v[36:39], v3 offset:18432
  ds_read_b128 v[40:43], v3 offset:18944
  s_mov_b64 exec, -1
  v_exp_f32 v56, v56
  v_exp_f32 v57, v57
  v_cvt_pk_bf16_f32 v129, v54, v55
  v_exp_f32 v58, v58
  v_exp_f32 v59, v59
  v_cvt_pk_bf16_f32 v130, v56, v57
  v_cvt_pk_bf16_f32 v131, v58, v59
  s_waitcnt lgkmcnt(5)
  v_mfma_f32_32x32x16_bf16 v[44:59], v[20:23], v[8:11], v[92:107]
  v_exp_f32 v60, v60
  v_exp_f32 v61, v61
  v_exp_f32 v62, v62
  v_exp_f32 v63, v63
  v_cvt_pk_bf16_f32 v132, v60, v61
  v_exp_f32 v64, v64
  s_waitcnt lgkmcnt(4)
  v_mfma_f32_32x32x16_bf16 v[108:123], v[28:31], v[124:127], v[108:123]
  v_exp_f32 v65, v65
  v_cvt_pk_bf16_f32 v133, v62, v63
  v_exp_f32 v66, v66
  v_exp_f32 v67, v67
  v_cvt_pk_bf16_f32 v134, v64, v65
  v_exp_f32 v68, v68
  v_exp_f32 v69, v69
  v_cvt_pk_bf16_f32 v135, v66, v67
  v_exp_f32 v70, v70
  s_waitcnt lgkmcnt(3)
  v_mfma_f32_32x32x16_bf16 v[108:123], v[32:35], v[128:131], v[108:123]
  v_exp_f32 v71, v71
  v_cvt_pk_bf16_f32 v136, v68, v69
  s_mov_b64 exec, s[78:79]
  ds_read_b128 v[28:31], v3 offset:17408
  ds_read_b128 v[32:35], v3 offset:17920
  s_mov_b64 exec, -1
  v_exp_f32 v72, v72
  v_exp_f32 v73, v73
  v_cvt_pk_bf16_f32 v137, v70, v71
  v_exp_f32 v74, v74
  v_exp_f32 v75, v75
  v_cvt_pk_bf16_f32 v138, v72, v73
  v_cvt_pk_bf16_f32 v139, v74, v75
  s_waitcnt lgkmcnt(4)
  v_mfma_f32_32x32x16_bf16 v[60:75], v[24:27], v[8:11], v[92:107]
  v_exp_f32 v44, v44
  v_exp_f32 v45, v45
  v_exp_f32 v46, v46
  v_exp_f32 v47, v47
  v_cvt_pk_bf16_f32 v124, v44, v45
  v_exp_f32 v48, v48
  s_waitcnt lgkmcnt(3)
  v_mfma_f32_32x32x16_bf16 v[108:123], v[36:39], v[132:135], v[108:123]
  v_exp_f32 v49, v49
  v_cvt_pk_bf16_f32 v125, v46, v47
  v_exp_f32 v50, v50
  v_exp_f32 v51, v51
  v_cvt_pk_bf16_f32 v126, v48, v49
  v_exp_f32 v52, v52
  v_exp_f32 v53, v53
  v_cvt_pk_bf16_f32 v127, v50, v51
  v_exp_f32 v54, v54
  s_waitcnt lgkmcnt(2)
  v_mfma_f32_32x32x16_bf16 v[108:123], v[40:43], v[136:139], v[108:123]
  v_exp_f32 v55, v55
  v_cvt_pk_bf16_f32 v128, v52, v53
  s_mov_b64 exec, s[78:79]
  ds_read_b128 v[36:39], v3 offset:16384
  ds_read_b128 v[40:43], v3 offset:16896
  s_mov_b64 exec, -1
  v_exp_f32 v56, v56
  v_exp_f32 v57, v57
  v_cvt_pk_bf16_f32 v129, v54, v55
  v_exp_f32 v58, v58
  v_exp_f32 v59, v59
  v_cvt_pk_bf16_f32 v130, v56, v57
  v_cvt_pk_bf16_f32 v131, v58, v59
  v_exp_f32 v60, v60
  v_exp_f32 v61, v61
  v_exp_f32 v62, v62
  v_exp_f32 v63, v63
  v_cvt_pk_bf16_f32 v132, v60, v61
  v_exp_f32 v64, v64
  s_waitcnt lgkmcnt(3)
  v_mfma_f32_32x32x16_bf16 v[108:123], v[28:31], v[124:127], v[108:123]
  v_exp_f32 v65, v65
  v_cvt_pk_bf16_f32 v133, v62, v63
  v_exp_f32 v66, v66
  v_exp_f32 v67, v67
  v_cvt_pk_bf16_f32 v134, v64, v65
  v_exp_f32 v68, v68
  v_exp_f32 v69, v69
  v_cvt_pk_bf16_f32 v135, v66, v67
  v_exp_f32 v70, v70
  s_waitcnt lgkmcnt(2)
  v_mfma_f32_32x32x16_bf16 v[108:123], v[32:35], v[128:131], v[108:123]
  v_exp_f32 v71, v71
  v_cvt_pk_bf16_f32 v136, v68, v69
  v_exp_f32 v72, v72
  v_exp_f32 v73, v73
  v_cvt_pk_bf16_f32 v137, v70, v71
  v_exp_f32 v74, v74
  v_exp_f32 v75, v75
  v_cvt_pk_bf16_f32 v138, v72, v73
  v_cvt_pk_bf16_f32 v139, v74, v75
  v_and_b32 v132, v132, v148
  v_and_b32 v133, v133, v149
  v_and_b32 v134, v134, v150
  v_and_b32 v135, v135, v151
  v_and_b32 v136, v136, v152
  v_and_b32 v137, v137, v153
  v_and_b32 v138, v138, v154
  v_and_b32 v139, v139, v155
  s_waitcnt lgkmcnt(1)
  v_mfma_f32_32x32x16_bf16 v[108:123], v[36:39], v[132:135], v[108:123]
  s_waitcnt lgkmcnt(0)
  v_mfma_f32_32x32x16_bf16 v[108:123], v[40:43], v[136:139], v[108:123]
  s_branch gm_AC_fz
gm_AC_v1:
  s_waitcnt lgkmcnt(0)
  s_nop 10
  s_setprio 3
  ds_read_b128 v[12:15], v2 offset:8192
  ds_read_b128 v[16:19], v2 offset:7168
  s_mov_b64 exec, s[78:79]
  ds_read_b128 v[28:31], v3 offset:8192
  ds_read_b128 v[32:35], v3 offset:8704
  s_mov_b64 exec, -1
  s_mov_b64 exec, s[78:79]
  ds_read_b128 v[36:39], v3 offset:7168
  ds_read_b128 v[40:43], v3 offset:7680
  s_mov_b64 exec, -1
  s_waitcnt lgkmcnt(5)
  v_mfma_f32_32x32x16_bf16 v[44:59], v[12:15], v[4:7], 0
  s_nop 11
  v_cndmask_b32 v44, v44, v158, s[44:45]
  v_cndmask_b32 v45, v45, v158, s[46:47]
  v_cndmask_b32 v46, v46, v158, s[48:49]
  v_cndmask_b32 v47, v47, v158, s[50:51]
  v_cndmask_b32 v48, v48, v158, s[52:53]
  v_cndmask_b32 v49, v49, v158, s[54:55]
  v_cndmask_b32 v50, v50, v158, s[56:57]
  v_cndmask_b32 v51, v51, v158, s[58:59]
  v_cndmask_b32 v52, v52, v158, s[60:61]
  v_cndmask_b32 v53, v53, v158, s[62:63]
  v_cndmask_b32 v54, v54, v158, s[64:65]
  v_cndmask_b32 v55, v55, v158, s[66:67]
  v_cndmask_b32 v56, v56, v158, s[68:69]
  v_cndmask_b32 v57, v57, v158, s[70:71]
  v_cndmask_b32 v58, v58, v158, s[72:73]
  v_cndmask_b32 v59, v59, v158, s[74:75]
  v_max3_f32 v156, v44, v45, v46
  v_max3_f32 v157, v47, v48, v49
  v_max3_f32 v157, v50, v51, v157
  v_max3_f32 v156, v52, v53, v156
  v_max3_f32 v157, v54, v55, v157
  v_max3_f32 v156, v56, v57, v156
  v_max3_f32 v157, v58, v59, v157
  v_max_f32 v156, v156, v157
  v_mov_b32 v157, v156
  s_nop 1
  v_permlane32_swap_b32 v156, v157
  v_max_f32 v162, v156, v157
  v_sub_f32 v92, 0, v162
  v_sub_f32 v93, 0, v162
  v_sub_f32 v94, 0, v162
  v_sub_f32 v95, 0, v162
  v_sub_f32 v96, 0, v162
  v_sub_f32 v97, 0, v162
  v_sub_f32 v98, 0, v162
  v_sub_f32 v99, 0, v162
  v_sub_f32 v100, 0, v162
  v_sub_f32 v101, 0, v162
  v_sub_f32 v102, 0, v162
  v_sub_f32 v103, 0, v162
  v_sub_f32 v104, 0, v162
  v_sub_f32 v105, 0, v162
  v_sub_f32 v106, 0, v162
  v_sub_f32 v107, 0, v162
  v_sub_f32 v44, v44, v162
  v_sub_f32 v45, v45, v162
  v_sub_f32 v46, v46, v162
  v_sub_f32 v47, v47, v162
  v_sub_f32 v48, v48, v162
  v_sub_f32 v49, v49, v162
  v_sub_f32 v50, v50, v162
  v_sub_f32 v51, v51, v162
  v_sub_f32 v52, v52, v162
  v_sub_f32 v53, v53, v162
  v_sub_f32 v54, v54, v162
  v_sub_f32 v55, v55, v162
  v_sub_f32 v56, v56, v162
  v_sub_f32 v57, v57, v162
  v_sub_f32 v58, v58, v162
  v_sub_f32 v59, v59, v162
  s_waitcnt lgkmcnt(4)
  v_mfma_f32_32x32x16_bf16 v[60:75], v[16:19], v[4:7], v[92:107]
  v_exp_f32 v44, v44
  v_exp_f32 v45, v45
  v_exp_f32 v46, v46
  v_exp_f32 v47, v47
  v_cvt_pk_bf16_f32 v124, v44, v45
  v_exp_f32 v48, v48
  v_exp_f32 v49, v49
  v_cvt_pk_bf16_f32 v125, v46, v47
  v_exp_f32 v50, v50
  v_exp_f32 v51, v51
  v_cvt_pk_bf16_f32 v126, v48, v49
  v_exp_f32 v52, v52
  v_exp_f32 v53, v53
  v_cvt_pk_bf16_f32 v127, v50, v51
  v_exp_f32 v54, v54
  v_exp_f32 v55, v55
  v_cvt_pk_bf16_f32 v128, v52, v53
  v_exp_f32 v56, v56
  v_exp_f32 v57, v57
  v_cvt_pk_bf16_f32 v129, v54, v55
  v_exp_f32 v58, v58
  v_exp_f32 v59, v59
  v_cvt_pk_bf16_f32 v130, v56, v57
  v_cvt_pk_bf16_f32 v131, v58, v59
  v_exp_f32 v60, v60
  v_exp_f32 v61, v61
  v_exp_f32 v62, v62
  v_exp_f32 v63, v63
  v_cvt_pk_bf16_f32 v132, v60, v61
  v_exp_f32 v64, v64
  s_waitcnt lgkmcnt(3)
  v_mfma_f32_32x32x16_bf16 v[76:91], v[28:31], v[124:127], 0
  v_exp_f32 v65, v65
  v_cvt_pk_bf16_f32 v133, v62, v63
  v_exp_f32 v66, v66
  v_exp_f32 v67, v67
  v_cvt_pk_bf16_f32 v134, v64, v65
  v_exp_f32 v68, v68
  v_exp_f32 v69, v69
  v_cvt_pk_bf16_f32 v135, v66, v67
  v_exp_f32 v70, v70
  s_waitcnt lgkmcnt(2)
  v_mfma_f32_32x32x16_bf16 v[76:91], v[32:35], v[128:131], v[76:91]
  v_exp_f32 v71, v71
  v_cvt_pk_bf16_f32 v136, v68, v69
  v_exp_f32 v72, v72
  v_exp_f32 v73, v73
  v_cvt_pk_bf16_f32 v137, v70, v71
  v_exp_f32 v74, v74
  v_exp_f32 v75, v75
  v_cvt_pk_bf16_f32 v138, v72, v73
  v_cvt_pk_bf16_f32 v139, v74, v75
  s_waitcnt lgkmcnt(1)
  v_mfma_f32_32x32x16_bf16 v[76:91], v[36:39], v[132:135], v[76:91]
  s_waitcnt lgkmcnt(0)
  v_mfma_f32_32x32x16_bf16 v[76:91], v[40:43], v[136:139], v[76:91]
  s_setprio 2
  ds_read_b128 v[12:15], v2 offset:24576
  ds_read_b128 v[16:19], v2 offset:23552
  s_mov_b64 exec, s[78:79]
  ds_read_b128 v[28:31], v3 offset:24576
  ds_read_b128 v[32:35], v3 offset:25088
  s_mov_b64 exec, -1
  s_mov_b64 exec, s[78:79]
  ds_read_b128 v[36:39], v3 offset:23552
  ds_read_b128 v[40:43], v3 offset:24064
  s_mov_b64 exec, -1
  s_waitcnt lgkmcnt(5)
  v_mfma_f32_32x32x16_bf16 v[44:59], v[12:15], v[8:11], 0
  s_nop 11
  v_cndmask_b32 v44, v44, v158, s[44:45]
  v_cndmask_b32 v45, v45, v158, s[46:47]
  v_cndmask_b32 v46, v46, v158, s[48:49]
  v_cndmask_b32 v47, v47, v158, s[50:51]
  v_cndmask_b32 v48, v48, v158, s[52:53]
  v_cndmask_b32 v49, v49, v158, s[54:55]
  v_cndmask_b32 v50, v50, v158, s[56:57]
  v_cndmask_b32 v51, v51, v158, s[58:59]
  v_cndmask_b32 v52, v52, v158, s[60:61]
  v_cndmask_b32 v53, v53, v158, s[62:63]
  v_cndmask_b32 v54, v54, v158, s[64:65]
  v_cndmask_b32 v55, v55, v158, s[66:67]
  v_cndmask_b32 v56, v56, v158, s[68:69]
  v_cndmask_b32 v57, v57, v158, s[70:71]
  v_cndmask_b32 v58, v58, v158, s[72:73]
  v_cndmask_b32 v59, v59, v158, s[74:75]
  v_max3_f32 v156, v44, v45, v46
  v_max3_f32 v157, v47, v48, v49
  v_max3_f32 v157, v50, v51, v157
  v_max3_f32 v156, v52, v53, v156
  v_max3_f32 v157, v54, v55, v157
  v_max3_f32 v156, v56, v57, v156
  v_max3_f32 v157, v58, v59, v157
  v_max_f32 v156, v156, v157
  v_mov_b32 v157, v156
  s_nop 1
  v_permlane32_swap_b32 v156, v157
  v_max_f32 v163, v156, v157
  v_sub_f32 v92, 0, v163
  v_sub_f32 v93, 0, v163
  v_sub_f32 v94, 0, v163
  v_sub_f32 v95, 0, v163
  v_sub_f32 v96, 0, v163
  v_sub_f32 v97, 0, v163
  v_sub_f32 v98, 0, v163
  v_sub_f32 v99, 0, v163
  v_sub_f32 v100, 0, v163
  v_sub_f32 v101, 0, v163
  v_sub_f32 v102, 0, v163
  v_sub_f32 v103, 0, v163
  v_sub_f32 v104, 0, v163
  v_sub_f32 v105, 0, v163
  v_sub_f32 v106, 0, v163
  v_sub_f32 v107, 0, v163
  v_sub_f32 v44, v44, v163
  v_sub_f32 v45, v45, v163
  v_sub_f32 v46, v46, v163
  v_sub_f32 v47, v47, v163
  v_sub_f32 v48, v48, v163
  v_sub_f32 v49, v49, v163
  v_sub_f32 v50, v50, v163
  v_sub_f32 v51, v51, v163
  v_sub_f32 v52, v52, v163
  v_sub_f32 v53, v53, v163
  v_sub_f32 v54, v54, v163
  v_sub_f32 v55, v55, v163
  v_sub_f32 v56, v56, v163
  v_sub_f32 v57, v57, v163
  v_sub_f32 v58, v58, v163
  v_sub_f32 v59, v59, v163
  s_waitcnt lgkmcnt(4)
  v_mfma_f32_32x32x16_bf16 v[60:75], v[16:19], v[8:11], v[92:107]
  v_exp_f32 v44, v44
  v_exp_f32 v45, v45
  v_exp_f32 v46, v46
  v_exp_f32 v47, v47
  v_cvt_pk_bf16_f32 v124, v44, v45
  v_exp_f32 v48, v48
  v_exp_f32 v49, v49
  v_cvt_pk_bf16_f32 v125, v46, v47
  v_exp_f32 v50, v50
  v_exp_f32 v51, v51
  v_cvt_pk_bf16_f32 v126, v48, v49
  v_exp_f32 v52, v52
  v_exp_f32 v53, v53
  v_cvt_pk_bf16_f32 v127, v50, v51
  v_exp_f32 v54, v54
  v_exp_f32 v55, v55
  v_cvt_pk_bf16_f32 v128, v52, v53
  v_exp_f32 v56, v56
  v_exp_f32 v57, v57
  v_cvt_pk_bf16_f32 v129, v54, v55
  v_exp_f32 v58, v58
  v_exp_f32 v59, v59
  v_cvt_pk_bf16_f32 v130, v56, v57
  v_cvt_pk_bf16_f32 v131, v58, v59
  v_exp_f32 v60, v60
  v_exp_f32 v61, v61
  v_exp_f32 v62, v62
  v_exp_f32 v63, v63
  v_cvt_pk_bf16_f32 v132, v60, v61
  v_exp_f32 v64, v64
  s_waitcnt lgkmcnt(3)
  v_mfma_f32_32x32x16_bf16 v[108:123], v[28:31], v[124:127], 0
  v_exp_f32 v65, v65
  v_cvt_pk_bf16_f32 v133, v62, v63
  v_exp_f32 v66, v66
  v_exp_f32 v67, v67
  v_cvt_pk_bf16_f32 v134, v64, v65
  v_exp_f32 v68, v68
  v_exp_f32 v69, v69
  v_cvt_pk_bf16_f32 v135, v66, v67
  v_exp_f32 v70, v70
  s_waitcnt lgkmcnt(2)
  v_mfma_f32_32x32x16_bf16 v[108:123], v[32:35], v[128:131], v[108:123]
  v_exp_f32 v71, v71
  v_cvt_pk_bf16_f32 v136, v68, v69
  v_exp_f32 v72, v72
  v_exp_f32 v73, v73
  v_cvt_pk_bf16_f32 v137, v70, v71
  v_exp_f32 v74, v74
  v_exp_f32 v75, v75
  v_cvt_pk_bf16_f32 v138, v72, v73
  v_cvt_pk_bf16_f32 v139, v74, v75
  s_waitcnt lgkmcnt(1)
  v_mfma_f32_32x32x16_bf16 v[108:123], v[36:39], v[132:135], v[108:123]
  s_waitcnt lgkmcnt(0)
  v_mfma_f32_32x32x16_bf16 v[108:123], v[40:43], v[136:139], v[108:123]
  s_waitcnt lgkmcnt(0)
  s_barrier
  s_cmp_eq_u32 s83, 0
  s_cbranch_scc1 gm_AC_fz
  s_setprio 1
  ds_read_b128 v[12:15], v2 offset:6144
  ds_read_b128 v[16:19], v2 offset:5120
  ds_read_b128 v[20:23], v2 offset:4096
  s_mov_b64 exec, s[78:79]
  ds_read_b128 v[28:31], v3 offset:6144
  ds_read_b128 v[32:35], v3 offset:6656
  s_mov_b64 exec, -1
  s_mov_b64 exec, s[78:79]
  ds_read_b128 v[36:39], v3 offset:5120
  ds_read_b128 v[40:43], v3 offset:5632
  s_mov_b64 exec, -1
  v_sub_f32 v92, 0, v162
  v_sub_f32 v93, 0, v162
  v_sub_f32 v94, 0, v162
  v_sub_f32 v95, 0, v162
  v_sub_f32 v96, 0, v162
  v_sub_f32 v97, 0, v162
  v_sub_f32 v98, 0, v162
  v_sub_f32 v99, 0, v162
  v_sub_f32 v100, 0, v162
  v_sub_f32 v101, 0, v162
  v_sub_f32 v102, 0, v162
  v_sub_f32 v103, 0, v162
  v_sub_f32 v104, 0, v162
  v_sub_f32 v105, 0, v162
  v_sub_f32 v106, 0, v162
  v_sub_f32 v107, 0, v162
  s_waitcnt lgkmcnt(6)
  s_nop 0
  v_mfma_f32_32x32x16_bf16 v[44:59], v[12:15], v[4:7], v[92:107]
  s_waitcnt lgkmcnt(5)
  v_mfma_f32_32x32x16_bf16 v[60:75], v[16:19], v[4:7], v[92:107]
  ds_read_b128 v[24:27], v2 offset:3072
  s_nop 8
  v_exp_f32 v44, v44
  v_exp_f32 v45, v45
  v_exp_f32 v46, v46
  v_exp_f32 v47, v47
  v_cvt_pk_bf16_f32 v124, v44, v45
  v_exp_f32 v48, v48
  v_exp_f32 v49, v49
  v_cvt_pk_bf16_f32 v125, v46, v47
  v_exp_f32 v50, v50
  v_exp_f32 v51, v51
  v_cvt_pk_bf16_f32 v126, v48, v49
  v_exp_f32 v52, v52
  v_exp_f32 v53, v53
  v_cvt_pk_bf16_f32 v127, v50, v51
  v_exp_f32 v54, v54
  v_exp_f32 v55, v55
  v_cvt_pk_bf16_f32 v128, v52, v53
  v_exp_f32 v56, v56
  v_exp_f32 v57, v57
  v_cvt_pk_bf16_f32 v129, v54, v55
  v_exp_f32 v58, v58
  v_exp_f32 v59, v59
  v_cvt_pk_bf16_f32 v130, v56, v57
  v_cvt_pk_bf16_f32 v131, v58, v59
  s_waitcnt lgkmcnt(5)
  v_mfma_f32_32x32x16_bf16 v[44:59], v[20:23], v[4:7], v[92:107]
  ds_read_b128 v[12:15], v2 offset:2048
  v_exp_f32 v60, v60
  v_exp_f32 v61, v61
  v_exp_f32 v62, v62
  v_exp_f32 v63, v63
  v_cvt_pk_bf16_f32 v132, v60, v61
  v_exp_f32 v64, v64
  s_waitcnt lgkmcnt(5)
  v_mfma_f32_32x32x16_bf16 v[76:91], v[28:31], v[124:127], v[76:91]
  v_exp_f32 v65, v65
  v_cvt_pk_bf16_f32 v133, v62, v63
  v_exp_f32 v66, v66
  v_exp_f32 v67, v67
  v_cvt_pk_bf16_f32 v134, v64, v65
  v_exp_f32 v68, v68
  v_exp_f32 v69, v69
  v_cvt_pk_bf16_f32 v135, v66, v67
  v_exp_f32 v70, v70
  s_waitcnt lgkmcnt(4)
  v_mfma_f32_32x32x16_bf16 v[76:91], v[32:35], v[128:131], v[76:91]
  v_exp_f32 v71, v71
  v_cvt_pk_bf16_f32 v136, v68, v69
  s_mov_b64 exec, s[78:79]
  ds_read_b128 v[28:31], v3 offset:4096
  ds_read_b128 v[32:35], v3 offset:4608
  s_mov_b64 exec, -1
  v_exp_f32 v72, v72
  v_exp_f32 v73, v73
  v_cvt_pk_bf16_f32 v137, v70, v71
  v_exp_f32 v74, v74
  v_exp_f32 v75, v75
  v_cvt_pk_bf16_f32 v138, v72, v73
  v_cvt_pk_bf16_f32 v139, v74, v75
  s_waitcnt lgkmcnt(3)
  v_mfma_f32_32x32x16_bf16 v[60:75], v[24:27], v[4:7], v[92:107]
  ds_read_b128 v[16:19], v2 offset:1024
  v_exp_f32 v44, v44
  v_exp_f32 v45, v45
  v_exp_f32 v46, v46
  v_exp_f32 v47, v47
  v_cvt_pk_bf16_f32 v124, v44, v45
  v_exp_f32 v48, v48
  v_mfma_f32_32x32x16_bf16 v[76:91], v[36:39], v[132:135], v[76:91]
  v_exp_f32 v49, v49
  v_cvt_pk_bf16_f32 v125, v46, v47
  v_exp_f32 v50, v50
  v_exp_f32 v51, v51
  v_cvt_pk_bf16_f32 v126, v48, v49
  v_exp_f32 v52, v52
  v_exp_f32 v53, v53
  v_cvt_pk_bf16_f32 v127, v50, v51
  v_exp_f32 v54, v54
  v_mfma_f32_32x32x16_bf16 v[76:91], v[40:43], v[136:139], v[76:91]
  v_exp_f32 v55, v55
  v_cvt_pk_bf16_f32 v128, v52, v53
  s_mov_b64 exec, s[78:79]
  ds_read_b128 v[36:39], v3 offset:3072
  ds_read_b128 v[40:43], v3 offset:3584
  s_mov_b64 exec, -1
  v_exp_f32 v56, v56
  v_exp_f32 v57, v57
  v_cvt_pk_bf16_f32 v129, v54, v55
  v_exp_f32 v58, v58
  v_exp_f32 v59, v59
  v_cvt_pk_bf16_f32 v130, v56, v57
  v_cvt_pk_bf16_f32 v131, v58, v59
  s_waitcnt lgkmcnt(5)
  v_mfma_f32_32x32x16_bf16 v[44:59], v[12:15], v[4:7], v[92:107]
  ds_read_b128 v[20:23], v2 offset:0
  v_exp_f32 v60, v60
  v_exp_f32 v61, v61
  v_exp_f32 v62, v62
  v_exp_f32 v63, v63
  v_cvt_pk_bf16_f32 v132, v60, v61
  v_exp_f32 v64, v64
  s_waitcnt lgkmcnt(5)
  v_mfma_f32_32x32x16_bf16 v[76:91], v[28:31], v[124:127], v[76:91]
  v_exp_f32 v65, v65
  v_cvt_pk_bf16_f32 v133, v62, v63
  v_exp_f32 v66, v66
  v_exp_f32 v67, v67
  v_cvt_pk_bf16_f32 v134, v64, v65
  v_exp_f32 v68, v68
  v_exp_f32 v69, v69
  v_cvt_pk_bf16_f32 v135, v66, v67
  v_exp_f32 v70, v70
  s_waitcnt lgkmcnt(4)
  v_mfma_f32_32x32x16_bf16 v[76:91], v[32:35], v[128:131], v[76:91]
  v_exp_f32 v71, v71
  v_cvt_pk_bf16_f32 v136, v68, v69
  s_mov_b64 exec, s[78:79]
  ds_read_b128 v[28:31], v3 offset:2048
  ds_read_b128 v[32:35], v3 offset:2560
  s_mov_b64 exec, -1
  v_exp_f32 v72, v72
  v_exp_f32 v73, v73
  v_cvt_pk_bf16_f32 v137, v70, v71
  v_exp_f32 v74, v74
  v_exp_f32 v75, v75
  v_cvt_pk_bf16_f32 v138, v72, v73
  v_cvt_pk_bf16_f32 v139, v74, v75
  s_waitcnt lgkmcnt(5)
  v_mfma_f32_32x32x16_bf16 v[60:75], v[16:19], v[4:7], v[92:107]
  v_exp_f32 v44, v44
  v_exp_f32 v45, v45
  v_exp_f32 v46, v46
  v_exp_f32 v47, v47
  v_cvt_pk_bf16_f32 v124, v44, v45
  v_exp_f32 v48, v48
  s_waitcnt lgkmcnt(4)
  v_mfma_f32_32x32x16_bf16 v[76:91], v[36:39], v[132:135], v[76:91]
  v_exp_f32 v49, v49
  v_cvt_pk_bf16_f32 v125, v46, v47
  v_exp_f32 v50, v50
  v_exp_f32 v51, v51
  v_cvt_pk_bf16_f32 v126, v48, v49
  v_exp_f32 v52, v52
  v_exp_f32 v53, v53
  v_cvt_pk_bf16_f32 v127, v50, v51
  v_exp_f32 v54, v54
  s_waitcnt lgkmcnt(3)
  v_mfma_f32_32x32x16_bf16 v[76:91], v[40:43], v[136:139], v[76:91]
  v_exp_f32 v55, v55
  v_cvt_pk_bf16_f32 v128, v52, v53
  s_mov_b64 exec, s[78:79]
  ds_read_b128 v[36:39], v3 offset:1024
  ds_read_b128 v[40:43], v3 offset:1536
  s_mov_b64 exec, -1
  v_exp_f32 v56, v56
  v_exp_f32 v57, v57
  v_cvt_pk_bf16_f32 v129, v54, v55
  v_exp_f32 v58, v58
  v_exp_f32 v59, v59
  v_cvt_pk_bf16_f32 v130, v56, v57
  v_cvt_pk_bf16_f32 v131, v58, v59
  s_waitcnt lgkmcnt(4)
  v_mfma_f32_32x32x16_bf16 v[44:59], v[20:23], v[4:7], v[92:107]
  v_exp_f32 v60, v60
  v_exp_f32 v61, v61
  v_exp_f32 v62, v62
  v_exp_f32 v63, v63
  v_cvt_pk_bf16_f32 v132, v60, v61
  v_exp_f32 v64, v64
  s_waitcnt lgkmcnt(3)
  v_mfma_f32_32x32x16_bf16 v[76:91], v[28:31], v[124:127], v[76:91]
  v_exp_f32 v65, v65
  v_cvt_pk_bf16_f32 v133, v62, v63
  v_exp_f32 v66, v66
  v_exp_f32 v67, v67
  v_cvt_pk_bf16_f32 v134, v64, v65
  v_exp_f32 v68, v68
  v_exp_f32 v69, v69
  v_cvt_pk_bf16_f32 v135, v66, v67
  v_exp_f32 v70, v70
  s_waitcnt lgkmcnt(2)
  v_mfma_f32_32x32x16_bf16 v[76:91], v[32:35], v[128:131], v[76:91]
  v_exp_f32 v71, v71
  v_cvt_pk_bf16_f32 v136, v68, v69
  s_mov_b64 exec, s[78:79]
  ds_read_b128 v[28:31], v3 offset:0
  ds_read_b128 v[32:35], v3 offset:512
  s_mov_b64 exec, -1
  v_exp_f32 v72, v72
  v_exp_f32 v73, v73
  v_cvt_pk_bf16_f32 v137, v70, v71
  v_exp_f32 v74, v74
  v_exp_f32 v75, v75
  v_cvt_pk_bf16_f32 v138, v72, v73
  v_cvt_pk_bf16_f32 v139, v74, v75
  v_exp_f32 v44, v44
  v_exp_f32 v45, v45
  v_exp_f32 v46, v46
  v_exp_f32 v47, v47
  v_cvt_pk_bf16_f32 v124, v44, v45
  v_exp_f32 v48, v48
  s_waitcnt lgkmcnt(3)
  v_mfma_f32_32x32x16_bf16 v[76:91], v[36:39], v[132:135], v[76:91]
  v_exp_f32 v49, v49
  v_cvt_pk_bf16_f32 v125, v46, v47
  v_exp_f32 v50, v50
  v_exp_f32 v51, v51
  v_cvt_pk_bf16_f32 v126, v48, v49
  v_exp_f32 v52, v52
  v_exp_f32 v53, v53
  v_cvt_pk_bf16_f32 v127, v50, v51
  v_exp_f32 v54, v54
  s_waitcnt lgkmcnt(2)
  v_mfma_f32_32x32x16_bf16 v[76:91], v[40:43], v[136:139], v[76:91]
  v_exp_f32 v55, v55
  v_cvt_pk_bf16_f32 v128, v52, v53
  v_exp_f32 v56, v56
  v_exp_f32 v57, v57
  v_cvt_pk_bf16_f32 v129, v54, v55
  v_exp_f32 v58, v58
  v_exp_f32 v59, v59
  v_cvt_pk_bf16_f32 v130, v56, v57
  v_cvt_pk_bf16_f32 v131, v58, v59
  v_and_b32 v124, v124, v148
  v_and_b32 v125, v125, v149
  v_and_b32 v126, v126, v150
  v_and_b32 v127, v127, v151
  v_and_b32 v128, v128, v152
  v_and_b32 v129, v129, v153
  v_and_b32 v130, v130, v154
  v_and_b32 v131, v131, v155
  s_waitcnt lgkmcnt(1)
  v_mfma_f32_32x32x16_bf16 v[76:91], v[28:31], v[124:127], v[76:91]
  s_waitcnt lgkmcnt(0)
  v_mfma_f32_32x32x16_bf16 v[76:91], v[32:35], v[128:131], v[76:91]
  s_setprio 0
  ds_read_b128 v[12:15], v2 offset:22528
  ds_read_b128 v[16:19], v2 offset:21504
  ds_read_b128 v[20:23], v2 offset:20480
  s_mov_b64 exec, s[78:79]
  ds_read_b128 v[28:31], v3 offset:22528
  ds_read_b128 v[32:35], v3 offset:23040
  s_mov_b64 exec, -1
  s_mov_b64 exec, s[78:79]
  ds_read_b128 v[36:39], v3 offset:21504
  ds_read_b128 v[40:43], v3 offset:22016
  s_mov_b64 exec, -1
  v_sub_f32 v92, 0, v163
  v_sub_f32 v93, 0, v163
  v_sub_f32 v94, 0, v163
  v_sub_f32 v95, 0, v163
  v_sub_f32 v96, 0, v163
  v_sub_f32 v97, 0, v163
  v_sub_f32 v98, 0, v163
  v_sub_f32 v99, 0, v163
  v_sub_f32 v100, 0, v163
  v_sub_f32 v101, 0, v163
  v_sub_f32 v102, 0, v163
  v_sub_f32 v103, 0, v163
  v_sub_f32 v104, 0, v163
  v_sub_f32 v105, 0, v163
  v_sub_f32 v106, 0, v163
  v_sub_f32 v107, 0, v163
  s_waitcnt lgkmcnt(6)
  s_nop 0
  v_mfma_f32_32x32x16_bf16 v[44:59], v[12:15], v[8:11], v[92:107]
  s_waitcnt lgkmcnt(5)
  v_mfma_f32_32x32x16_bf16 v[60:75], v[16:19], v[8:11], v[92:107]
  ds_read_b128 v[24:27], v2 offset:19456
  s_nop 8
  v_exp_f32 v44, v44
  v_exp_f32 v45, v45
  v_exp_f32 v46, v46
  v_exp_f32 v47, v47
  v_cvt_pk_bf16_f32 v124, v44, v45
  v_exp_f32 v48, v48
  v_exp_f32 v49, v49
  v_cvt_pk_bf16_f32 v125, v46, v47
  v_exp_f32 v50, v50
  v_exp_f32 v51, v51
  v_cvt_pk_bf16_f32 v126, v48, v49
  v_exp_f32 v52, v52
  v_exp_f32 v53, v53
  v_cvt_pk_bf16_f32 v127, v50, v51
  v_exp_f32 v54, v54
  v_exp_f32 v55, v55
  v_cvt_pk_bf16_f32 v128, v52, v53
  v_exp_f32 v56, v56
  v_exp_f32 v57, v57
  v_cvt_pk_bf16_f32 v129, v54, v55
  v_exp_f32 v58, v58
  v_exp_f32 v59, v59
  v_cvt_pk_bf16_f32 v130, v56, v57
  v_cvt_pk_bf16_f32 v131, v58, v59
  s_waitcnt lgkmcnt(5)
  v_mfma_f32_32x32x16_bf16 v[44:59], v[20:23], v[8:11], v[92:107]
  ds_read_b128 v[12:15], v2 offset:18432
  v_exp_f32 v60, v60
  v_exp_f32 v61, v61
  v_exp_f32 v62, v62
  v_exp_f32 v63, v63
  v_cvt_pk_bf16_f32 v132, v60, v61
  v_exp_f32 v64, v64
  s_waitcnt lgkmcnt(5)
  v_mfma_f32_32x32x16_bf16 v[108:123], v[28:31], v[124:127], v[108:123]
  v_exp_f32 v65, v65
  v_cvt_pk_bf16_f32 v133, v62, v63
  v_exp_f32 v66, v66
  v_exp_f32 v67, v67
  v_cvt_pk_bf16_f32 v134, v64, v65
  v_exp_f32 v68, v68
  v_exp_f32 v69, v69
  v_cvt_pk_bf16_f32 v135, v66, v67
  v_exp_f32 v70, v70
  s_waitcnt lgkmcnt(4)
  v_mfma_f32_32x32x16_bf16 v[108:123], v[32:35], v[128:131], v[108:123]
  v_exp_f32 v71, v71
  v_cvt_pk_bf16_f32 v136, v68, v69
  s_mov_b64 exec, s[78:79]
  ds_read_b128 v[28:31], v3 offset:20480
  ds_read_b128 v[32:35], v3 offset:20992
  s_mov_b64 exec, -1
  v_exp_f32 v72, v72
  v_exp_f32 v73, v73
  v_cvt_pk_bf16_f32 v137, v70, v71
  v_exp_f32 v74, v74
  v_exp_f32 v75, v75
  v_cvt_pk_bf16_f32 v138, v72, v73
  v_cvt_pk_bf16_f32 v139, v74, v75
  s_waitcnt lgkmcnt(3)
  v_mfma_f32_32x32x16_bf16 v[60:75], v[24:27], v[8:11], v[92:107]
  ds_read_b128 v[16:19], v2 offset:17408
  v_exp_f32 v44, v44
  v_exp_f32 v45, v45
  v_exp_f32 v46, v46
  v_exp_f32 v47, v47
  v_cvt_pk_bf16_f32 v124, v44, v45
  v_exp_f32 v48, v48
  v_mfma_f32_32x32x16_bf16 v[108:123], v[36:39], v[132:135], v[108:123]
  v_exp_f32 v49, v49
  v_cvt_pk_bf16_f32 v125, v46, v47
  v_exp_f32 v50, v50
  v_exp_f32 v51, v51
  v_cvt_pk_bf16_f32 v126, v48, v49
  v_exp_f32 v52, v52
  v_exp_f32 v53, v53
  v_cvt_pk_bf16_f32 v127, v50, v51
  v_exp_f32 v54, v54
  v_mfma_f32_32x32x16_bf16 v[108:123], v[40:43], v[136:139], v[108:123]
  v_exp_f32 v55, v55
  v_cvt_pk_bf16_f32 v128, v52, v53
  s_mov_b64 exec, s[78:79]
  ds_read_b128 v[36:39], v3 offset:19456
  ds_read_b128 v[40:43], v3 offset:19968
  s_mov_b64 exec, -1
  v_exp_f32 v56, v56
  v_exp_f32 v57, v57
  v_cvt_pk_bf16_f32 v129, v54, v55
  v_exp_f32 v58, v58
  v_exp_f32 v59, v59
  v_cvt_pk_bf16_f32 v130, v56, v57
  v_cvt_pk_bf16_f32 v131, v58, v59
  s_waitcnt lgkmcnt(5)
  v_mfma_f32_32x32x16_bf16 v[44:59], v[12:15], v[8:11], v[92:107]
  ds_read_b128 v[20:23], v2 offset:16384
  v_exp_f32 v60, v60
  v_exp_f32 v61, v61
  v_exp_f32 v62, v62
  v_exp_f32 v63, v63
  v_cvt_pk_bf16_f32 v132, v60, v61
  v_exp_f32 v64, v64
  s_waitcnt lgkmcnt(5)
  v_mfma_f32_32x32x16_bf16 v[108:123], v[28:31], v[124:127], v[108:123]
  v_exp_f32 v65, v65
  v_cvt_pk_bf16_f32 v133, v62, v63
  v_exp_f32 v66, v66
  v_exp_f32 v67, v67
  v_cvt_pk_bf16_f32 v134, v64, v65
  v_exp_f32 v68, v68
  v_exp_f32 v69, v69
  v_cvt_pk_bf16_f32 v135, v66, v67
  v_exp_f32 v70, v70
  s_waitcnt lgkmcnt(4)
  v_mfma_f32_32x32x16_bf16 v[108:123], v[32:35], v[128:131], v[108:123]
  v_exp_f32 v71, v71
  v_cvt_pk_bf16_f32 v136, v68, v69
  s_mov_b64 exec, s[78:79]
  ds_read_b128 v[28:31], v3 offset:18432
  ds_read_b128 v[32:35], v3 offset:18944
  s_mov_b64 exec, -1
  v_exp_f32 v72, v72
  v_exp_f32 v73, v73
  v_cvt_pk_bf16_f32 v137, v70, v71
  v_exp_f32 v74, v74
  v_exp_f32 v75, v75
  v_cvt_pk_bf16_f32 v138, v72, v73
  v_cvt_pk_bf16_f32 v139, v74, v75
  s_waitcnt lgkmcnt(5)
  v_mfma_f32_32x32x16_bf16 v[60:75], v[16:19], v[8:11], v[92:107]
  v_exp_f32 v44, v44
  v_exp_f32 v45, v45
  v_exp_f32 v46, v46
  v_exp_f32 v47, v47
  v_cvt_pk_bf16_f32 v124, v44, v45
  v_exp_f32 v48, v48
  s_waitcnt lgkmcnt(4)
  v_mfma_f32_32x32x16_bf16 v[108:123], v[36:39], v[132:135], v[108:123]
  v_exp_f32 v49, v49
  v_cvt_pk_bf16_f32 v125, v46, v47
  v_exp_f32 v50, v50
  v_exp_f32 v51, v51
  v_cvt_pk_bf16_f32 v126, v48, v49
  v_exp_f32 v52, v52
  v_exp_f32 v53, v53
  v_cvt_pk_bf16_f32 v127, v50, v51
  v_exp_f32 v54, v54
  s_waitcnt lgkmcnt(3)
  v_mfma_f32_32x32x16_bf16 v[108:123], v[40:43], v[136:139], v[108:123]
  v_exp_f32 v55, v55
  v_cvt_pk_bf16_f32 v128, v52, v53
  s_mov_b64 exec, s[78:79]
  ds_read_b128 v[36:39], v3 offset:17408
  ds_read_b128 v[40:43], v3 offset:17920
  s_mov_b64 exec, -1
  v_exp_f32 v56, v56
  v_exp_f32 v57, v57
  v_cvt_pk_bf16_f32 v129, v54, v55
  v_exp_f32 v58, v58
  v_exp_f32 v59, v59
  v_cvt_pk_bf16_f32 v130, v56, v57
  v_cvt_pk_bf16_f32 v131, v58, v59
  s_waitcnt lgkmcnt(4)
  v_mfma_f32_32x32x16_bf16 v[44:59], v[20:23], v[8:11], v[92:107]
  v_exp_f32 v60, v60
  v_exp_f32 v61, v61
  v_exp_f32 v62, v62
  v_exp_f32 v63, v63
  v_cvt_pk_bf16_f32 v132, v60, v61
  v_exp_f32 v64, v64
  s_waitcnt lgkmcnt(3)
  v_mfma_f32_32x32x16_bf16 v[108:123], v[28:31], v[124:127], v[108:123]
  v_exp_f32 v65, v65
  v_cvt_pk_bf16_f32 v133, v62, v63
  v_exp_f32 v66, v66
  v_exp_f32 v67, v67
  v_cvt_pk_bf16_f32 v134, v64, v65
  v_exp_f32 v68, v68
  v_exp_f32 v69, v69
  v_cvt_pk_bf16_f32 v135, v66, v67
  v_exp_f32 v70, v70
  s_waitcnt lgkmcnt(2)
  v_mfma_f32_32x32x16_bf16 v[108:123], v[32:35], v[128:131], v[108:123]
  v_exp_f32 v71, v71
  v_cvt_pk_bf16_f32 v136, v68, v69
  s_mov_b64 exec, s[78:79]
  ds_read_b128 v[28:31], v3 offset:16384
  ds_read_b128 v[32:35], v3 offset:16896
  s_mov_b64 exec, -1
  v_exp_f32 v72, v72
  v_exp_f32 v73, v73
  v_cvt_pk_bf16_f32 v137, v70, v71
  v_exp_f32 v74, v74
  v_exp_f32 v75, v75
  v_cvt_pk_bf16_f32 v138, v72, v73
  v_cvt_pk_bf16_f32 v139, v74, v75
  v_exp_f32 v44, v44
  v_exp_f32 v45, v45
  v_exp_f32 v46, v46
  v_exp_f32 v47, v47
  v_cvt_pk_bf16_f32 v124, v44, v45
  v_exp_f32 v48, v48
  s_waitcnt lgkmcnt(3)
  v_mfma_f32_32x32x16_bf16 v[108:123], v[36:39], v[132:135], v[108:123]
  v_exp_f32 v49, v49
  v_cvt_pk_bf16_f32 v125, v46, v47
  v_exp_f32 v50, v50
  v_exp_f32 v51, v51
  v_cvt_pk_bf16_f32 v126, v48, v49
  v_exp_f32 v52, v52
  v_exp_f32 v53, v53
  v_cvt_pk_bf16_f32 v127, v50, v51
  v_exp_f32 v54, v54
  s_waitcnt lgkmcnt(2)
  v_mfma_f32_32x32x16_bf16 v[108:123], v[40:43], v[136:139], v[108:123]
  v_exp_f32 v55, v55
  v_cvt_pk_bf16_f32 v128, v52, v53
  v_exp_f32 v56, v56
  v_exp_f32 v57, v57
  v_cvt_pk_bf16_f32 v129, v54, v55
  v_exp_f32 v58, v58
  v_exp_f32 v59, v59
  v_cvt_pk_bf16_f32 v130, v56, v57
  v_cvt_pk_bf16_f32 v131, v58, v59
  v_and_b32 v124, v124, v148
  v_and_b32 v125, v125, v149
  v_and_b32 v126, v126, v150
  v_and_b32 v127, v127, v151
  v_and_b32 v128, v128, v152
  v_and_b32 v129, v129, v153
  v_and_b32 v130, v130, v154
  v_and_b32 v131, v131, v155
  s_waitcnt lgkmcnt(1)
  v_mfma_f32_32x32x16_bf16 v[108:123], v[28:31], v[124:127], v[108:123]
  s_waitcnt lgkmcnt(0)
  v_mfma_f32_32x32x16_bf16 v[108:123], v[32:35], v[128:131], v[108:123]
  s_branch gm_AC_fz
gm_AC_v2:
  s_waitcnt lgkmcnt(0)
  s_nop 10
  s_setprio 3
  ds_read_b128 v[12:15], v2 offset:8192
  ds_read_b128 v[16:19], v2 offset:7168
  ds_read_b128 v[20:23], v2 offset:6144
  s_mov_b64 exec, s[78:79]
  ds_read_b128 v[28:31], v3 offset:8192
  ds_read_b128 v[32:35], v3 offset:8704
  s_mov_b64 exec, -1
  s_mov_b64 exec, s[78:79]
  ds_read_b128 v[36:39], v3 offset:7168
  ds_read_b128 v[40:43], v3 offset:7680
  s_mov_b64 exec, -1
  s_waitcnt lgkmcnt(6)
  v_mfma_f32_32x32x16_bf16 v[44:59], v[12:15], v[4:7], 0
  s_nop 11
  v_cndmask_b32 v44, v44, v158, s[44:45]
  v_cndmask_b32 v45, v45, v158, s[46:47]
  v_cndmask_b32 v46, v46, v158, s[48:49]
  v_cndmask_b32 v47, v47, v158, s[50:51]
  v_cndmask_b32 v48, v48, v158, s[52:53]
  v_cndmask_b32 v49, v49, v158, s[54:55]
  v_cndmask_b32 v50, v50, v158, s[56:57]
  v_cndmask_b32 v51, v51, v158, s[58:59]
  v_cndmask_b32 v52, v52, v158, s[60:61]
  v_cndmask_b32 v53, v53, v158, s[62:63]
  v_cndmask_b32 v54, v54, v158, s[64:65]
  v_cndmask_b32 v55, v55, v158, s[66:67]
  v_cndmask_b32 v56, v56, v158, s[68:69]
  v_cndmask_b32 v57, v57, v158, s[70:71]
  v_cndmask_b32 v58, v58, v158, s[72:73]
  v_cndmask_b32 v59, v59, v158, s[74:75]
  v_max3_f32 v156, v44, v45, v46
  v_max3_f32 v157, v47, v48, v49
  v_max3_f32 v157, v50, v51, v157
  v_max3_f32 v156, v52, v53, v156
  v_max3_f32 v157, v54, v55, v157
  v_max3_f32 v156, v56, v57, v156
  v_max3_f32 v157, v58, v59, v157
  v_max_f32 v156, v156, v157
  v_mov_b32 v157, v156
  s_nop 1
  v_permlane32_swap_b32 v156, v157
  v_max_f32 v162, v156, v157
  v_sub_f32 v92, 0, v162
  v_sub_f32 v93, 0, v162
  v_sub_f32 v94, 0, v162
  v_sub_f32 v95, 0, v162
  v_sub_f32 v96, 0, v162
  v_sub_f32 v97, 0, v162
  v_sub_f32 v98, 0, v162
  v_sub_f32 v99, 0, v162
  v_sub_f32 v100, 0, v162
  v_sub_f32 v101, 0, v162
  v_sub_f32 v102, 0, v162
  v_sub_f32 v103, 0, v162
  v_sub_f32 v104, 0, v162
  v_sub_f32 v105, 0, v162
  v_sub_f32 v106, 0, v162
  v_sub_f32 v107, 0, v162
  v_sub_f32 v44, v44, v162
  v_sub_f32 v45, v45, v162
  v_sub_f32 v46, v46, v162
  v_sub_f32 v47, v47, v162
  v_sub_f32 v48, v48, v162
  v_sub_f32 v49, v49, v162
  v_sub_f32 v50, v50, v162
  v_sub_f32 v51, v51, v162
  v_sub_f32 v52, v52, v162
  v_sub_f32 v53, v53, v162
  v_sub_f32 v54, v54, v162
  v_sub_f32 v55, v55, v162
  v_sub_f32 v56, v56, v162
  v_sub_f32 v57, v57, v162
  v_sub_f32 v58, v58, v162
  v_sub_f32 v59, v59, v162
  s_waitcnt lgkmcnt(5)
  v_mfma_f32_32x32x16_bf16 v[60:75], v[16:19], v[4:7], v[92:107]
  v_exp_f32 v44, v44
  v_exp_f32 v45, v45
  v_exp_f32 v46, v46
  v_exp_f32 v47, v47
  v_cvt_pk_bf16_f32 v124, v44, v45
  v_exp_f32 v48, v48
  v_exp_f32 v49, v49
  v_cvt_pk_bf16_f32 v125, v46, v47
  v_exp_f32 v50, v50
  v_exp_f32 v51, v51
  v_cvt_pk_bf16_f32 v126, v48, v49
  v_exp_f32 v52, v52
  v_exp_f32 v53, v53
  v_cvt_pk_bf16_f32 v127, v50, v51
  v_exp_f32 v54, v54
  v_exp_f32 v55, v55
  v_cvt_pk_bf16_f32 v128, v52, v53
  v_exp_f32 v56, v56
  v_exp_f32 v57, v57
  v_cvt_pk_bf16_f32 v129, v54, v55
  v_exp_f32 v58, v58
  v_exp_f32 v59, v59
  v_cvt_pk_bf16_f32 v130, v56, v57
  v_cvt_pk_bf16_f32 v131, v58, v59
  s_waitcnt lgkmcnt(4)
  v_mfma_f32_32x32x16_bf16 v[44:59], v[20:23], v[4:7], v[92:107]
  v_exp_f32 v60, v60
  v_exp_f32 v61, v61
  v_exp_f32 v62, v62
  v_exp_f32 v63, v63
  v_cvt_pk_bf16_f32 v132, v60, v61
  v_exp_f32 v64, v64
  s_waitcnt lgkmcnt(3)
  v_mfma_f32_32x32x16_bf16 v[76:91], v[28:31], v[124:127], 0
  v_exp_f32 v65, v65
  v_cvt_pk_bf16_f32 v133, v62, v63
  v_exp_f32 v66, v66
  v_exp_f32 v67, v67
  v_cvt_pk_bf16_f32 v134, v64, v65
  v_exp_f32 v68, v68
  v_exp_f32 v69, v69
  v_cvt_pk_bf16_f32 v135, v66, v67
  v_exp_f32 v70, v70
  s_waitcnt lgkmcnt(2)
  v_mfma_f32_32x32x16_bf16 v[76:91], v[32:35], v[128:131], v[76:91]
  v_exp_f32 v71, v71
  v_cvt_pk_bf16_f32 v136, v68, v69
  s_mov_b64 exec, s[78:79]
  ds_read_b128 v[28:31], v3 offset:6144
  ds_read_b128 v[32:35], v3 offset:6656
  s_mov_b64 exec, -1
  v_exp_f32 v72, v72
  v_exp_f32 v73, v73
  v_cvt_pk_bf16_f32 v137, v70, v71
  v_exp_f32 v74, v74
  v_exp_f32 v75, v75
  v_cvt_pk_bf16_f32 v138, v72, v73
  v_cvt_pk_bf16_f32 v139, v74, v75
  v_exp_f32 v44, v44
  v_exp_f32 v45, v45
  v_exp_f32 v46, v46
  v_exp_f32 v47, v47
  v_cvt_pk_bf16_f32 v124, v44, v45
  v_exp_f32 v48, v48
  s_waitcnt lgkmcnt(3)
  v_mfma_f32_32x32x16_bf16 v[76:91], v[36:39], v[132:135], v[76:91]
  v_exp_f32 v49, v49
  v_cvt_pk_bf16_f32 v125, v46, v47
  v_exp_f32 v50, v50
  v_exp_f32 v51, v51
  v_cvt_pk_bf16_f32 v126, v48, v49
  v_exp_f32 v52, v52
  v_exp_f32 v53, v53
  v_cvt_pk_bf16_f32 v127, v50, v51
  v_exp_f32 v54, v54
  s_waitcnt lgkmcnt(2)
  v_mfma_f32_32x32x16_bf16 v[76:91], v[40:43], v[136:139], v[76:91]
  v_exp_f32 v55, v55
  v_cvt_pk_bf16_f32 v128, v52, v53
  v_exp_f32 v56, v56
  v_exp_f32 v57, v57
  v_cvt_pk_bf16_f32 v129, v54, v55
  v_exp_f32 v58, v58
  v_exp_f32 v59, v59
  v_cvt_pk_bf16_f32 v130, v56, v57
  v_cvt_pk_bf16_f32 v131, v58, v59
  s_waitcnt lgkmcnt(1)
  v_mfma_f32_32x32x16_bf16 v[76:91], v[28:31], v[124:127], v[76:91]
  s_waitcnt lgkmcnt(0)
  v_mfma_f32_32x32x16_bf16 v[76:91], v[32:35], v[128:131], v[76:91]
  s_setprio 2
  ds_read_b128 v[12:15], v2 offset:24576
  ds_read_b128 v[16:19], v2 offset:23552
  ds_read_b128 v[20:23], v2 offset:22528
  s_mov_b64 exec, s[78:79]
  ds_read_b128 v[28:31], v3 offset:24576
  ds_read_b128 v[32:35], v3 offset:25088
  s_mov_b64 exec, -1
  s_mov_b64 exec, s[78:79]
  ds_read_b128 v[36:39], v3 offset:23552
  ds_read_b128 v[40:43], v3 offset:24064
  s_mov_b64 exec, -1
  s_waitcnt lgkmcnt(6)
  v_mfma_f32_32x32x16_bf16 v[44:59], v[12:15], v[8:11], 0
  s_nop 11
  v_cndmask_b32 v44, v44, v158, s[44:45]
  v_cndmask_b32 v45, v45, v158, s[46:47]
  v_cndmask_b32 v46, v46, v158, s[48:49]
  v_cndmask_b32 v47, v47, v158, s[50:51]
  v_cndmask_b32 v48, v48, v158, s[52:53]
  v_cndmask_b32 v49, v49, v158, s[54:55]
  v_cndmask_b32 v50, v50, v158, s[56:57]
  v_cndmask_b32 v51, v51, v158, s[58:59]
  v_cndmask_b32 v52, v52, v158, s[60:61]
  v_cndmask_b32 v53, v53, v158, s[62:63]
  v_cndmask_b32 v54, v54, v158, s[64:65]
  v_cndmask_b32 v55, v55, v158, s[66:67]
  v_cndmask_b32 v56, v56, v158, s[68:69]
  v_cndmask_b32 v57, v57, v158, s[70:71]
  v_cndmask_b32 v58, v58, v158, s[72:73]
  v_cndmask_b32 v59, v59, v158, s[74:75]
  v_max3_f32 v156, v44, v45, v46
  v_max3_f32 v157, v47, v48, v49
  v_max3_f32 v157, v50, v51, v157
  v_max3_f32 v156, v52, v53, v156
  v_max3_f32 v157, v54, v55, v157
  v_max3_f32 v156, v56, v57, v156
  v_max3_f32 v157, v58, v59, v157
  v_max_f32 v156, v156, v157
  v_mov_b32 v157, v156
  s_nop 1
  v_permlane32_swap_b32 v156, v157
  v_max_f32 v163, v156, v157
  v_sub_f32 v92, 0, v163
  v_sub_f32 v93, 0, v163
  v_sub_f32 v94, 0, v163
  v_sub_f32 v95, 0, v163
  v_sub_f32 v96, 0, v163
  v_sub_f32 v97, 0, v163
  v_sub_f32 v98, 0, v163
  v_sub_f32 v99, 0, v163
  v_sub_f32 v100, 0, v163
  v_sub_f32 v101, 0, v163
  v_sub_f32 v102, 0, v163
  v_sub_f32 v103, 0, v163
  v_sub_f32 v104, 0, v163
  v_sub_f32 v105, 0, v163
  v_sub_f32 v106, 0, v163
  v_sub_f32 v107, 0, v163
  v_sub_f32 v44, v44, v163
  v_sub_f32 v45, v45, v163
  v_sub_f32 v46, v46, v163
  v_sub_f32 v47, v47, v163
  v_sub_f32 v48, v48, v163
  v_sub_f32 v49, v49, v163
  v_sub_f32 v50, v50, v163
  v_sub_f32 v51, v51, v163
  v_sub_f32 v52, v52, v163
  v_sub_f32 v53, v53, v163
  v_sub_f32 v54, v54, v163
  v_sub_f32 v55, v55, v163
  v_sub_f32 v56, v56, v163
  v_sub_f32 v57, v57, v163
  v_sub_f32 v58, v58, v163
  v_sub_f32 v59, v59, v163
  s_waitcnt lgkmcnt(5)
  v_mfma_f32_32x32x16_bf16 v[60:75], v[16:19], v[8:11], v[92:107]
  v_exp_f32 v44, v44
  v_exp_f32 v45, v45
  v_exp_f32 v46, v46
  v_exp_f32 v47, v47
  v_cvt_pk_bf16_f32 v124, v44, v45
  v_exp_f32 v48, v48
  v_exp_f32 v49, v49
  v_cvt_pk_bf16_f32 v125, v46, v47
  v_exp_f32 v50, v50
  v_exp_f32 v51, v51
  v_cvt_pk_bf16_f32 v126, v48, v49
  v_exp_f32 v52, v52
  v_exp_f32 v53, v53
  v_cvt_pk_bf16_f32 v127, v50, v51
  v_exp_f32 v54, v54
  v_exp_f32 v55, v55
  v_cvt_pk_bf16_f32 v128, v52, v53
  v_exp_f32 v56, v56
  v_exp_f32 v57, v57
  v_cvt_pk_bf16_f32 v129, v54, v55
  v_exp_f32 v58, v58
  v_exp_f32 v59, v59
  v_cvt_pk_bf16_f32 v130, v56, v57
  v_cvt_pk_bf16_f32 v131, v58, v59
  s_waitcnt lgkmcnt(4)
  v_mfma_f32_32x32x16_bf16 v[44:59], v[20:23], v[8:11], v[92:107]
  v_exp_f32 v60, v60
  v_exp_f32 v61, v61
  v_exp_f32 v62, v62
  v_exp_f32 v63, v63
  v_cvt_pk_bf16_f32 v132, v60, v61
  v_exp_f32 v64, v64
  s_waitcnt lgkmcnt(3)
  v_mfma_f32_32x32x16_bf16 v[108:123], v[28:31], v[124:127], 0
  v_exp_f32 v65, v65
  v_cvt_pk_bf16_f32 v133, v62, v63
  v_exp_f32 v66, v66
  v_exp_f32 v67, v67
  v_cvt_pk_bf16_f32 v134, v64, v65
  v_exp_f32 v68, v68
  v_exp_f32 v69, v69
  v_cvt_pk_bf16_f32 v135, v66, v67
  v_exp_f32 v70, v70
  s_waitcnt lgkmcnt(2)
  v_mfma_f32_32x32x16_bf16 v[108:123], v[32:35], v[128:131], v[108:123]
  v_exp_f32 v71, v71
  v_cvt_pk_bf16_f32 v136, v68, v69
  s_mov_b64 exec, s[78:79]
  ds_read_b128 v[28:31], v3 offset:22528
  ds_read_b128 v[32:35], v3 offset:23040
  s_mov_b64 exec, -1
  v_exp_f32 v72, v72
  v_exp_f32 v73, v73
  v_cvt_pk_bf16_f32 v137, v70, v71
  v_exp_f32 v74, v74
  v_exp_f32 v75, v75
  v_cvt_pk_bf16_f32 v138, v72, v73
  v_cvt_pk_bf16_f32 v139, v74, v75
  v_exp_f32 v44, v44
  v_exp_f32 v45, v45
  v_exp_f32 v46, v46
  v_exp_f32 v47, v47
  v_cvt_pk_bf16_f32 v124, v44, v45
  v_exp_f32 v48, v48
  s_waitcnt lgkmcnt(3)
  v_mfma_f32_32x32x16_bf16 v[108:123], v[36:39], v[132:135], v[108:123]
  v_exp_f32 v49, v49
  v_cvt_pk_bf16_f32 v125, v46, v47
  v_exp_f32 v50, v50
  v_exp_f32 v51, v51
  v_cvt_pk_bf16_f32 v126, v48, v49
  v_exp_f32 v52, v52
  v_exp_f32 v53, v53
  v_cvt_pk_bf16_f32 v127, v50, v51
  v_exp_f32 v54, v54
  s_waitcnt lgkmcnt(2)
  v_mfma_f32_32x32x16_bf16 v[108:123], v[40:43], v[136:139], v[108:123]
  v_exp_f32 v55, v55
  v_cvt_pk_bf16_f32 v128, v52, v53
  v_exp_f32 v56, v56
  v_exp_f32 v57, v57
  v_cvt_pk_bf16_f32 v129, v54, v55
  v_exp_f32 v58, v58
  v_exp_f32 v59, v59
  v_cvt_pk_bf16_f32 v130, v56, v57
  v_cvt_pk_bf16_f32 v131, v58, v59
  s_waitcnt lgkmcnt(1)
  v_mfma_f32_32x32x16_bf16 v[108:123], v[28:31], v[124:127], v[108:123]
  s_waitcnt lgkmcnt(0)
  v_mfma_f32_32x32x16_bf16 v[108:123], v[32:35], v[128:131], v[108:123]
  s_waitcnt lgkmcnt(0)
  s_barrier
  s_cmp_eq_u32 s83, 0
  s_cbranch_scc1 gm_AC_fz
  s_setprio 1
  ds_read_b128 v[12:15], v2 offset:5120
  ds_read_b128 v[16:19], v2 offset:4096
  ds_read_b128 v[20:23], v2 offset:3072
  s_mov_b64 exec, s[78:79]
  ds_read_b128 v[28:31], v3 offset:5120
  ds_read_b128 v[32:35], v3 offset:5632
  s_mov_b64 exec, -1
  s_mov_b64 exec, s[78:79]
  ds_read_b128 v[36:39], v3 offset:4096
  ds_read_b128 v[40:43], v3 offset:4608
  s_mov_b64 exec, -1
  v_sub_f32 v92, 0, v162
  v_sub_f32 v93, 0, v162
  v_sub_f32 v94, 0, v162
  v_sub_f32 v95, 0, v162
  v_sub_f32 v96, 0, v162
  v_sub_f32 v97, 0, v162
  v_sub_f32 v98, 0, v162
  v_sub_f32 v99, 0, v162
  v_sub_f32 v100, 0, v162
  v_sub_f32 v101, 0, v162
  v_sub_f32 v102, 0, v162
  v_sub_f32 v103, 0, v162
  v_sub_f32 v104, 0, v162
  v_sub_f32 v105, 0, v162
  v_sub_f32 v106, 0, v162
  v_sub_f32 v107, 0, v162
  s_waitcnt lgkmcnt(6)
  s_nop 0
  v_mfma_f32_32x32x16_bf16 v[44:59], v[12:15], v[4:7], v[92:107]
  s_waitcnt lgkmcnt(5)
  v_mfma_f32_32x32x16_bf16 v[60:75], v[16:19], v[4:7], v[92:107]
  ds_read_b128 v[24:27], v2 offset:2048
  s_nop 8
  v_exp_f32 v44, v44
  v_exp_f32 v45, v45
  v_exp_f32 v46, v46
  v_exp_f32 v47, v47
  v_cvt_pk_bf16_f32 v124, v44, v45
  v_exp_f32 v48, v48
  v_exp_f32 v49, v49
  v_cvt_pk_bf16_f32 v125, v46, v47
  v_exp_f32 v50, v50
  v_exp_f32 v51, v51
  v_cvt_pk_bf16_f32 v126, v48, v49
  v_exp_f32 v52, v52
  v_exp_f32 v53, v53
  v_cvt_pk_bf16_f32 v127, v50, v51
  v_exp_f32 v54, v54
  v_exp_f32 v55, v55
  v_cvt_pk_bf16_f32 v128, v52, v53
  v_exp_f32 v56, v56
  v_exp_f32 v57, v57
  v_cvt_pk_bf16_f32 v129, v54, v55
  v_exp_f32 v58, v58
  v_exp_f32 v59, v59
  v_cvt_pk_bf16_f32 v130, v56, v57
  v_cvt_pk_bf16_f32 v131, v58, v59
  s_waitcnt lgkmcnt(5)
  v_mfma_f32_32x32x16_bf16 v[44:59], v[20:23], v[4:7], v[92:107]
  ds_read_b128 v[12:15], v2 offset:1024
  v_exp_f32 v60, v60
  v_exp_f32 v61, v61
  v_exp_f32 v62, v62
  v_exp_f32 v63, v63
  v_cvt_pk_bf16_f32 v132, v60, v61
  v_exp_f32 v64, v64
  s_waitcnt lgkmcnt(5)
  v_mfma_f32_32x32x16_bf16 v[76:91], v[28:31], v[124:127], v[76:91]
  v_exp_f32 v65, v65
  v_cvt_pk_bf16_f32 v133, v62, v63
  v_exp_f32 v66, v66
  v_exp_f32 v67, v67
  v_cvt_pk_bf16_f32 v134, v64, v65
  v_exp_f32 v68, v68
  v_exp_f32 v69, v69
  v_cvt_pk_bf16_f32 v135, v66, v67
  v_exp_f32 v70, v70
  s_waitcnt lgkmcnt(4)
  v_mfma_f32_32x32x16_bf16 v[76:91], v[32:35], v[128:131], v[76:91]
  v_exp_f32 v71, v71
  v_cvt_pk_bf16_f32 v136, v68, v69
  s_mov_b64 exec, s[78:79]
  ds_read_b128 v[28:31], v3 offset:3072
  ds_read_b128 v[32:35], v3 offset:3584
  s_mov_b64 exec, -1
  v_exp_f32 v72, v72
  v_exp_f32 v73, v73
  v_cvt_pk_bf16_f32 v137, v70, v71
  v_exp_f32 v74, v74
  v_exp_f32 v75, v75
  v_cvt_pk_bf16_f32 v138, v72, v73
  v_cvt_pk_bf16_f32 v139, v74, v75
  s_waitcnt lgkmcnt(3)
  v_mfma_f32_32x32x16_bf16 v[60:75], v[24:27], v[4:7], v[92:107]
  ds_read_b128 v[16:19], v2 offset:0
  v_exp_f32 v44, v44
  v_exp_f32 v45, v45
  v_exp_f32 v46, v46
  v_exp_f32 v47, v47
  v_cvt_pk_bf16_f32 v124, v44, v45
  v_exp_f32 v48, v48
  v_mfma_f32_32x32x16_bf16 v[76:91], v[36:39], v[132:135], v[76:91]
  v_exp_f32 v49, v49
  v_cvt_pk_bf16_f32 v125, v46, v47
  v_exp_f32 v50, v50
  v_exp_f32 v51, v51
  v_cvt_pk_bf16_f32 v126, v48, v49
  v_exp_f32 v52, v52
  v_exp_f32 v53, v53
  v_cvt_pk_bf16_f32 v127, v50, v51
  v_exp_f32 v54, v54
  v_mfma_f32_32x32x16_bf16 v[76:91], v[40:43], v[136:139], v[76:91]
  v_exp_f32 v55, v55
  v_cvt_pk_bf16_f32 v128, v52, v53
  s_mov_b64 exec, s[78:79]
  ds_read_b128 v[36:39], v3 offset:2048
  ds_read_b128 v[40:43], v3 offset:2560
  s_mov_b64 exec, -1
  v_exp_f32 v56, v56
  v_exp_f32 v57, v57
  v_cvt_pk_bf16_f32 v129, v54, v55
  v_exp_f32 v58, v58
  v_exp_f32 v59, v59
  v_cvt_pk_bf16_f32 v130, v56, v57
  v_cvt_pk_bf16_f32 v131, v58, v59
  s_waitcnt lgkmcnt(5)
  v_mfma_f32_32x32x16_bf16 v[44:59], v[12:15], v[4:7], v[92:107]
  v_exp_f32 v60, v60
  v_exp_f32 v61, v61
  v_exp_f32 v62, v62
  v_exp_f32 v63, v63
  v_cvt_pk_bf16_f32 v132, v60, v61
  v_exp_f32 v64, v64
  s_waitcnt lgkmcnt(4)
  v_mfma_f32_32x32x16_bf16 v[76:91], v[28:31], v[124:127], v[76:91]
  v_exp_f32 v65, v65
  v_cvt_pk_bf16_f32 v133, v62, v63
  v_exp_f32 v66, v66
  v_exp_f32 v67, v67
  v_cvt_pk_bf16_f32 v134, v64, v65
  v_exp_f32 v68, v68
  v_exp_f32 v69, v69
  v_cvt_pk_bf16_f32 v135, v66, v67
  v_exp_f32 v70, v70
  s_waitcnt lgkmcnt(3)
  v_mfma_f32_32x32x16_bf16 v[76:91], v[32:35], v[128:131], v[76:91]
  v_exp_f32 v71, v71
  v_cvt_pk_bf16_f32 v136, v68, v69
  s_mov_b64 exec, s[78:79]
  ds_read_b128 v[28:31], v3 offset:1024
  ds_read_b128 v[32:35], v3 offset:1536
  s_mov_b64 exec, -1
  v_exp_f32 v72, v72
  v_exp_f32 v73, v73
  v_cvt_pk_bf16_f32 v137, v70, v71
  v_exp_f32 v74, v74
  v_exp_f32 v75, v75
  v_cvt_pk_bf16_f32 v138, v72, v73
  v_cvt_pk_bf16_f32 v139, v74, v75
  s_waitcnt lgkmcnt(4)
  v_mfma_f32_32x32x16_bf16 v[60:75], v[16:19], v[4:7], v[92:107]
  v_exp_f32 v44, v44
  v_exp_f32 v45, v45
  v_exp_f32 v46, v46
  v_exp_f32 v47, v47
  v_cvt_pk_bf16_f32 v124, v44, v45
  v_exp_f32 v48, v48
  s_waitcnt lgkmcnt(3)
  v_mfma_f32_32x32x16_bf16 v[76:91], v[36:39], v[132:135], v[76:91]
  v_exp_f32 v49, v49
  v_cvt_pk_bf16_f32 v125, v46, v47
  v_exp_f32 v50, v50
  v_exp_f32 v51, v51
  v_cvt_pk_bf16_f32 v126, v48, v49
  v_exp_f32 v52, v52
  v_exp_f32 v53, v53
  v_cvt_pk_bf16_f32 v127, v50, v51
  v_exp_f32 v54, v54
  s_waitcnt lgkmcnt(2)
  v_mfma_f32_32x32x16_bf16 v[76:91], v[40:43], v[136:139], v[76:91]
  v_exp_f32 v55, v55
  v_cvt_pk_bf16_f32 v128, v52, v53
  s_mov_b64 exec, s[78:79]
  ds_read_b128 v[36:39], v3 offset:0
  ds_read_b128 v[40:43], v3 offset:512
  s_mov_b64 exec, -1
  v_exp_f32 v56, v56
  v_exp_f32 v57, v57
  v_cvt_pk_bf16_f32 v129, v54, v55
  v_exp_f32 v58, v58
  v_exp_f32 v59, v59
  v_cvt_pk_bf16_f32 v130, v56, v57
  v_cvt_pk_bf16_f32 v131, v58, v59
  v_exp_f32 v60, v60
  v_exp_f32 v61, v61
  v_exp_f32 v62, v62
  v_exp_f32 v63, v63
  v_cvt_pk_bf16_f32 v132, v60, v61
  v_exp_f32 v64, v64
  s_waitcnt lgkmcnt(3)
  v_mfma_f32_32x32x16_bf16 v[76:91], v[28:31], v[124:127], v[76:91]
  v_exp_f32 v65, v65
  v_cvt_pk_bf16_f32 v133, v62, v63
  v_exp_f32 v66, v66
  v_exp_f32 v67, v67
  v_cvt_pk_bf16_f32 v134, v64, v65
  v_exp_f32 v68, v68
  v_exp_f32 v69, v69
  v_cvt_pk_bf16_f32 v135, v66, v67
  v_exp_f32 v70, v70
  s_waitcnt lgkmcnt(2)
  v_mfma_f32_32x32x16_bf16 v[76:91], v[32:35], v[128:131], v[76:91]
  v_exp_f32 v71, v71
  v_cvt_pk_bf16_f32 v136, v68, v69
  v_exp_f32 v72, v72
  v_exp_f32 v73, v73
  v_cvt_pk_bf16_f32 v137, v70, v71
  v_exp_f32 v74, v74
  v_exp_f32 v75, v75
  v_cvt_pk_bf16_f32 v138, v72, v73
  v_cvt_pk_bf16_f32 v139, v74, v75
  v_and_b32 v132, v132, v148
  v_and_b32 v133, v133, v149
  v_and_b32 v134, v134, v150
  v_and_b32 v135, v135, v151
  v_and_b32 v136, v136, v152
  v_and_b32 v137, v137, v153
  v_and_b32 v138, v138, v154
  v_and_b32 v139, v139, v155
  s_waitcnt lgkmcnt(1)
  v_mfma_f32_32x32x16_bf16 v[76:91], v[36:39], v[132:135], v[76:91]
  s_waitcnt lgkmcnt(0)
  v_mfma_f32_32x32x16_bf16 v[76:91], v[40:43], v[136:139], v[76:91]
  s_setprio 0
  ds_read_b128 v[12:15], v2 offset:21504
  ds_read_b128 v[16:19], v2 offset:20480
  ds_read_b128 v[20:23], v2 offset:19456
  s_mov_b64 exec, s[78:79]
  ds_read_b128 v[28:31], v3 offset:21504
  ds_read_b128 v[32:35], v3 offset:22016
  s_mov_b64 exec, -1
  s_mov_b64 exec, s[78:79]
  ds_read_b128 v[36:39], v3 offset:20480
  ds_read_b128 v[40:43], v3 offset:20992
  s_mov_b64 exec, -1
  v_sub_f32 v92, 0, v163
  v_sub_f32 v93, 0, v163
  v_sub_f32 v94, 0, v163
  v_sub_f32 v95, 0, v163
  v_sub_f32 v96, 0, v163
  v_sub_f32 v97, 0, v163
  v_sub_f32 v98, 0, v163
  v_sub_f32 v99, 0, v163
  v_sub_f32 v100, 0, v163
  v_sub_f32 v101, 0, v163
  v_sub_f32 v102, 0, v163
  v_sub_f32 v103, 0, v163
  v_sub_f32 v104, 0, v163
  v_sub_f32 v105, 0, v163
  v_sub_f32 v106, 0, v163
  v_sub_f32 v107, 0, v163
  s_waitcnt lgkmcnt(6)
  s_nop 0
  v_mfma_f32_32x32x16_bf16 v[44:59], v[12:15], v[8:11], v[92:107]
  s_waitcnt lgkmcnt(5)
  v_mfma_f32_32x32x16_bf16 v[60:75], v[16:19], v[8:11], v[92:107]
  ds_read_b128 v[24:27], v2 offset:18432
  s_nop 8
  v_exp_f32 v44, v44
  v_exp_f32 v45, v45
  v_exp_f32 v46, v46
  v_exp_f32 v47, v47
  v_cvt_pk_bf16_f32 v124, v44, v45
  v_exp_f32 v48, v48
  v_exp_f32 v49, v49
  v_cvt_pk_bf16_f32 v125, v46, v47
  v_exp_f32 v50, v50
  v_exp_f32 v51, v51
  v_cvt_pk_bf16_f32 v126, v48, v49
  v_exp_f32 v52, v52
  v_exp_f32 v53, v53
  v_cvt_pk_bf16_f32 v127, v50, v51
  v_exp_f32 v54, v54
  v_exp_f32 v55, v55
  v_cvt_pk_bf16_f32 v128, v52, v53
  v_exp_f32 v56, v56
  v_exp_f32 v57, v57
  v_cvt_pk_bf16_f32 v129, v54, v55
  v_exp_f32 v58, v58
  v_exp_f32 v59, v59
  v_cvt_pk_bf16_f32 v130, v56, v57
  v_cvt_pk_bf16_f32 v131, v58, v59
  s_waitcnt lgkmcnt(5)
  v_mfma_f32_32x32x16_bf16 v[44:59], v[20:23], v[8:11], v[92:107]
  ds_read_b128 v[12:15], v2 offset:17408
  v_exp_f32 v60, v60
  v_exp_f32 v61, v61
  v_exp_f32 v62, v62
  v_exp_f32 v63, v63
  v_cvt_pk_bf16_f32 v132, v60, v61
  v_exp_f32 v64, v64
  s_waitcnt lgkmcnt(5)
  v_mfma_f32_32x32x16_bf16 v[108:123], v[28:31], v[124:127], v[108:123]
  v_exp_f32 v65, v65
  v_cvt_pk_bf16_f32 v133, v62, v63
  v_exp_f32 v66, v66
  v_exp_f32 v67, v67
  v_cvt_pk_bf16_f32 v134, v64, v65
  v_exp_f32 v68, v68
  v_exp_f32 v69, v69
  v_cvt_pk_bf16_f32 v135, v66, v67
  v_exp_f32 v70, v70
  s_waitcnt lgkmcnt(4)
  v_mfma_f32_32x32x16_bf16 v[108:123], v[32:35], v[128:131], v[108:123]
  v_exp_f32 v71, v71
  v_cvt_pk_bf16_f32 v136, v68, v69
  s_mov_b64 exec, s[78:79]
  ds_read_b128 v[28:31], v3 offset:19456
  ds_read_b128 v[32:35], v3 offset:19968
  s_mov_b64 exec, -1
  v_exp_f32 v72, v72
  v_exp_f32 v73, v73
  v_cvt_pk_bf16_f32 v137, v70, v71
  v_exp_f32 v74, v74
  v_exp_f32 v75, v75
  v_cvt_pk_bf16_f32 v138, v72, v73
  v_cvt_pk_bf16_f32 v139, v74, v75
  s_waitcnt lgkmcnt(3)
  v_mfma_f32_32x32x16_bf16 v[60:75], v[24:27], v[8:11], v[92:107]
  ds_read_b128 v[16:19], v2 offset:16384
  v_exp_f32 v44, v44
  v_exp_f32 v45, v45
  v_exp_f32 v46, v46
  v_exp_f32 v47, v47
  v_cvt_pk_bf16_f32 v124, v44, v45
  v_exp_f32 v48, v48
  v_mfma_f32_32x32x16_bf16 v[108:123], v[36:39], v[132:135], v[108:123]
  v_exp_f32 v49, v49
  v_cvt_pk_bf16_f32 v125, v46, v47
  v_exp_f32 v50, v50
  v_exp_f32 v51, v51
  v_cvt_pk_bf16_f32 v126, v48, v49
  v_exp_f32 v52, v52
  v_exp_f32 v53, v53
  v_cvt_pk_bf16_f32 v127, v50, v51
  v_exp_f32 v54, v54
  v_mfma_f32_32x32x16_bf16 v[108:123], v[40:43], v[136:139], v[108:123]
  v_exp_f32 v55, v55
  v_cvt_pk_bf16_f32 v128, v52, v53
  s_mov_b64 exec, s[78:79]
  ds_read_b128 v[36:39], v3 offset:18432
  ds_read_b128 v[40:43], v3 offset:18944
  s_mov_b64 exec, -1
  v_exp_f32 v56, v56
  v_exp_f32 v57, v57
  v_cvt_pk_bf16_f32 v129, v54, v55
  v_exp_f32 v58, v58
  v_exp_f32 v59, v59
  v_cvt_pk_bf16_f32 v130, v56, v57
  v_cvt_pk_bf16_f32 v131, v58, v59
  s_waitcnt lgkmcnt(5)
  v_mfma_f32_32x32x16_bf16 v[44:59], v[12:15], v[8:11], v[92:107]
  v_exp_f32 v60, v60
  v_exp_f32 v61, v61
  v_exp_f32 v62, v62
  v_exp_f32 v63, v63
  v_cvt_pk_bf16_f32 v132, v60, v61
  v_exp_f32 v64, v64
  s_waitcnt lgkmcnt(4)
  v_mfma_f32_32x32x16_bf16 v[108:123], v[28:31], v[124:127], v[108:123]
  v_exp_f32 v65, v65
  v_cvt_pk_bf16_f32 v133, v62, v63
  v_exp_f32 v66, v66
  v_exp_f32 v67, v67
  v_cvt_pk_bf16_f32 v134, v64, v65
  v_exp_f32 v68, v68
  v_exp_f32 v69, v69
  v_cvt_pk_bf16_f32 v135, v66, v67
  v_exp_f32 v70, v70
  s_waitcnt lgkmcnt(3)
  v_mfma_f32_32x32x16_bf16 v[108:123], v[32:35], v[128:131], v[108:123]
  v_exp_f32 v71, v71
  v_cvt_pk_bf16_f32 v136, v68, v69
  s_mov_b64 exec, s[78:79]
  ds_read_b128 v[28:31], v3 offset:17408
  ds_read_b128 v[32:35], v3 offset:17920
  s_mov_b64 exec, -1
  v_exp_f32 v72, v72
  v_exp_f32 v73, v73
  v_cvt_pk_bf16_f32 v137, v70, v71
  v_exp_f32 v74, v74
  v_exp_f32 v75, v75
  v_cvt_pk_bf16_f32 v138, v72, v73
  v_cvt_pk_bf16_f32 v139, v74, v75
  s_waitcnt lgkmcnt(4)
  v_mfma_f32_32x32x16_bf16 v[60:75], v[16:19], v[8:11], v[92:107]
  v_exp_f32 v44, v44
  v_exp_f32 v45, v45
  v_exp_f32 v46, v46
  v_exp_f32 v47, v47
  v_cvt_pk_bf16_f32 v124, v44, v45
  v_exp_f32 v48, v48
  s_waitcnt lgkmcnt(3)
  v_mfma_f32_32x32x16_bf16 v[108:123], v[36:39], v[132:135], v[108:123]
  v_exp_f32 v49, v49
  v_cvt_pk_bf16_f32 v125, v46, v47
  v_exp_f32 v50, v50
  v_exp_f32 v51, v51
  v_cvt_pk_bf16_f32 v126, v48, v49
  v_exp_f32 v52, v52
  v_exp_f32 v53, v53
  v_cvt_pk_bf16_f32 v127, v50, v51
  v_exp_f32 v54, v54
  s_waitcnt lgkmcnt(2)
  v_mfma_f32_32x32x16_bf16 v[108:123], v[40:43], v[136:139], v[108:123]
  v_exp_f32 v55, v55
  v_cvt_pk_bf16_f32 v128, v52, v53
  s_mov_b64 exec, s[78:79]
  ds_read_b128 v[36:39], v3 offset:16384
  ds_read_b128 v[40:43], v3 offset:16896
  s_mov_b64 exec, -1
  v_exp_f32 v56, v56
  v_exp_f32 v57, v57
  v_cvt_pk_bf16_f32 v129, v54, v55
  v_exp_f32 v58, v58
  v_exp_f32 v59, v59
  v_cvt_pk_bf16_f32 v130, v56, v57
  v_cvt_pk_bf16_f32 v131, v58, v59
  v_exp_f32 v60, v60
  v_exp_f32 v61, v61
  v_exp_f32 v62, v62
  v_exp_f32 v63, v63
  v_cvt_pk_bf16_f32 v132, v60, v61
  v_exp_f32 v64, v64
  s_waitcnt lgkmcnt(3)
  v_mfma_f32_32x32x16_bf16 v[108:123], v[28:31], v[124:127], v[108:123]
  v_exp_f32 v65, v65
  v_cvt_pk_bf16_f32 v133, v62, v63
  v_exp_f32 v66, v66
  v_exp_f32 v67, v67
  v_cvt_pk_bf16_f32 v134, v64, v65
  v_exp_f32 v68, v68
  v_exp_f32 v69, v69
  v_cvt_pk_bf16_f32 v135, v66, v67
  v_exp_f32 v70, v70
  s_waitcnt lgkmcnt(2)
  v_mfma_f32_32x32x16_bf16 v[108:123], v[32:35], v[128:131], v[108:123]
  v_exp_f32 v71, v71
  v_cvt_pk_bf16_f32 v136, v68, v69
  v_exp_f32 v72, v72
  v_exp_f32 v73, v73
  v_cvt_pk_bf16_f32 v137, v70, v71
  v_exp_f32 v74, v74
  v_exp_f32 v75, v75
  v_cvt_pk_bf16_f32 v138, v72, v73
  v_cvt_pk_bf16_f32 v139, v74, v75
  v_and_b32 v132, v132, v148
  v_and_b32 v133, v133, v149
  v_and_b32 v134, v134, v150
  v_and_b32 v135, v135, v151
  v_and_b32 v136, v136, v152
  v_and_b32 v137, v137, v153
  v_and_b32 v138, v138, v154
  v_and_b32 v139, v139, v155
  s_waitcnt lgkmcnt(1)
  v_mfma_f32_32x32x16_bf16 v[108:123], v[36:39], v[132:135], v[108:123]
  s_waitcnt lgkmcnt(0)
  v_mfma_f32_32x32x16_bf16 v[108:123], v[40:43], v[136:139], v[108:123]
  s_branch gm_AC_fz
gm_AC_v3:
  s_waitcnt lgkmcnt(0)
  s_nop 10
  s_setprio 3
  ds_read_b128 v[12:15], v2 offset:8192
  ds_read_b128 v[16:19], v2 offset:7168
  ds_read_b128 v[20:23], v2 offset:6144
  s_mov_b64 exec, s[78:79]
  ds_read_b128 v[28:31], v3 offset:8192
  ds_read_b128 v[32:35], v3 offset:8704
  s_mov_b64 exec, -1
  s_mov_b64 exec, s[78:79]
  ds_read_b128 v[36:39], v3 offset:7168
  ds_read_b128 v[40:43], v3 offset:7680
  s_mov_b64 exec, -1
  s_waitcnt lgkmcnt(6)
  v_mfma_f32_32x32x16_bf16 v[44:59], v[12:15], v[4:7], 0
  s_nop 11
  v_cndmask_b32 v44, v44, v158, s[44:45]
  v_cndmask_b32 v45, v45, v158, s[46:47]
  v_cndmask_b32 v46, v46, v158, s[48:49]
  v_cndmask_b32 v47, v47, v158, s[50:51]
  v_cndmask_b32 v48, v48, v158, s[52:53]
  v_cndmask_b32 v49, v49, v158, s[54:55]
  v_cndmask_b32 v50, v50, v158, s[56:57]
  v_cndmask_b32 v51, v51, v158, s[58:59]
  v_cndmask_b32 v52, v52, v158, s[60:61]
  v_cndmask_b32 v53, v53, v158, s[62:63]
  v_cndmask_b32 v54, v54, v158, s[64:65]
  v_cndmask_b32 v55, v55, v158, s[66:67]
  v_cndmask_b32 v56, v56, v158, s[68:69]
  v_cndmask_b32 v57, v57, v158, s[70:71]
  v_cndmask_b32 v58, v58, v158, s[72:73]
  v_cndmask_b32 v59, v59, v158, s[74:75]
  v_max3_f32 v156, v44, v45, v46
  v_max3_f32 v157, v47, v48, v49
  v_max3_f32 v157, v50, v51, v157
  v_max3_f32 v156, v52, v53, v156
  v_max3_f32 v157, v54, v55, v157
  v_max3_f32 v156, v56, v57, v156
  v_max3_f32 v157, v58, v59, v157
  v_max_f32 v156, v156, v157
  v_mov_b32 v157, v156
  s_nop 1
  v_permlane32_swap_b32 v156, v157
  v_max_f32 v162, v156, v157
  v_sub_f32 v92, 0, v162
  v_sub_f32 v93, 0, v162
  v_sub_f32 v94, 0, v162
  v_sub_f32 v95, 0, v162
  v_sub_f32 v96, 0, v162
  v_sub_f32 v97, 0, v162
  v_sub_f32 v98, 0, v162
  v_sub_f32 v99, 0, v162
  v_sub_f32 v100, 0, v162
  v_sub_f32 v101, 0, v162
  v_sub_f32 v102, 0, v162
  v_sub_f32 v103, 0, v162
  v_sub_f32 v104, 0, v162
  v_sub_f32 v105, 0, v162
  v_sub_f32 v106, 0, v162
  v_sub_f32 v107, 0, v162
  v_sub_f32 v44, v44, v162
  v_sub_f32 v45, v45, v162
  v_sub_f32 v46, v46, v162
  v_sub_f32 v47, v47, v162
  v_sub_f32 v48, v48, v162
  v_sub_f32 v49, v49, v162
  v_sub_f32 v50, v50, v162
  v_sub_f32 v51, v51, v162
  v_sub_f32 v52, v52, v162
  v_sub_f32 v53, v53, v162
  v_sub_f32 v54, v54, v162
  v_sub_f32 v55, v55, v162
  v_sub_f32 v56, v56, v162
  v_sub_f32 v57, v57, v162
  v_sub_f32 v58, v58, v162
  v_sub_f32 v59, v59, v162
  s_waitcnt lgkmcnt(5)
  v_mfma_f32_32x32x16_bf16 v[60:75], v[16:19], v[4:7], v[92:107]
  ds_read_b128 v[24:27], v2 offset:5120
  v_exp_f32 v44, v44
  v_exp_f32 v45, v45
  v_exp_f32 v46, v46
  v_exp_f32 v47, v47
  v_cvt_pk_bf16_f32 v124, v44, v45
  v_exp_f32 v48, v48
  v_exp_f32 v49, v49
  v_cvt_pk_bf16_f32 v125, v46, v47
  v_exp_f32 v50, v50
  v_exp_f32 v51, v51
  v_cvt_pk_bf16_f32 v126, v48, v49
  v_exp_f32 v52, v52
  v_exp_f32 v53, v53
  v_cvt_pk_bf16_f32 v127, v50, v51
  v_exp_f32 v54, v54
  v_exp_f32 v55, v55
  v_cvt_pk_bf16_f32 v128, v52, v53
  v_exp_f32 v56, v56
  v_exp_f32 v57, v57
  v_cvt_pk_bf16_f32 v129, v54, v55
  v_exp_f32 v58, v58
  v_exp_f32 v59, v59
  v_cvt_pk_bf16_f32 v130, v56, v57
  v_cvt_pk_bf16_f32 v131, v58, v59
  s_waitcnt lgkmcnt(5)
  v_mfma_f32_32x32x16_bf16 v[44:59], v[20:23], v[4:7], v[92:107]
  v_exp_f32 v60, v60
  v_exp_f32 v61, v61
  v_exp_f32 v62, v62
  v_exp_f32 v63, v63
  v_cvt_pk_bf16_f32 v132, v60, v61
  v_exp_f32 v64, v64
  s_waitcnt lgkmcnt(4)
  v_mfma_f32_32x32x16_bf16 v[76:91], v[28:31], v[124:127], 0
  v_exp_f32 v65, v65
  v_cvt_pk_bf16_f32 v133, v62, v63
  v_exp_f32 v66, v66
  v_exp_f32 v67, v67
  v_cvt_pk_bf16_f32 v134, v64, v65
  v_exp_f32 v68, v68
  v_exp_f32 v69, v69
  v_cvt_pk_bf16_f32 v135, v66, v67
  v_exp_f32 v70, v70
  s_waitcnt lgkmcnt(3)
  v_mfma_f32_32x32x16_bf16 v[76:91], v[32:35], v[128:131], v[76:91]
  v_exp_f32 v71, v71
  v_cvt_pk_bf16_f32 v136, v68, v69
  s_mov_b64 exec, s[78:79]
  ds_read_b128 v[28:31], v3 offset:6144
  ds_read_b128 v[32:35], v3 offset:6656
  s_mov_b64 exec, -1
  v_exp_f32 v72, v72
  v_exp_f32 v73, v73
  v_cvt_pk_bf16_f32 v137, v70, v71
  v_exp_f32 v74, v74
  v_exp_f32 v75, v75
  v_cvt_pk_bf16_f32 v138, v72, v73
  v_cvt_pk_bf16_f32 v139, v74, v75
  s_waitcnt lgkmcnt(2)
  v_mfma_f32_32x32x16_bf16 v[60:75], v[24:27], v[4:7], v[92:107]
  v_exp_f32 v44, v44
  v_exp_f32 v45, v45
  v_exp_f32 v46, v46
  v_exp_f32 v47, v47
  v_cvt_pk_bf16_f32 v124, v44, v45
  v_exp_f32 v48, v48
  v_mfma_f32_32x32x16_bf16 v[76:91], v[36:39], v[132:135], v[76:91]
  v_exp_f32 v49, v49
  v_cvt_pk_bf16_f32 v125, v46, v47
  v_exp_f32 v50, v50
  v_exp_f32 v51, v51
  v_cvt_pk_bf16_f32 v126, v48, v49
  v_exp_f32 v52, v52
  v_exp_f32 v53, v53
  v_cvt_pk_bf16_f32 v127, v50, v51
  v_exp_f32 v54, v54
  v_mfma_f32_32x32x16_bf16 v[76:91], v[40:43], v[136:139], v[76:91]
  v_exp_f32 v55, v55
  v_cvt_pk_bf16_f32 v128, v52, v53
  s_mov_b64 exec, s[78:79]
  ds_read_b128 v[36:39], v3 offset:5120
  ds_read_b128 v[40:43], v3 offset:5632
  s_mov_b64 exec, -1
  v_exp_f32 v56, v56
  v_exp_f32 v57, v57
  v_cvt_pk_bf16_f32 v129, v54, v55
  v_exp_f32 v58, v58
  v_exp_f32 v59, v59
  v_cvt_pk_bf16_f32 v130, v56, v57
  v_cvt_pk_bf16_f32 v131, v58, v59
  v_exp_f32 v60, v60
  v_exp_f32 v61, v61
  v_exp_f32 v62, v62
  v_exp_f32 v63, v63
  v_cvt_pk_bf16_f32 v132, v60, v61
  v_exp_f32 v64, v64
  s_waitcnt lgkmcnt(3)
  v_mfma_f32_32x32x16_bf16 v[76:91], v[28:31], v[124:127], v[76:91]
  v_exp_f32 v65, v65
  v_cvt_pk_bf16_f32 v133, v62, v63
  v_exp_f32 v66, v66
  v_exp_f32 v67, v67
  v_cvt_pk_bf16_f32 v134, v64, v65
  v_exp_f32 v68, v68
  v_exp_f32 v69, v69
  v_cvt_pk_bf16_f32 v135, v66, v67
  v_exp_f32 v70, v70
  s_waitcnt lgkmcnt(2)
  v_mfma_f32_32x32x16_bf16 v[76:91], v[32:35], v[128:131], v[76:91]
  v_exp_f32 v71, v71
  v_cvt_pk_bf16_f32 v136, v68, v69
  v_exp_f32 v72, v72
  v_exp_f32 v73, v73
  v_cvt_pk_bf16_f32 v137, v70, v71
  v_exp_f32 v74, v74
  v_exp_f32 v75, v75
  v_cvt_pk_bf16_f32 v138, v72, v73
  v_cvt_pk_bf16_f32 v139, v74, v75
  s_waitcnt lgkmcnt(1)
  v_mfma_f32_32x32x16_bf16 v[76:91], v[36:39], v[132:135], v[76:91]
  s_waitcnt lgkmcnt(0)
  v_mfma_f32_32x32x16_bf16 v[76:91], v[40:43], v[136:139], v[76:91]
  s_setprio 2
  ds_read_b128 v[12:15], v2 offset:24576
  ds_read_b128 v[16:19], v2 offset:23552
  ds_read_b128 v[20:23], v2 offset:22528
  s_mov_b64 exec, s[78:79]
  ds_read_b128 v[28:31], v3 offset:24576
  ds_read_b128 v[32:35], v3 offset:25088
  s_mov_b64 exec, -1
  s_mov_b64 exec, s[78:79]
  ds_read_b128 v[36:39], v3 offset:23552
  ds_read_b128 v[40:43], v3 offset:24064
  s_mov_b64 exec, -1
  s_waitcnt lgkmcnt(6)
  v_mfma_f32_32x32x16_bf16 v[44:59], v[12:15], v[8:11], 0
  s_nop 11
  v_cndmask_b32 v44, v44, v158, s[44:45]
  v_cndmask_b32 v45, v45, v158, s[46:47]
  v_cndmask_b32 v46, v46, v158, s[48:49]
  v_cndmask_b32 v47, v47, v158, s[50:51]
  v_cndmask_b32 v48, v48, v158, s[52:53]
  v_cndmask_b32 v49, v49, v158, s[54:55]
  v_cndmask_b32 v50, v50, v158, s[56:57]
  v_cndmask_b32 v51, v51, v158, s[58:59]
  v_cndmask_b32 v52, v52, v158, s[60:61]
  v_cndmask_b32 v53, v53, v158, s[62:63]
  v_cndmask_b32 v54, v54, v158, s[64:65]
  v_cndmask_b32 v55, v55, v158, s[66:67]
  v_cndmask_b32 v56, v56, v158, s[68:69]
  v_cndmask_b32 v57, v57, v158, s[70:71]
  v_cndmask_b32 v58, v58, v158, s[72:73]
  v_cndmask_b32 v59, v59, v158, s[74:75]
  v_max3_f32 v156, v44, v45, v46
  v_max3_f32 v157, v47, v48, v49
  v_max3_f32 v157, v50, v51, v157
  v_max3_f32 v156, v52, v53, v156
  v_max3_f32 v157, v54, v55, v157
  v_max3_f32 v156, v56, v57, v156
  v_max3_f32 v157, v58, v59, v157
  v_max_f32 v156, v156, v157
  v_mov_b32 v157, v156
  s_nop 1
  v_permlane32_swap_b32 v156, v157
  v_max_f32 v163, v156, v157
  v_sub_f32 v92, 0, v163
  v_sub_f32 v93, 0, v163
  v_sub_f32 v94, 0, v163
  v_sub_f32 v95, 0, v163
  v_sub_f32 v96, 0, v163
  v_sub_f32 v97, 0, v163
  v_sub_f32 v98, 0, v163
  v_sub_f32 v99, 0, v163
  v_sub_f32 v100, 0, v163
  v_sub_f32 v101, 0, v163
  v_sub_f32 v102, 0, v163
  v_sub_f32 v103, 0, v163
  v_sub_f32 v104, 0, v163
  v_sub_f32 v105, 0, v163
  v_sub_f32 v106, 0, v163
  v_sub_f32 v107, 0, v163
  v_sub_f32 v44, v44, v163
  v_sub_f32 v45, v45, v163
  v_sub_f32 v46, v46, v163
  v_sub_f32 v47, v47, v163
  v_sub_f32 v48, v48, v163
  v_sub_f32 v49, v49, v163
  v_sub_f32 v50, v50, v163
  v_sub_f32 v51, v51, v163
  v_sub_f32 v52, v52, v163
  v_sub_f32 v53, v53, v163
  v_sub_f32 v54, v54, v163
  v_sub_f32 v55, v55, v163
  v_sub_f32 v56, v56, v163
  v_sub_f32 v57, v57, v163
  v_sub_f32 v58, v58, v163
  v_sub_f32 v59, v59, v163
  s_waitcnt lgkmcnt(5)
  v_mfma_f32_32x32x16_bf16 v[60:75], v[16:19], v[8:11], v[92:107]
  ds_read_b128 v[24:27], v2 offset:21504
  v_exp_f32 v44, v44
  v_exp_f32 v45, v45
  v_exp_f32 v46, v46
  v_exp_f32 v47, v47
  v_cvt_pk_bf16_f32 v124, v44, v45
  v_exp_f32 v48, v48
  v_exp_f32 v49, v49
  v_cvt_pk_bf16_f32 v125, v46, v47
  v_exp_f32 v50, v50
  v_exp_f32 v51, v51
  v_cvt_pk_bf16_f32 v126, v48, v49
  v_exp_f32 v52, v52
  v_exp_f32 v53, v53
  v_cvt_pk_bf16_f32 v127, v50, v51
  v_exp_f32 v54, v54
  v_exp_f32 v55, v55
  v_cvt_pk_bf16_f32 v128, v52, v53
  v_exp_f32 v56, v56
  v_exp_f32 v57, v57
  v_cvt_pk_bf16_f32 v129, v54, v55
  v_exp_f32 v58, v58
  v_exp_f32 v59, v59
  v_cvt_pk_bf16_f32 v130, v56, v57
  v_cvt_pk_bf16_f32 v131, v58, v59
  s_waitcnt lgkmcnt(5)
  v_mfma_f32_32x32x16_bf16 v[44:59], v[20:23], v[8:11], v[92:107]
  v_exp_f32 v60, v60
  v_exp_f32 v61, v61
  v_exp_f32 v62, v62
  v_exp_f32 v63, v63
  v_cvt_pk_bf16_f32 v132, v60, v61
  v_exp_f32 v64, v64
  s_waitcnt lgkmcnt(4)
  v_mfma_f32_32x32x16_bf16 v[108:123], v[28:31], v[124:127], 0
  v_exp_f32 v65, v65
  v_cvt_pk_bf16_f32 v133, v62, v63
  v_exp_f32 v66, v66
  v_exp_f32 v67, v67
  v_cvt_pk_bf16_f32 v134, v64, v65
  v_exp_f32 v68, v68
  v_exp_f32 v69, v69
  v_cvt_pk_bf16_f32 v135, v66, v67
  v_exp_f32 v70, v70
  s_waitcnt lgkmcnt(3)
  v_mfma_f32_32x32x16_bf16 v[108:123], v[32:35], v[128:131], v[108:123]
  v_exp_f32 v71, v71
  v_cvt_pk_bf16_f32 v136, v68, v69
  s_mov_b64 exec, s[78:79]
  ds_read_b128 v[28:31], v3 offset:22528
  ds_read_b128 v[32:35], v3 offset:23040
  s_mov_b64 exec, -1
  v_exp_f32 v72, v72
  v_exp_f32 v73, v73
  v_cvt_pk_bf16_f32 v137, v70, v71
  v_exp_f32 v74, v74
  v_exp_f32 v75, v75
  v_cvt_pk_bf16_f32 v138, v72, v73
  v_cvt_pk_bf16_f32 v139, v74, v75
  s_waitcnt lgkmcnt(2)
  v_mfma_f32_32x32x16_bf16 v[60:75], v[24:27], v[8:11], v[92:107]
  v_exp_f32 v44, v44
  v_exp_f32 v45, v45
  v_exp_f32 v46, v46
  v_exp_f32 v47, v47
  v_cvt_pk_bf16_f32 v124, v44, v45
  v_exp_f32 v48, v48
  v_mfma_f32_32x32x16_bf16 v[108:123], v[36:39], v[132:135], v[108:123]
  v_exp_f32 v49, v49
  v_cvt_pk_bf16_f32 v125, v46, v47
  v_exp_f32 v50, v50
  v_exp_f32 v51, v51
  v_cvt_pk_bf16_f32 v126, v48, v49
  v_exp_f32 v52, v52
  v_exp_f32 v53, v53
  v_cvt_pk_bf16_f32 v127, v50, v51
  v_exp_f32 v54, v54
  v_mfma_f32_32x32x16_bf16 v[108:123], v[40:43], v[136:139], v[108:123]
  v_exp_f32 v55, v55
  v_cvt_pk_bf16_f32 v128, v52, v53
  s_mov_b64 exec, s[78:79]
  ds_read_b128 v[36:39], v3 offset:21504
  ds_read_b128 v[40:43], v3 offset:22016
  s_mov_b64 exec, -1
  v_exp_f32 v56, v56
  v_exp_f32 v57, v57
  v_cvt_pk_bf16_f32 v129, v54, v55
  v_exp_f32 v58, v58
  v_exp_f32 v59, v59
  v_cvt_pk_bf16_f32 v130, v56, v57
  v_cvt_pk_bf16_f32 v131, v58, v59
  v_exp_f32 v60, v60
  v_exp_f32 v61, v61
  v_exp_f32 v62, v62
  v_exp_f32 v63, v63
  v_cvt_pk_bf16_f32 v132, v60, v61
  v_exp_f32 v64, v64
  s_waitcnt lgkmcnt(3)
  v_mfma_f32_32x32x16_bf16 v[108:123], v[28:31], v[124:127], v[108:123]
  v_exp_f32 v65, v65
  v_cvt_pk_bf16_f32 v133, v62, v63
  v_exp_f32 v66, v66
  v_exp_f32 v67, v67
  v_cvt_pk_bf16_f32 v134, v64, v65
  v_exp_f32 v68, v68
  v_exp_f32 v69, v69
  v_cvt_pk_bf16_f32 v135, v66, v67
  v_exp_f32 v70, v70
  s_waitcnt lgkmcnt(2)
  v_mfma_f32_32x32x16_bf16 v[108:123], v[32:35], v[128:131], v[108:123]
  v_exp_f32 v71, v71
  v_cvt_pk_bf16_f32 v136, v68, v69
  v_exp_f32 v72, v72
  v_exp_f32 v73, v73
  v_cvt_pk_bf16_f32 v137, v70, v71
  v_exp_f32 v74, v74
  v_exp_f32 v75, v75
  v_cvt_pk_bf16_f32 v138, v72, v73
  v_cvt_pk_bf16_f32 v139, v74, v75
  s_waitcnt lgkmcnt(1)
  v_mfma_f32_32x32x16_bf16 v[108:123], v[36:39], v[132:135], v[108:123]
  s_waitcnt lgkmcnt(0)
  v_mfma_f32_32x32x16_bf16 v[108:123], v[40:43], v[136:139], v[108:123]
  s_waitcnt lgkmcnt(0)
  s_barrier
  s_cmp_eq_u32 s83, 0
  s_cbranch_scc1 gm_AC_fz
  s_setprio 1
  ds_read_b128 v[12:15], v2 offset:4096
  ds_read_b128 v[16:19], v2 offset:3072
  ds_read_b128 v[20:23], v2 offset:2048
  s_mov_b64 exec, s[78:79]
  ds_read_b128 v[28:31], v3 offset:4096
  ds_read_b128 v[32:35], v3 offset:4608
  s_mov_b64 exec, -1
  s_mov_b64 exec, s[78:79]
  ds_read_b128 v[36:39], v3 offset:3072
  ds_read_b128 v[40:43], v3 offset:3584
  s_mov_b64 exec, -1
  v_sub_f32 v92, 0, v162
  v_sub_f32 v93, 0, v162
  v_sub_f32 v94, 0, v162
  v_sub_f32 v95, 0, v162
  v_sub_f32 v96, 0, v162
  v_sub_f32 v97, 0, v162
  v_sub_f32 v98, 0, v162
  v_sub_f32 v99, 0, v162
  v_sub_f32 v100, 0, v162
  v_sub_f32 v101, 0, v162
  v_sub_f32 v102, 0, v162
  v_sub_f32 v103, 0, v162
  v_sub_f32 v104, 0, v162
  v_sub_f32 v105, 0, v162
  v_sub_f32 v106, 0, v162
  v_sub_f32 v107, 0, v162
  s_waitcnt lgkmcnt(6)
  s_nop 0
  v_mfma_f32_32x32x16_bf16 v[44:59], v[12:15], v[4:7], v[92:107]
  s_waitcnt lgkmcnt(5)
  v_mfma_f32_32x32x16_bf16 v[60:75], v[16:19], v[4:7], v[92:107]
  ds_read_b128 v[24:27], v2 offset:1024
  s_nop 8
  v_exp_f32 v44, v44
  v_exp_f32 v45, v45
  v_exp_f32 v46, v46
  v_exp_f32 v47, v47
  v_cvt_pk_bf16_f32 v124, v44, v45
  v_exp_f32 v48, v48
  v_exp_f32 v49, v49
  v_cvt_pk_bf16_f32 v125, v46, v47
  v_exp_f32 v50, v50
  v_exp_f32 v51, v51
  v_cvt_pk_bf16_f32 v126, v48, v49
  v_exp_f32 v52, v52
  v_exp_f32 v53, v53
  v_cvt_pk_bf16_f32 v127, v50, v51
  v_exp_f32 v54, v54
  v_exp_f32 v55, v55
  v_cvt_pk_bf16_f32 v128, v52, v53
  v_exp_f32 v56, v56
  v_exp_f32 v57, v57
  v_cvt_pk_bf16_f32 v129, v54, v55
  v_exp_f32 v58, v58
  v_exp_f32 v59, v59
  v_cvt_pk_bf16_f32 v130, v56, v57
  v_cvt_pk_bf16_f32 v131, v58, v59
  s_waitcnt lgkmcnt(5)
  v_mfma_f32_32x32x16_bf16 v[44:59], v[20:23], v[4:7], v[92:107]
  ds_read_b128 v[12:15], v2 offset:0
  v_exp_f32 v60, v60
  v_exp_f32 v61, v61
  v_exp_f32 v62, v62
  v_exp_f32 v63, v63
  v_cvt_pk_bf16_f32 v132, v60, v61
  v_exp_f32 v64, v64
  s_waitcnt lgkmcnt(5)
  v_mfma_f32_32x32x16_bf16 v[76:91], v[28:31], v[124:127], v[76:91]
  v_exp_f32 v65, v65
  v_cvt_pk_bf16_f32 v133, v62, v63
  v_exp_f32 v66, v66
  v_exp_f32 v67, v67
  v_cvt_pk_bf16_f32 v134, v64, v65
  v_exp_f32 v68, v68
  v_exp_f32 v69, v69
  v_cvt_pk_bf16_f32 v135, v66, v67
  v_exp_f32 v70, v70
  s_waitcnt lgkmcnt(4)
  v_mfma_f32_32x32x16_bf16 v[76:91], v[32:35], v[128:131], v[76:91]
  v_exp_f32 v71, v71
  v_cvt_pk_bf16_f32 v136, v68, v69
  s_mov_b64 exec, s[78:79]
  ds_read_b128 v[28:31], v3 offset:2048
  ds_read_b128 v[32:35], v3 offset:2560
  s_mov_b64 exec, -1
  v_exp_f32 v72, v72
  v_exp_f32 v73, v73
  v_cvt_pk_bf16_f32 v137, v70, v71
  v_exp_f32 v74, v74
  v_exp_f32 v75, v75
  v_cvt_pk_bf16_f32 v138, v72, v73
  v_cvt_pk_bf16_f32 v139, v74, v75
  s_waitcnt lgkmcnt(3)
  v_mfma_f32_32x32x16_bf16 v[60:75], v[24:27], v[4:7], v[92:107]
  v_exp_f32 v44, v44
  v_exp_f32 v45, v45
  v_exp_f32 v46, v46
  v_exp_f32 v47, v47
  v_cvt_pk_bf16_f32 v124, v44, v45
  v_exp_f32 v48, v48
  v_mfma_f32_32x32x16_bf16 v[76:91], v[36:39], v[132:135], v[76:91]
  v_exp_f32 v49, v49
  v_cvt_pk_bf16_f32 v125, v46, v47
  v_exp_f32 v50, v50
  v_exp_f32 v51, v51
  v_cvt_pk_bf16_f32 v126, v48, v49
  v_exp_f32 v52, v52
  v_exp_f32 v53, v53
  v_cvt_pk_bf16_f32 v127, v50, v51
  v_exp_f32 v54, v54
  v_mfma_f32_32x32x16_bf16 v[76:91], v[40:43], v[136:139], v[76:91]
  v_exp_f32 v55, v55
  v_cvt_pk_bf16_f32 v128, v52, v53
  s_mov_b64 exec, s[78:79]
  ds_read_b128 v[36:39], v3 offset:1024
  ds_read_b128 v[40:43], v3 offset:1536
  s_mov_b64 exec, -1
  v_exp_f32 v56, v56
  v_exp_f32 v57, v57
  v_cvt_pk_bf16_f32 v129, v54, v55
  v_exp_f32 v58, v58
  v_exp_f32 v59, v59
  v_cvt_pk_bf16_f32 v130, v56, v57
  v_cvt_pk_bf16_f32 v131, v58, v59
  s_waitcnt lgkmcnt(4)
  v_mfma_f32_32x32x16_bf16 v[44:59], v[12:15], v[4:7], v[92:107]
  v_exp_f32 v60, v60
  v_exp_f32 v61, v61
  v_exp_f32 v62, v62
  v_exp_f32 v63, v63
  v_cvt_pk_bf16_f32 v132, v60, v61
  v_exp_f32 v64, v64
  s_waitcnt lgkmcnt(3)
  v_mfma_f32_32x32x16_bf16 v[76:91], v[28:31], v[124:127], v[76:91]
  v_exp_f32 v65, v65
  v_cvt_pk_bf16_f32 v133, v62, v63
  v_exp_f32 v66, v66
  v_exp_f32 v67, v67
  v_cvt_pk_bf16_f32 v134, v64, v65
  v_exp_f32 v68, v68
  v_exp_f32 v69, v69
  v_cvt_pk_bf16_f32 v135, v66, v67
  v_exp_f32 v70, v70
  s_waitcnt lgkmcnt(2)
  v_mfma_f32_32x32x16_bf16 v[76:91], v[32:35], v[128:131], v[76:91]
  v_exp_f32 v71, v71
  v_cvt_pk_bf16_f32 v136, v68, v69
  s_mov_b64 exec, s[78:79]
  ds_read_b128 v[28:31], v3 offset:0
  ds_read_b128 v[32:35], v3 offset:512
  s_mov_b64 exec, -1
  v_exp_f32 v72, v72
  v_exp_f32 v73, v73
  v_cvt_pk_bf16_f32 v137, v70, v71
  v_exp_f32 v74, v74
  v_exp_f32 v75, v75
  v_cvt_pk_bf16_f32 v138, v72, v73
  v_cvt_pk_bf16_f32 v139, v74, v75
  v_exp_f32 v44, v44
  v_exp_f32 v45, v45
  v_exp_f32 v46, v46
  v_exp_f32 v47, v47
  v_cvt_pk_bf16_f32 v124, v44, v45
  v_exp_f32 v48, v48
  s_waitcnt lgkmcnt(3)
  v_mfma_f32_32x32x16_bf16 v[76:91], v[36:39], v[132:135], v[76:91]
  v_exp_f32 v49, v49
  v_cvt_pk_bf16_f32 v125, v46, v47
  v_exp_f32 v50, v50
  v_exp_f32 v51, v51
  v_cvt_pk_bf16_f32 v126, v48, v49
  v_exp_f32 v52, v52
  v_exp_f32 v53, v53
  v_cvt_pk_bf16_f32 v127, v50, v51
  v_exp_f32 v54, v54
  s_waitcnt lgkmcnt(2)
  v_mfma_f32_32x32x16_bf16 v[76:91], v[40:43], v[136:139], v[76:91]
  v_exp_f32 v55, v55
  v_cvt_pk_bf16_f32 v128, v52, v53
  v_exp_f32 v56, v56
  v_exp_f32 v57, v57
  v_cvt_pk_bf16_f32 v129, v54, v55
  v_exp_f32 v58, v58
  v_exp_f32 v59, v59
  v_cvt_pk_bf16_f32 v130, v56, v57
  v_cvt_pk_bf16_f32 v131, v58, v59
  v_and_b32 v124, v124, v148
  v_and_b32 v125, v125, v149
  v_and_b32 v126, v126, v150
  v_and_b32 v127, v127, v151
  v_and_b32 v128, v128, v152
  v_and_b32 v129, v129, v153
  v_and_b32 v130, v130, v154
  v_and_b32 v131, v131, v155
  s_waitcnt lgkmcnt(1)
  v_mfma_f32_32x32x16_bf16 v[76:91], v[28:31], v[124:127], v[76:91]
  s_waitcnt lgkmcnt(0)
  v_mfma_f32_32x32x16_bf16 v[76:91], v[32:35], v[128:131], v[76:91]
  s_setprio 0
  ds_read_b128 v[12:15], v2 offset:20480
  ds_read_b128 v[16:19], v2 offset:19456
  ds_read_b128 v[20:23], v2 offset:18432
  s_mov_b64 exec, s[78:79]
  ds_read_b128 v[28:31], v3 offset:20480
  ds_read_b128 v[32:35], v3 offset:20992
  s_mov_b64 exec, -1
  s_mov_b64 exec, s[78:79]
  ds_read_b128 v[36:39], v3 offset:19456
  ds_read_b128 v[40:43], v3 offset:19968
  s_mov_b64 exec, -1
  v_sub_f32 v92, 0, v163
  v_sub_f32 v93, 0, v163
  v_sub_f32 v94, 0, v163
  v_sub_f32 v95, 0, v163
  v_sub_f32 v96, 0, v163
  v_sub_f32 v97, 0, v163
  v_sub_f32 v98, 0, v163
  v_sub_f32 v99, 0, v163
  v_sub_f32 v100, 0, v163
  v_sub_f32 v101, 0, v163
  v_sub_f32 v102, 0, v163
  v_sub_f32 v103, 0, v163
  v_sub_f32 v104, 0, v163
  v_sub_f32 v105, 0, v163
  v_sub_f32 v106, 0, v163
  v_sub_f32 v107, 0, v163
  s_waitcnt lgkmcnt(6)
  s_nop 0
  v_mfma_f32_32x32x16_bf16 v[44:59], v[12:15], v[8:11], v[92:107]
  s_waitcnt lgkmcnt(5)
  v_mfma_f32_32x32x16_bf16 v[60:75], v[16:19], v[8:11], v[92:107]
  ds_read_b128 v[24:27], v2 offset:17408
  s_nop 8
  v_exp_f32 v44, v44
  v_exp_f32 v45, v45
  v_exp_f32 v46, v46
  v_exp_f32 v47, v47
  v_cvt_pk_bf16_f32 v124, v44, v45
  v_exp_f32 v48, v48
  v_exp_f32 v49, v49
  v_cvt_pk_bf16_f32 v125, v46, v47
  v_exp_f32 v50, v50
  v_exp_f32 v51, v51
  v_cvt_pk_bf16_f32 v126, v48, v49
  v_exp_f32 v52, v52
  v_exp_f32 v53, v53
  v_cvt_pk_bf16_f32 v127, v50, v51
  v_exp_f32 v54, v54
  v_exp_f32 v55, v55
  v_cvt_pk_bf16_f32 v128, v52, v53
  v_exp_f32 v56, v56
  v_exp_f32 v57, v57
  v_cvt_pk_bf16_f32 v129, v54, v55
  v_exp_f32 v58, v58
  v_exp_f32 v59, v59
  v_cvt_pk_bf16_f32 v130, v56, v57
  v_cvt_pk_bf16_f32 v131, v58, v59
  s_waitcnt lgkmcnt(5)
  v_mfma_f32_32x32x16_bf16 v[44:59], v[20:23], v[8:11], v[92:107]
  ds_read_b128 v[12:15], v2 offset:16384
  v_exp_f32 v60, v60
  v_exp_f32 v61, v61
  v_exp_f32 v62, v62
  v_exp_f32 v63, v63
  v_cvt_pk_bf16_f32 v132, v60, v61
  v_exp_f32 v64, v64
  s_waitcnt lgkmcnt(5)
  v_mfma_f32_32x32x16_bf16 v[108:123], v[28:31], v[124:127], v[108:123]
  v_exp_f32 v65, v65
  v_cvt_pk_bf16_f32 v133, v62, v63
  v_exp_f32 v66, v66
  v_exp_f32 v67, v67
  v_cvt_pk_bf16_f32 v134, v64, v65
  v_exp_f32 v68, v68
  v_exp_f32 v69, v69
  v_cvt_pk_bf16_f32 v135, v66, v67
  v_exp_f32 v70, v70
  s_waitcnt lgkmcnt(4)
  v_mfma_f32_32x32x16_bf16 v[108:123], v[32:35], v[128:131], v[108:123]
  v_exp_f32 v71, v71
  v_cvt_pk_bf16_f32 v136, v68, v69
  s_mov_b64 exec, s[78:79]
  ds_read_b128 v[28:31], v3 offset:18432
  ds_read_b128 v[32:35], v3 offset:18944
  s_mov_b64 exec, -1
  v_exp_f32 v72, v72
  v_exp_f32 v73, v73
  v_cvt_pk_bf16_f32 v137, v70, v71
  v_exp_f32 v74, v74
  v_exp_f32 v75, v75
  v_cvt_pk_bf16_f32 v138, v72, v73
  v_cvt_pk_bf16_f32 v139, v74, v75
  s_waitcnt lgkmcnt(3)
  v_mfma_f32_32x32x16_bf16 v[60:75], v[24:27], v[8:11], v[92:107]
  v_exp_f32 v44, v44
  v_exp_f32 v45, v45
  v_exp_f32 v46, v46
  v_exp_f32 v47, v47
  v_cvt_pk_bf16_f32 v124, v44, v45
  v_exp_f32 v48, v48
  v_mfma_f32_32x32x16_bf16 v[108:123], v[36:39], v[132:135], v[108:123]
  v_exp_f32 v49, v49
  v_cvt_pk_bf16_f32 v125, v46, v47
  v_exp_f32 v50, v50
  v_exp_f32 v51, v51
  v_cvt_pk_bf16_f32 v126, v48, v49
  v_exp_f32 v52, v52
  v_exp_f32 v53, v53
  v_cvt_pk_bf16_f32 v127, v50, v51
  v_exp_f32 v54, v54
  v_mfma_f32_32x32x16_bf16 v[108:123], v[40:43], v[136:139], v[108:123]
  v_exp_f32 v55, v55
  v_cvt_pk_bf16_f32 v128, v52, v53
  s_mov_b64 exec, s[78:79]
  ds_read_b128 v[36:39], v3 offset:17408
  ds_read_b128 v[40:43], v3 offset:17920
  s_mov_b64 exec, -1
  v_exp_f32 v56, v56
  v_exp_f32 v57, v57
  v_cvt_pk_bf16_f32 v129, v54, v55
  v_exp_f32 v58, v58
  v_exp_f32 v59, v59
  v_cvt_pk_bf16_f32 v130, v56, v57
  v_cvt_pk_bf16_f32 v131, v58, v59
  s_waitcnt lgkmcnt(4)
  v_mfma_f32_32x32x16_bf16 v[44:59], v[12:15], v[8:11], v[92:107]
  v_exp_f32 v60, v60
  v_exp_f32 v61, v61
  v_exp_f32 v62, v62
  v_exp_f32 v63, v63
  v_cvt_pk_bf16_f32 v132, v60, v61
  v_exp_f32 v64, v64
  s_waitcnt lgkmcnt(3)
  v_mfma_f32_32x32x16_bf16 v[108:123], v[28:31], v[124:127], v[108:123]
  v_exp_f32 v65, v65
  v_cvt_pk_bf16_f32 v133, v62, v63
  v_exp_f32 v66, v66
  v_exp_f32 v67, v67
  v_cvt_pk_bf16_f32 v134, v64, v65
  v_exp_f32 v68, v68
  v_exp_f32 v69, v69
  v_cvt_pk_bf16_f32 v135, v66, v67
  v_exp_f32 v70, v70
  s_waitcnt lgkmcnt(2)
  v_mfma_f32_32x32x16_bf16 v[108:123], v[32:35], v[128:131], v[108:123]
  v_exp_f32 v71, v71
  v_cvt_pk_bf16_f32 v136, v68, v69
  s_mov_b64 exec, s[78:79]
  ds_read_b128 v[28:31], v3 offset:16384
  ds_read_b128 v[32:35], v3 offset:16896
  s_mov_b64 exec, -1
  v_exp_f32 v72, v72
  v_exp_f32 v73, v73
  v_cvt_pk_bf16_f32 v137, v70, v71
  v_exp_f32 v74, v74
  v_exp_f32 v75, v75
  v_cvt_pk_bf16_f32 v138, v72, v73
  v_cvt_pk_bf16_f32 v139, v74, v75
  v_exp_f32 v44, v44
  v_exp_f32 v45, v45
  v_exp_f32 v46, v46
  v_exp_f32 v47, v47
  v_cvt_pk_bf16_f32 v124, v44, v45
  v_exp_f32 v48, v48
  s_waitcnt lgkmcnt(3)
  v_mfma_f32_32x32x16_bf16 v[108:123], v[36:39], v[132:135], v[108:123]
  v_exp_f32 v49, v49
  v_cvt_pk_bf16_f32 v125, v46, v47
  v_exp_f32 v50, v50
  v_exp_f32 v51, v51
  v_cvt_pk_bf16_f32 v126, v48, v49
  v_exp_f32 v52, v52
  v_exp_f32 v53, v53
  v_cvt_pk_bf16_f32 v127, v50, v51
  v_exp_f32 v54, v54
  s_waitcnt lgkmcnt(2)
  v_mfma_f32_32x32x16_bf16 v[108:123], v[40:43], v[136:139], v[108:123]
  v_exp_f32 v55, v55
  v_cvt_pk_bf16_f32 v128, v52, v53
  v_exp_f32 v56, v56
  v_exp_f32 v57, v57
  v_cvt_pk_bf16_f32 v129, v54, v55
  v_exp_f32 v58, v58
  v_exp_f32 v59, v59
  v_cvt_pk_bf16_f32 v130, v56, v57
  v_cvt_pk_bf16_f32 v131, v58, v59
  v_and_b32 v124, v124, v148
  v_and_b32 v125, v125, v149
  v_and_b32 v126, v126, v150
  v_and_b32 v127, v127, v151
  v_and_b32 v128, v128, v152
  v_and_b32 v129, v129, v153
  v_and_b32 v130, v130, v154
  v_and_b32 v131, v131, v155
  s_waitcnt lgkmcnt(1)
  v_mfma_f32_32x32x16_bf16 v[108:123], v[28:31], v[124:127], v[108:123]
  s_waitcnt lgkmcnt(0)
  v_mfma_f32_32x32x16_bf16 v[108:123], v[32:35], v[128:131], v[108:123]
  s_branch gm_AC_fz
gm_AC_v4:
  s_waitcnt lgkmcnt(0)
  s_nop 10
  s_setprio 3
  ds_read_b128 v[12:15], v2 offset:8192
  ds_read_b128 v[16:19], v2 offset:7168
  ds_read_b128 v[20:23], v2 offset:6144
  s_mov_b64 exec, s[78:79]
  ds_read_b128 v[28:31], v3 offset:8192
  ds_read_b128 v[32:35], v3 offset:8704
  s_mov_b64 exec, -1
  s_mov_b64 exec, s[78:79]
  ds_read_b128 v[36:39], v3 offset:7168
  ds_read_b128 v[40:43], v3 offset:7680
  s_mov_b64 exec, -1
  s_waitcnt lgkmcnt(6)
  v_mfma_f32_32x32x16_bf16 v[44:59], v[12:15], v[4:7], 0
  s_nop 11
  v_cndmask_b32 v44, v44, v158, s[44:45]
  v_cndmask_b32 v45, v45, v158, s[46:47]
  v_cndmask_b32 v46, v46, v158, s[48:49]
  v_cndmask_b32 v47, v47, v158, s[50:51]
  v_cndmask_b32 v48, v48, v158, s[52:53]
  v_cndmask_b32 v49, v49, v158, s[54:55]
  v_cndmask_b32 v50, v50, v158, s[56:57]
  v_cndmask_b32 v51, v51, v158, s[58:59]
  v_cndmask_b32 v52, v52, v158, s[60:61]
  v_cndmask_b32 v53, v53, v158, s[62:63]
  v_cndmask_b32 v54, v54, v158, s[64:65]
  v_cndmask_b32 v55, v55, v158, s[66:67]
  v_cndmask_b32 v56, v56, v158, s[68:69]
  v_cndmask_b32 v57, v57, v158, s[70:71]
  v_cndmask_b32 v58, v58, v158, s[72:73]
  v_cndmask_b32 v59, v59, v158, s[74:75]
  v_max3_f32 v156, v44, v45, v46
  v_max3_f32 v157, v47, v48, v49
  v_max3_f32 v157, v50, v51, v157
  v_max3_f32 v156, v52, v53, v156
  v_max3_f32 v157, v54, v55, v157
  v_max3_f32 v156, v56, v57, v156
  v_max3_f32 v157, v58, v59, v157
  v_max_f32 v156, v156, v157
  v_mov_b32 v157, v156
  s_nop 1
  v_permlane32_swap_b32 v156, v157
  v_max_f32 v162, v156, v157
  v_sub_f32 v92, 0, v162
  v_sub_f32 v93, 0, v162
  v_sub_f32 v94, 0, v162
  v_sub_f32 v95, 0, v162
  v_sub_f32 v96, 0, v162
  v_sub_f32 v97, 0, v162
  v_sub_f32 v98, 0, v162
  v_sub_f32 v99, 0, v162
  v_sub_f32 v100, 0, v162
  v_sub_f32 v101, 0, v162
  v_sub_f32 v102, 0, v162
  v_sub_f32 v103, 0, v162
  v_sub_f32 v104, 0, v162
  v_sub_f32 v105, 0, v162
  v_sub_f32 v106, 0, v162
  v_sub_f32 v107, 0, v162
  v_sub_f32 v44, v44, v162
  v_sub_f32 v45, v45, v162
  v_sub_f32 v46, v46, v162
  v_sub_f32 v47, v47, v162
  v_sub_f32 v48, v48, v162
  v_sub_f32 v49, v49, v162
  v_sub_f32 v50, v50, v162
  v_sub_f32 v51, v51, v162
  v_sub_f32 v52, v52, v162
  v_sub_f32 v53, v53, v162
  v_sub_f32 v54, v54, v162
  v_sub_f32 v55, v55, v162
  v_sub_f32 v56, v56, v162
  v_sub_f32 v57, v57, v162
  v_sub_f32 v58, v58, v162
  v_sub_f32 v59, v59, v162
  s_waitcnt lgkmcnt(5)
  v_mfma_f32_32x32x16_bf16 v[60:75], v[16:19], v[4:7], v[92:107]
  ds_read_b128 v[24:27], v2 offset:5120
  v_exp_f32 v44, v44
  v_exp_f32 v45, v45
  v_exp_f32 v46, v46
  v_exp_f32 v47, v47
  v_cvt_pk_bf16_f32 v124, v44, v45
  v_exp_f32 v48, v48
  v_exp_f32 v49, v49
  v_cvt_pk_bf16_f32 v125, v46, v47
  v_exp_f32 v50, v50
  v_exp_f32 v51, v51
  v_cvt_pk_bf16_f32 v126, v48, v49
  v_exp_f32 v52, v52
  v_exp_f32 v53, v53
  v_cvt_pk_bf16_f32 v127, v50, v51
  v_exp_f32 v54, v54
  v_exp_f32 v55, v55
  v_cvt_pk_bf16_f32 v128, v52, v53
  v_exp_f32 v56, v56
  v_exp_f32 v57, v57
  v_cvt_pk_bf16_f32 v129, v54, v55
  v_exp_f32 v58, v58
  v_exp_f32 v59, v59
  v_cvt_pk_bf16_f32 v130, v56, v57
  v_cvt_pk_bf16_f32 v131, v58, v59
  s_waitcnt lgkmcnt(5)
  v_mfma_f32_32x32x16_bf16 v[44:59], v[20:23], v[4:7], v[92:107]
  ds_read_b128 v[12:15], v2 offset:4096
  v_exp_f32 v60, v60
  v_exp_f32 v61, v61
  v_exp_f32 v62, v62
  v_exp_f32 v63, v63
  v_cvt_pk_bf16_f32 v132, v60, v61
  v_exp_f32 v64, v64
  s_waitcnt lgkmcnt(5)
  v_mfma_f32_32x32x16_bf16 v[76:91], v[28:31], v[124:127], 0
  v_exp_f32 v65, v65
  v_cvt_pk_bf16_f32 v133, v62, v63
  v_exp_f32 v66, v66
  v_exp_f32 v67, v67
  v_cvt_pk_bf16_f32 v134, v64, v65
  v_exp_f32 v68, v68
  v_exp_f32 v69, v69
  v_cvt_pk_bf16_f32 v135, v66, v67
  v_exp_f32 v70, v70
  s_waitcnt lgkmcnt(4)
  v_mfma_f32_32x32x16_bf16 v[76:91], v[32:35], v[128:131], v[76:91]
  v_exp_f32 v71, v71
  v_cvt_pk_bf16_f32 v136, v68, v69
  s_mov_b64 exec, s[78:79]
  ds_read_b128 v[28:31], v3 offset:6144
  ds_read_b128 v[32:35], v3 offset:6656
  s_mov_b64 exec, -1
  v_exp_f32 v72, v72
  v_exp_f32 v73, v73
  v_cvt_pk_bf16_f32 v137, v70, v71
  v_exp_f32 v74, v74
  v_exp_f32 v75, v75
  v_cvt_pk_bf16_f32 v138, v72, v73
  v_cvt_pk_bf16_f32 v139, v74, v75
  s_waitcnt lgkmcnt(3)
  v_mfma_f32_32x32x16_bf16 v[60:75], v[24:27], v[4:7], v[92:107]
  v_exp_f32 v44, v44
  v_exp_f32 v45, v45
  v_exp_f32 v46, v46
  v_exp_f32 v47, v47
  v_cvt_pk_bf16_f32 v124, v44, v45
  v_exp_f32 v48, v48
  v_mfma_f32_32x32x16_bf16 v[76:91], v[36:39], v[132:135], v[76:91]
  v_exp_f32 v49, v49
  v_cvt_pk_bf16_f32 v125, v46, v47
  v_exp_f32 v50, v50
  v_exp_f32 v51, v51
  v_cvt_pk_bf16_f32 v126, v48, v49
  v_exp_f32 v52, v52
  v_exp_f32 v53, v53
  v_cvt_pk_bf16_f32 v127, v50, v51
  v_exp_f32 v54, v54
  v_mfma_f32_32x32x16_bf16 v[76:91], v[40:43], v[136:139], v[76:91]
  v_exp_f32 v55, v55
  v_cvt_pk_bf16_f32 v128, v52, v53
  s_mov_b64 exec, s[78:79]
  ds_read_b128 v[36:39], v3 offset:5120
  ds_read_b128 v[40:43], v3 offset:5632
  s_mov_b64 exec, -1
  v_exp_f32 v56, v56
  v_exp_f32 v57, v57
  v_cvt_pk_bf16_f32 v129, v54, v55
  v_exp_f32 v58, v58
  v_exp_f32 v59, v59
  v_cvt_pk_bf16_f32 v130, v56, v57
  v_cvt_pk_bf16_f32 v131, v58, v59
  s_waitcnt lgkmcnt(4)
  v_mfma_f32_32x32x16_bf16 v[44:59], v[12:15], v[4:7], v[92:107]
  v_exp_f32 v60, v60
  v_exp_f32 v61, v61
  v_exp_f32 v62, v62
  v_exp_f32 v63, v63
  v_cvt_pk_bf16_f32 v132, v60, v61
  v_exp_f32 v64, v64
  s_waitcnt lgkmcnt(3)
  v_mfma_f32_32x32x16_bf16 v[76:91], v[28:31], v[124:127], v[76:91]
  v_exp_f32 v65, v65
  v_cvt_pk_bf16_f32 v133, v62, v63
  v_exp_f32 v66, v66
  v_exp_f32 v67, v67
  v_cvt_pk_bf16_f32 v134, v64, v65
  v_exp_f32 v68, v68
  v_exp_f32 v69, v69
  v_cvt_pk_bf16_f32 v135, v66, v67
  v_exp_f32 v70, v70
  s_waitcnt lgkmcnt(2)
  v_mfma_f32_32x32x16_bf16 v[76:91], v[32:35], v[128:131], v[76:91]
  v_exp_f32 v71, v71
  v_cvt_pk_bf16_f32 v136, v68, v69
  s_mov_b64 exec, s[78:79]
  ds_read_b128 v[28:31], v3 offset:4096
  ds_read_b128 v[32:35], v3 offset:4608
  s_mov_b64 exec, -1
  v_exp_f32 v72, v72
  v_exp_f32 v73, v73
  v_cvt_pk_bf16_f32 v137, v70, v71
  v_exp_f32 v74, v74
  v_exp_f32 v75, v75
  v_cvt_pk_bf16_f32 v138, v72, v73
  v_cvt_pk_bf16_f32 v139, v74, v75
  v_exp_f32 v44, v44
  v_exp_f32 v45, v45
  v_exp_f32 v46, v46
  v_exp_f32 v47, v47
  v_cvt_pk_bf16_f32 v124, v44, v45
  v_exp_f32 v48, v48
  s_waitcnt lgkmcnt(3)
  v_mfma_f32_32x32x16_bf16 v[76:91], v[36:39], v[132:135], v[76:91]
  v_exp_f32 v49, v49
  v_cvt_pk_bf16_f32 v125, v46, v47
  v_exp_f32 v50, v50
  v_exp_f32 v51, v51
  v_cvt_pk_bf16_f32 v126, v48, v49
  v_exp_f32 v52, v52
  v_exp_f32 v53, v53
  v_cvt_pk_bf16_f32 v127, v50, v51
  v_exp_f32 v54, v54
  s_waitcnt lgkmcnt(2)
  v_mfma_f32_32x32x16_bf16 v[76:91], v[40:43], v[136:139], v[76:91]
  v_exp_f32 v55, v55
  v_cvt_pk_bf16_f32 v128, v52, v53
  v_exp_f32 v56, v56
  v_exp_f32 v57, v57
  v_cvt_pk_bf16_f32 v129, v54, v55
  v_exp_f32 v58, v58
  v_exp_f32 v59, v59
  v_cvt_pk_bf16_f32 v130, v56, v57
  v_cvt_pk_bf16_f32 v131, v58, v59
  s_waitcnt lgkmcnt(1)
  v_mfma_f32_32x32x16_bf16 v[76:91], v[28:31], v[124:127], v[76:91]
  s_waitcnt lgkmcnt(0)
  v_mfma_f32_32x32x16_bf16 v[76:91], v[32:35], v[128:131], v[76:91]
  s_setprio 2
  ds_read_b128 v[12:15], v2 offset:24576
  ds_read_b128 v[16:19], v2 offset:23552
  ds_read_b128 v[20:23], v2 offset:22528
  s_mov_b64 exec, s[78:79]
  ds_read_b128 v[28:31], v3 offset:24576
  ds_read_b128 v[32:35], v3 offset:25088
  s_mov_b64 exec, -1
  s_mov_b64 exec, s[78:79]
  ds_read_b128 v[36:39], v3 offset:23552
  ds_read_b128 v[40:43], v3 offset:24064
  s_mov_b64 exec, -1
  s_waitcnt lgkmcnt(6)
  v_mfma_f32_32x32x16_bf16 v[44:59], v[12:15], v[8:11], 0
  s_nop 11
  v_cndmask_b32 v44, v44, v158, s[44:45]
  v_cndmask_b32 v45, v45, v158, s[46:47]
  v_cndmask_b32 v46, v46, v158, s[48:49]
  v_cndmask_b32 v47, v47, v158, s[50:51]
  v_cndmask_b32 v48, v48, v158, s[52:53]
  v_cndmask_b32 v49, v49, v158, s[54:55]
  v_cndmask_b32 v50, v50, v158, s[56:57]
  v_cndmask_b32 v51, v51, v158, s[58:59]
  v_cndmask_b32 v52, v52, v158, s[60:61]
  v_cndmask_b32 v53, v53, v158, s[62:63]
  v_cndmask_b32 v54, v54, v158, s[64:65]
  v_cndmask_b32 v55, v55, v158, s[66:67]
  v_cndmask_b32 v56, v56, v158, s[68:69]
  v_cndmask_b32 v57, v57, v158, s[70:71]
  v_cndmask_b32 v58, v58, v158, s[72:73]
  v_cndmask_b32 v59, v59, v158, s[74:75]
  v_max3_f32 v156, v44, v45, v46
  v_max3_f32 v157, v47, v48, v49
  v_max3_f32 v157, v50, v51, v157
  v_max3_f32 v156, v52, v53, v156
  v_max3_f32 v157, v54, v55, v157
  v_max3_f32 v156, v56, v57, v156
  v_max3_f32 v157, v58, v59, v157
  v_max_f32 v156, v156, v157
  v_mov_b32 v157, v156
  s_nop 1
  v_permlane32_swap_b32 v156, v157
  v_max_f32 v163, v156, v157
  v_sub_f32 v92, 0, v163
  v_sub_f32 v93, 0, v163
  v_sub_f32 v94, 0, v163
  v_sub_f32 v95, 0, v163
  v_sub_f32 v96, 0, v163
  v_sub_f32 v97, 0, v163
  v_sub_f32 v98, 0, v163
  v_sub_f32 v99, 0, v163
  v_sub_f32 v100, 0, v163
  v_sub_f32 v101, 0, v163
  v_sub_f32 v102, 0, v163
  v_sub_f32 v103, 0, v163
  v_sub_f32 v104, 0, v163
  v_sub_f32 v105, 0, v163
  v_sub_f32 v106, 0, v163
  v_sub_f32 v107, 0, v163
  v_sub_f32 v44, v44, v163
  v_sub_f32 v45, v45, v163
  v_sub_f32 v46, v46, v163
  v_sub_f32 v47, v47, v163
  v_sub_f32 v48, v48, v163
  v_sub_f32 v49, v49, v163
  v_sub_f32 v50, v50, v163
  v_sub_f32 v51, v51, v163
  v_sub_f32 v52, v52, v163
  v_sub_f32 v53, v53, v163
  v_sub_f32 v54, v54, v163
  v_sub_f32 v55, v55, v163
  v_sub_f32 v56, v56, v163
  v_sub_f32 v57, v57, v163
  v_sub_f32 v58, v58, v163
  v_sub_f32 v59, v59, v163
  s_waitcnt lgkmcnt(5)
  v_mfma_f32_32x32x16_bf16 v[60:75], v[16:19], v[8:11], v[92:107]
  ds_read_b128 v[24:27], v2 offset:21504
  v_exp_f32 v44, v44
  v_exp_f32 v45, v45
  v_exp_f32 v46, v46
  v_exp_f32 v47, v47
  v_cvt_pk_bf16_f32 v124, v44, v45
  v_exp_f32 v48, v48
  v_exp_f32 v49, v49
  v_cvt_pk_bf16_f32 v125, v46, v47
  v_exp_f32 v50, v50
  v_exp_f32 v51, v51
  v_cvt_pk_bf16_f32 v126, v48, v49
  v_exp_f32 v52, v52
  v_exp_f32 v53, v53
  v_cvt_pk_bf16_f32 v127, v50, v51
  v_exp_f32 v54, v54
  v_exp_f32 v55, v55
  v_cvt_pk_bf16_f32 v128, v52, v53
  v_exp_f32 v56, v56
  v_exp_f32 v57, v57
  v_cvt_pk_bf16_f32 v129, v54, v55
  v_exp_f32 v58, v58
  v_exp_f32 v59, v59
  v_cvt_pk_bf16_f32 v130, v56, v57
  v_cvt_pk_bf16_f32 v131, v58, v59
  s_waitcnt lgkmcnt(5)
  v_mfma_f32_32x32x16_bf16 v[44:59], v[20:23], v[8:11], v[92:107]
  ds_read_b128 v[12:15], v2 offset:20480
  v_exp_f32 v60, v60
  v_exp_f32 v61, v61
  v_exp_f32 v62, v62
  v_exp_f32 v63, v63
  v_cvt_pk_bf16_f32 v132, v60, v61
  v_exp_f32 v64, v64
  s_waitcnt lgkmcnt(5)
  v_mfma_f32_32x32x16_bf16 v[108:123], v[28:31], v[124:127], 0
  v_exp_f32 v65, v65
  v_cvt_pk_bf16_f32 v133, v62, v63
  v_exp_f32 v66, v66
  v_exp_f32 v67, v67
  v_cvt_pk_bf16_f32 v134, v64, v65
  v_exp_f32 v68, v68
  v_exp_f32 v69, v69
  v_cvt_pk_bf16_f32 v135, v66, v67
  v_exp_f32 v70, v70
  s_waitcnt lgkmcnt(4)
  v_mfma_f32_32x32x16_bf16 v[108:123], v[32:35], v[128:131], v[108:123]
  v_exp_f32 v71, v71
  v_cvt_pk_bf16_f32 v136, v68, v69
  s_mov_b64 exec, s[78:79]
  ds_read_b128 v[28:31], v3 offset:22528
  ds_read_b128 v[32:35], v3 offset:23040
  s_mov_b64 exec, -1
  v_exp_f32 v72, v72
  v_exp_f32 v73, v73
  v_cvt_pk_bf16_f32 v137, v70, v71
  v_exp_f32 v74, v74
  v_exp_f32 v75, v75
  v_cvt_pk_bf16_f32 v138, v72, v73
  v_cvt_pk_bf16_f32 v139, v74, v75
  s_waitcnt lgkmcnt(3)
  v_mfma_f32_32x32x16_bf16 v[60:75], v[24:27], v[8:11], v[92:107]
  v_exp_f32 v44, v44
  v_exp_f32 v45, v45
  v_exp_f32 v46, v46
  v_exp_f32 v47, v47
  v_cvt_pk_bf16_f32 v124, v44, v45
  v_exp_f32 v48, v48
  v_mfma_f32_32x32x16_bf16 v[108:123], v[36:39], v[132:135], v[108:123]
  v_exp_f32 v49, v49
  v_cvt_pk_bf16_f32 v125, v46, v47
  v_exp_f32 v50, v50
  v_exp_f32 v51, v51
  v_cvt_pk_bf16_f32 v126, v48, v49
  v_exp_f32 v52, v52
  v_exp_f32 v53, v53
  v_cvt_pk_bf16_f32 v127, v50, v51
  v_exp_f32 v54, v54
  v_mfma_f32_32x32x16_bf16 v[108:123], v[40:43], v[136:139], v[108:123]
  v_exp_f32 v55, v55
  v_cvt_pk_bf16_f32 v128, v52, v53
  s_mov_b64 exec, s[78:79]
  ds_read_b128 v[36:39], v3 offset:21504
  ds_read_b128 v[40:43], v3 offset:22016
  s_mov_b64 exec, -1
  v_exp_f32 v56, v56
  v_exp_f32 v57, v57
  v_cvt_pk_bf16_f32 v129, v54, v55
  v_exp_f32 v58, v58
  v_exp_f32 v59, v59
  v_cvt_pk_bf16_f32 v130, v56, v57
  v_cvt_pk_bf16_f32 v131, v58, v59
  s_waitcnt lgkmcnt(4)
  v_mfma_f32_32x32x16_bf16 v[44:59], v[12:15], v[8:11], v[92:107]
  v_exp_f32 v60, v60
  v_exp_f32 v61, v61
  v_exp_f32 v62, v62
  v_exp_f32 v63, v63
  v_cvt_pk_bf16_f32 v132, v60, v61
  v_exp_f32 v64, v64
  s_waitcnt lgkmcnt(3)
  v_mfma_f32_32x32x16_bf16 v[108:123], v[28:31], v[124:127], v[108:123]
  v_exp_f32 v65, v65
  v_cvt_pk_bf16_f32 v133, v62, v63
  v_exp_f32 v66, v66
  v_exp_f32 v67, v67
  v_cvt_pk_bf16_f32 v134, v64, v65
  v_exp_f32 v68, v68
  v_exp_f32 v69, v69
  v_cvt_pk_bf16_f32 v135, v66, v67
  v_exp_f32 v70, v70
  s_waitcnt lgkmcnt(2)
  v_mfma_f32_32x32x16_bf16 v[108:123], v[32:35], v[128:131], v[108:123]
  v_exp_f32 v71, v71
  v_cvt_pk_bf16_f32 v136, v68, v69
  s_mov_b64 exec, s[78:79]
  ds_read_b128 v[28:31], v3 offset:20480
  ds_read_b128 v[32:35], v3 offset:20992
  s_mov_b64 exec, -1
  v_exp_f32 v72, v72
  v_exp_f32 v73, v73
  v_cvt_pk_bf16_f32 v137, v70, v71
  v_exp_f32 v74, v74
  v_exp_f32 v75, v75
  v_cvt_pk_bf16_f32 v138, v72, v73
  v_cvt_pk_bf16_f32 v139, v74, v75
  v_exp_f32 v44, v44
  v_exp_f32 v45, v45
  v_exp_f32 v46, v46
  v_exp_f32 v47, v47
  v_cvt_pk_bf16_f32 v124, v44, v45
  v_exp_f32 v48, v48
  s_waitcnt lgkmcnt(3)
  v_mfma_f32_32x32x16_bf16 v[108:123], v[36:39], v[132:135], v[108:123]
  v_exp_f32 v49, v49
  v_cvt_pk_bf16_f32 v125, v46, v47
  v_exp_f32 v50, v50
  v_exp_f32 v51, v51
  v_cvt_pk_bf16_f32 v126, v48, v49
  v_exp_f32 v52, v52
  v_exp_f32 v53, v53
  v_cvt_pk_bf16_f32 v127, v50, v51
  v_exp_f32 v54, v54
  s_waitcnt lgkmcnt(2)
  v_mfma_f32_32x32x16_bf16 v[108:123], v[40:43], v[136:139], v[108:123]
  v_exp_f32 v55, v55
  v_cvt_pk_bf16_f32 v128, v52, v53
  v_exp_f32 v56, v56
  v_exp_f32 v57, v57
  v_cvt_pk_bf16_f32 v129, v54, v55
  v_exp_f32 v58, v58
  v_exp_f32 v59, v59
  v_cvt_pk_bf16_f32 v130, v56, v57
  v_cvt_pk_bf16_f32 v131, v58, v59
  s_waitcnt lgkmcnt(1)
  v_mfma_f32_32x32x16_bf16 v[108:123], v[28:31], v[124:127], v[108:123]
  s_waitcnt lgkmcnt(0)
  v_mfma_f32_32x32x16_bf16 v[108:123], v[32:35], v[128:131], v[108:123]
  s_waitcnt lgkmcnt(0)
  s_barrier
  s_cmp_eq_u32 s83, 0
  s_cbranch_scc1 gm_AC_fz
  s_setprio 1
  ds_read_b128 v[12:15], v2 offset:3072
  ds_read_b128 v[16:19], v2 offset:2048
  ds_read_b128 v[20:23], v2 offset:1024
  s_mov_b64 exec, s[78:79]
  ds_read_b128 v[28:31], v3 offset:3072
  ds_read_b128 v[32:35], v3 offset:3584
  s_mov_b64 exec, -1
  s_mov_b64 exec, s[78:79]
  ds_read_b128 v[36:39], v3 offset:2048
  ds_read_b128 v[40:43], v3 offset:2560
  s_mov_b64 exec, -1
  v_sub_f32 v92, 0, v162
  v_sub_f32 v93, 0, v162
  v_sub_f32 v94, 0, v162
  v_sub_f32 v95, 0, v162
  v_sub_f32 v96, 0, v162
  v_sub_f32 v97, 0, v162
  v_sub_f32 v98, 0, v162
  v_sub_f32 v99, 0, v162
  v_sub_f32 v100, 0, v162
  v_sub_f32 v101, 0, v162
  v_sub_f32 v102, 0, v162
  v_sub_f32 v103, 0, v162
  v_sub_f32 v104, 0, v162
  v_sub_f32 v105, 0, v162
  v_sub_f32 v106, 0, v162
  v_sub_f32 v107, 0, v162
  s_waitcnt lgkmcnt(6)
  s_nop 0
  v_mfma_f32_32x32x16_bf16 v[44:59], v[12:15], v[4:7], v[92:107]
  s_waitcnt lgkmcnt(5)
  v_mfma_f32_32x32x16_bf16 v[60:75], v[16:19], v[4:7], v[92:107]
  ds_read_b128 v[24:27], v2 offset:0
  s_nop 8
  v_exp_f32 v44, v44
  v_exp_f32 v45, v45
  v_exp_f32 v46, v46
  v_exp_f32 v47, v47
  v_cvt_pk_bf16_f32 v124, v44, v45
  v_exp_f32 v48, v48
  v_exp_f32 v49, v49
  v_cvt_pk_bf16_f32 v125, v46, v47
  v_exp_f32 v50, v50
  v_exp_f32 v51, v51
  v_cvt_pk_bf16_f32 v126, v48, v49
  v_exp_f32 v52, v52
  v_exp_f32 v53, v53
  v_cvt_pk_bf16_f32 v127, v50, v51
  v_exp_f32 v54, v54
  v_exp_f32 v55, v55
  v_cvt_pk_bf16_f32 v128, v52, v53
  v_exp_f32 v56, v56
  v_exp_f32 v57, v57
  v_cvt_pk_bf16_f32 v129, v54, v55
  v_exp_f32 v58, v58
  v_exp_f32 v59, v59
  v_cvt_pk_bf16_f32 v130, v56, v57
  v_cvt_pk_bf16_f32 v131, v58, v59
  s_waitcnt lgkmcnt(5)
  v_mfma_f32_32x32x16_bf16 v[44:59], v[20:23], v[4:7], v[92:107]
  v_exp_f32 v60, v60
  v_exp_f32 v61, v61
  v_exp_f32 v62, v62
  v_exp_f32 v63, v63
  v_cvt_pk_bf16_f32 v132, v60, v61
  v_exp_f32 v64, v64
  s_waitcnt lgkmcnt(4)
  v_mfma_f32_32x32x16_bf16 v[76:91], v[28:31], v[124:127], v[76:91]
  v_exp_f32 v65, v65
  v_cvt_pk_bf16_f32 v133, v62, v63
  v_exp_f32 v66, v66
  v_exp_f32 v67, v67
  v_cvt_pk_bf16_f32 v134, v64, v65
  v_exp_f32 v68, v68
  v_exp_f32 v69, v69
  v_cvt_pk_bf16_f32 v135, v66, v67
  v_exp_f32 v70, v70
  s_waitcnt lgkmcnt(3)
  v_mfma_f32_32x32x16_bf16 v[76:91], v[32:35], v[128:131], v[76:91]
  v_exp_f32 v71, v71
  v_cvt_pk_bf16_f32 v136, v68, v69
  s_mov_b64 exec, s[78:79]
  ds_read_b128 v[28:31], v3 offset:1024
  ds_read_b128 v[32:35], v3 offset:1536
  s_mov_b64 exec, -1
  v_exp_f32 v72, v72
  v_exp_f32 v73, v73
  v_cvt_pk_bf16_f32 v137, v70, v71
  v_exp_f32 v74, v74
  v_exp_f32 v75, v75
  v_cvt_pk_bf16_f32 v138, v72, v73
  v_cvt_pk_bf16_f32 v139, v74, v75
  s_waitcnt lgkmcnt(2)
  v_mfma_f32_32x32x16_bf16 v[60:75], v[24:27], v[4:7], v[92:107]
  v_exp_f32 v44, v44
  v_exp_f32 v45, v45
  v_exp_f32 v46, v46
  v_exp_f32 v47, v47
  v_cvt_pk_bf16_f32 v124, v44, v45
  v_exp_f32 v48, v48
  v_mfma_f32_32x32x16_bf16 v[76:91], v[36:39], v[132:135], v[76:91]
  v_exp_f32 v49, v49
  v_cvt_pk_bf16_f32 v125, v46, v47
  v_exp_f32 v50, v50
  v_exp_f32 v51, v51
  v_cvt_pk_bf16_f32 v126, v48, v49
  v_exp_f32 v52, v52
  v_exp_f32 v53, v53
  v_cvt_pk_bf16_f32 v127, v50, v51
  v_exp_f32 v54, v54
  v_mfma_f32_32x32x16_bf16 v[76:91], v[40:43], v[136:139], v[76:91]
  v_exp_f32 v55, v55
  v_cvt_pk_bf16_f32 v128, v52, v53
  s_mov_b64 exec, s[78:79]
  ds_read_b128 v[36:39], v3 offset:0
  ds_read_b128 v[40:43], v3 offset:512
  s_mov_b64 exec, -1
  v_exp_f32 v56, v56
  v_exp_f32 v57, v57
  v_cvt_pk_bf16_f32 v129, v54, v55
  v_exp_f32 v58, v58
  v_exp_f32 v59, v59
  v_cvt_pk_bf16_f32 v130, v56, v57
  v_cvt_pk_bf16_f32 v131, v58, v59
  v_exp_f32 v60, v60
  v_exp_f32 v61, v61
  v_exp_f32 v62, v62
  v_exp_f32 v63, v63
  v_cvt_pk_bf16_f32 v132, v60, v61
  v_exp_f32 v64, v64
  s_waitcnt lgkmcnt(3)
  v_mfma_f32_32x32x16_bf16 v[76:91], v[28:31], v[124:127], v[76:91]
  v_exp_f32 v65, v65
  v_cvt_pk_bf16_f32 v133, v62, v63
  v_exp_f32 v66, v66
  v_exp_f32 v67, v67
  v_cvt_pk_bf16_f32 v134, v64, v65
  v_exp_f32 v68, v68
  v_exp_f32 v69, v69
  v_cvt_pk_bf16_f32 v135, v66, v67
  v_exp_f32 v70, v70
  s_waitcnt lgkmcnt(2)
  v_mfma_f32_32x32x16_bf16 v[76:91], v[32:35], v[128:131], v[76:91]
  v_exp_f32 v71, v71
  v_cvt_pk_bf16_f32 v136, v68, v69
  v_exp_f32 v72, v72
  v_exp_f32 v73, v73
  v_cvt_pk_bf16_f32 v137, v70, v71
  v_exp_f32 v74, v74
  v_exp_f32 v75, v75
  v_cvt_pk_bf16_f32 v138, v72, v73
  v_cvt_pk_bf16_f32 v139, v74, v75
  v_and_b32 v132, v132, v148
  v_and_b32 v133, v133, v149
  v_and_b32 v134, v134, v150
  v_and_b32 v135, v135, v151
  v_and_b32 v136, v136, v152
  v_and_b32 v137, v137, v153
  v_and_b32 v138, v138, v154
  v_and_b32 v139, v139, v155
  s_waitcnt lgkmcnt(1)
  v_mfma_f32_32x32x16_bf16 v[76:91], v[36:39], v[132:135], v[76:91]
  s_waitcnt lgkmcnt(0)
  v_mfma_f32_32x32x16_bf16 v[76:91], v[40:43], v[136:139], v[76:91]
  s_setprio 0
  ds_read_b128 v[12:15], v2 offset:19456
  ds_read_b128 v[16:19], v2 offset:18432
  ds_read_b128 v[20:23], v2 offset:17408
  s_mov_b64 exec, s[78:79]
  ds_read_b128 v[28:31], v3 offset:19456
  ds_read_b128 v[32:35], v3 offset:19968
  s_mov_b64 exec, -1
  s_mov_b64 exec, s[78:79]
  ds_read_b128 v[36:39], v3 offset:18432
  ds_read_b128 v[40:43], v3 offset:18944
  s_mov_b64 exec, -1
  v_sub_f32 v92, 0, v163
  v_sub_f32 v93, 0, v163
  v_sub_f32 v94, 0, v163
  v_sub_f32 v95, 0, v163
  v_sub_f32 v96, 0, v163
  v_sub_f32 v97, 0, v163
  v_sub_f32 v98, 0, v163
  v_sub_f32 v99, 0, v163
  v_sub_f32 v100, 0, v163
  v_sub_f32 v101, 0, v163
  v_sub_f32 v102, 0, v163
  v_sub_f32 v103, 0, v163
  v_sub_f32 v104, 0, v163
  v_sub_f32 v105, 0, v163
  v_sub_f32 v106, 0, v163
  v_sub_f32 v107, 0, v163
  s_waitcnt lgkmcnt(6)
  s_nop 0
  v_mfma_f32_32x32x16_bf16 v[44:59], v[12:15], v[8:11], v[92:107]
  s_waitcnt lgkmcnt(5)
  v_mfma_f32_32x32x16_bf16 v[60:75], v[16:19], v[8:11], v[92:107]
  ds_read_b128 v[24:27], v2 offset:16384
  s_nop 8
  v_exp_f32 v44, v44
  v_exp_f32 v45, v45
  v_exp_f32 v46, v46
  v_exp_f32 v47, v47
  v_cvt_pk_bf16_f32 v124, v44, v45
  v_exp_f32 v48, v48
  v_exp_f32 v49, v49
  v_cvt_pk_bf16_f32 v125, v46, v47
  v_exp_f32 v50, v50
  v_exp_f32 v51, v51
  v_cvt_pk_bf16_f32 v126, v48, v49
  v_exp_f32 v52, v52
  v_exp_f32 v53, v53
  v_cvt_pk_bf16_f32 v127, v50, v51
  v_exp_f32 v54, v54
  v_exp_f32 v55, v55
  v_cvt_pk_bf16_f32 v128, v52, v53
  v_exp_f32 v56, v56
  v_exp_f32 v57, v57
  v_cvt_pk_bf16_f32 v129, v54, v55
  v_exp_f32 v58, v58
  v_exp_f32 v59, v59
  v_cvt_pk_bf16_f32 v130, v56, v57
  v_cvt_pk_bf16_f32 v131, v58, v59
  s_waitcnt lgkmcnt(5)
  v_mfma_f32_32x32x16_bf16 v[44:59], v[20:23], v[8:11], v[92:107]
  v_exp_f32 v60, v60
  v_exp_f32 v61, v61
  v_exp_f32 v62, v62
  v_exp_f32 v63, v63
  v_cvt_pk_bf16_f32 v132, v60, v61
  v_exp_f32 v64, v64
  s_waitcnt lgkmcnt(4)
  v_mfma_f32_32x32x16_bf16 v[108:123], v[28:31], v[124:127], v[108:123]
  v_exp_f32 v65, v65
  v_cvt_pk_bf16_f32 v133, v62, v63
  v_exp_f32 v66, v66
  v_exp_f32 v67, v67
  v_cvt_pk_bf16_f32 v134, v64, v65
  v_exp_f32 v68, v68
  v_exp_f32 v69, v69
  v_cvt_pk_bf16_f32 v135, v66, v67
  v_exp_f32 v70, v70
  s_waitcnt lgkmcnt(3)
  v_mfma_f32_32x32x16_bf16 v[108:123], v[32:35], v[128:131], v[108:123]
  v_exp_f32 v71, v71
  v_cvt_pk_bf16_f32 v136, v68, v69
  s_mov_b64 exec, s[78:79]
  ds_read_b128 v[28:31], v3 offset:17408
  ds_read_b128 v[32:35], v3 offset:17920
  s_mov_b64 exec, -1
  v_exp_f32 v72, v72
  v_exp_f32 v73, v73
  v_cvt_pk_bf16_f32 v137, v70, v71
  v_exp_f32 v74, v74
  v_exp_f32 v75, v75
  v_cvt_pk_bf16_f32 v138, v72, v73
  v_cvt_pk_bf16_f32 v139, v74, v75
  s_waitcnt lgkmcnt(2)
  v_mfma_f32_32x32x16_bf16 v[60:75], v[24:27], v[8:11], v[92:107]
  v_exp_f32 v44, v44
  v_exp_f32 v45, v45
  v_exp_f32 v46, v46
  v_exp_f32 v47, v47
  v_cvt_pk_bf16_f32 v124, v44, v45
  v_exp_f32 v48, v48
  v_mfma_f32_32x32x16_bf16 v[108:123], v[36:39], v[132:135], v[108:123]
  v_exp_f32 v49, v49
  v_cvt_pk_bf16_f32 v125, v46, v47
  v_exp_f32 v50, v50
  v_exp_f32 v51, v51
  v_cvt_pk_bf16_f32 v126, v48, v49
  v_exp_f32 v52, v52
  v_exp_f32 v53, v53
  v_cvt_pk_bf16_f32 v127, v50, v51
  v_exp_f32 v54, v54
  v_mfma_f32_32x32x16_bf16 v[108:123], v[40:43], v[136:139], v[108:123]
  v_exp_f32 v55, v55
  v_cvt_pk_bf16_f32 v128, v52, v53
  s_mov_b64 exec, s[78:79]
  ds_read_b128 v[36:39], v3 offset:16384
  ds_read_b128 v[40:43], v3 offset:16896
  s_mov_b64 exec, -1
  v_exp_f32 v56, v56
  v_exp_f32 v57, v57
  v_cvt_pk_bf16_f32 v129, v54, v55
  v_exp_f32 v58, v58
  v_exp_f32 v59, v59
  v_cvt_pk_bf16_f32 v130, v56, v57
  v_cvt_pk_bf16_f32 v131, v58, v59
  v_exp_f32 v60, v60
  v_exp_f32 v61, v61
  v_exp_f32 v62, v62
  v_exp_f32 v63, v63
  v_cvt_pk_bf16_f32 v132, v60, v61
  v_exp_f32 v64, v64
  s_waitcnt lgkmcnt(3)
  v_mfma_f32_32x32x16_bf16 v[108:123], v[28:31], v[124:127], v[108:123]
  v_exp_f32 v65, v65
  v_cvt_pk_bf16_f32 v133, v62, v63
  v_exp_f32 v66, v66
  v_exp_f32 v67, v67
  v_cvt_pk_bf16_f32 v134, v64, v65
  v_exp_f32 v68, v68
  v_exp_f32 v69, v69
  v_cvt_pk_bf16_f32 v135, v66, v67
  v_exp_f32 v70, v70
  s_waitcnt lgkmcnt(2)
  v_mfma_f32_32x32x16_bf16 v[108:123], v[32:35], v[128:131], v[108:123]
  v_exp_f32 v71, v71
  v_cvt_pk_bf16_f32 v136, v68, v69
  v_exp_f32 v72, v72
  v_exp_f32 v73, v73
  v_cvt_pk_bf16_f32 v137, v70, v71
  v_exp_f32 v74, v74
  v_exp_f32 v75, v75
  v_cvt_pk_bf16_f32 v138, v72, v73
  v_cvt_pk_bf16_f32 v139, v74, v75
  v_and_b32 v132, v132, v148
  v_and_b32 v133, v133, v149
  v_and_b32 v134, v134, v150
  v_and_b32 v135, v135, v151
  v_and_b32 v136, v136, v152
  v_and_b32 v137, v137, v153
  v_and_b32 v138, v138, v154
  v_and_b32 v139, v139, v155
  s_waitcnt lgkmcnt(1)
  v_mfma_f32_32x32x16_bf16 v[108:123], v[36:39], v[132:135], v[108:123]
  s_waitcnt lgkmcnt(0)
  v_mfma_f32_32x32x16_bf16 v[108:123], v[40:43], v[136:139], v[108:123]
  s_branch gm_AC_fz
gm_AC_v5:
  s_waitcnt lgkmcnt(0)
  s_nop 10
  s_setprio 3
  ds_read_b128 v[12:15], v2 offset:8192
  ds_read_b128 v[16:19], v2 offset:7168
  ds_read_b128 v[20:23], v2 offset:6144
  s_mov_b64 exec, s[78:79]
  ds_read_b128 v[28:31], v3 offset:8192
  ds_read_b128 v[32:35], v3 offset:8704
  s_mov_b64 exec, -1
  s_mov_b64 exec, s[78:79]
  ds_read_b128 v[36:39], v3 offset:7168
  ds_read_b128 v[40:43], v3 offset:7680
  s_mov_b64 exec, -1
  s_waitcnt lgkmcnt(6)
  v_mfma_f32_32x32x16_bf16 v[44:59], v[12:15], v[4:7], 0
  s_nop 11
  v_cndmask_b32 v44, v44, v158, s[44:45]
  v_cndmask_b32 v45, v45, v158, s[46:47]
  v_cndmask_b32 v46, v46, v158, s[48:49]
  v_cndmask_b32 v47, v47, v158, s[50:51]
  v_cndmask_b32 v48, v48, v158, s[52:53]
  v_cndmask_b32 v49, v49, v158, s[54:55]
  v_cndmask_b32 v50, v50, v158, s[56:57]
  v_cndmask_b32 v51, v51, v158, s[58:59]
  v_cndmask_b32 v52, v52, v158, s[60:61]
  v_cndmask_b32 v53, v53, v158, s[62:63]
  v_cndmask_b32 v54, v54, v158, s[64:65]
  v_cndmask_b32 v55, v55, v158, s[66:67]
  v_cndmask_b32 v56, v56, v158, s[68:69]
  v_cndmask_b32 v57, v57, v158, s[70:71]
  v_cndmask_b32 v58, v58, v158, s[72:73]
  v_cndmask_b32 v59, v59, v158, s[74:75]
  v_max3_f32 v156, v44, v45, v46
  v_max3_f32 v157, v47, v48, v49
  v_max3_f32 v157, v50, v51, v157
  v_max3_f32 v156, v52, v53, v156
  v_max3_f32 v157, v54, v55, v157
  v_max3_f32 v156, v56, v57, v156
  v_max3_f32 v157, v58, v59, v157
  v_max_f32 v156, v156, v157
  v_mov_b32 v157, v156
  s_nop 1
  v_permlane32_swap_b32 v156, v157
  v_max_f32 v162, v156, v157
  v_sub_f32 v92, 0, v162
  v_sub_f32 v93, 0, v162
  v_sub_f32 v94, 0, v162
  v_sub_f32 v95, 0, v162
  v_sub_f32 v96, 0, v162
  v_sub_f32 v97, 0, v162
  v_sub_f32 v98, 0, v162
  v_sub_f32 v99, 0, v162
  v_sub_f32 v100, 0, v162
  v_sub_f32 v101, 0, v162
  v_sub_f32 v102, 0, v162
  v_sub_f32 v103, 0, v162
  v_sub_f32 v104, 0, v162
  v_sub_f32 v105, 0, v162
  v_sub_f32 v106, 0, v162
  v_sub_f32 v107, 0, v162
  v_sub_f32 v44, v44, v162
  v_sub_f32 v45, v45, v162
  v_sub_f32 v46, v46, v162
  v_sub_f32 v47, v47, v162
  v_sub_f32 v48, v48, v162
  v_sub_f32 v49, v49, v162
  v_sub_f32 v50, v50, v162
  v_sub_f32 v51, v51, v162
  v_sub_f32 v52, v52, v162
  v_sub_f32 v53, v53, v162
  v_sub_f32 v54, v54, v162
  v_sub_f32 v55, v55, v162
  v_sub_f32 v56, v56, v162
  v_sub_f32 v57, v57, v162
  v_sub_f32 v58, v58, v162
  v_sub_f32 v59, v59, v162
  s_waitcnt lgkmcnt(5)
  v_mfma_f32_32x32x16_bf16 v[60:75], v[16:19], v[4:7], v[92:107]
  ds_read_b128 v[24:27], v2 offset:5120
  v_exp_f32 v44, v44
  v_exp_f32 v45, v45
  v_exp_f32 v46, v46
  v_exp_f32 v47, v47
  v_cvt_pk_bf16_f32 v124, v44, v45
  v_exp_f32 v48, v48
  v_exp_f32 v49, v49
  v_cvt_pk_bf16_f32 v125, v46, v47
  v_exp_f32 v50, v50
  v_exp_f32 v51, v51
  v_cvt_pk_bf16_f32 v126, v48, v49
  v_exp_f32 v52, v52
  v_exp_f32 v53, v53
  v_cvt_pk_bf16_f32 v127, v50, v51
  v_exp_f32 v54, v54
  v_exp_f32 v55, v55
  v_cvt_pk_bf16_f32 v128, v52, v53
  v_exp_f32 v56, v56
  v_exp_f32 v57, v57
  v_cvt_pk_bf16_f32 v129, v54, v55
  v_exp_f32 v58, v58
  v_exp_f32 v59, v59
  v_cvt_pk_bf16_f32 v130, v56, v57
  v_cvt_pk_bf16_f32 v131, v58, v59
  s_waitcnt lgkmcnt(5)
  v_mfma_f32_32x32x16_bf16 v[44:59], v[20:23], v[4:7], v[92:107]
  ds_read_b128 v[12:15], v2 offset:4096
  v_exp_f32 v60, v60
  v_exp_f32 v61, v61
  v_exp_f32 v62, v62
  v_exp_f32 v63, v63
  v_cvt_pk_bf16_f32 v132, v60, v61
  v_exp_f32 v64, v64
  s_waitcnt lgkmcnt(5)
  v_mfma_f32_32x32x16_bf16 v[76:91], v[28:31], v[124:127], 0
  v_exp_f32 v65, v65
  v_cvt_pk_bf16_f32 v133, v62, v63
  v_exp_f32 v66, v66
  v_exp_f32 v67, v67
  v_cvt_pk_bf16_f32 v134, v64, v65
  v_exp_f32 v68, v68
  v_exp_f32 v69, v69
  v_cvt_pk_bf16_f32 v135, v66, v67
  v_exp_f32 v70, v70
  s_waitcnt lgkmcnt(4)
  v_mfma_f32_32x32x16_bf16 v[76:91], v[32:35], v[128:131], v[76:91]
  v_exp_f32 v71, v71
  v_cvt_pk_bf16_f32 v136, v68, v69
  s_mov_b64 exec, s[78:79]
  ds_read_b128 v[28:31], v3 offset:6144
  ds_read_b128 v[32:35], v3 offset:6656
  s_mov_b64 exec, -1
  v_exp_f32 v72, v72
  v_exp_f32 v73, v73
  v_cvt_pk_bf16_f32 v137, v70, v71
  v_exp_f32 v74, v74
  v_exp_f32 v75, v75
  v_cvt_pk_bf16_f32 v138, v72, v73
  v_cvt_pk_bf16_f32 v139, v74, v75
  s_waitcnt lgkmcnt(3)
  v_mfma_f32_32x32x16_bf16 v[60:75], v[24:27], v[4:7], v[92:107]
  ds_read_b128 v[16:19], v2 offset:3072
  v_exp_f32 v44, v44
  v_exp_f32 v45, v45
  v_exp_f32 v46, v46
  v_exp_f32 v47, v47
  v_cvt_pk_bf16_f32 v124, v44, v45
  v_exp_f32 v48, v48
  v_mfma_f32_32x32x16_bf16 v[76:91], v[36:39], v[132:135], v[76:91]
  v_exp_f32 v49, v49
  v_cvt_pk_bf16_f32 v125, v46, v47
  v_exp_f32 v50, v50
  v_exp_f32 v51, v51
  v_cvt_pk_bf16_f32 v126, v48, v49
  v_exp_f32 v52, v52
  v_exp_f32 v53, v53
  v_cvt_pk_bf16_f32 v127, v50, v51
  v_exp_f32 v54, v54
  v_mfma_f32_32x32x16_bf16 v[76:91], v[40:43], v[136:139], v[76:91]
  v_exp_f32 v55, v55
  v_cvt_pk_bf16_f32 v128, v52, v53
  s_mov_b64 exec, s[78:79]
  ds_read_b128 v[36:39], v3 offset:5120
  ds_read_b128 v[40:43], v3 offset:5632
  s_mov_b64 exec, -1
  v_exp_f32 v56, v56
  v_exp_f32 v57, v57
  v_cvt_pk_bf16_f32 v129, v54, v55
  v_exp_f32 v58, v58
  v_exp_f32 v59, v59
  v_cvt_pk_bf16_f32 v130, v56, v57
  v_cvt_pk_bf16_f32 v131, v58, v59
  s_waitcnt lgkmcnt(5)
  v_mfma_f32_32x32x16_bf16 v[44:59], v[12:15], v[4:7], v[92:107]
  v_exp_f32 v60, v60
  v_exp_f32 v61, v61
  v_exp_f32 v62, v62
  v_exp_f32 v63, v63
  v_cvt_pk_bf16_f32 v132, v60, v61
  v_exp_f32 v64, v64
  s_waitcnt lgkmcnt(4)
  v_mfma_f32_32x32x16_bf16 v[76:91], v[28:31], v[124:127], v[76:91]
  v_exp_f32 v65, v65
  v_cvt_pk_bf16_f32 v133, v62, v63
  v_exp_f32 v66, v66
  v_exp_f32 v67, v67
  v_cvt_pk_bf16_f32 v134, v64, v65
  v_exp_f32 v68, v68
  v_exp_f32 v69, v69
  v_cvt_pk_bf16_f32 v135, v66, v67
  v_exp_f32 v70, v70
  s_waitcnt lgkmcnt(3)
  v_mfma_f32_32x32x16_bf16 v[76:91], v[32:35], v[128:131], v[76:91]
  v_exp_f32 v71, v71
  v_cvt_pk_bf16_f32 v136, v68, v69
  s_mov_b64 exec, s[78:79]
  ds_read_b128 v[28:31], v3 offset:4096
  ds_read_b128 v[32:35], v3 offset:4608
  s_mov_b64 exec, -1
  v_exp_f32 v72, v72
  v_exp_f32 v73, v73
  v_cvt_pk_bf16_f32 v137, v70, v71
  v_exp_f32 v74, v74
  v_exp_f32 v75, v75
  v_cvt_pk_bf16_f32 v138, v72, v73
  v_cvt_pk_bf16_f32 v139, v74, v75
  s_waitcnt lgkmcnt(4)
  v_mfma_f32_32x32x16_bf16 v[60:75], v[16:19], v[4:7], v[92:107]
  v_exp_f32 v44, v44
  v_exp_f32 v45, v45
  v_exp_f32 v46, v46
  v_exp_f32 v47, v47
  v_cvt_pk_bf16_f32 v124, v44, v45
  v_exp_f32 v48, v48
  s_waitcnt lgkmcnt(3)
  v_mfma_f32_32x32x16_bf16 v[76:91], v[36:39], v[132:135], v[76:91]
  v_exp_f32 v49, v49
  v_cvt_pk_bf16_f32 v125, v46, v47
  v_exp_f32 v50, v50
  v_exp_f32 v51, v51
  v_cvt_pk_bf16_f32 v126, v48, v49
  v_exp_f32 v52, v52
  v_exp_f32 v53, v53
  v_cvt_pk_bf16_f32 v127, v50, v51
  v_exp_f32 v54, v54
  s_waitcnt lgkmcnt(2)
  v_mfma_f32_32x32x16_bf16 v[76:91], v[40:43], v[136:139], v[76:91]
  v_exp_f32 v55, v55
  v_cvt_pk_bf16_f32 v128, v52, v53
  s_mov_b64 exec, s[78:79]
  ds_read_b128 v[36:39], v3 offset:3072
  ds_read_b128 v[40:43], v3 offset:3584
  s_mov_b64 exec, -1
  v_exp_f32 v56, v56
  v_exp_f32 v57, v57
  v_cvt_pk_bf16_f32 v129, v54, v55
  v_exp_f32 v58, v58
  v_exp_f32 v59, v59
  v_cvt_pk_bf16_f32 v130, v56, v57
  v_cvt_pk_bf16_f32 v131, v58, v59
  v_exp_f32 v60, v60
  v_exp_f32 v61, v61
  v_exp_f32 v62, v62
  v_exp_f32 v63, v63
  v_cvt_pk_bf16_f32 v132, v60, v61
  v_exp_f32 v64, v64
  s_waitcnt lgkmcnt(3)
  v_mfma_f32_32x32x16_bf16 v[76:91], v[28:31], v[124:127], v[76:91]
  v_exp_f32 v65, v65
  v_cvt_pk_bf16_f32 v133, v62, v63
  v_exp_f32 v66, v66
  v_exp_f32 v67, v67
  v_cvt_pk_bf16_f32 v134, v64, v65
  v_exp_f32 v68, v68
  v_exp_f32 v69, v69
  v_cvt_pk_bf16_f32 v135, v66, v67
  v_exp_f32 v70, v70
  s_waitcnt lgkmcnt(2)
  v_mfma_f32_32x32x16_bf16 v[76:91], v[32:35], v[128:131], v[76:91]
  v_exp_f32 v71, v71
  v_cvt_pk_bf16_f32 v136, v68, v69
  v_exp_f32 v72, v72
  v_exp_f32 v73, v73
  v_cvt_pk_bf16_f32 v137, v70, v71
  v_exp_f32 v74, v74
  v_exp_f32 v75, v75
  v_cvt_pk_bf16_f32 v138, v72, v73
  v_cvt_pk_bf16_f32 v139, v74, v75
  s_waitcnt lgkmcnt(1)
  v_mfma_f32_32x32x16_bf16 v[76:91], v[36:39], v[132:135], v[76:91]
  s_waitcnt lgkmcnt(0)
  v_mfma_f32_32x32x16_bf16 v[76:91], v[40:43], v[136:139], v[76:91]
  s_setprio 2
  ds_read_b128 v[12:15], v2 offset:24576
  ds_read_b128 v[16:19], v2 offset:23552
  ds_read_b128 v[20:23], v2 offset:22528
  s_mov_b64 exec, s[78:79]
  ds_read_b128 v[28:31], v3 offset:24576
  ds_read_b128 v[32:35], v3 offset:25088
  s_mov_b64 exec, -1
  s_mov_b64 exec, s[78:79]
  ds_read_b128 v[36:39], v3 offset:23552
  ds_read_b128 v[40:43], v3 offset:24064
  s_mov_b64 exec, -1
  s_waitcnt lgkmcnt(6)
  v_mfma_f32_32x32x16_bf16 v[44:59], v[12:15], v[8:11], 0
  s_nop 11
  v_cndmask_b32 v44, v44, v158, s[44:45]
  v_cndmask_b32 v45, v45, v158, s[46:47]
  v_cndmask_b32 v46, v46, v158, s[48:49]
  v_cndmask_b32 v47, v47, v158, s[50:51]
  v_cndmask_b32 v48, v48, v158, s[52:53]
  v_cndmask_b32 v49, v49, v158, s[54:55]
  v_cndmask_b32 v50, v50, v158, s[56:57]
  v_cndmask_b32 v51, v51, v158, s[58:59]
  v_cndmask_b32 v52, v52, v158, s[60:61]
  v_cndmask_b32 v53, v53, v158, s[62:63]
  v_cndmask_b32 v54, v54, v158, s[64:65]
  v_cndmask_b32 v55, v55, v158, s[66:67]
  v_cndmask_b32 v56, v56, v158, s[68:69]
  v_cndmask_b32 v57, v57, v158, s[70:71]
  v_cndmask_b32 v58, v58, v158, s[72:73]
  v_cndmask_b32 v59, v59, v158, s[74:75]
  v_max3_f32 v156, v44, v45, v46
  v_max3_f32 v157, v47, v48, v49
  v_max3_f32 v157, v50, v51, v157
  v_max3_f32 v156, v52, v53, v156
  v_max3_f32 v157, v54, v55, v157
  v_max3_f32 v156, v56, v57, v156
  v_max3_f32 v157, v58, v59, v157
  v_max_f32 v156, v156, v157
  v_mov_b32 v157, v156
  s_nop 1
  v_permlane32_swap_b32 v156, v157
  v_max_f32 v163, v156, v157
  v_sub_f32 v92, 0, v163
  v_sub_f32 v93, 0, v163
  v_sub_f32 v94, 0, v163
  v_sub_f32 v95, 0, v163
  v_sub_f32 v96, 0, v163
  v_sub_f32 v97, 0, v163
  v_sub_f32 v98, 0, v163
  v_sub_f32 v99, 0, v163
  v_sub_f32 v100, 0, v163
  v_sub_f32 v101, 0, v163
  v_sub_f32 v102, 0, v163
  v_sub_f32 v103, 0, v163
  v_sub_f32 v104, 0, v163
  v_sub_f32 v105, 0, v163
  v_sub_f32 v106, 0, v163
  v_sub_f32 v107, 0, v163
  v_sub_f32 v44, v44, v163
  v_sub_f32 v45, v45, v163
  v_sub_f32 v46, v46, v163
  v_sub_f32 v47, v47, v163
  v_sub_f32 v48, v48, v163
  v_sub_f32 v49, v49, v163
  v_sub_f32 v50, v50, v163
  v_sub_f32 v51, v51, v163
  v_sub_f32 v52, v52, v163
  v_sub_f32 v53, v53, v163
  v_sub_f32 v54, v54, v163
  v_sub_f32 v55, v55, v163
  v_sub_f32 v56, v56, v163
  v_sub_f32 v57, v57, v163
  v_sub_f32 v58, v58, v163
  v_sub_f32 v59, v59, v163
  s_waitcnt lgkmcnt(5)
  v_mfma_f32_32x32x16_bf16 v[60:75], v[16:19], v[8:11], v[92:107]
  ds_read_b128 v[24:27], v2 offset:21504
  v_exp_f32 v44, v44
  v_exp_f32 v45, v45
  v_exp_f32 v46, v46
  v_exp_f32 v47, v47
  v_cvt_pk_bf16_f32 v124, v44, v45
  v_exp_f32 v48, v48
  v_exp_f32 v49, v49
  v_cvt_pk_bf16_f32 v125, v46, v47
  v_exp_f32 v50, v50
  v_exp_f32 v51, v51
  v_cvt_pk_bf16_f32 v126, v48, v49
  v_exp_f32 v52, v52
  v_exp_f32 v53, v53
  v_cvt_pk_bf16_f32 v127, v50, v51
  v_exp_f32 v54, v54
  v_exp_f32 v55, v55
  v_cvt_pk_bf16_f32 v128, v52, v53
  v_exp_f32 v56, v56
  v_exp_f32 v57, v57
  v_cvt_pk_bf16_f32 v129, v54, v55
  v_exp_f32 v58, v58
  v_exp_f32 v59, v59
  v_cvt_pk_bf16_f32 v130, v56, v57
  v_cvt_pk_bf16_f32 v131, v58, v59
  s_waitcnt lgkmcnt(5)
  v_mfma_f32_32x32x16_bf16 v[44:59], v[20:23], v[8:11], v[92:107]
  ds_read_b128 v[12:15], v2 offset:20480
  v_exp_f32 v60, v60
  v_exp_f32 v61, v61
  v_exp_f32 v62, v62
  v_exp_f32 v63, v63
  v_cvt_pk_bf16_f32 v132, v60, v61
  v_exp_f32 v64, v64
  s_waitcnt lgkmcnt(5)
  v_mfma_f32_32x32x16_bf16 v[108:123], v[28:31], v[124:127], 0
  v_exp_f32 v65, v65
  v_cvt_pk_bf16_f32 v133, v62, v63
  v_exp_f32 v66, v66
  v_exp_f32 v67, v67
  v_cvt_pk_bf16_f32 v134, v64, v65
  v_exp_f32 v68, v68
  v_exp_f32 v69, v69
  v_cvt_pk_bf16_f32 v135, v66, v67
  v_exp_f32 v70, v70
  s_waitcnt lgkmcnt(4)
  v_mfma_f32_32x32x16_bf16 v[108:123], v[32:35], v[128:131], v[108:123]
  v_exp_f32 v71, v71
  v_cvt_pk_bf16_f32 v136, v68, v69
  s_mov_b64 exec, s[78:79]
  ds_read_b128 v[28:31], v3 offset:22528
  ds_read_b128 v[32:35], v3 offset:23040
  s_mov_b64 exec, -1
  v_exp_f32 v72, v72
  v_exp_f32 v73, v73
  v_cvt_pk_bf16_f32 v137, v70, v71
  v_exp_f32 v74, v74
  v_exp_f32 v75, v75
  v_cvt_pk_bf16_f32 v138, v72, v73
  v_cvt_pk_bf16_f32 v139, v74, v75
  s_waitcnt lgkmcnt(3)
  v_mfma_f32_32x32x16_bf16 v[60:75], v[24:27], v[8:11], v[92:107]
  ds_read_b128 v[16:19], v2 offset:19456
  v_exp_f32 v44, v44
  v_exp_f32 v45, v45
  v_exp_f32 v46, v46
  v_exp_f32 v47, v47
  v_cvt_pk_bf16_f32 v124, v44, v45
  v_exp_f32 v48, v48
  v_mfma_f32_32x32x16_bf16 v[108:123], v[36:39], v[132:135], v[108:123]
  v_exp_f32 v49, v49
  v_cvt_pk_bf16_f32 v125, v46, v47
  v_exp_f32 v50, v50
  v_exp_f32 v51, v51
  v_cvt_pk_bf16_f32 v126, v48, v49
  v_exp_f32 v52, v52
  v_exp_f32 v53, v53
  v_cvt_pk_bf16_f32 v127, v50, v51
  v_exp_f32 v54, v54
  v_mfma_f32_32x32x16_bf16 v[108:123], v[40:43], v[136:139], v[108:123]
  v_exp_f32 v55, v55
  v_cvt_pk_bf16_f32 v128, v52, v53
  s_mov_b64 exec, s[78:79]
  ds_read_b128 v[36:39], v3 offset:21504
  ds_read_b128 v[40:43], v3 offset:22016
  s_mov_b64 exec, -1
  v_exp_f32 v56, v56
  v_exp_f32 v57, v57
  v_cvt_pk_bf16_f32 v129, v54, v55
  v_exp_f32 v58, v58
  v_exp_f32 v59, v59
  v_cvt_pk_bf16_f32 v130, v56, v57
  v_cvt_pk_bf16_f32 v131, v58, v59
  s_waitcnt lgkmcnt(5)
  v_mfma_f32_32x32x16_bf16 v[44:59], v[12:15], v[8:11], v[92:107]
  v_exp_f32 v60, v60
  v_exp_f32 v61, v61
  v_exp_f32 v62, v62
  v_exp_f32 v63, v63
  v_cvt_pk_bf16_f32 v132, v60, v61
  v_exp_f32 v64, v64
  s_waitcnt lgkmcnt(4)
  v_mfma_f32_32x32x16_bf16 v[108:123], v[28:31], v[124:127], v[108:123]
  v_exp_f32 v65, v65
  v_cvt_pk_bf16_f32 v133, v62, v63
  v_exp_f32 v66, v66
  v_exp_f32 v67, v67
  v_cvt_pk_bf16_f32 v134, v64, v65
  v_exp_f32 v68, v68
  v_exp_f32 v69, v69
  v_cvt_pk_bf16_f32 v135, v66, v67
  v_exp_f32 v70, v70
  s_waitcnt lgkmcnt(3)
  v_mfma_f32_32x32x16_bf16 v[108:123], v[32:35], v[128:131], v[108:123]
  v_exp_f32 v71, v71
  v_cvt_pk_bf16_f32 v136, v68, v69
  s_mov_b64 exec, s[78:79]
  ds_read_b128 v[28:31], v3 offset:20480
  ds_read_b128 v[32:35], v3 offset:20992
  s_mov_b64 exec, -1
  v_exp_f32 v72, v72
  v_exp_f32 v73, v73
  v_cvt_pk_bf16_f32 v137, v70, v71
  v_exp_f32 v74, v74
  v_exp_f32 v75, v75
  v_cvt_pk_bf16_f32 v138, v72, v73
  v_cvt_pk_bf16_f32 v139, v74, v75
  s_waitcnt lgkmcnt(4)
  v_mfma_f32_32x32x16_bf16 v[60:75], v[16:19], v[8:11], v[92:107]
  v_exp_f32 v44, v44
  v_exp_f32 v45, v45
  v_exp_f32 v46, v46
  v_exp_f32 v47, v47
  v_cvt_pk_bf16_f32 v124, v44, v45
  v_exp_f32 v48, v48
  s_waitcnt lgkmcnt(3)
  v_mfma_f32_32x32x16_bf16 v[108:123], v[36:39], v[132:135], v[108:123]
  v_exp_f32 v49, v49
  v_cvt_pk_bf16_f32 v125, v46, v47
  v_exp_f32 v50, v50
  v_exp_f32 v51, v51
  v_cvt_pk_bf16_f32 v126, v48, v49
  v_exp_f32 v52, v52
  v_exp_f32 v53, v53
  v_cvt_pk_bf16_f32 v127, v50, v51
  v_exp_f32 v54, v54
  s_waitcnt lgkmcnt(2)
  v_mfma_f32_32x32x16_bf16 v[108:123], v[40:43], v[136:139], v[108:123]
  v_exp_f32 v55, v55
  v_cvt_pk_bf16_f32 v128, v52, v53
  s_mov_b64 exec, s[78:79]
  ds_read_b128 v[36:39], v3 offset:19456
  ds_read_b128 v[40:43], v3 offset:19968
  s_mov_b64 exec, -1
  v_exp_f32 v56, v56
  v_exp_f32 v57, v57
  v_cvt_pk_bf16_f32 v129, v54, v55
  v_exp_f32 v58, v58
  v_exp_f32 v59, v59
  v_cvt_pk_bf16_f32 v130, v56, v57
  v_cvt_pk_bf16_f32 v131, v58, v59
  v_exp_f32 v60, v60
  v_exp_f32 v61, v61
  v_exp_f32 v62, v62
  v_exp_f32 v63, v63
  v_cvt_pk_bf16_f32 v132, v60, v61
  v_exp_f32 v64, v64
  s_waitcnt lgkmcnt(3)
  v_mfma_f32_32x32x16_bf16 v[108:123], v[28:31], v[124:127], v[108:123]
  v_exp_f32 v65, v65
  v_cvt_pk_bf16_f32 v133, v62, v63
  v_exp_f32 v66, v66
  v_exp_f32 v67, v67
  v_cvt_pk_bf16_f32 v134, v64, v65
  v_exp_f32 v68, v68
  v_exp_f32 v69, v69
  v_cvt_pk_bf16_f32 v135, v66, v67
  v_exp_f32 v70, v70
  s_waitcnt lgkmcnt(2)
  v_mfma_f32_32x32x16_bf16 v[108:123], v[32:35], v[128:131], v[108:123]
  v_exp_f32 v71, v71
  v_cvt_pk_bf16_f32 v136, v68, v69
  v_exp_f32 v72, v72
  v_exp_f32 v73, v73
  v_cvt_pk_bf16_f32 v137, v70, v71
  v_exp_f32 v74, v74
  v_exp_f32 v75, v75
  v_cvt_pk_bf16_f32 v138, v72, v73
  v_cvt_pk_bf16_f32 v139, v74, v75
  s_waitcnt lgkmcnt(1)
  v_mfma_f32_32x32x16_bf16 v[108:123], v[36:39], v[132:135], v[108:123]
  s_waitcnt lgkmcnt(0)
  v_mfma_f32_32x32x16_bf16 v[108:123], v[40:43], v[136:139], v[108:123]
  s_waitcnt lgkmcnt(0)
  s_barrier
  s_cmp_eq_u32 s83, 0
  s_cbranch_scc1 gm_AC_fz
  s_setprio 1
  ds_read_b128 v[12:15], v2 offset:2048
  ds_read_b128 v[16:19], v2 offset:1024
  ds_read_b128 v[20:23], v2 offset:0
  s_mov_b64 exec, s[78:79]
  ds_read_b128 v[28:31], v3 offset:2048
  ds_read_b128 v[32:35], v3 offset:2560
  s_mov_b64 exec, -1
  s_mov_b64 exec, s[78:79]
  ds_read_b128 v[36:39], v3 offset:1024
  ds_read_b128 v[40:43], v3 offset:1536
  s_mov_b64 exec, -1
  v_sub_f32 v92, 0, v162
  v_sub_f32 v93, 0, v162
  v_sub_f32 v94, 0, v162
  v_sub_f32 v95, 0, v162
  v_sub_f32 v96, 0, v162
  v_sub_f32 v97, 0, v162
  v_sub_f32 v98, 0, v162
  v_sub_f32 v99, 0, v162
  v_sub_f32 v100, 0, v162
  v_sub_f32 v101, 0, v162
  v_sub_f32 v102, 0, v162
  v_sub_f32 v103, 0, v162
  v_sub_f32 v104, 0, v162
  v_sub_f32 v105, 0, v162
  v_sub_f32 v106, 0, v162
  v_sub_f32 v107, 0, v162
  s_waitcnt lgkmcnt(6)
  s_nop 0
  v_mfma_f32_32x32x16_bf16 v[44:59], v[12:15], v[4:7], v[92:107]
  s_waitcnt lgkmcnt(5)
  v_mfma_f32_32x32x16_bf16 v[60:75], v[16:19], v[4:7], v[92:107]
  s_nop 9
  v_exp_f32 v44, v44
  v_exp_f32 v45, v45
  v_exp_f32 v46, v46
  v_exp_f32 v47, v47
  v_cvt_pk_bf16_f32 v124, v44, v45
  v_exp_f32 v48, v48
  v_exp_f32 v49, v49
  v_cvt_pk_bf16_f32 v125, v46, v47
  v_exp_f32 v50, v50
  v_exp_f32 v51, v51
  v_cvt_pk_bf16_f32 v126, v48, v49
  v_exp_f32 v52, v52
  v_exp_f32 v53, v53
  v_cvt_pk_bf16_f32 v127, v50, v51
  v_exp_f32 v54, v54
  v_exp_f32 v55, v55
  v_cvt_pk_bf16_f32 v128, v52, v53
  v_exp_f32 v56, v56
  v_exp_f32 v57, v57
  v_cvt_pk_bf16_f32 v129, v54, v55
  v_exp_f32 v58, v58
  v_exp_f32 v59, v59
  v_cvt_pk_bf16_f32 v130, v56, v57
  v_cvt_pk_bf16_f32 v131, v58, v59
  s_waitcnt lgkmcnt(4)
  v_mfma_f32_32x32x16_bf16 v[44:59], v[20:23], v[4:7], v[92:107]
  v_exp_f32 v60, v60
  v_exp_f32 v61, v61
  v_exp_f32 v62, v62
  v_exp_f32 v63, v63
  v_cvt_pk_bf16_f32 v132, v60, v61
  v_exp_f32 v64, v64
  s_waitcnt lgkmcnt(3)
  v_mfma_f32_32x32x16_bf16 v[76:91], v[28:31], v[124:127], v[76:91]
  v_exp_f32 v65, v65
  v_cvt_pk_bf16_f32 v133, v62, v63
  v_exp_f32 v66, v66
  v_exp_f32 v67, v67
  v_cvt_pk_bf16_f32 v134, v64, v65
  v_exp_f32 v68, v68
  v_exp_f32 v69, v69
  v_cvt_pk_bf16_f32 v135, v66, v67
  v_exp_f32 v70, v70
  s_waitcnt lgkmcnt(2)
  v_mfma_f32_32x32x16_bf16 v[76:91], v[32:35], v[128:131], v[76:91]
  v_exp_f32 v71, v71
  v_cvt_pk_bf16_f32 v136, v68, v69
  s_mov_b64 exec, s[78:79]
  ds_read_b128 v[28:31], v3 offset:0
  ds_read_b128 v[32:35], v3 offset:512
  s_mov_b64 exec, -1
  v_exp_f32 v72, v72
  v_exp_f32 v73, v73
  v_cvt_pk_bf16_f32 v137, v70, v71
  v_exp_f32 v74, v74
  v_exp_f32 v75, v75
  v_cvt_pk_bf16_f32 v138, v72, v73
  v_cvt_pk_bf16_f32 v139, v74, v75
  v_exp_f32 v44, v44
  v_exp_f32 v45, v45
  v_exp_f32 v46, v46
  v_exp_f32 v47, v47
  v_cvt_pk_bf16_f32 v124, v44, v45
  v_exp_f32 v48, v48
  s_waitcnt lgkmcnt(3)
  v_mfma_f32_32x32x16_bf16 v[76:91], v[36:39], v[132:135], v[76:91]
  v_exp_f32 v49, v49
  v_cvt_pk_bf16_f32 v125, v46, v47
  v_exp_f32 v50, v50
  v_exp_f32 v51, v51
  v_cvt_pk_bf16_f32 v126, v48, v49
  v_exp_f32 v52, v52
  v_exp_f32 v53, v53
  v_cvt_pk_bf16_f32 v127, v50, v51
  v_exp_f32 v54, v54
  s_waitcnt lgkmcnt(2)
  v_mfma_f32_32x32x16_bf16 v[76:91], v[40:43], v[136:139], v[76:91]
  v_exp_f32 v55, v55
  v_cvt_pk_bf16_f32 v128, v52, v53
  v_exp_f32 v56, v56
  v_exp_f32 v57, v57
  v_cvt_pk_bf16_f32 v129, v54, v55
  v_exp_f32 v58, v58
  v_exp_f32 v59, v59
  v_cvt_pk_bf16_f32 v130, v56, v57
  v_cvt_pk_bf16_f32 v131, v58, v59
  v_and_b32 v124, v124, v148
  v_and_b32 v125, v125, v149
  v_and_b32 v126, v126, v150
  v_and_b32 v127, v127, v151
  v_and_b32 v128, v128, v152
  v_and_b32 v129, v129, v153
  v_and_b32 v130, v130, v154
  v_and_b32 v131, v131, v155
  s_waitcnt lgkmcnt(1)
  v_mfma_f32_32x32x16_bf16 v[76:91], v[28:31], v[124:127], v[76:91]
  s_waitcnt lgkmcnt(0)
  v_mfma_f32_32x32x16_bf16 v[76:91], v[32:35], v[128:131], v[76:91]
  s_setprio 0
  ds_read_b128 v[12:15], v2 offset:18432
  ds_read_b128 v[16:19], v2 offset:17408
  ds_read_b128 v[20:23], v2 offset:16384
  s_mov_b64 exec, s[78:79]
  ds_read_b128 v[28:31], v3 offset:18432
  ds_read_b128 v[32:35], v3 offset:18944
  s_mov_b64 exec, -1
  s_mov_b64 exec, s[78:79]
  ds_read_b128 v[36:39], v3 offset:17408
  ds_read_b128 v[40:43], v3 offset:17920
  s_mov_b64 exec, -1
  v_sub_f32 v92, 0, v163
  v_sub_f32 v93, 0, v163
  v_sub_f32 v94, 0, v163
  v_sub_f32 v95, 0, v163
  v_sub_f32 v96, 0, v163
  v_sub_f32 v97, 0, v163
  v_sub_f32 v98, 0, v163
  v_sub_f32 v99, 0, v163
  v_sub_f32 v100, 0, v163
  v_sub_f32 v101, 0, v163
  v_sub_f32 v102, 0, v163
  v_sub_f32 v103, 0, v163
  v_sub_f32 v104, 0, v163
  v_sub_f32 v105, 0, v163
  v_sub_f32 v106, 0, v163
  v_sub_f32 v107, 0, v163
  s_waitcnt lgkmcnt(6)
  s_nop 0
  v_mfma_f32_32x32x16_bf16 v[44:59], v[12:15], v[8:11], v[92:107]
  s_waitcnt lgkmcnt(5)
  v_mfma_f32_32x32x16_bf16 v[60:75], v[16:19], v[8:11], v[92:107]
  s_nop 9
  v_exp_f32 v44, v44
  v_exp_f32 v45, v45
  v_exp_f32 v46, v46
  v_exp_f32 v47, v47
  v_cvt_pk_bf16_f32 v124, v44, v45
  v_exp_f32 v48, v48
  v_exp_f32 v49, v49
  v_cvt_pk_bf16_f32 v125, v46, v47
  v_exp_f32 v50, v50
  v_exp_f32 v51, v51
  v_cvt_pk_bf16_f32 v126, v48, v49
  v_exp_f32 v52, v52
  v_exp_f32 v53, v53
  v_cvt_pk_bf16_f32 v127, v50, v51
  v_exp_f32 v54, v54
  v_exp_f32 v55, v55
  v_cvt_pk_bf16_f32 v128, v52, v53
  v_exp_f32 v56, v56
  v_exp_f32 v57, v57
  v_cvt_pk_bf16_f32 v129, v54, v55
  v_exp_f32 v58, v58
  v_exp_f32 v59, v59
  v_cvt_pk_bf16_f32 v130, v56, v57
  v_cvt_pk_bf16_f32 v131, v58, v59
  s_waitcnt lgkmcnt(4)
  v_mfma_f32_32x32x16_bf16 v[44:59], v[20:23], v[8:11], v[92:107]
  v_exp_f32 v60, v60
  v_exp_f32 v61, v61
  v_exp_f32 v62, v62
  v_exp_f32 v63, v63
  v_cvt_pk_bf16_f32 v132, v60, v61
  v_exp_f32 v64, v64
  s_waitcnt lgkmcnt(3)
  v_mfma_f32_32x32x16_bf16 v[108:123], v[28:31], v[124:127], v[108:123]
  v_exp_f32 v65, v65
  v_cvt_pk_bf16_f32 v133, v62, v63
  v_exp_f32 v66, v66
  v_exp_f32 v67, v67
  v_cvt_pk_bf16_f32 v134, v64, v65
  v_exp_f32 v68, v68
  v_exp_f32 v69, v69
  v_cvt_pk_bf16_f32 v135, v66, v67
  v_exp_f32 v70, v70
  s_waitcnt lgkmcnt(2)
  v_mfma_f32_32x32x16_bf16 v[108:123], v[32:35], v[128:131], v[108:123]
  v_exp_f32 v71, v71
  v_cvt_pk_bf16_f32 v136, v68, v69
  s_mov_b64 exec, s[78:79]
  ds_read_b128 v[28:31], v3 offset:16384
  ds_read_b128 v[32:35], v3 offset:16896
  s_mov_b64 exec, -1
  v_exp_f32 v72, v72
  v_exp_f32 v73, v73
  v_cvt_pk_bf16_f32 v137, v70, v71
  v_exp_f32 v74, v74
  v_exp_f32 v75, v75
  v_cvt_pk_bf16_f32 v138, v72, v73
  v_cvt_pk_bf16_f32 v139, v74, v75
  v_exp_f32 v44, v44
  v_exp_f32 v45, v45
  v_exp_f32 v46, v46
  v_exp_f32 v47, v47
  v_cvt_pk_bf16_f32 v124, v44, v45
  v_exp_f32 v48, v48
  s_waitcnt lgkmcnt(3)
  v_mfma_f32_32x32x16_bf16 v[108:123], v[36:39], v[132:135], v[108:123]
  v_exp_f32 v49, v49
  v_cvt_pk_bf16_f32 v125, v46, v47
  v_exp_f32 v50, v50
  v_exp_f32 v51, v51
  v_cvt_pk_bf16_f32 v126, v48, v49
  v_exp_f32 v52, v52
  v_exp_f32 v53, v53
  v_cvt_pk_bf16_f32 v127, v50, v51
  v_exp_f32 v54, v54
  s_waitcnt lgkmcnt(2)
  v_mfma_f32_32x32x16_bf16 v[108:123], v[40:43], v[136:139], v[108:123]
  v_exp_f32 v55, v55
  v_cvt_pk_bf16_f32 v128, v52, v53
  v_exp_f32 v56, v56
  v_exp_f32 v57, v57
  v_cvt_pk_bf16_f32 v129, v54, v55
  v_exp_f32 v58, v58
  v_exp_f32 v59, v59
  v_cvt_pk_bf16_f32 v130, v56, v57
  v_cvt_pk_bf16_f32 v131, v58, v59
  v_and_b32 v124, v124, v148
  v_and_b32 v125, v125, v149
  v_and_b32 v126, v126, v150
  v_and_b32 v127, v127, v151
  v_and_b32 v128, v128, v152
  v_and_b32 v129, v129, v153
  v_and_b32 v130, v130, v154
  v_and_b32 v131, v131, v155
  s_waitcnt lgkmcnt(1)
  v_mfma_f32_32x32x16_bf16 v[108:123], v[28:31], v[124:127], v[108:123]
  s_waitcnt lgkmcnt(0)
  v_mfma_f32_32x32x16_bf16 v[108:123], v[32:35], v[128:131], v[108:123]
  s_branch gm_AC_fz
gm_AC_v6:
  s_waitcnt lgkmcnt(0)
  s_nop 10
  s_setprio 3
  ds_read_b128 v[12:15], v2 offset:8192
  ds_read_b128 v[16:19], v2 offset:7168
  ds_read_b128 v[20:23], v2 offset:6144
  s_mov_b64 exec, s[78:79]
  ds_read_b128 v[28:31], v3 offset:8192
  ds_read_b128 v[32:35], v3 offset:8704
  s_mov_b64 exec, -1
  s_mov_b64 exec, s[78:79]
  ds_read_b128 v[36:39], v3 offset:7168
  ds_read_b128 v[40:43], v3 offset:7680
  s_mov_b64 exec, -1
  s_waitcnt lgkmcnt(6)
  v_mfma_f32_32x32x16_bf16 v[44:59], v[12:15], v[4:7], 0
  s_nop 11
  v_cndmask_b32 v44, v44, v158, s[44:45]
  v_cndmask_b32 v45, v45, v158, s[46:47]
  v_cndmask_b32 v46, v46, v158, s[48:49]
  v_cndmask_b32 v47, v47, v158, s[50:51]
  v_cndmask_b32 v48, v48, v158, s[52:53]
  v_cndmask_b32 v49, v49, v158, s[54:55]
  v_cndmask_b32 v50, v50, v158, s[56:57]
  v_cndmask_b32 v51, v51, v158, s[58:59]
  v_cndmask_b32 v52, v52, v158, s[60:61]
  v_cndmask_b32 v53, v53, v158, s[62:63]
  v_cndmask_b32 v54, v54, v158, s[64:65]
  v_cndmask_b32 v55, v55, v158, s[66:67]
  v_cndmask_b32 v56, v56, v158, s[68:69]
  v_cndmask_b32 v57, v57, v158, s[70:71]
  v_cndmask_b32 v58, v58, v158, s[72:73]
  v_cndmask_b32 v59, v59, v158, s[74:75]
  v_max3_f32 v156, v44, v45, v46
  v_max3_f32 v157, v47, v48, v49
  v_max3_f32 v157, v50, v51, v157
  v_max3_f32 v156, v52, v53, v156
  v_max3_f32 v157, v54, v55, v157
  v_max3_f32 v156, v56, v57, v156
  v_max3_f32 v157, v58, v59, v157
  v_max_f32 v156, v156, v157
  v_mov_b32 v157, v156
  s_nop 1
  v_permlane32_swap_b32 v156, v157
  v_max_f32 v162, v156, v157
  v_sub_f32 v92, 0, v162
  v_sub_f32 v93, 0, v162
  v_sub_f32 v94, 0, v162
  v_sub_f32 v95, 0, v162
  v_sub_f32 v96, 0, v162
  v_sub_f32 v97, 0, v162
  v_sub_f32 v98, 0, v162
  v_sub_f32 v99, 0, v162
  v_sub_f32 v100, 0, v162
  v_sub_f32 v101, 0, v162
  v_sub_f32 v102, 0, v162
  v_sub_f32 v103, 0, v162
  v_sub_f32 v104, 0, v162
  v_sub_f32 v105, 0, v162
  v_sub_f32 v106, 0, v162
  v_sub_f32 v107, 0, v162
  v_sub_f32 v44, v44, v162
  v_sub_f32 v45, v45, v162
  v_sub_f32 v46, v46, v162
  v_sub_f32 v47, v47, v162
  v_sub_f32 v48, v48, v162
  v_sub_f32 v49, v49, v162
  v_sub_f32 v50, v50, v162
  v_sub_f32 v51, v51, v162
  v_sub_f32 v52, v52, v162
  v_sub_f32 v53, v53, v162
  v_sub_f32 v54, v54, v162
  v_sub_f32 v55, v55, v162
  v_sub_f32 v56, v56, v162
  v_sub_f32 v57, v57, v162
  v_sub_f32 v58, v58, v162
  v_sub_f32 v59, v59, v162
  s_waitcnt lgkmcnt(5)
  v_mfma_f32_32x32x16_bf16 v[60:75], v[16:19], v[4:7], v[92:107]
  ds_read_b128 v[24:27], v2 offset:5120
  v_exp_f32 v44, v44
  v_exp_f32 v45, v45
  v_exp_f32 v46, v46
  v_exp_f32 v47, v47
  v_cvt_pk_bf16_f32 v124, v44, v45
  v_exp_f32 v48, v48
  v_exp_f32 v49, v49
  v_cvt_pk_bf16_f32 v125, v46, v47
  v_exp_f32 v50, v50
  v_exp_f32 v51, v51
  v_cvt_pk_bf16_f32 v126, v48, v49
  v_exp_f32 v52, v52
  v_exp_f32 v53, v53
  v_cvt_pk_bf16_f32 v127, v50, v51
  v_exp_f32 v54, v54
  v_exp_f32 v55, v55
  v_cvt_pk_bf16_f32 v128, v52, v53
  v_exp_f32 v56, v56
  v_exp_f32 v57, v57
  v_cvt_pk_bf16_f32 v129, v54, v55
  v_exp_f32 v58, v58
  v_exp_f32 v59, v59
  v_cvt_pk_bf16_f32 v130, v56, v57
  v_cvt_pk_bf16_f32 v131, v58, v59
  s_waitcnt lgkmcnt(5)
  v_mfma_f32_32x32x16_bf16 v[44:59], v[20:23], v[4:7], v[92:107]
  ds_read_b128 v[12:15], v2 offset:4096
  v_exp_f32 v60, v60
  v_exp_f32 v61, v61
  v_exp_f32 v62, v62
  v_exp_f32 v63, v63
  v_cvt_pk_bf16_f32 v132, v60, v61
  v_exp_f32 v64, v64
  s_waitcnt lgkmcnt(5)
  v_mfma_f32_32x32x16_bf16 v[76:91], v[28:31], v[124:127], 0
  v_exp_f32 v65, v65
  v_cvt_pk_bf16_f32 v133, v62, v63
  v_exp_f32 v66, v66
  v_exp_f32 v67, v67
  v_cvt_pk_bf16_f32 v134, v64, v65
  v_exp_f32 v68, v68
  v_exp_f32 v69, v69
  v_cvt_pk_bf16_f32 v135, v66, v67
  v_exp_f32 v70, v70
  s_waitcnt lgkmcnt(4)
  v_mfma_f32_32x32x16_bf16 v[76:91], v[32:35], v[128:131], v[76:91]
  v_exp_f32 v71, v71
  v_cvt_pk_bf16_f32 v136, v68, v69
  s_mov_b64 exec, s[78:79]
  ds_read_b128 v[28:31], v3 offset:6144
  ds_read_b128 v[32:35], v3 offset:6656
  s_mov_b64 exec, -1
  v_exp_f32 v72, v72
  v_exp_f32 v73, v73
  v_cvt_pk_bf16_f32 v137, v70, v71
  v_exp_f32 v74, v74
  v_exp_f32 v75, v75
  v_cvt_pk_bf16_f32 v138, v72, v73
  v_cvt_pk_bf16_f32 v139, v74, v75
  s_waitcnt lgkmcnt(3)
  v_mfma_f32_32x32x16_bf16 v[60:75], v[24:27], v[4:7], v[92:107]
  ds_read_b128 v[16:19], v2 offset:3072
  v_exp_f32 v44, v44
  v_exp_f32 v45, v45
  v_exp_f32 v46, v46
  v_exp_f32 v47, v47
  v_cvt_pk_bf16_f32 v124, v44, v45
  v_exp_f32 v48, v48
  v_mfma_f32_32x32x16_bf16 v[76:91], v[36:39], v[132:135], v[76:91]
  v_exp_f32 v49, v49
  v_cvt_pk_bf16_f32 v125, v46, v47
  v_exp_f32 v50, v50
  v_exp_f32 v51, v51
  v_cvt_pk_bf16_f32 v126, v48, v49
  v_exp_f32 v52, v52
  v_exp_f32 v53, v53
  v_cvt_pk_bf16_f32 v127, v50, v51
  v_exp_f32 v54, v54
  v_mfma_f32_32x32x16_bf16 v[76:91], v[40:43], v[136:139], v[76:91]
  v_exp_f32 v55, v55
  v_cvt_pk_bf16_f32 v128, v52, v53
  s_mov_b64 exec, s[78:79]
  ds_read_b128 v[36:39], v3 offset:5120
  ds_read_b128 v[40:43], v3 offset:5632
  s_mov_b64 exec, -1
  v_exp_f32 v56, v56
  v_exp_f32 v57, v57
  v_cvt_pk_bf16_f32 v129, v54, v55
  v_exp_f32 v58, v58
  v_exp_f32 v59, v59
  v_cvt_pk_bf16_f32 v130, v56, v57
  v_cvt_pk_bf16_f32 v131, v58, v59
  s_waitcnt lgkmcnt(5)
  v_mfma_f32_32x32x16_bf16 v[44:59], v[12:15], v[4:7], v[92:107]
  ds_read_b128 v[20:23], v2 offset:2048
  v_exp_f32 v60, v60
  v_exp_f32 v61, v61
  v_exp_f32 v62, v62
  v_exp_f32 v63, v63
  v_cvt_pk_bf16_f32 v132, v60, v61
  v_exp_f32 v64, v64
  s_waitcnt lgkmcnt(5)
  v_mfma_f32_32x32x16_bf16 v[76:91], v[28:31], v[124:127], v[76:91]
  v_exp_f32 v65, v65
  v_cvt_pk_bf16_f32 v133, v62, v63
  v_exp_f32 v66, v66
  v_exp_f32 v67, v67
  v_cvt_pk_bf16_f32 v134, v64, v65
  v_exp_f32 v68, v68
  v_exp_f32 v69, v69
  v_cvt_pk_bf16_f32 v135, v66, v67
  v_exp_f32 v70, v70
  s_waitcnt lgkmcnt(4)
  v_mfma_f32_32x32x16_bf16 v[76:91], v[32:35], v[128:131], v[76:91]
  v_exp_f32 v71, v71
  v_cvt_pk_bf16_f32 v136, v68, v69
  s_mov_b64 exec, s[78:79]
  ds_read_b128 v[28:31], v3 offset:4096
  ds_read_b128 v[32:35], v3 offset:4608
  s_mov_b64 exec, -1
  v_exp_f32 v72, v72
  v_exp_f32 v73, v73
  v_cvt_pk_bf16_f32 v137, v70, v71
  v_exp_f32 v74, v74
  v_exp_f32 v75, v75
  v_cvt_pk_bf16_f32 v138, v72, v73
  v_cvt_pk_bf16_f32 v139, v74, v75
  s_waitcnt lgkmcnt(5)
  v_mfma_f32_32x32x16_bf16 v[60:75], v[16:19], v[4:7], v[92:107]
  v_exp_f32 v44, v44
  v_exp_f32 v45, v45
  v_exp_f32 v46, v46
  v_exp_f32 v47, v47
  v_cvt_pk_bf16_f32 v124, v44, v45
  v_exp_f32 v48, v48
  s_waitcnt lgkmcnt(4)
  v_mfma_f32_32x32x16_bf16 v[76:91], v[36:39], v[132:135], v[76:91]
  v_exp_f32 v49, v49
  v_cvt_pk_bf16_f32 v125, v46, v47
  v_exp_f32 v50, v50
  v_exp_f32 v51, v51
  v_cvt_pk_bf16_f32 v126, v48, v49
  v_exp_f32 v52, v52
  v_exp_f32 v53, v53
  v_cvt_pk_bf16_f32 v127, v50, v51
  v_exp_f32 v54, v54
  s_waitcnt lgkmcnt(3)
  v_mfma_f32_32x32x16_bf16 v[76:91], v[40:43], v[136:139], v[76:91]
  v_exp_f32 v55, v55
  v_cvt_pk_bf16_f32 v128, v52, v53
  s_mov_b64 exec, s[78:79]
  ds_read_b128 v[36:39], v3 offset:3072
  ds_read_b128 v[40:43], v3 offset:3584
  s_mov_b64 exec, -1
  v_exp_f32 v56, v56
  v_exp_f32 v57, v57
  v_cvt_pk_bf16_f32 v129, v54, v55
  v_exp_f32 v58, v58
  v_exp_f32 v59, v59
  v_cvt_pk_bf16_f32 v130, v56, v57
  v_cvt_pk_bf16_f32 v131, v58, v59
  s_waitcnt lgkmcnt(4)
  v_mfma_f32_32x32x16_bf16 v[44:59], v[20:23], v[4:7], v[92:107]
  v_exp_f32 v60, v60
  v_exp_f32 v61, v61
  v_exp_f32 v62, v62
  v_exp_f32 v63, v63
  v_cvt_pk_bf16_f32 v132, v60, v61
  v_exp_f32 v64, v64
  s_waitcnt lgkmcnt(3)
  v_mfma_f32_32x32x16_bf16 v[76:91], v[28:31], v[124:127], v[76:91]
  v_exp_f32 v65, v65
  v_cvt_pk_bf16_f32 v133, v62, v63
  v_exp_f32 v66, v66
  v_exp_f32 v67, v67
  v_cvt_pk_bf16_f32 v134, v64, v65
  v_exp_f32 v68, v68
  v_exp_f32 v69, v69
  v_cvt_pk_bf16_f32 v135, v66, v67
  v_exp_f32 v70, v70
  s_waitcnt lgkmcnt(2)
  v_mfma_f32_32x32x16_bf16 v[76:91], v[32:35], v[128:131], v[76:91]
  v_exp_f32 v71, v71
  v_cvt_pk_bf16_f32 v136, v68, v69
  s_mov_b64 exec, s[78:79]
  ds_read_b128 v[28:31], v3 offset:2048
  ds_read_b128 v[32:35], v3 offset:2560
  s_mov_b64 exec, -1
  v_exp_f32 v72, v72
  v_exp_f32 v73, v73
  v_cvt_pk_bf16_f32 v137, v70, v71
  v_exp_f32 v74, v74
  v_exp_f32 v75, v75
  v_cvt_pk_bf16_f32 v138, v72, v73
  v_cvt_pk_bf16_f32 v139, v74, v75
  v_exp_f32 v44, v44
  v_exp_f32 v45, v45
  v_exp_f32 v46, v46
  v_exp_f32 v47, v47
  v_cvt_pk_bf16_f32 v124, v44, v45
  v_exp_f32 v48, v48
  s_waitcnt lgkmcnt(3)
  v_mfma_f32_32x32x16_bf16 v[76:91], v[36:39], v[132:135], v[76:91]
  v_exp_f32 v49, v49
  v_cvt_pk_bf16_f32 v125, v46, v47
  v_exp_f32 v50, v50
  v_exp_f32 v51, v51
  v_cvt_pk_bf16_f32 v126, v48, v49
  v_exp_f32 v52, v52
  v_exp_f32 v53, v53
  v_cvt_pk_bf16_f32 v127, v50, v51
  v_exp_f32 v54, v54
  s_waitcnt lgkmcnt(2)
  v_mfma_f32_32x32x16_bf16 v[76:91], v[40:43], v[136:139], v[76:91]
  v_exp_f32 v55, v55
  v_cvt_pk_bf16_f32 v128, v52, v53
  v_exp_f32 v56, v56
  v_exp_f32 v57, v57
  v_cvt_pk_bf16_f32 v129, v54, v55
  v_exp_f32 v58, v58
  v_exp_f32 v59, v59
  v_cvt_pk_bf16_f32 v130, v56, v57
  v_cvt_pk_bf16_f32 v131, v58, v59
  s_waitcnt lgkmcnt(1)
  v_mfma_f32_32x32x16_bf16 v[76:91], v[28:31], v[124:127], v[76:91]
  s_waitcnt lgkmcnt(0)
  v_mfma_f32_32x32x16_bf16 v[76:91], v[32:35], v[128:131], v[76:91]
  s_setprio 2
  ds_read_b128 v[12:15], v2 offset:24576
  ds_read_b128 v[16:19], v2 offset:23552
  ds_read_b128 v[20:23], v2 offset:22528
  s_mov_b64 exec, s[78:79]
  ds_read_b128 v[28:31], v3 offset:24576
  ds_read_b128 v[32:35], v3 offset:25088
  s_mov_b64 exec, -1
  s_mov_b64 exec, s[78:79]
  ds_read_b128 v[36:39], v3 offset:23552
  ds_read_b128 v[40:43], v3 offset:24064
  s_mov_b64 exec, -1
  s_waitcnt lgkmcnt(6)
  v_mfma_f32_32x32x16_bf16 v[44:59], v[12:15], v[8:11], 0
  s_nop 11
  v_cndmask_b32 v44, v44, v158, s[44:45]
  v_cndmask_b32 v45, v45, v158, s[46:47]
  v_cndmask_b32 v46, v46, v158, s[48:49]
  v_cndmask_b32 v47, v47, v158, s[50:51]
  v_cndmask_b32 v48, v48, v158, s[52:53]
  v_cndmask_b32 v49, v49, v158, s[54:55]
  v_cndmask_b32 v50, v50, v158, s[56:57]
  v_cndmask_b32 v51, v51, v158, s[58:59]
  v_cndmask_b32 v52, v52, v158, s[60:61]
  v_cndmask_b32 v53, v53, v158, s[62:63]
  v_cndmask_b32 v54, v54, v158, s[64:65]
  v_cndmask_b32 v55, v55, v158, s[66:67]
  v_cndmask_b32 v56, v56, v158, s[68:69]
  v_cndmask_b32 v57, v57, v158, s[70:71]
  v_cndmask_b32 v58, v58, v158, s[72:73]
  v_cndmask_b32 v59, v59, v158, s[74:75]
  v_max3_f32 v156, v44, v45, v46
  v_max3_f32 v157, v47, v48, v49
  v_max3_f32 v157, v50, v51, v157
  v_max3_f32 v156, v52, v53, v156
  v_max3_f32 v157, v54, v55, v157
  v_max3_f32 v156, v56, v57, v156
  v_max3_f32 v157, v58, v59, v157
  v_max_f32 v156, v156, v157
  v_mov_b32 v157, v156
  s_nop 1
  v_permlane32_swap_b32 v156, v157
  v_max_f32 v163, v156, v157
  v_sub_f32 v92, 0, v163
  v_sub_f32 v93, 0, v163
  v_sub_f32 v94, 0, v163
  v_sub_f32 v95, 0, v163
  v_sub_f32 v96, 0, v163
  v_sub_f32 v97, 0, v163
  v_sub_f32 v98, 0, v163
  v_sub_f32 v99, 0, v163
  v_sub_f32 v100, 0, v163
  v_sub_f32 v101, 0, v163
  v_sub_f32 v102, 0, v163
  v_sub_f32 v103, 0, v163
  v_sub_f32 v104, 0, v163
  v_sub_f32 v105, 0, v163
  v_sub_f32 v106, 0, v163
  v_sub_f32 v107, 0, v163
  v_sub_f32 v44, v44, v163
  v_sub_f32 v45, v45, v163
  v_sub_f32 v46, v46, v163
  v_sub_f32 v47, v47, v163
  v_sub_f32 v48, v48, v163
  v_sub_f32 v49, v49, v163
  v_sub_f32 v50, v50, v163
  v_sub_f32 v51, v51, v163
  v_sub_f32 v52, v52, v163
  v_sub_f32 v53, v53, v163
  v_sub_f32 v54, v54, v163
  v_sub_f32 v55, v55, v163
  v_sub_f32 v56, v56, v163
  v_sub_f32 v57, v57, v163
  v_sub_f32 v58, v58, v163
  v_sub_f32 v59, v59, v163
  s_waitcnt lgkmcnt(5)
  v_mfma_f32_32x32x16_bf16 v[60:75], v[16:19], v[8:11], v[92:107]
  ds_read_b128 v[24:27], v2 offset:21504
  v_exp_f32 v44, v44
  v_exp_f32 v45, v45
  v_exp_f32 v46, v46
  v_exp_f32 v47, v47
  v_cvt_pk_bf16_f32 v124, v44, v45
  v_exp_f32 v48, v48
  v_exp_f32 v49, v49
  v_cvt_pk_bf16_f32 v125, v46, v47
  v_exp_f32 v50, v50
  v_exp_f32 v51, v51
  v_cvt_pk_bf16_f32 v126, v48, v49
  v_exp_f32 v52, v52
  v_exp_f32 v53, v53
  v_cvt_pk_bf16_f32 v127, v50, v51
  v_exp_f32 v54, v54
  v_exp_f32 v55, v55
  v_cvt_pk_bf16_f32 v128, v52, v53
  v_exp_f32 v56, v56
  v_exp_f32 v57, v57
  v_cvt_pk_bf16_f32 v129, v54, v55
  v_exp_f32 v58, v58
  v_exp_f32 v59, v59
  v_cvt_pk_bf16_f32 v130, v56, v57
  v_cvt_pk_bf16_f32 v131, v58, v59
  s_waitcnt lgkmcnt(5)
  v_mfma_f32_32x32x16_bf16 v[44:59], v[20:23], v[8:11], v[92:107]
  ds_read_b128 v[12:15], v2 offset:20480
  v_exp_f32 v60, v60
  v_exp_f32 v61, v61
  v_exp_f32 v62, v62
  v_exp_f32 v63, v63
  v_cvt_pk_bf16_f32 v132, v60, v61
  v_exp_f32 v64, v64
  s_waitcnt lgkmcnt(5)
  v_mfma_f32_32x32x16_bf16 v[108:123], v[28:31], v[124:127], 0
  v_exp_f32 v65, v65
  v_cvt_pk_bf16_f32 v133, v62, v63
  v_exp_f32 v66, v66
  v_exp_f32 v67, v67
  v_cvt_pk_bf16_f32 v134, v64, v65
  v_exp_f32 v68, v68
  v_exp_f32 v69, v69
  v_cvt_pk_bf16_f32 v135, v66, v67
  v_exp_f32 v70, v70
  s_waitcnt lgkmcnt(4)
  v_mfma_f32_32x32x16_bf16 v[108:123], v[32:35], v[128:131], v[108:123]
  v_exp_f32 v71, v71
  v_cvt_pk_bf16_f32 v136, v68, v69
  s_mov_b64 exec, s[78:79]
  ds_read_b128 v[28:31], v3 offset:22528
  ds_read_b128 v[32:35], v3 offset:23040
  s_mov_b64 exec, -1
  v_exp_f32 v72, v72
  v_exp_f32 v73, v73
  v_cvt_pk_bf16_f32 v137, v70, v71
  v_exp_f32 v74, v74
  v_exp_f32 v75, v75
  v_cvt_pk_bf16_f32 v138, v72, v73
  v_cvt_pk_bf16_f32 v139, v74, v75
  s_waitcnt lgkmcnt(3)
  v_mfma_f32_32x32x16_bf16 v[60:75], v[24:27], v[8:11], v[92:107]
  ds_read_b128 v[16:19], v2 offset:19456
  v_exp_f32 v44, v44
  v_exp_f32 v45, v45
  v_exp_f32 v46, v46
  v_exp_f32 v47, v47
  v_cvt_pk_bf16_f32 v124, v44, v45
  v_exp_f32 v48, v48
  v_mfma_f32_32x32x16_bf16 v[108:123], v[36:39], v[132:135], v[108:123]
  v_exp_f32 v49, v49
  v_cvt_pk_bf16_f32 v125, v46, v47
  v_exp_f32 v50, v50
  v_exp_f32 v51, v51
  v_cvt_pk_bf16_f32 v126, v48, v49
  v_exp_f32 v52, v52
  v_exp_f32 v53, v53
  v_cvt_pk_bf16_f32 v127, v50, v51
  v_exp_f32 v54, v54
  v_mfma_f32_32x32x16_bf16 v[108:123], v[40:43], v[136:139], v[108:123]
  v_exp_f32 v55, v55
  v_cvt_pk_bf16_f32 v128, v52, v53
  s_mov_b64 exec, s[78:79]
  ds_read_b128 v[36:39], v3 offset:21504
  ds_read_b128 v[40:43], v3 offset:22016
  s_mov_b64 exec, -1
  v_exp_f32 v56, v56
  v_exp_f32 v57, v57
  v_cvt_pk_bf16_f32 v129, v54, v55
  v_exp_f32 v58, v58
  v_exp_f32 v59, v59
  v_cvt_pk_bf16_f32 v130, v56, v57
  v_cvt_pk_bf16_f32 v131, v58, v59
  s_waitcnt lgkmcnt(5)
  v_mfma_f32_32x32x16_bf16 v[44:59], v[12:15], v[8:11], v[92:107]
  ds_read_b128 v[20:23], v2 offset:18432
  v_exp_f32 v60, v60
  v_exp_f32 v61, v61
  v_exp_f32 v62, v62
  v_exp_f32 v63, v63
  v_cvt_pk_bf16_f32 v132, v60, v61
  v_exp_f32 v64, v64
  s_waitcnt lgkmcnt(5)
  v_mfma_f32_32x32x16_bf16 v[108:123], v[28:31], v[124:127], v[108:123]
  v_exp_f32 v65, v65
  v_cvt_pk_bf16_f32 v133, v62, v63
  v_exp_f32 v66, v66
  v_exp_f32 v67, v67
  v_cvt_pk_bf16_f32 v134, v64, v65
  v_exp_f32 v68, v68
  v_exp_f32 v69, v69
  v_cvt_pk_bf16_f32 v135, v66, v67
  v_exp_f32 v70, v70
  s_waitcnt lgkmcnt(4)
  v_mfma_f32_32x32x16_bf16 v[108:123], v[32:35], v[128:131], v[108:123]
  v_exp_f32 v71, v71
  v_cvt_pk_bf16_f32 v136, v68, v69
  s_mov_b64 exec, s[78:79]
  ds_read_b128 v[28:31], v3 offset:20480
  ds_read_b128 v[32:35], v3 offset:20992
  s_mov_b64 exec, -1
  v_exp_f32 v72, v72
  v_exp_f32 v73, v73
  v_cvt_pk_bf16_f32 v137, v70, v71
  v_exp_f32 v74, v74
  v_exp_f32 v75, v75
  v_cvt_pk_bf16_f32 v138, v72, v73
  v_cvt_pk_bf16_f32 v139, v74, v75
  s_waitcnt lgkmcnt(5)
  v_mfma_f32_32x32x16_bf16 v[60:75], v[16:19], v[8:11], v[92:107]
  v_exp_f32 v44, v44
  v_exp_f32 v45, v45
  v_exp_f32 v46, v46
  v_exp_f32 v47, v47
  v_cvt_pk_bf16_f32 v124, v44, v45
  v_exp_f32 v48, v48
  s_waitcnt lgkmcnt(4)
  v_mfma_f32_32x32x16_bf16 v[108:123], v[36:39], v[132:135], v[108:123]
  v_exp_f32 v49, v49
  v_cvt_pk_bf16_f32 v125, v46, v47
  v_exp_f32 v50, v50
  v_exp_f32 v51, v51
  v_cvt_pk_bf16_f32 v126, v48, v49
  v_exp_f32 v52, v52
  v_exp_f32 v53, v53
  v_cvt_pk_bf16_f32 v127, v50, v51
  v_exp_f32 v54, v54
  s_waitcnt lgkmcnt(3)
  v_mfma_f32_32x32x16_bf16 v[108:123], v[40:43], v[136:139], v[108:123]
  v_exp_f32 v55, v55
  v_cvt_pk_bf16_f32 v128, v52, v53
  s_mov_b64 exec, s[78:79]
  ds_read_b128 v[36:39], v3 offset:19456
  ds_read_b128 v[40:43], v3 offset:19968
  s_mov_b64 exec, -1
  v_exp_f32 v56, v56
  v_exp_f32 v57, v57
  v_cvt_pk_bf16_f32 v129, v54, v55
  v_exp_f32 v58, v58
  v_exp_f32 v59, v59
  v_cvt_pk_bf16_f32 v130, v56, v57
  v_cvt_pk_bf16_f32 v131, v58, v59
  s_waitcnt lgkmcnt(4)
  v_mfma_f32_32x32x16_bf16 v[44:59], v[20:23], v[8:11], v[92:107]
  v_exp_f32 v60, v60
  v_exp_f32 v61, v61
  v_exp_f32 v62, v62
  v_exp_f32 v63, v63
  v_cvt_pk_bf16_f32 v132, v60, v61
  v_exp_f32 v64, v64
  s_waitcnt lgkmcnt(3)
  v_mfma_f32_32x32x16_bf16 v[108:123], v[28:31], v[124:127], v[108:123]
  v_exp_f32 v65, v65
  v_cvt_pk_bf16_f32 v133, v62, v63
  v_exp_f32 v66, v66
  v_exp_f32 v67, v67
  v_cvt_pk_bf16_f32 v134, v64, v65
  v_exp_f32 v68, v68
  v_exp_f32 v69, v69
  v_cvt_pk_bf16_f32 v135, v66, v67
  v_exp_f32 v70, v70
  s_waitcnt lgkmcnt(2)
  v_mfma_f32_32x32x16_bf16 v[108:123], v[32:35], v[128:131], v[108:123]
  v_exp_f32 v71, v71
  v_cvt_pk_bf16_f32 v136, v68, v69
  s_mov_b64 exec, s[78:79]
  ds_read_b128 v[28:31], v3 offset:18432
  ds_read_b128 v[32:35], v3 offset:18944
  s_mov_b64 exec, -1
  v_exp_f32 v72, v72
  v_exp_f32 v73, v73
  v_cvt_pk_bf16_f32 v137, v70, v71
  v_exp_f32 v74, v74
  v_exp_f32 v75, v75
  v_cvt_pk_bf16_f32 v138, v72, v73
  v_cvt_pk_bf16_f32 v139, v74, v75
  v_exp_f32 v44, v44
  v_exp_f32 v45, v45
  v_exp_f32 v46, v46
  v_exp_f32 v47, v47
  v_cvt_pk_bf16_f32 v124, v44, v45
  v_exp_f32 v48, v48
  s_waitcnt lgkmcnt(3)
  v_mfma_f32_32x32x16_bf16 v[108:123], v[36:39], v[132:135], v[108:123]
  v_exp_f32 v49, v49
  v_cvt_pk_bf16_f32 v125, v46, v47
  v_exp_f32 v50, v50
  v_exp_f32 v51, v51
  v_cvt_pk_bf16_f32 v126, v48, v49
  v_exp_f32 v52, v52
  v_exp_f32 v53, v53
  v_cvt_pk_bf16_f32 v127, v50, v51
  v_exp_f32 v54, v54
  s_waitcnt lgkmcnt(2)
  v_mfma_f32_32x32x16_bf16 v[108:123], v[40:43], v[136:139], v[108:123]
  v_exp_f32 v55, v55
  v_cvt_pk_bf16_f32 v128, v52, v53
  v_exp_f32 v56, v56
  v_exp_f32 v57, v57
  v_cvt_pk_bf16_f32 v129, v54, v55
  v_exp_f32 v58, v58
  v_exp_f32 v59, v59
  v_cvt_pk_bf16_f32 v130, v56, v57
  v_cvt_pk_bf16_f32 v131, v58, v59
  s_waitcnt lgkmcnt(1)
  v_mfma_f32_32x32x16_bf16 v[108:123], v[28:31], v[124:127], v[108:123]
  s_waitcnt lgkmcnt(0)
  v_mfma_f32_32x32x16_bf16 v[108:123], v[32:35], v[128:131], v[108:123]
  s_waitcnt lgkmcnt(0)
  s_barrier
  s_cmp_eq_u32 s83, 0
  s_cbranch_scc1 gm_AC_fz
  s_setprio 1
  ds_read_b128 v[12:15], v2 offset:1024
  ds_read_b128 v[16:19], v2 offset:0
  s_mov_b64 exec, s[78:79]
  ds_read_b128 v[28:31], v3 offset:1024
  ds_read_b128 v[32:35], v3 offset:1536
  s_mov_b64 exec, -1
  s_mov_b64 exec, s[78:79]
  ds_read_b128 v[36:39], v3 offset:0
  ds_read_b128 v[40:43], v3 offset:512
  s_mov_b64 exec, -1
  v_sub_f32 v92, 0, v162
  v_sub_f32 v93, 0, v162
  v_sub_f32 v94, 0, v162
  v_sub_f32 v95, 0, v162
  v_sub_f32 v96, 0, v162
  v_sub_f32 v97, 0, v162
  v_sub_f32 v98, 0, v162
  v_sub_f32 v99, 0, v162
  v_sub_f32 v100, 0, v162
  v_sub_f32 v101, 0, v162
  v_sub_f32 v102, 0, v162
  v_sub_f32 v103, 0, v162
  v_sub_f32 v104, 0, v162
  v_sub_f32 v105, 0, v162
  v_sub_f32 v106, 0, v162
  v_sub_f32 v107, 0, v162
  s_waitcnt lgkmcnt(5)
  s_nop 0
  v_mfma_f32_32x32x16_bf16 v[44:59], v[12:15], v[4:7], v[92:107]
  s_waitcnt lgkmcnt(4)
  v_mfma_f32_32x32x16_bf16 v[60:75], v[16:19], v[4:7], v[92:107]
  s_nop 9
  v_exp_f32 v44, v44
  v_exp_f32 v45, v45
  v_exp_f32 v46, v46
  v_exp_f32 v47, v47
  v_cvt_pk_bf16_f32 v124, v44, v45
  v_exp_f32 v48, v48
  v_exp_f32 v49, v49
  v_cvt_pk_bf16_f32 v125, v46, v47
  v_exp_f32 v50, v50
  v_exp_f32 v51, v51
  v_cvt_pk_bf16_f32 v126, v48, v49
  v_exp_f32 v52, v52
  v_exp_f32 v53, v53
  v_cvt_pk_bf16_f32 v127, v50, v51
  v_exp_f32 v54, v54
  v_exp_f32 v55, v55
  v_cvt_pk_bf16_f32 v128, v52, v53
  v_exp_f32 v56, v56
  v_exp_f32 v57, v57
  v_cvt_pk_bf16_f32 v129, v54, v55
  v_exp_f32 v58, v58
  v_exp_f32 v59, v59
  v_cvt_pk_bf16_f32 v130, v56, v57
  v_cvt_pk_bf16_f32 v131, v58, v59
  v_exp_f32 v60, v60
  v_exp_f32 v61, v61
  v_exp_f32 v62, v62
  v_exp_f32 v63, v63
  v_cvt_pk_bf16_f32 v132, v60, v61
  v_exp_f32 v64, v64
  s_waitcnt lgkmcnt(3)
  v_mfma_f32_32x32x16_bf16 v[76:91], v[28:31], v[124:127], v[76:91]
  v_exp_f32 v65, v65
  v_cvt_pk_bf16_f32 v133, v62, v63
  v_exp_f32 v66, v66
  v_exp_f32 v67, v67
  v_cvt_pk_bf16_f32 v134, v64, v65
  v_exp_f32 v68, v68
  v_exp_f32 v69, v69
  v_cvt_pk_bf16_f32 v135, v66, v67
  v_exp_f32 v70, v70
  s_waitcnt lgkmcnt(2)
  v_mfma_f32_32x32x16_bf16 v[76:91], v[32:35], v[128:131], v[76:91]
  v_exp_f32 v71, v71
  v_cvt_pk_bf16_f32 v136, v68, v69
  v_exp_f32 v72, v72
  v_exp_f32 v73, v73
  v_cvt_pk_bf16_f32 v137, v70, v71
  v_exp_f32 v74, v74
  v_exp_f32 v75, v75
  v_cvt_pk_bf16_f32 v138, v72, v73
  v_cvt_pk_bf16_f32 v139, v74, v75
  v_and_b32 v132, v132, v148
  v_and_b32 v133, v133, v149
  v_and_b32 v134, v134, v150
  v_and_b32 v135, v135, v151
  v_and_b32 v136, v136, v152
  v_and_b32 v137, v137, v153
  v_and_b32 v138, v138, v154
  v_and_b32 v139, v139, v155
  s_waitcnt lgkmcnt(1)
  v_mfma_f32_32x32x16_bf16 v[76:91], v[36:39], v[132:135], v[76:91]
  s_waitcnt lgkmcnt(0)
  v_mfma_f32_32x32x16_bf16 v[76:91], v[40:43], v[136:139], v[76:91]
  s_setprio 0
  ds_read_b128 v[12:15], v2 offset:17408
  ds_read_b128 v[16:19], v2 offset:16384
  s_mov_b64 exec, s[78:79]
  ds_read_b128 v[28:31], v3 offset:17408
  ds_read_b128 v[32:35], v3 offset:17920
  s_mov_b64 exec, -1
  s_mov_b64 exec, s[78:79]
  ds_read_b128 v[36:39], v3 offset:16384
  ds_read_b128 v[40:43], v3 offset:16896
  s_mov_b64 exec, -1
  v_sub_f32 v92, 0, v163
  v_sub_f32 v93, 0, v163
  v_sub_f32 v94, 0, v163
  v_sub_f32 v95, 0, v163
  v_sub_f32 v96, 0, v163
  v_sub_f32 v97, 0, v163
  v_sub_f32 v98, 0, v163
  v_sub_f32 v99, 0, v163
  v_sub_f32 v100, 0, v163
  v_sub_f32 v101, 0, v163
  v_sub_f32 v102, 0, v163
  v_sub_f32 v103, 0, v163
  v_sub_f32 v104, 0, v163
  v_sub_f32 v105, 0, v163
  v_sub_f32 v106, 0, v163
  v_sub_f32 v107, 0, v163
  s_waitcnt lgkmcnt(5)
  s_nop 0
  v_mfma_f32_32x32x16_bf16 v[44:59], v[12:15], v[8:11], v[92:107]
  s_waitcnt lgkmcnt(4)
  v_mfma_f32_32x32x16_bf16 v[60:75], v[16:19], v[8:11], v[92:107]
  s_nop 9
  v_exp_f32 v44, v44
  v_exp_f32 v45, v45
  v_exp_f32 v46, v46
  v_exp_f32 v47, v47
  v_cvt_pk_bf16_f32 v124, v44, v45
  v_exp_f32 v48, v48
  v_exp_f32 v49, v49
  v_cvt_pk_bf16_f32 v125, v46, v47
  v_exp_f32 v50, v50
  v_exp_f32 v51, v51
  v_cvt_pk_bf16_f32 v126, v48, v49
  v_exp_f32 v52, v52
  v_exp_f32 v53, v53
  v_cvt_pk_bf16_f32 v127, v50, v51
  v_exp_f32 v54, v54
  v_exp_f32 v55, v55
  v_cvt_pk_bf16_f32 v128, v52, v53
  v_exp_f32 v56, v56
  v_exp_f32 v57, v57
  v_cvt_pk_bf16_f32 v129, v54, v55
  v_exp_f32 v58, v58
  v_exp_f32 v59, v59
  v_cvt_pk_bf16_f32 v130, v56, v57
  v_cvt_pk_bf16_f32 v131, v58, v59
  v_exp_f32 v60, v60
  v_exp_f32 v61, v61
  v_exp_f32 v62, v62
  v_exp_f32 v63, v63
  v_cvt_pk_bf16_f32 v132, v60, v61
  v_exp_f32 v64, v64
  s_waitcnt lgkmcnt(3)
  v_mfma_f32_32x32x16_bf16 v[108:123], v[28:31], v[124:127], v[108:123]
  v_exp_f32 v65, v65
  v_cvt_pk_bf16_f32 v133, v62, v63
  v_exp_f32 v66, v66
  v_exp_f32 v67, v67
  v_cvt_pk_bf16_f32 v134, v64, v65
  v_exp_f32 v68, v68
  v_exp_f32 v69, v69
  v_cvt_pk_bf16_f32 v135, v66, v67
  v_exp_f32 v70, v70
  s_waitcnt lgkmcnt(2)
  v_mfma_f32_32x32x16_bf16 v[108:123], v[32:35], v[128:131], v[108:123]
  v_exp_f32 v71, v71
  v_cvt_pk_bf16_f32 v136, v68, v69
  v_exp_f32 v72, v72
  v_exp_f32 v73, v73
  v_cvt_pk_bf16_f32 v137, v70, v71
  v_exp_f32 v74, v74
  v_exp_f32 v75, v75
  v_cvt_pk_bf16_f32 v138, v72, v73
  v_cvt_pk_bf16_f32 v139, v74, v75
  v_and_b32 v132, v132, v148
  v_and_b32 v133, v133, v149
  v_and_b32 v134, v134, v150
  v_and_b32 v135, v135, v151
  v_and_b32 v136, v136, v152
  v_and_b32 v137, v137, v153
  v_and_b32 v138, v138, v154
  v_and_b32 v139, v139, v155
  s_waitcnt lgkmcnt(1)
  v_mfma_f32_32x32x16_bf16 v[108:123], v[36:39], v[132:135], v[108:123]
  s_waitcnt lgkmcnt(0)
  v_mfma_f32_32x32x16_bf16 v[108:123], v[40:43], v[136:139], v[108:123]
  s_branch gm_AC_fz
gm_AC_v7:
  s_waitcnt lgkmcnt(0)
  s_nop 10
  s_setprio 3
  ds_read_b128 v[12:15], v2 offset:8192
  ds_read_b128 v[16:19], v2 offset:7168
  ds_read_b128 v[20:23], v2 offset:6144
  s_mov_b64 exec, s[78:79]
  ds_read_b128 v[28:31], v3 offset:8192
  ds_read_b128 v[32:35], v3 offset:8704
  s_mov_b64 exec, -1
  s_mov_b64 exec, s[78:79]
  ds_read_b128 v[36:39], v3 offset:7168
  ds_read_b128 v[40:43], v3 offset:7680
  s_mov_b64 exec, -1
  s_waitcnt lgkmcnt(6)
  v_mfma_f32_32x32x16_bf16 v[44:59], v[12:15], v[4:7], 0
  s_nop 11
  v_cndmask_b32 v44, v44, v158, s[44:45]
  v_cndmask_b32 v45, v45, v158, s[46:47]
  v_cndmask_b32 v46, v46, v158, s[48:49]
  v_cndmask_b32 v47, v47, v158, s[50:51]
  v_cndmask_b32 v48, v48, v158, s[52:53]
  v_cndmask_b32 v49, v49, v158, s[54:55]
  v_cndmask_b32 v50, v50, v158, s[56:57]
  v_cndmask_b32 v51, v51, v158, s[58:59]
  v_cndmask_b32 v52, v52, v158, s[60:61]
  v_cndmask_b32 v53, v53, v158, s[62:63]
  v_cndmask_b32 v54, v54, v158, s[64:65]
  v_cndmask_b32 v55, v55, v158, s[66:67]
  v_cndmask_b32 v56, v56, v158, s[68:69]
  v_cndmask_b32 v57, v57, v158, s[70:71]
  v_cndmask_b32 v58, v58, v158, s[72:73]
  v_cndmask_b32 v59, v59, v158, s[74:75]
  v_max3_f32 v156, v44, v45, v46
  v_max3_f32 v157, v47, v48, v49
  v_max3_f32 v157, v50, v51, v157
  v_max3_f32 v156, v52, v53, v156
  v_max3_f32 v157, v54, v55, v157
  v_max3_f32 v156, v56, v57, v156
  v_max3_f32 v157, v58, v59, v157
  v_max_f32 v156, v156, v157
  v_mov_b32 v157, v156
  s_nop 1
  v_permlane32_swap_b32 v156, v157
  v_max_f32 v162, v156, v157
  v_sub_f32 v92, 0, v162
  v_sub_f32 v93, 0, v162
  v_sub_f32 v94, 0, v162
  v_sub_f32 v95, 0, v162
  v_sub_f32 v96, 0, v162
  v_sub_f32 v97, 0, v162
  v_sub_f32 v98, 0, v162
  v_sub_f32 v99, 0, v162
  v_sub_f32 v100, 0, v162
  v_sub_f32 v101, 0, v162
  v_sub_f32 v102, 0, v162
  v_sub_f32 v103, 0, v162
  v_sub_f32 v104, 0, v162
  v_sub_f32 v105, 0, v162
  v_sub_f32 v106, 0, v162
  v_sub_f32 v107, 0, v162
  v_sub_f32 v44, v44, v162
  v_sub_f32 v45, v45, v162
  v_sub_f32 v46, v46, v162
  v_sub_f32 v47, v47, v162
  v_sub_f32 v48, v48, v162
  v_sub_f32 v49, v49, v162
  v_sub_f32 v50, v50, v162
  v_sub_f32 v51, v51, v162
  v_sub_f32 v52, v52, v162
  v_sub_f32 v53, v53, v162
  v_sub_f32 v54, v54, v162
  v_sub_f32 v55, v55, v162
  v_sub_f32 v56, v56, v162
  v_sub_f32 v57, v57, v162
  v_sub_f32 v58, v58, v162
  v_sub_f32 v59, v59, v162
  s_waitcnt lgkmcnt(5)
  v_mfma_f32_32x32x16_bf16 v[60:75], v[16:19], v[4:7], v[92:107]
  ds_read_b128 v[24:27], v2 offset:5120
  v_exp_f32 v44, v44
  v_exp_f32 v45, v45
  v_exp_f32 v46, v46
  v_exp_f32 v47, v47
  v_cvt_pk_bf16_f32 v124, v44, v45
  v_exp_f32 v48, v48
  v_exp_f32 v49, v49
  v_cvt_pk_bf16_f32 v125, v46, v47
  v_exp_f32 v50, v50
  v_exp_f32 v51, v51
  v_cvt_pk_bf16_f32 v126, v48, v49
  v_exp_f32 v52, v52
  v_exp_f32 v53, v53
  v_cvt_pk_bf16_f32 v127, v50, v51
  v_exp_f32 v54, v54
  v_exp_f32 v55, v55
  v_cvt_pk_bf16_f32 v128, v52, v53
  v_exp_f32 v56, v56
  v_exp_f32 v57, v57
  v_cvt_pk_bf16_f32 v129, v54, v55
  v_exp_f32 v58, v58
  v_exp_f32 v59, v59
  v_cvt_pk_bf16_f32 v130, v56, v57
  v_cvt_pk_bf16_f32 v131, v58, v59
  s_waitcnt lgkmcnt(5)
  v_mfma_f32_32x32x16_bf16 v[44:59], v[20:23], v[4:7], v[92:107]
  ds_read_b128 v[12:15], v2 offset:4096
  v_exp_f32 v60, v60
  v_exp_f32 v61, v61
  v_exp_f32 v62, v62
  v_exp_f32 v63, v63
  v_cvt_pk_bf16_f32 v132, v60, v61
  v_exp_f32 v64, v64
  s_waitcnt lgkmcnt(5)
  v_mfma_f32_32x32x16_bf16 v[76:91], v[28:31], v[124:127], 0
  v_exp_f32 v65, v65
  v_cvt_pk_bf16_f32 v133, v62, v63
  v_exp_f32 v66, v66
  v_exp_f32 v67, v67
  v_cvt_pk_bf16_f32 v134, v64, v65
  v_exp_f32 v68, v68
  v_exp_f32 v69, v69
  v_cvt_pk_bf16_f32 v135, v66, v67
  v_exp_f32 v70, v70
  s_waitcnt lgkmcnt(4)
  v_mfma_f32_32x32x16_bf16 v[76:91], v[32:35], v[128:131], v[76:91]
  v_exp_f32 v71, v71
  v_cvt_pk_bf16_f32 v136, v68, v69
  s_mov_b64 exec, s[78:79]
  ds_read_b128 v[28:31], v3 offset:6144
  ds_read_b128 v[32:35], v3 offset:6656
  s_mov_b64 exec, -1
  v_exp_f32 v72, v72
  v_exp_f32 v73, v73
  v_cvt_pk_bf16_f32 v137, v70, v71
  v_exp_f32 v74, v74
  v_exp_f32 v75, v75
  v_cvt_pk_bf16_f32 v138, v72, v73
  v_cvt_pk_bf16_f32 v139, v74, v75
  s_waitcnt lgkmcnt(3)
  v_mfma_f32_32x32x16_bf16 v[60:75], v[24:27], v[4:7], v[92:107]
  ds_read_b128 v[16:19], v2 offset:3072
  v_exp_f32 v44, v44
  v_exp_f32 v45, v45
  v_exp_f32 v46, v46
  v_exp_f32 v47, v47
  v_cvt_pk_bf16_f32 v124, v44, v45
  v_exp_f32 v48, v48
  v_mfma_f32_32x32x16_bf16 v[76:91], v[36:39], v[132:135], v[76:91]
  v_exp_f32 v49, v49
  v_cvt_pk_bf16_f32 v125, v46, v47
  v_exp_f32 v50, v50
  v_exp_f32 v51, v51
  v_cvt_pk_bf16_f32 v126, v48, v49
  v_exp_f32 v52, v52
  v_exp_f32 v53, v53
  v_cvt_pk_bf16_f32 v127, v50, v51
  v_exp_f32 v54, v54
  v_mfma_f32_32x32x16_bf16 v[76:91], v[40:43], v[136:139], v[76:91]
  v_exp_f32 v55, v55
  v_cvt_pk_bf16_f32 v128, v52, v53
  s_mov_b64 exec, s[78:79]
  ds_read_b128 v[36:39], v3 offset:5120
  ds_read_b128 v[40:43], v3 offset:5632
  s_mov_b64 exec, -1
  v_exp_f32 v56, v56
  v_exp_f32 v57, v57
  v_cvt_pk_bf16_f32 v129, v54, v55
  v_exp_f32 v58, v58
  v_exp_f32 v59, v59
  v_cvt_pk_bf16_f32 v130, v56, v57
  v_cvt_pk_bf16_f32 v131, v58, v59
  s_waitcnt lgkmcnt(5)
  v_mfma_f32_32x32x16_bf16 v[44:59], v[12:15], v[4:7], v[92:107]
  ds_read_b128 v[20:23], v2 offset:2048
  v_exp_f32 v60, v60
  v_exp_f32 v61, v61
  v_exp_f32 v62, v62
  v_exp_f32 v63, v63
  v_cvt_pk_bf16_f32 v132, v60, v61
  v_exp_f32 v64, v64
  s_waitcnt lgkmcnt(5)
  v_mfma_f32_32x32x16_bf16 v[76:91], v[28:31], v[124:127], v[76:91]
  v_exp_f32 v65, v65
  v_cvt_pk_bf16_f32 v133, v62, v63
  v_exp_f32 v66, v66
  v_exp_f32 v67, v67
  v_cvt_pk_bf16_f32 v134, v64, v65
  v_exp_f32 v68, v68
  v_exp_f32 v69, v69
  v_cvt_pk_bf16_f32 v135, v66, v67
  v_exp_f32 v70, v70
  s_waitcnt lgkmcnt(4)
  v_mfma_f32_32x32x16_bf16 v[76:91], v[32:35], v[128:131], v[76:91]
  v_exp_f32 v71, v71
  v_cvt_pk_bf16_f32 v136, v68, v69
  s_mov_b64 exec, s[78:79]
  ds_read_b128 v[28:31], v3 offset:4096
  ds_read_b128 v[32:35], v3 offset:4608
  s_mov_b64 exec, -1
  v_exp_f32 v72, v72
  v_exp_f32 v73, v73
  v_cvt_pk_bf16_f32 v137, v70, v71
  v_exp_f32 v74, v74
  v_exp_f32 v75, v75
  v_cvt_pk_bf16_f32 v138, v72, v73
  v_cvt_pk_bf16_f32 v139, v74, v75
  s_waitcnt lgkmcnt(5)
  v_mfma_f32_32x32x16_bf16 v[60:75], v[16:19], v[4:7], v[92:107]
  ds_read_b128 v[24:27], v2 offset:1024
  v_exp_f32 v44, v44
  v_exp_f32 v45, v45
  v_exp_f32 v46, v46
  v_exp_f32 v47, v47
  v_cvt_pk_bf16_f32 v124, v44, v45
  v_exp_f32 v48, v48
  s_waitcnt lgkmcnt(5)
  v_mfma_f32_32x32x16_bf16 v[76:91], v[36:39], v[132:135], v[76:91]
  v_exp_f32 v49, v49
  v_cvt_pk_bf16_f32 v125, v46, v47
  v_exp_f32 v50, v50
  v_exp_f32 v51, v51
  v_cvt_pk_bf16_f32 v126, v48, v49
  v_exp_f32 v52, v52
  v_exp_f32 v53, v53
  v_cvt_pk_bf16_f32 v127, v50, v51
  v_exp_f32 v54, v54
  s_waitcnt lgkmcnt(4)
  v_mfma_f32_32x32x16_bf16 v[76:91], v[40:43], v[136:139], v[76:91]
  v_exp_f32 v55, v55
  v_cvt_pk_bf16_f32 v128, v52, v53
  s_mov_b64 exec, s[78:79]
  ds_read_b128 v[36:39], v3 offset:3072
  ds_read_b128 v[40:43], v3 offset:3584
  s_mov_b64 exec, -1
  v_exp_f32 v56, v56
  v_exp_f32 v57, v57
  v_cvt_pk_bf16_f32 v129, v54, v55
  v_exp_f32 v58, v58
  v_exp_f32 v59, v59
  v_cvt_pk_bf16_f32 v130, v56, v57
  v_cvt_pk_bf16_f32 v131, v58, v59
  s_waitcnt lgkmcnt(5)
  v_mfma_f32_32x32x16_bf16 v[44:59], v[20:23], v[4:7], v[92:107]
  v_exp_f32 v60, v60
  v_exp_f32 v61, v61
  v_exp_f32 v62, v62
  v_exp_f32 v63, v63
  v_cvt_pk_bf16_f32 v132, v60, v61
  v_exp_f32 v64, v64
  s_waitcnt lgkmcnt(4)
  v_mfma_f32_32x32x16_bf16 v[76:91], v[28:31], v[124:127], v[76:91]
  v_exp_f32 v65, v65
  v_cvt_pk_bf16_f32 v133, v62, v63
  v_exp_f32 v66, v66
  v_exp_f32 v67, v67
  v_cvt_pk_bf16_f32 v134, v64, v65
  v_exp_f32 v68, v68
  v_exp_f32 v69, v69
  v_cvt_pk_bf16_f32 v135, v66, v67
  v_exp_f32 v70, v70
  s_waitcnt lgkmcnt(3)
  v_mfma_f32_32x32x16_bf16 v[76:91], v[32:35], v[128:131], v[76:91]
  v_exp_f32 v71, v71
  v_cvt_pk_bf16_f32 v136, v68, v69
  s_mov_b64 exec, s[78:79]
  ds_read_b128 v[28:31], v3 offset:2048
  ds_read_b128 v[32:35], v3 offset:2560
  s_mov_b64 exec, -1
  v_exp_f32 v72, v72
  v_exp_f32 v73, v73
  v_cvt_pk_bf16_f32 v137, v70, v71
  v_exp_f32 v74, v74
  v_exp_f32 v75, v75
  v_cvt_pk_bf16_f32 v138, v72, v73
  v_cvt_pk_bf16_f32 v139, v74, v75
  s_waitcnt lgkmcnt(4)
  v_mfma_f32_32x32x16_bf16 v[60:75], v[24:27], v[4:7], v[92:107]
  v_exp_f32 v44, v44
  v_exp_f32 v45, v45
  v_exp_f32 v46, v46
  v_exp_f32 v47, v47
  v_cvt_pk_bf16_f32 v124, v44, v45
  v_exp_f32 v48, v48
  s_waitcnt lgkmcnt(3)
  v_mfma_f32_32x32x16_bf16 v[76:91], v[36:39], v[132:135], v[76:91]
  v_exp_f32 v49, v49
  v_cvt_pk_bf16_f32 v125, v46, v47
  v_exp_f32 v50, v50
  v_exp_f32 v51, v51
  v_cvt_pk_bf16_f32 v126, v48, v49
  v_exp_f32 v52, v52
  v_exp_f32 v53, v53
  v_cvt_pk_bf16_f32 v127, v50, v51
  v_exp_f32 v54, v54
  s_waitcnt lgkmcnt(2)
  v_mfma_f32_32x32x16_bf16 v[76:91], v[40:43], v[136:139], v[76:91]
  v_exp_f32 v55, v55
  v_cvt_pk_bf16_f32 v128, v52, v53
  s_mov_b64 exec, s[78:79]
  ds_read_b128 v[36:39], v3 offset:1024
  ds_read_b128 v[40:43], v3 offset:1536
  s_mov_b64 exec, -1
  v_exp_f32 v56, v56
  v_exp_f32 v57, v57
  v_cvt_pk_bf16_f32 v129, v54, v55
  v_exp_f32 v58, v58
  v_exp_f32 v59, v59
  v_cvt_pk_bf16_f32 v130, v56, v57
  v_cvt_pk_bf16_f32 v131, v58, v59
  v_exp_f32 v60, v60
  v_exp_f32 v61, v61
  v_exp_f32 v62, v62
  v_exp_f32 v63, v63
  v_cvt_pk_bf16_f32 v132, v60, v61
  v_exp_f32 v64, v64
  s_waitcnt lgkmcnt(3)
  v_mfma_f32_32x32x16_bf16 v[76:91], v[28:31], v[124:127], v[76:91]
  v_exp_f32 v65, v65
  v_cvt_pk_bf16_f32 v133, v62, v63
  v_exp_f32 v66, v66
  v_exp_f32 v67, v67
  v_cvt_pk_bf16_f32 v134, v64, v65
  v_exp_f32 v68, v68
  v_exp_f32 v69, v69
  v_cvt_pk_bf16_f32 v135, v66, v67
  v_exp_f32 v70, v70
  s_waitcnt lgkmcnt(2)
  v_mfma_f32_32x32x16_bf16 v[76:91], v[32:35], v[128:131], v[76:91]
  v_exp_f32 v71, v71
  v_cvt_pk_bf16_f32 v136, v68, v69
  v_exp_f32 v72, v72
  v_exp_f32 v73, v73
  v_cvt_pk_bf16_f32 v137, v70, v71
  v_exp_f32 v74, v74
  v_exp_f32 v75, v75
  v_cvt_pk_bf16_f32 v138, v72, v73
  v_cvt_pk_bf16_f32 v139, v74, v75
  s_waitcnt lgkmcnt(1)
  v_mfma_f32_32x32x16_bf16 v[76:91], v[36:39], v[132:135], v[76:91]
  s_waitcnt lgkmcnt(0)
  v_mfma_f32_32x32x16_bf16 v[76:91], v[40:43], v[136:139], v[76:91]
  s_setprio 2
  ds_read_b128 v[12:15], v2 offset:24576
  ds_read_b128 v[16:19], v2 offset:23552
  ds_read_b128 v[20:23], v2 offset:22528
  s_mov_b64 exec, s[78:79]
  ds_read_b128 v[28:31], v3 offset:24576
  ds_read_b128 v[32:35], v3 offset:25088
  s_mov_b64 exec, -1
  s_mov_b64 exec, s[78:79]
  ds_read_b128 v[36:39], v3 offset:23552
  ds_read_b128 v[40:43], v3 offset:24064
  s_mov_b64 exec, -1
  s_waitcnt lgkmcnt(6)
  v_mfma_f32_32x32x16_bf16 v[44:59], v[12:15], v[8:11], 0
  s_nop 11
  v_cndmask_b32 v44, v44, v158, s[44:45]
  v_cndmask_b32 v45, v45, v158, s[46:47]
  v_cndmask_b32 v46, v46, v158, s[48:49]
  v_cndmask_b32 v47, v47, v158, s[50:51]
  v_cndmask_b32 v48, v48, v158, s[52:53]
  v_cndmask_b32 v49, v49, v158, s[54:55]
  v_cndmask_b32 v50, v50, v158, s[56:57]
  v_cndmask_b32 v51, v51, v158, s[58:59]
  v_cndmask_b32 v52, v52, v158, s[60:61]
  v_cndmask_b32 v53, v53, v158, s[62:63]
  v_cndmask_b32 v54, v54, v158, s[64:65]
  v_cndmask_b32 v55, v55, v158, s[66:67]
  v_cndmask_b32 v56, v56, v158, s[68:69]
  v_cndmask_b32 v57, v57, v158, s[70:71]
  v_cndmask_b32 v58, v58, v158, s[72:73]
  v_cndmask_b32 v59, v59, v158, s[74:75]
  v_max3_f32 v156, v44, v45, v46
  v_max3_f32 v157, v47, v48, v49
  v_max3_f32 v157, v50, v51, v157
  v_max3_f32 v156, v52, v53, v156
  v_max3_f32 v157, v54, v55, v157
  v_max3_f32 v156, v56, v57, v156
  v_max3_f32 v157, v58, v59, v157
  v_max_f32 v156, v156, v157
  v_mov_b32 v157, v156
  s_nop 1
  v_permlane32_swap_b32 v156, v157
  v_max_f32 v163, v156, v157
  v_sub_f32 v92, 0, v163
  v_sub_f32 v93, 0, v163
  v_sub_f32 v94, 0, v163
  v_sub_f32 v95, 0, v163
  v_sub_f32 v96, 0, v163
  v_sub_f32 v97, 0, v163
  v_sub_f32 v98, 0, v163
  v_sub_f32 v99, 0, v163
  v_sub_f32 v100, 0, v163
  v_sub_f32 v101, 0, v163
  v_sub_f32 v102, 0, v163
  v_sub_f32 v103, 0, v163
  v_sub_f32 v104, 0, v163
  v_sub_f32 v105, 0, v163
  v_sub_f32 v106, 0, v163
  v_sub_f32 v107, 0, v163
  v_sub_f32 v44, v44, v163
  v_sub_f32 v45, v45, v163
  v_sub_f32 v46, v46, v163
  v_sub_f32 v47, v47, v163
  v_sub_f32 v48, v48, v163
  v_sub_f32 v49, v49, v163
  v_sub_f32 v50, v50, v163
  v_sub_f32 v51, v51, v163
  v_sub_f32 v52, v52, v163
  v_sub_f32 v53, v53, v163
  v_sub_f32 v54, v54, v163
  v_sub_f32 v55, v55, v163
  v_sub_f32 v56, v56, v163
  v_sub_f32 v57, v57, v163
  v_sub_f32 v58, v58, v163
  v_sub_f32 v59, v59, v163
  s_waitcnt lgkmcnt(5)
  v_mfma_f32_32x32x16_bf16 v[60:75], v[16:19], v[8:11], v[92:107]
  ds_read_b128 v[24:27], v2 offset:21504
  v_exp_f32 v44, v44
  v_exp_f32 v45, v45
  v_exp_f32 v46, v46
  v_exp_f32 v47, v47
  v_cvt_pk_bf16_f32 v124, v44, v45
  v_exp_f32 v48, v48
  v_exp_f32 v49, v49
  v_cvt_pk_bf16_f32 v125, v46, v47
  v_exp_f32 v50, v50
  v_exp_f32 v51, v51
  v_cvt_pk_bf16_f32 v126, v48, v49
  v_exp_f32 v52, v52
  v_exp_f32 v53, v53
  v_cvt_pk_bf16_f32 v127, v50, v51
  v_exp_f32 v54, v54
  v_exp_f32 v55, v55
  v_cvt_pk_bf16_f32 v128, v52, v53
  v_exp_f32 v56, v56
  v_exp_f32 v57, v57
  v_cvt_pk_bf16_f32 v129, v54, v55
  v_exp_f32 v58, v58
  v_exp_f32 v59, v59
  v_cvt_pk_bf16_f32 v130, v56, v57
  v_cvt_pk_bf16_f32 v131, v58, v59
  s_waitcnt lgkmcnt(5)
  v_mfma_f32_32x32x16_bf16 v[44:59], v[20:23], v[8:11], v[92:107]
  ds_read_b128 v[12:15], v2 offset:20480
  v_exp_f32 v60, v60
  v_exp_f32 v61, v61
  v_exp_f32 v62, v62
  v_exp_f32 v63, v63
  v_cvt_pk_bf16_f32 v132, v60, v61
  v_exp_f32 v64, v64
  s_waitcnt lgkmcnt(5)
  v_mfma_f32_32x32x16_bf16 v[108:123], v[28:31], v[124:127], 0
  v_exp_f32 v65, v65
  v_cvt_pk_bf16_f32 v133, v62, v63
  v_exp_f32 v66, v66
  v_exp_f32 v67, v67
  v_cvt_pk_bf16_f32 v134, v64, v65
  v_exp_f32 v68, v68
  v_exp_f32 v69, v69
  v_cvt_pk_bf16_f32 v135, v66, v67
  v_exp_f32 v70, v70
  s_waitcnt lgkmcnt(4)
  v_mfma_f32_32x32x16_bf16 v[108:123], v[32:35], v[128:131], v[108:123]
  v_exp_f32 v71, v71
  v_cvt_pk_bf16_f32 v136, v68, v69
  s_mov_b64 exec, s[78:79]
  ds_read_b128 v[28:31], v3 offset:22528
  ds_read_b128 v[32:35], v3 offset:23040
  s_mov_b64 exec, -1
  v_exp_f32 v72, v72
  v_exp_f32 v73, v73
  v_cvt_pk_bf16_f32 v137, v70, v71
  v_exp_f32 v74, v74
  v_exp_f32 v75, v75
  v_cvt_pk_bf16_f32 v138, v72, v73
  v_cvt_pk_bf16_f32 v139, v74, v75
  s_waitcnt lgkmcnt(3)
  v_mfma_f32_32x32x16_bf16 v[60:75], v[24:27], v[8:11], v[92:107]
  ds_read_b128 v[16:19], v2 offset:19456
  v_exp_f32 v44, v44
  v_exp_f32 v45, v45
  v_exp_f32 v46, v46
  v_exp_f32 v47, v47
  v_cvt_pk_bf16_f32 v124, v44, v45
  v_exp_f32 v48, v48
  v_mfma_f32_32x32x16_bf16 v[108:123], v[36:39], v[132:135], v[108:123]
  v_exp_f32 v49, v49
  v_cvt_pk_bf16_f32 v125, v46, v47
  v_exp_f32 v50, v50
  v_exp_f32 v51, v51
  v_cvt_pk_bf16_f32 v126, v48, v49
  v_exp_f32 v52, v52
  v_exp_f32 v53, v53
  v_cvt_pk_bf16_f32 v127, v50, v51
  v_exp_f32 v54, v54
  v_mfma_f32_32x32x16_bf16 v[108:123], v[40:43], v[136:139], v[108:123]
  v_exp_f32 v55, v55
  v_cvt_pk_bf16_f32 v128, v52, v53
  s_mov_b64 exec, s[78:79]
  ds_read_b128 v[36:39], v3 offset:21504
  ds_read_b128 v[40:43], v3 offset:22016
  s_mov_b64 exec, -1
  v_exp_f32 v56, v56
  v_exp_f32 v57, v57
  v_cvt_pk_bf16_f32 v129, v54, v55
  v_exp_f32 v58, v58
  v_exp_f32 v59, v59
  v_cvt_pk_bf16_f32 v130, v56, v57
  v_cvt_pk_bf16_f32 v131, v58, v59
  s_waitcnt lgkmcnt(5)
  v_mfma_f32_32x32x16_bf16 v[44:59], v[12:15], v[8:11], v[92:107]
  ds_read_b128 v[20:23], v2 offset:18432
  v_exp_f32 v60, v60
  v_exp_f32 v61, v61
  v_exp_f32 v62, v62
  v_exp_f32 v63, v63
  v_cvt_pk_bf16_f32 v132, v60, v61
  v_exp_f32 v64, v64
  s_waitcnt lgkmcnt(5)
  v_mfma_f32_32x32x16_bf16 v[108:123], v[28:31], v[124:127], v[108:123]
  v_exp_f32 v65, v65
  v_cvt_pk_bf16_f32 v133, v62, v63
  v_exp_f32 v66, v66
  v_exp_f32 v67, v67
  v_cvt_pk_bf16_f32 v134, v64, v65
  v_exp_f32 v68, v68
  v_exp_f32 v69, v69
  v_cvt_pk_bf16_f32 v135, v66, v67
  v_exp_f32 v70, v70
  s_waitcnt lgkmcnt(4)
  v_mfma_f32_32x32x16_bf16 v[108:123], v[32:35], v[128:131], v[108:123]
  v_exp_f32 v71, v71
  v_cvt_pk_bf16_f32 v136, v68, v69
  s_mov_b64 exec, s[78:79]
  ds_read_b128 v[28:31], v3 offset:20480
  ds_read_b128 v[32:35], v3 offset:20992
  s_mov_b64 exec, -1
  v_exp_f32 v72, v72
  v_exp_f32 v73, v73
  v_cvt_pk_bf16_f32 v137, v70, v71
  v_exp_f32 v74, v74
  v_exp_f32 v75, v75
  v_cvt_pk_bf16_f32 v138, v72, v73
  v_cvt_pk_bf16_f32 v139, v74, v75
  s_waitcnt lgkmcnt(5)
  v_mfma_f32_32x32x16_bf16 v[60:75], v[16:19], v[8:11], v[92:107]
  ds_read_b128 v[24:27], v2 offset:17408
  v_exp_f32 v44, v44
  v_exp_f32 v45, v45
  v_exp_f32 v46, v46
  v_exp_f32 v47, v47
  v_cvt_pk_bf16_f32 v124, v44, v45
  v_exp_f32 v48, v48
  s_waitcnt lgkmcnt(5)
  v_mfma_f32_32x32x16_bf16 v[108:123], v[36:39], v[132:135], v[108:123]
  v_exp_f32 v49, v49
  v_cvt_pk_bf16_f32 v125, v46, v47
  v_exp_f32 v50, v50
  v_exp_f32 v51, v51
  v_cvt_pk_bf16_f32 v126, v48, v49
  v_exp_f32 v52, v52
  v_exp_f32 v53, v53
  v_cvt_pk_bf16_f32 v127, v50, v51
  v_exp_f32 v54, v54
  s_waitcnt lgkmcnt(4)
  v_mfma_f32_32x32x16_bf16 v[108:123], v[40:43], v[136:139], v[108:123]
  v_exp_f32 v55, v55
  v_cvt_pk_bf16_f32 v128, v52, v53
  s_mov_b64 exec, s[78:79]
  ds_read_b128 v[36:39], v3 offset:19456
  ds_read_b128 v[40:43], v3 offset:19968
  s_mov_b64 exec, -1
  v_exp_f32 v56, v56
  v_exp_f32 v57, v57
  v_cvt_pk_bf16_f32 v129, v54, v55
  v_exp_f32 v58, v58
  v_exp_f32 v59, v59
  v_cvt_pk_bf16_f32 v130, v56, v57
  v_cvt_pk_bf16_f32 v131, v58, v59
  s_waitcnt lgkmcnt(5)
  v_mfma_f32_32x32x16_bf16 v[44:59], v[20:23], v[8:11], v[92:107]
  v_exp_f32 v60, v60
  v_exp_f32 v61, v61
  v_exp_f32 v62, v62
  v_exp_f32 v63, v63
  v_cvt_pk_bf16_f32 v132, v60, v61
  v_exp_f32 v64, v64
  s_waitcnt lgkmcnt(4)
  v_mfma_f32_32x32x16_bf16 v[108:123], v[28:31], v[124:127], v[108:123]
  v_exp_f32 v65, v65
  v_cvt_pk_bf16_f32 v133, v62, v63
  v_exp_f32 v66, v66
  v_exp_f32 v67, v67
  v_cvt_pk_bf16_f32 v134, v64, v65
  v_exp_f32 v68, v68
  v_exp_f32 v69, v69
  v_cvt_pk_bf16_f32 v135, v66, v67
  v_exp_f32 v70, v70
  s_waitcnt lgkmcnt(3)
  v_mfma_f32_32x32x16_bf16 v[108:123], v[32:35], v[128:131], v[108:123]
  v_exp_f32 v71, v71
  v_cvt_pk_bf16_f32 v136, v68, v69
  s_mov_b64 exec, s[78:79]
  ds_read_b128 v[28:31], v3 offset:18432
  ds_read_b128 v[32:35], v3 offset:18944
  s_mov_b64 exec, -1
  v_exp_f32 v72, v72
  v_exp_f32 v73, v73
  v_cvt_pk_bf16_f32 v137, v70, v71
  v_exp_f32 v74, v74
  v_exp_f32 v75, v75
  v_cvt_pk_bf16_f32 v138, v72, v73
  v_cvt_pk_bf16_f32 v139, v74, v75
  s_waitcnt lgkmcnt(4)
  v_mfma_f32_32x32x16_bf16 v[60:75], v[24:27], v[8:11], v[92:107]
  v_exp_f32 v44, v44
  v_exp_f32 v45, v45
  v_exp_f32 v46, v46
  v_exp_f32 v47, v47
  v_cvt_pk_bf16_f32 v124, v44, v45
  v_exp_f32 v48, v48
  s_waitcnt lgkmcnt(3)
  v_mfma_f32_32x32x16_bf16 v[108:123], v[36:39], v[132:135], v[108:123]
  v_exp_f32 v49, v49
  v_cvt_pk_bf16_f32 v125, v46, v47
  v_exp_f32 v50, v50
  v_exp_f32 v51, v51
  v_cvt_pk_bf16_f32 v126, v48, v49
  v_exp_f32 v52, v52
  v_exp_f32 v53, v53
  v_cvt_pk_bf16_f32 v127, v50, v51
  v_exp_f32 v54, v54
  s_waitcnt lgkmcnt(2)
  v_mfma_f32_32x32x16_bf16 v[108:123], v[40:43], v[136:139], v[108:123]
  v_exp_f32 v55, v55
  v_cvt_pk_bf16_f32 v128, v52, v53
  s_mov_b64 exec, s[78:79]
  ds_read_b128 v[36:39], v3 offset:17408
  ds_read_b128 v[40:43], v3 offset:17920
  s_mov_b64 exec, -1
  v_exp_f32 v56, v56
  v_exp_f32 v57, v57
  v_cvt_pk_bf16_f32 v129, v54, v55
  v_exp_f32 v58, v58
  v_exp_f32 v59, v59
  v_cvt_pk_bf16_f32 v130, v56, v57
  v_cvt_pk_bf16_f32 v131, v58, v59
  v_exp_f32 v60, v60
  v_exp_f32 v61, v61
  v_exp_f32 v62, v62
  v_exp_f32 v63, v63
  v_cvt_pk_bf16_f32 v132, v60, v61
  v_exp_f32 v64, v64
  s_waitcnt lgkmcnt(3)
  v_mfma_f32_32x32x16_bf16 v[108:123], v[28:31], v[124:127], v[108:123]
  v_exp_f32 v65, v65
  v_cvt_pk_bf16_f32 v133, v62, v63
  v_exp_f32 v66, v66
  v_exp_f32 v67, v67
  v_cvt_pk_bf16_f32 v134, v64, v65
  v_exp_f32 v68, v68
  v_exp_f32 v69, v69
  v_cvt_pk_bf16_f32 v135, v66, v67
  v_exp_f32 v70, v70
  s_waitcnt lgkmcnt(2)
  v_mfma_f32_32x32x16_bf16 v[108:123], v[32:35], v[128:131], v[108:123]
  v_exp_f32 v71, v71
  v_cvt_pk_bf16_f32 v136, v68, v69
  v_exp_f32 v72, v72
  v_exp_f32 v73, v73
  v_cvt_pk_bf16_f32 v137, v70, v71
  v_exp_f32 v74, v74
  v_exp_f32 v75, v75
  v_cvt_pk_bf16_f32 v138, v72, v73
  v_cvt_pk_bf16_f32 v139, v74, v75
  s_waitcnt lgkmcnt(1)
  v_mfma_f32_32x32x16_bf16 v[108:123], v[36:39], v[132:135], v[108:123]
  s_waitcnt lgkmcnt(0)
  v_mfma_f32_32x32x16_bf16 v[108:123], v[40:43], v[136:139], v[108:123]
  s_waitcnt lgkmcnt(0)
  s_barrier
  s_cmp_eq_u32 s83, 0
  s_cbranch_scc1 gm_AC_fz
  s_setprio 1
  ds_read_b128 v[12:15], v2 offset:0
  s_mov_b64 exec, s[78:79]
  ds_read_b128 v[28:31], v3 offset:0
  ds_read_b128 v[32:35], v3 offset:512
  s_mov_b64 exec, -1
  v_sub_f32 v92, 0, v162
  v_sub_f32 v93, 0, v162
  v_sub_f32 v94, 0, v162
  v_sub_f32 v95, 0, v162
  v_sub_f32 v96, 0, v162
  v_sub_f32 v97, 0, v162
  v_sub_f32 v98, 0, v162
  v_sub_f32 v99, 0, v162
  v_sub_f32 v100, 0, v162
  v_sub_f32 v101, 0, v162
  v_sub_f32 v102, 0, v162
  v_sub_f32 v103, 0, v162
  v_sub_f32 v104, 0, v162
  v_sub_f32 v105, 0, v162
  v_sub_f32 v106, 0, v162
  v_sub_f32 v107, 0, v162
  s_waitcnt lgkmcnt(2)
  s_nop 0
  v_mfma_f32_32x32x16_bf16 v[44:59], v[12:15], v[4:7], v[92:107]
  s_nop 11
  v_exp_f32 v44, v44
  v_exp_f32 v45, v45
  v_exp_f32 v46, v46
  v_exp_f32 v47, v47
  v_cvt_pk_bf16_f32 v124, v44, v45
  v_exp_f32 v48, v48
  v_exp_f32 v49, v49
  v_cvt_pk_bf16_f32 v125, v46, v47
  v_exp_f32 v50, v50
  v_exp_f32 v51, v51
  v_cvt_pk_bf16_f32 v126, v48, v49
  v_exp_f32 v52, v52
  v_exp_f32 v53, v53
  v_cvt_pk_bf16_f32 v127, v50, v51
  v_exp_f32 v54, v54
  v_exp_f32 v55, v55
  v_cvt_pk_bf16_f32 v128, v52, v53
  v_exp_f32 v56, v56
  v_exp_f32 v57, v57
  v_cvt_pk_bf16_f32 v129, v54, v55
  v_exp_f32 v58, v58
  v_exp_f32 v59, v59
  v_cvt_pk_bf16_f32 v130, v56, v57
  v_cvt_pk_bf16_f32 v131, v58, v59
  v_and_b32 v124, v124, v148
  v_and_b32 v125, v125, v149
  v_and_b32 v126, v126, v150
  v_and_b32 v127, v127, v151
  v_and_b32 v128, v128, v152
  v_and_b32 v129, v129, v153
  v_and_b32 v130, v130, v154
  v_and_b32 v131, v131, v155
  s_waitcnt lgkmcnt(1)
  v_mfma_f32_32x32x16_bf16 v[76:91], v[28:31], v[124:127], v[76:91]
  s_waitcnt lgkmcnt(0)
  v_mfma_f32_32x32x16_bf16 v[76:91], v[32:35], v[128:131], v[76:91]
  s_setprio 0
  ds_read_b128 v[12:15], v2 offset:16384
  s_mov_b64 exec, s[78:79]
  ds_read_b128 v[28:31], v3 offset:16384
  ds_read_b128 v[32:35], v3 offset:16896
  s_mov_b64 exec, -1
  v_sub_f32 v92, 0, v163
  v_sub_f32 v93, 0, v163
  v_sub_f32 v94, 0, v163
  v_sub_f32 v95, 0, v163
  v_sub_f32 v96, 0, v163
  v_sub_f32 v97, 0, v163
  v_sub_f32 v98, 0, v163
  v_sub_f32 v99, 0, v163
  v_sub_f32 v100, 0, v163
  v_sub_f32 v101, 0, v163
  v_sub_f32 v102, 0, v163
  v_sub_f32 v103, 0, v163
  v_sub_f32 v104, 0, v163
  v_sub_f32 v105, 0, v163
  v_sub_f32 v106, 0, v163
  v_sub_f32 v107, 0, v163
  s_waitcnt lgkmcnt(2)
  s_nop 0
  v_mfma_f32_32x32x16_bf16 v[44:59], v[12:15], v[8:11], v[92:107]
  s_nop 11
  v_exp_f32 v44, v44
  v_exp_f32 v45, v45
  v_exp_f32 v46, v46
  v_exp_f32 v47, v47
  v_cvt_pk_bf16_f32 v124, v44, v45
  v_exp_f32 v48, v48
  v_exp_f32 v49, v49
  v_cvt_pk_bf16_f32 v125, v46, v47
  v_exp_f32 v50, v50
  v_exp_f32 v51, v51
  v_cvt_pk_bf16_f32 v126, v48, v49
  v_exp_f32 v52, v52
  v_exp_f32 v53, v53
  v_cvt_pk_bf16_f32 v127, v50, v51
  v_exp_f32 v54, v54
  v_exp_f32 v55, v55
  v_cvt_pk_bf16_f32 v128, v52, v53
  v_exp_f32 v56, v56
  v_exp_f32 v57, v57
  v_cvt_pk_bf16_f32 v129, v54, v55
  v_exp_f32 v58, v58
  v_exp_f32 v59, v59
  v_cvt_pk_bf16_f32 v130, v56, v57
  v_cvt_pk_bf16_f32 v131, v58, v59
  v_and_b32 v124, v124, v148
  v_and_b32 v125, v125, v149
  v_and_b32 v126, v126, v150
  v_and_b32 v127, v127, v151
  v_and_b32 v128, v128, v152
  v_and_b32 v129, v129, v153
  v_and_b32 v130, v130, v154
  v_and_b32 v131, v131, v155
  s_waitcnt lgkmcnt(1)
  v_mfma_f32_32x32x16_bf16 v[108:123], v[28:31], v[124:127], v[108:123]
  s_waitcnt lgkmcnt(0)
  v_mfma_f32_32x32x16_bf16 v[108:123], v[32:35], v[128:131], v[108:123]
  s_branch gm_AC_fz
gm_AC_fz:
  s_waitcnt lgkmcnt(0)
  s_nop 10
  s_setprio 0
  v_mov_b32 v157, 0x71800000
  v_cmp_nle_f32 s[84:85], v84, v157
  v_rcp_f32 v156, v84
  s_nop 0
  v_mul_f32 v76, v76, v156
  v_mul_f32 v77, v77, v156
  v_mul_f32 v78, v78, v156
  v_mul_f32 v79, v79, v156
  v_mul_f32 v80, v80, v156
  v_mul_f32 v81, v81, v156
  v_mul_f32 v82, v82, v156
  v_mul_f32 v83, v83, v156
  v_cvt_pk_bf16_f32 v124, v76, v77
  v_cvt_pk_bf16_f32 v125, v78, v79
  v_cvt_pk_bf16_f32 v126, v80, v81
  v_cvt_pk_bf16_f32 v127, v82, v83
  buffer_store_dwordx4 v[124:127], v1, s[36:39], s40 offen offset:0 sc1
  v_fma_f32 v92, v76, v159, v159
  v_fma_f32 v92, v77, v159, v92
  v_fma_f32 v92, v78, v159, v92
  v_fma_f32 v92, v79, v159, v92
  v_fma_f32 v92, v80, v159, v92
  v_fma_f32 v92, v81, v159, v92
  v_fma_f32 v92, v82, v159, v92
  v_fma_f32 v92, v83, v159, v92
  v_cmp_nle_f32 s[86:87], v116, v157
  v_rcp_f32 v156, v116
  s_nop 0
  v_mul_f32 v108, v108, v156
  v_mul_f32 v109, v109, v156
  v_mul_f32 v110, v110, v156
  v_mul_f32 v111, v111, v156
  v_mul_f32 v112, v112, v156
  v_mul_f32 v113, v113, v156
  v_mul_f32 v114, v114, v156
  v_mul_f32 v115, v115, v156
  v_cvt_pk_bf16_f32 v128, v108, v109
  v_cvt_pk_bf16_f32 v129, v110, v111
  v_cvt_pk_bf16_f32 v130, v112, v113
  v_cvt_pk_bf16_f32 v131, v114, v115
  buffer_store_dwordx4 v[128:131], v1, s[36:39], s40 offen offset:1024 sc1
  v_fma_f32 v92, v108, v159, v92
  v_fma_f32 v92, v109, v159, v92
  v_fma_f32 v92, v110, v159, v92
  v_fma_f32 v92, v111, v159, v92
  v_fma_f32 v92, v112, v159, v92
  v_fma_f32 v92, v113, v159, v92
  v_fma_f32 v92, v114, v159, v92
  v_fma_f32 v92, v115, v159, v92
  v_cmp_u_f32 s[88:89], v92, v92
  s_or_b64 s[84:85], s[84:85], s[86:87]
  s_nop 2
  s_or_b64 s[84:85], s[84:85], s[88:89]
  s_cmp_eq_u64 s[84:85], 0
  s_cbranch_scc1 gm_AC_fin
  s_waitcnt vmcnt(0)
  s_cmp_eq_u32 s83, 0
  s_cbranch_scc1 gm_AC_gen
  ds_read_b128 v[12:15], v2 offset:8192
  ds_read_b128 v[16:19], v2 offset:0
  ds_read_b128 v[20:23], v2 offset:7168
  ds_read_b128 v[24:27], v2 offset:6144
  s_waitcnt lgkmcnt(3)
  v_mfma_f32_32x32x16_bf16 v[44:59], v[12:15], v[4:7], 0
  s_waitcnt lgkmcnt(2)
  v_mfma_f32_32x32x16_bf16 v[60:75], v[16:19], v[4:7], 0
  s_waitcnt lgkmcnt(1)
  v_mfma_f32_32x32x16_bf16 v[76:91], v[20:23], v[4:7], 0
  ds_read_b128 v[12:15], v2 offset:5120
  ds_read_b128 v[16:19], v2 offset:4096
  s_waitcnt lgkmcnt(2)
  v_mfma_f32_32x32x16_bf16 v[92:107], v[24:27], v[4:7], 0
  ds_read_b128 v[20:23], v2 offset:3072
  ds_read_b128 v[24:27], v2 offset:2048
  s_nop 3
  v_cndmask_b32 v44, v44, v60, s[44:45]
  v_cndmask_b32 v45, v45, v61, s[46:47]
  v_cndmask_b32 v46, v46, v62, s[48:49]
  v_cndmask_b32 v47, v47, v63, s[50:51]
  v_cndmask_b32 v48, v48, v64, s[52:53]
  v_cndmask_b32 v49, v49, v65, s[54:55]
  v_cndmask_b32 v50, v50, v66, s[56:57]
  v_cndmask_b32 v51, v51, v67, s[58:59]
  v_cndmask_b32 v52, v52, v68, s[60:61]
  v_cndmask_b32 v53, v53, v69, s[62:63]
  v_cndmask_b32 v54, v54, v70, s[64:65]
  v_cndmask_b32 v55, v55, v71, s[66:67]
  v_cndmask_b32 v56, v56, v72, s[68:69]
  v_cndmask_b32 v57, v57, v73, s[70:71]
  v_cndmask_b32 v58, v58, v74, s[72:73]
  v_cndmask_b32 v59, v59, v75, s[74:75]
  s_waitcnt lgkmcnt(3)
  v_mfma_f32_32x32x16_bf16 v[108:123], v[12:15], v[4:7], 0
  ds_read_b128 v[12:15], v2 offset:1024
  v_max3_f32 v156, v44, v45, v46
  v_max3_f32 v157, v47, v48, v49
  v_max3_f32 v156, v50, v51, v156
  v_max3_f32 v157, v52, v53, v157
  v_max3_f32 v156, v54, v55, v156
  v_max3_f32 v157, v56, v57, v157
  v_max3_f32 v156, v58, v59, v156
  s_waitcnt lgkmcnt(3)
  v_mfma_f32_32x32x16_bf16 v[60:75], v[16:19], v[4:7], 0
  v_max3_f32 v156, v76, v77, v156
  v_max3_f32 v157, v78, v79, v157
  v_max3_f32 v156, v80, v81, v156
  v_max3_f32 v157, v82, v83, v157
  v_max3_f32 v156, v84, v85, v156
  v_max3_f32 v157, v86, v87, v157
  v_max3_f32 v156, v88, v89, v156
  v_max3_f32 v157, v90, v91, v157
  s_waitcnt lgkmcnt(2)
  v_mfma_f32_32x32x16_bf16 v[44:59], v[20:23], v[4:7], 0
  v_max3_f32 v156, v92, v93, v156
  v_max3_f32 v157, v94, v95, v157
  v_max3_f32 v156, v96, v97, v156
  v_max3_f32 v157, v98, v99, v157
  v_max3_f32 v156, v100, v101, v156
  v_max3_f32 v157, v102, v103, v157
  v_max3_f32 v156, v104, v105, v156
  v_max3_f32 v157, v106, v107, v157
  s_waitcnt lgkmcnt(1)
  v_mfma_f32_32x32x16_bf16 v[76:91], v[24:27], v[4:7], 0
  v_max3_f32 v156, v108, v109, v156
  v_max3_f32 v157, v110, v111, v157
  v_max3_f32 v156, v112, v113, v156
  v_max3_f32 v157, v114, v115, v157
  v_max3_f32 v156, v116, v117, v156
  v_max3_f32 v157, v118, v119, v157
  v_max3_f32 v156, v120, v121, v156
  v_max3_f32 v157, v122, v123, v157
  s_waitcnt lgkmcnt(0)
  v_mfma_f32_32x32x16_bf16 v[92:107], v[12:15], v[4:7], 0
  v_max3_f32 v156, v60, v61, v156
  v_max3_f32 v157, v62, v63, v157
  v_max3_f32 v156, v64, v65, v156
  v_max3_f32 v157, v66, v67, v157
  v_max3_f32 v156, v68, v69, v156
  v_max3_f32 v157, v70, v71, v157
  v_max3_f32 v156, v72, v73, v156
  v_max3_f32 v157, v74, v75, v157
  v_max3_f32 v156, v44, v45, v156
  v_max3_f32 v157, v46, v47, v157
  v_max3_f32 v156, v48, v49, v156
  v_max3_f32 v157, v50, v51, v157
  v_max3_f32 v156, v52, v53, v156
  v_max3_f32 v157, v54, v55, v157
  v_max3_f32 v156, v56, v57, v156
  v_max3_f32 v157, v58, v59, v157
  v_max3_f32 v156, v76, v77, v156
  v_max3_f32 v157, v78, v79, v157
  v_max3_f32 v156, v80, v81, v156
  v_max3_f32 v157, v82, v83, v157
  v_max3_f32 v156, v84, v85, v156
  v_max3_f32 v157, v86, v87, v157
  v_max3_f32 v156, v88, v89, v156
  v_max3_f32 v157, v90, v91, v157
  v_max3_f32 v156, v92, v93, v156
  v_max3_f32 v157, v94, v95, v157
  v_max3_f32 v156, v96, v97, v156
  v_max3_f32 v157, v98, v99, v157
  v_max3_f32 v156, v100, v101, v156
  v_max3_f32 v157, v102, v103, v157
  v_max3_f32 v156, v104, v105, v156
  v_max3_f32 v157, v106, v107, v157
  ds_read_b128 v[12:15], v2 offset:8192
  ds_read_b128 v[16:19], v2 offset:0
  ds_read_b128 v[20:23], v2 offset:7168
  v_max_f32 v156, v156, v157
  v_mov_b32 v157, v156
  s_nop 1
  v_permlane32_swap_b32 v156, v157
  v_max_f32 v156, v156, v157
  v_sub_f32 v92, 0, v156
  v_sub_f32 v93, 0, v156
  v_sub_f32 v94, 0, v156
  v_sub_f32 v95, 0, v156
  v_sub_f32 v96, 0, v156
  v_sub_f32 v97, 0, v156
  v_sub_f32 v98, 0, v156
  v_sub_f32 v99, 0, v156
  v_sub_f32 v100, 0, v156
  v_sub_f32 v101, 0, v156
  v_sub_f32 v102, 0, v156
  v_sub_f32 v103, 0, v156
  v_sub_f32 v104, 0, v156
  v_sub_f32 v105, 0, v156
  v_sub_f32 v106, 0, v156
  v_sub_f32 v107, 0, v156
  s_waitcnt lgkmcnt(2)
  s_nop 0
  v_mfma_f32_32x32x16_bf16 v[44:59], v[12:15], v[4:7], v[92:107]
  s_waitcnt lgkmcnt(1)
  v_mfma_f32_32x32x16_bf16 v[60:75], v[16:19], v[4:7], v[92:107]
  s_waitcnt lgkmcnt(0)
  v_mfma_f32_32x32x16_bf16 v[76:91], v[20:23], v[4:7], v[92:107]
  ds_read_b128 v[24:27], v2 offset:6144
  s_mov_b64 exec, s[78:79]
  ds_read_b128 v[28:31], v3 offset:8192
  ds_read_b128 v[32:35], v3 offset:8704
  s_mov_b64 exec, -1
  s_mov_b64 exec, s[78:79]
  ds_read_b128 v[36:39], v3 offset:0
  ds_read_b128 v[40:43], v3 offset:512
  s_mov_b64 exec, -1
  s_nop 0
  v_cndmask_b32 v44, v44, v60, s[44:45]
  v_cndmask_b32 v45, v45, v61, s[46:47]
  v_cndmask_b32 v46, v46, v62, s[48:49]
  v_cndmask_b32 v47, v47, v63, s[50:51]
  v_cndmask_b32 v48, v48, v64, s[52:53]
  v_cndmask_b32 v49, v49, v65, s[54:55]
  v_cndmask_b32 v50, v50, v66, s[56:57]
  v_cndmask_b32 v51, v51, v67, s[58:59]
  v_cndmask_b32 v52, v52, v68, s[60:61]
  v_cndmask_b32 v53, v53, v69, s[62:63]
  v_cndmask_b32 v54, v54, v70, s[64:65]
  v_cndmask_b32 v55, v55, v71, s[66:67]
  v_cndmask_b32 v56, v56, v72, s[68:69]
  v_cndmask_b32 v57, v57, v73, s[70:71]
  v_cndmask_b32 v58, v58, v74, s[72:73]
  v_cndmask_b32 v59, v59, v75, s[74:75]
  ds_read_b128 v[12:15], v2 offset:5120
  s_waitcnt lgkmcnt(5)
  v_mfma_f32_32x32x16_bf16 v[60:75], v[24:27], v[4:7], v[92:107]
  v_exp_f32 v44, v44
  v_exp_f32 v45, v45
  v_exp_f32 v46, v46
  v_exp_f32 v47, v47
  v_cvt_pk_bf16_f32 v124, v44, v45
  v_exp_f32 v48, v48
  v_exp_f32 v49, v49
  v_cvt_pk_bf16_f32 v125, v46, v47
  v_exp_f32 v50, v50
  v_exp_f32 v51, v51
  v_cvt_pk_bf16_f32 v126, v48, v49
  v_exp_f32 v52, v52
  v_exp_f32 v53, v53
  v_cvt_pk_bf16_f32 v127, v50, v51
  v_exp_f32 v54, v54
  v_exp_f32 v55, v55
  v_cvt_pk_bf16_f32 v128, v52, v53
  v_exp_f32 v56, v56
  v_exp_f32 v57, v57
  v_cvt_pk_bf16_f32 v129, v54, v55
  v_exp_f32 v58, v58
  v_exp_f32 v59, v59
  v_cvt_pk_bf16_f32 v130, v56, v57
  v_cvt_pk_bf16_f32 v131, v58, v59
  v_and_b32 v140, v124, v148
  v_xor_b32 v124, v124, v140
  v_and_b32 v141, v125, v149
  v_xor_b32 v125, v125, v141
  v_and_b32 v142, v126, v150
  v_xor_b32 v126, v126, v142
  v_and_b32 v143, v127, v151
  v_xor_b32 v127, v127, v143
  v_and_b32 v144, v128, v152
  v_xor_b32 v128, v128, v144
  v_and_b32 v145, v129, v153
  v_xor_b32 v129, v129, v145
  v_and_b32 v146, v130, v154
  v_xor_b32 v130, v130, v146
  v_and_b32 v147, v131, v155
  v_xor_b32 v131, v131, v147
  ds_read_b128 v[16:19], v2 offset:4096
  s_waitcnt lgkmcnt(1)
  v_mfma_f32_32x32x16_bf16 v[44:59], v[12:15], v[4:7], v[92:107]
  v_exp_f32 v76, v76
  v_exp_f32 v77, v77
  v_mfma_f32_32x32x16_bf16 v[108:123], v[28:31], v[124:127], 0
  v_exp_f32 v78, v78
  v_exp_f32 v79, v79
  v_cvt_pk_bf16_f32 v132, v76, v77
  v_exp_f32 v80, v80
  v_exp_f32 v81, v81
  v_cvt_pk_bf16_f32 v133, v78, v79
  v_mfma_f32_32x32x16_bf16 v[108:123], v[32:35], v[128:131], v[108:123]
  v_exp_f32 v82, v82
  v_exp_f32 v83, v83
  v_cvt_pk_bf16_f32 v134, v80, v81
  v_exp_f32 v84, v84
  v_exp_f32 v85, v85
  v_cvt_pk_bf16_f32 v135, v82, v83
  v_mfma_f32_32x32x16_bf16 v[108:123], v[36:39], v[140:143], v[108:123]
  v_exp_f32 v86, v86
  v_exp_f32 v87, v87
  v_cvt_pk_bf16_f32 v136, v84, v85
  v_exp_f32 v88, v88
  v_exp_f32 v89, v89
  v_cvt_pk_bf16_f32 v137, v86, v87
  v_mfma_f32_32x32x16_bf16 v[108:123], v[40:43], v[144:147], v[108:123]
  v_exp_f32 v90, v90
  s_mov_b64 exec, s[78:79]
  ds_read_b128 v[28:31], v3 offset:7168
  ds_read_b128 v[32:35], v3 offset:7680
  s_mov_b64 exec, -1
  s_mov_b64 exec, s[78:79]
  ds_read_b128 v[36:39], v3 offset:6144
  ds_read_b128 v[40:43], v3 offset:6656
  s_mov_b64 exec, -1
  v_exp_f32 v91, v91
  v_cvt_pk_bf16_f32 v138, v88, v89
  v_cvt_pk_bf16_f32 v139, v90, v91
  ds_read_b128 v[20:23], v2 offset:3072
  s_waitcnt lgkmcnt(5)
  v_mfma_f32_32x32x16_bf16 v[76:91], v[16:19], v[4:7], v[92:107]
  v_exp_f32 v60, v60
  v_exp_f32 v61, v61
  v_exp_f32 v62, v62
  v_exp_f32 v63, v63
  v_cvt_pk_bf16_f32 v124, v60, v61
  v_exp_f32 v64, v64
  s_waitcnt lgkmcnt(4)
  v_mfma_f32_32x32x16_bf16 v[108:123], v[28:31], v[132:135], v[108:123]
  v_exp_f32 v65, v65
  v_cvt_pk_bf16_f32 v125, v62, v63
  v_exp_f32 v66, v66
  v_exp_f32 v67, v67
  v_cvt_pk_bf16_f32 v126, v64, v65
  v_exp_f32 v68, v68
  v_exp_f32 v69, v69
  v_cvt_pk_bf16_f32 v127, v66, v67
  v_exp_f32 v70, v70
  s_waitcnt lgkmcnt(3)
  v_mfma_f32_32x32x16_bf16 v[108:123], v[32:35], v[136:139], v[108:123]
  v_exp_f32 v71, v71
  v_cvt_pk_bf16_f32 v128, v68, v69
  s_mov_b64 exec, s[78:79]
  ds_read_b128 v[28:31], v3 offset:5120
  ds_read_b128 v[32:35], v3 offset:5632
  s_mov_b64 exec, -1
  v_exp_f32 v72, v72
  v_exp_f32 v73, v73
  v_cvt_pk_bf16_f32 v129, v70, v71
  v_exp_f32 v74, v74
  v_exp_f32 v75, v75
  v_cvt_pk_bf16_f32 v130, v72, v73
  v_cvt_pk_bf16_f32 v131, v74, v75
  ds_read_b128 v[24:27], v2 offset:2048
  s_waitcnt lgkmcnt(3)
  v_mfma_f32_32x32x16_bf16 v[60:75], v[20:23], v[4:7], v[92:107]
  v_exp_f32 v44, v44
  v_exp_f32 v45, v45
  v_exp_f32 v46, v46
  v_exp_f32 v47, v47
  v_cvt_pk_bf16_f32 v132, v44, v45
  v_exp_f32 v48, v48
  v_mfma_f32_32x32x16_bf16 v[108:123], v[36:39], v[124:127], v[108:123]
  v_exp_f32 v49, v49
  v_cvt_pk_bf16_f32 v133, v46, v47
  v_exp_f32 v50, v50
  v_exp_f32 v51, v51
  v_cvt_pk_bf16_f32 v134, v48, v49
  v_exp_f32 v52, v52
  v_exp_f32 v53, v53
  v_cvt_pk_bf16_f32 v135, v50, v51
  v_exp_f32 v54, v54
  v_mfma_f32_32x32x16_bf16 v[108:123], v[40:43], v[128:131], v[108:123]
  v_exp_f32 v55, v55
  v_cvt_pk_bf16_f32 v136, v52, v53
  s_mov_b64 exec, s[78:79]
  ds_read_b128 v[36:39], v3 offset:4096
  ds_read_b128 v[40:43], v3 offset:4608
  s_mov_b64 exec, -1
  v_exp_f32 v56, v56
  v_exp_f32 v57, v57
  v_cvt_pk_bf16_f32 v137, v54, v55
  v_exp_f32 v58, v58
  v_exp_f32 v59, v59
  v_cvt_pk_bf16_f32 v138, v56, v57
  v_cvt_pk_bf16_f32 v139, v58, v59
  ds_read_b128 v[12:15], v2 offset:1024
  s_waitcnt lgkmcnt(3)
  v_mfma_f32_32x32x16_bf16 v[44:59], v[24:27], v[4:7], v[92:107]
  v_exp_f32 v76, v76
  v_exp_f32 v77, v77
  v_exp_f32 v78, v78
  v_exp_f32 v79, v79
  v_cvt_pk_bf16_f32 v124, v76, v77
  v_exp_f32 v80, v80
  v_mfma_f32_32x32x16_bf16 v[108:123], v[28:31], v[132:135], v[108:123]
  v_exp_f32 v81, v81
  v_cvt_pk_bf16_f32 v125, v78, v79
  v_exp_f32 v82, v82
  v_exp_f32 v83, v83
  v_cvt_pk_bf16_f32 v126, v80, v81
  v_exp_f32 v84, v84
  v_exp_f32 v85, v85
  v_cvt_pk_bf16_f32 v127, v82, v83
  v_exp_f32 v86, v86
  v_mfma_f32_32x32x16_bf16 v[108:123], v[32:35], v[136:139], v[108:123]
  v_exp_f32 v87, v87
  v_cvt_pk_bf16_f32 v128, v84, v85
  s_mov_b64 exec, s[78:79]
  ds_read_b128 v[28:31], v3 offset:3072
  ds_read_b128 v[32:35], v3 offset:3584
  s_mov_b64 exec, -1
  v_exp_f32 v88, v88
  v_exp_f32 v89, v89
  v_cvt_pk_bf16_f32 v129, v86, v87
  v_exp_f32 v90, v90
  v_exp_f32 v91, v91
  v_cvt_pk_bf16_f32 v130, v88, v89
  v_cvt_pk_bf16_f32 v131, v90, v91
  s_waitcnt lgkmcnt(2)
  v_mfma_f32_32x32x16_bf16 v[76:91], v[12:15], v[4:7], v[92:107]
  v_exp_f32 v60, v60
  v_exp_f32 v61, v61
  v_exp_f32 v62, v62
  v_exp_f32 v63, v63
  v_cvt_pk_bf16_f32 v132, v60, v61
  v_exp_f32 v64, v64
  v_mfma_f32_32x32x16_bf16 v[108:123], v[36:39], v[124:127], v[108:123]
  v_exp_f32 v65, v65
  v_cvt_pk_bf16_f32 v133, v62, v63
  v_exp_f32 v66, v66
  v_exp_f32 v67, v67
  v_cvt_pk_bf16_f32 v134, v64, v65
  v_exp_f32 v68, v68
  v_exp_f32 v69, v69
  v_cvt_pk_bf16_f32 v135, v66, v67
  v_exp_f32 v70, v70
  v_mfma_f32_32x32x16_bf16 v[108:123], v[40:43], v[128:131], v[108:123]
  v_exp_f32 v71, v71
  v_cvt_pk_bf16_f32 v136, v68, v69
  s_mov_b64 exec, s[78:79]
  ds_read_b128 v[36:39], v3 offset:2048
  ds_read_b128 v[40:43], v3 offset:2560
  s_mov_b64 exec, -1
  v_exp_f32 v72, v72
  v_exp_f32 v73, v73
  v_cvt_pk_bf16_f32 v137, v70, v71
  v_exp_f32 v74, v74
  v_exp_f32 v75, v75
  v_cvt_pk_bf16_f32 v138, v72, v73
  v_cvt_pk_bf16_f32 v139, v74, v75
  v_exp_f32 v44, v44
  v_exp_f32 v45, v45
  v_exp_f32 v46, v46
  v_exp_f32 v47, v47
  v_cvt_pk_bf16_f32 v124, v44, v45
  v_exp_f32 v48, v48
  s_waitcnt lgkmcnt(3)
  v_mfma_f32_32x32x16_bf16 v[108:123], v[28:31], v[132:135], v[108:123]
  v_exp_f32 v49, v49
  v_cvt_pk_bf16_f32 v125, v46, v47
  v_exp_f32 v50, v50
  v_exp_f32 v51, v51
  v_cvt_pk_bf16_f32 v126, v48, v49
  v_exp_f32 v52, v52
  v_exp_f32 v53, v53
  v_cvt_pk_bf16_f32 v127, v50, v51
  v_exp_f32 v54, v54
  s_waitcnt lgkmcnt(2)
  v_mfma_f32_32x32x16_bf16 v[108:123], v[32:35], v[136:139], v[108:123]
  v_exp_f32 v55, v55
  v_cvt_pk_bf16_f32 v128, v52, v53
  s_mov_b64 exec, s[78:79]
  ds_read_b128 v[28:31], v3 offset:1024
  ds_read_b128 v[32:35], v3 offset:1536
  s_mov_b64 exec, -1
  v_exp_f32 v56, v56
  v_exp_f32 v57, v57
  v_cvt_pk_bf16_f32 v129, v54, v55
  v_exp_f32 v58, v58
  v_exp_f32 v59, v59
  v_cvt_pk_bf16_f32 v130, v56, v57
  v_cvt_pk_bf16_f32 v131, v58, v59
  v_exp_f32 v76, v76
  v_exp_f32 v77, v77
  v_exp_f32 v78, v78
  v_exp_f32 v79, v79
  v_cvt_pk_bf16_f32 v132, v76, v77
  v_exp_f32 v80, v80
  s_waitcnt lgkmcnt(3)
  v_mfma_f32_32x32x16_bf16 v[108:123], v[36:39], v[124:127], v[108:123]
  v_exp_f32 v81, v81
  v_cvt_pk_bf16_f32 v133, v78, v79
  v_exp_f32 v82, v82
  v_exp_f32 v83, v83
  v_cvt_pk_bf16_f32 v134, v80, v81
  v_exp_f32 v84, v84
  v_exp_f32 v85, v85
  v_cvt_pk_bf16_f32 v135, v82, v83
  v_exp_f32 v86, v86
  s_waitcnt lgkmcnt(2)
  v_mfma_f32_32x32x16_bf16 v[108:123], v[40:43], v[128:131], v[108:123]
  v_exp_f32 v87, v87
  v_cvt_pk_bf16_f32 v136, v84, v85
  v_exp_f32 v88, v88
  v_exp_f32 v89, v89
  v_cvt_pk_bf16_f32 v137, v86, v87
  v_exp_f32 v90, v90
  v_exp_f32 v91, v91
  v_cvt_pk_bf16_f32 v138, v88, v89
  v_cvt_pk_bf16_f32 v139, v90, v91
  s_waitcnt lgkmcnt(1)
  v_mfma_f32_32x32x16_bf16 v[108:123], v[28:31], v[132:135], v[108:123]
  s_waitcnt lgkmcnt(0)
  v_mfma_f32_32x32x16_bf16 v[108:123], v[32:35], v[136:139], v[108:123]
  s_nop 11
  v_rcp_f32 v156, v116
  s_nop 0
  v_mul_f32 v108, v108, v156
  v_mul_f32 v109, v109, v156
  v_mul_f32 v110, v110, v156
  v_mul_f32 v111, v111, v156
  v_mul_f32 v112, v112, v156
  v_mul_f32 v113, v113, v156
  v_mul_f32 v114, v114, v156
  v_mul_f32 v115, v115, v156
  v_cvt_pk_bf16_f32 v140, v108, v109
  v_cvt_pk_bf16_f32 v141, v110, v111
  v_cvt_pk_bf16_f32 v142, v112, v113
  v_cvt_pk_bf16_f32 v143, v114, v115
  buffer_store_dwordx4 v[140:143], v1, s[36:39], s40 offen offset:0 sc1
  ds_read_b128 v[12:15], v2 offset:24576
  ds_read_b128 v[16:19], v2 offset:16384
  ds_read_b128 v[20:23], v2 offset:23552
  ds_read_b128 v[24:27], v2 offset:22528
  s_waitcnt lgkmcnt(3)
  v_mfma_f32_32x32x16_bf16 v[44:59], v[12:15], v[8:11], 0
  s_waitcnt lgkmcnt(2)
  v_mfma_f32_32x32x16_bf16 v[60:75], v[16:19], v[8:11], 0
  s_waitcnt lgkmcnt(1)
  v_mfma_f32_32x32x16_bf16 v[76:91], v[20:23], v[8:11], 0
  ds_read_b128 v[12:15], v2 offset:21504
  ds_read_b128 v[16:19], v2 offset:20480
  s_waitcnt lgkmcnt(2)
  v_mfma_f32_32x32x16_bf16 v[92:107], v[24:27], v[8:11], 0
  ds_read_b128 v[20:23], v2 offset:19456
  ds_read_b128 v[24:27], v2 offset:18432
  s_nop 3
  v_cndmask_b32 v44, v44, v60, s[44:45]
  v_cndmask_b32 v45, v45, v61, s[46:47]
  v_cndmask_b32 v46, v46, v62, s[48:49]
  v_cndmask_b32 v47, v47, v63, s[50:51]
  v_cndmask_b32 v48, v48, v64, s[52:53]
  v_cndmask_b32 v49, v49, v65, s[54:55]
  v_cndmask_b32 v50, v50, v66, s[56:57]
  v_cndmask_b32 v51, v51, v67, s[58:59]
  v_cndmask_b32 v52, v52, v68, s[60:61]
  v_cndmask_b32 v53, v53, v69, s[62:63]
  v_cndmask_b32 v54, v54, v70, s[64:65]
  v_cndmask_b32 v55, v55, v71, s[66:67]
  v_cndmask_b32 v56, v56, v72, s[68:69]
  v_cndmask_b32 v57, v57, v73, s[70:71]
  v_cndmask_b32 v58, v58, v74, s[72:73]
  v_cndmask_b32 v59, v59, v75, s[74:75]
  s_waitcnt lgkmcnt(3)
  v_mfma_f32_32x32x16_bf16 v[108:123], v[12:15], v[8:11], 0
  ds_read_b128 v[12:15], v2 offset:17408
  v_max3_f32 v156, v44, v45, v46
  v_max3_f32 v157, v47, v48, v49
  v_max3_f32 v156, v50, v51, v156
  v_max3_f32 v157, v52, v53, v157
  v_max3_f32 v156, v54, v55, v156
  v_max3_f32 v157, v56, v57, v157
  v_max3_f32 v156, v58, v59, v156
  s_waitcnt lgkmcnt(3)
  v_mfma_f32_32x32x16_bf16 v[60:75], v[16:19], v[8:11], 0
  v_max3_f32 v156, v76, v77, v156
  v_max3_f32 v157, v78, v79, v157
  v_max3_f32 v156, v80, v81, v156
  v_max3_f32 v157, v82, v83, v157
  v_max3_f32 v156, v84, v85, v156
  v_max3_f32 v157, v86, v87, v157
  v_max3_f32 v156, v88, v89, v156
  v_max3_f32 v157, v90, v91, v157
  s_waitcnt lgkmcnt(2)
  v_mfma_f32_32x32x16_bf16 v[44:59], v[20:23], v[8:11], 0
  v_max3_f32 v156, v92, v93, v156
  v_max3_f32 v157, v94, v95, v157
  v_max3_f32 v156, v96, v97, v156
  v_max3_f32 v157, v98, v99, v157
  v_max3_f32 v156, v100, v101, v156
  v_max3_f32 v157, v102, v103, v157
  v_max3_f32 v156, v104, v105, v156
  v_max3_f32 v157, v106, v107, v157
  s_waitcnt lgkmcnt(1)
  v_mfma_f32_32x32x16_bf16 v[76:91], v[24:27], v[8:11], 0
  v_max3_f32 v156, v108, v109, v156
  v_max3_f32 v157, v110, v111, v157
  v_max3_f32 v156, v112, v113, v156
  v_max3_f32 v157, v114, v115, v157
  v_max3_f32 v156, v116, v117, v156
  v_max3_f32 v157, v118, v119, v157
  v_max3_f32 v156, v120, v121, v156
  v_max3_f32 v157, v122, v123, v157
  s_waitcnt lgkmcnt(0)
  v_mfma_f32_32x32x16_bf16 v[92:107], v[12:15], v[8:11], 0
  v_max3_f32 v156, v60, v61, v156
  v_max3_f32 v157, v62, v63, v157
  v_max3_f32 v156, v64, v65, v156
  v_max3_f32 v157, v66, v67, v157
  v_max3_f32 v156, v68, v69, v156
  v_max3_f32 v157, v70, v71, v157
  v_max3_f32 v156, v72, v73, v156
  v_max3_f32 v157, v74, v75, v157
  v_max3_f32 v156, v44, v45, v156
  v_max3_f32 v157, v46, v47, v157
  v_max3_f32 v156, v48, v49, v156
  v_max3_f32 v157, v50, v51, v157
  v_max3_f32 v156, v52, v53, v156
  v_max3_f32 v157, v54, v55, v157
  v_max3_f32 v156, v56, v57, v156
  v_max3_f32 v157, v58, v59, v157
  v_max3_f32 v156, v76, v77, v156
  v_max3_f32 v157, v78, v79, v157
  v_max3_f32 v156, v80, v81, v156
  v_max3_f32 v157, v82, v83, v157
  v_max3_f32 v156, v84, v85, v156
  v_max3_f32 v157, v86, v87, v157
  v_max3_f32 v156, v88, v89, v156
  v_max3_f32 v157, v90, v91, v157
  v_max3_f32 v156, v92, v93, v156
  v_max3_f32 v157, v94, v95, v157
  v_max3_f32 v156, v96, v97, v156
  v_max3_f32 v157, v98, v99, v157
  v_max3_f32 v156, v100, v101, v156
  v_max3_f32 v157, v102, v103, v157
  v_max3_f32 v156, v104, v105, v156
  v_max3_f32 v157, v106, v107, v157
  ds_read_b128 v[12:15], v2 offset:24576
  ds_read_b128 v[16:19], v2 offset:16384
  ds_read_b128 v[20:23], v2 offset:23552
  v_max_f32 v156, v156, v157
  v_mov_b32 v157, v156
  s_nop 1
  v_permlane32_swap_b32 v156, v157
  v_max_f32 v156, v156, v157
  v_sub_f32 v92, 0, v156
  v_sub_f32 v93, 0, v156
  v_sub_f32 v94, 0, v156
  v_sub_f32 v95, 0, v156
  v_sub_f32 v96, 0, v156
  v_sub_f32 v97, 0, v156
  v_sub_f32 v98, 0, v156
  v_sub_f32 v99, 0, v156
  v_sub_f32 v100, 0, v156
  v_sub_f32 v101, 0, v156
  v_sub_f32 v102, 0, v156
  v_sub_f32 v103, 0, v156
  v_sub_f32 v104, 0, v156
  v_sub_f32 v105, 0, v156
  v_sub_f32 v106, 0, v156
  v_sub_f32 v107, 0, v156
  s_waitcnt lgkmcnt(2)
  s_nop 0
  v_mfma_f32_32x32x16_bf16 v[44:59], v[12:15], v[8:11], v[92:107]
  s_waitcnt lgkmcnt(1)
  v_mfma_f32_32x32x16_bf16 v[60:75], v[16:19], v[8:11], v[92:107]
  s_waitcnt lgkmcnt(0)
  v_mfma_f32_32x32x16_bf16 v[76:91], v[20:23], v[8:11], v[92:107]
  ds_read_b128 v[24:27], v2 offset:22528
  s_mov_b64 exec, s[78:79]
  ds_read_b128 v[28:31], v3 offset:24576
  ds_read_b128 v[32:35], v3 offset:25088
  s_mov_b64 exec, -1
  s_mov_b64 exec, s[78:79]
  ds_read_b128 v[36:39], v3 offset:16384
  ds_read_b128 v[40:43], v3 offset:16896
  s_mov_b64 exec, -1
  s_nop 0
  v_cndmask_b32 v44, v44, v60, s[44:45]
  v_cndmask_b32 v45, v45, v61, s[46:47]
  v_cndmask_b32 v46, v46, v62, s[48:49]
  v_cndmask_b32 v47, v47, v63, s[50:51]
  v_cndmask_b32 v48, v48, v64, s[52:53]
  v_cndmask_b32 v49, v49, v65, s[54:55]
  v_cndmask_b32 v50, v50, v66, s[56:57]
  v_cndmask_b32 v51, v51, v67, s[58:59]
  v_cndmask_b32 v52, v52, v68, s[60:61]
  v_cndmask_b32 v53, v53, v69, s[62:63]
  v_cndmask_b32 v54, v54, v70, s[64:65]
  v_cndmask_b32 v55, v55, v71, s[66:67]
  v_cndmask_b32 v56, v56, v72, s[68:69]
  v_cndmask_b32 v57, v57, v73, s[70:71]
  v_cndmask_b32 v58, v58, v74, s[72:73]
  v_cndmask_b32 v59, v59, v75, s[74:75]
  ds_read_b128 v[12:15], v2 offset:21504
  s_waitcnt lgkmcnt(5)
  v_mfma_f32_32x32x16_bf16 v[60:75], v[24:27], v[8:11], v[92:107]
  v_exp_f32 v44, v44
  v_exp_f32 v45, v45
  v_exp_f32 v46, v46
  v_exp_f32 v47, v47
  v_cvt_pk_bf16_f32 v124, v44, v45
  v_exp_f32 v48, v48
  v_exp_f32 v49, v49
  v_cvt_pk_bf16_f32 v125, v46, v47
  v_exp_f32 v50, v50
  v_exp_f32 v51, v51
  v_cvt_pk_bf16_f32 v126, v48, v49
  v_exp_f32 v52, v52
  v_exp_f32 v53, v53
  v_cvt_pk_bf16_f32 v127, v50, v51
  v_exp_f32 v54, v54
  v_exp_f32 v55, v55
  v_cvt_pk_bf16_f32 v128, v52, v53
  v_exp_f32 v56, v56
  v_exp_f32 v57, v57
  v_cvt_pk_bf16_f32 v129, v54, v55
  v_exp_f32 v58, v58
  v_exp_f32 v59, v59
  v_cvt_pk_bf16_f32 v130, v56, v57
  v_cvt_pk_bf16_f32 v131, v58, v59
  v_and_b32 v140, v124, v148
  v_xor_b32 v124, v124, v140
  v_and_b32 v141, v125, v149
  v_xor_b32 v125, v125, v141
  v_and_b32 v142, v126, v150
  v_xor_b32 v126, v126, v142
  v_and_b32 v143, v127, v151
  v_xor_b32 v127, v127, v143
  v_and_b32 v144, v128, v152
  v_xor_b32 v128, v128, v144
  v_and_b32 v145, v129, v153
  v_xor_b32 v129, v129, v145
  v_and_b32 v146, v130, v154
  v_xor_b32 v130, v130, v146
  v_and_b32 v147, v131, v155
  v_xor_b32 v131, v131, v147
  ds_read_b128 v[16:19], v2 offset:20480
  s_waitcnt lgkmcnt(1)
  v_mfma_f32_32x32x16_bf16 v[44:59], v[12:15], v[8:11], v[92:107]
  v_exp_f32 v76, v76
  v_exp_f32 v77, v77
  v_mfma_f32_32x32x16_bf16 v[108:123], v[28:31], v[124:127], 0
  v_exp_f32 v78, v78
  v_exp_f32 v79, v79
  v_cvt_pk_bf16_f32 v132, v76, v77
  v_exp_f32 v80, v80
  v_exp_f32 v81, v81
  v_cvt_pk_bf16_f32 v133, v78, v79
  v_mfma_f32_32x32x16_bf16 v[108:123], v[32:35], v[128:131], v[108:123]
  v_exp_f32 v82, v82
  v_exp_f32 v83, v83
  v_cvt_pk_bf16_f32 v134, v80, v81
  v_exp_f32 v84, v84
  v_exp_f32 v85, v85
  v_cvt_pk_bf16_f32 v135, v82, v83
  v_mfma_f32_32x32x16_bf16 v[108:123], v[36:39], v[140:143], v[108:123]
  v_exp_f32 v86, v86
  v_exp_f32 v87, v87
  v_cvt_pk_bf16_f32 v136, v84, v85
  v_exp_f32 v88, v88
  v_exp_f32 v89, v89
  v_cvt_pk_bf16_f32 v137, v86, v87
  v_mfma_f32_32x32x16_bf16 v[108:123], v[40:43], v[144:147], v[108:123]
  v_exp_f32 v90, v90
  s_mov_b64 exec, s[78:79]
  ds_read_b128 v[28:31], v3 offset:23552
  ds_read_b128 v[32:35], v3 offset:24064
  s_mov_b64 exec, -1
  s_mov_b64 exec, s[78:79]
  ds_read_b128 v[36:39], v3 offset:22528
  ds_read_b128 v[40:43], v3 offset:23040
  s_mov_b64 exec, -1
  v_exp_f32 v91, v91
  v_cvt_pk_bf16_f32 v138, v88, v89
  v_cvt_pk_bf16_f32 v139, v90, v91
  ds_read_b128 v[20:23], v2 offset:19456
  s_waitcnt lgkmcnt(5)
  v_mfma_f32_32x32x16_bf16 v[76:91], v[16:19], v[8:11], v[92:107]
  v_exp_f32 v60, v60
  v_exp_f32 v61, v61
  v_exp_f32 v62, v62
  v_exp_f32 v63, v63
  v_cvt_pk_bf16_f32 v124, v60, v61
  v_exp_f32 v64, v64
  s_waitcnt lgkmcnt(4)
  v_mfma_f32_32x32x16_bf16 v[108:123], v[28:31], v[132:135], v[108:123]
  v_exp_f32 v65, v65
  v_cvt_pk_bf16_f32 v125, v62, v63
  v_exp_f32 v66, v66
  v_exp_f32 v67, v67
  v_cvt_pk_bf16_f32 v126, v64, v65
  v_exp_f32 v68, v68
  v_exp_f32 v69, v69
  v_cvt_pk_bf16_f32 v127, v66, v67
  v_exp_f32 v70, v70
  s_waitcnt lgkmcnt(3)
  v_mfma_f32_32x32x16_bf16 v[108:123], v[32:35], v[136:139], v[108:123]
  v_exp_f32 v71, v71
  v_cvt_pk_bf16_f32 v128, v68, v69
  s_mov_b64 exec, s[78:79]
  ds_read_b128 v[28:31], v3 offset:21504
  ds_read_b128 v[32:35], v3 offset:22016
  s_mov_b64 exec, -1
  v_exp_f32 v72, v72
  v_exp_f32 v73, v73
  v_cvt_pk_bf16_f32 v129, v70, v71
  v_exp_f32 v74, v74
  v_exp_f32 v75, v75
  v_cvt_pk_bf16_f32 v130, v72, v73
  v_cvt_pk_bf16_f32 v131, v74, v75
  ds_read_b128 v[24:27], v2 offset:18432
  s_waitcnt lgkmcnt(3)
  v_mfma_f32_32x32x16_bf16 v[60:75], v[20:23], v[8:11], v[92:107]
  v_exp_f32 v44, v44
  v_exp_f32 v45, v45
  v_exp_f32 v46, v46
  v_exp_f32 v47, v47
  v_cvt_pk_bf16_f32 v132, v44, v45
  v_exp_f32 v48, v48
  v_mfma_f32_32x32x16_bf16 v[108:123], v[36:39], v[124:127], v[108:123]
  v_exp_f32 v49, v49
  v_cvt_pk_bf16_f32 v133, v46, v47
  v_exp_f32 v50, v50
  v_exp_f32 v51, v51
  v_cvt_pk_bf16_f32 v134, v48, v49
  v_exp_f32 v52, v52
  v_exp_f32 v53, v53
  v_cvt_pk_bf16_f32 v135, v50, v51
  v_exp_f32 v54, v54
  v_mfma_f32_32x32x16_bf16 v[108:123], v[40:43], v[128:131], v[108:123]
  v_exp_f32 v55, v55
  v_cvt_pk_bf16_f32 v136, v52, v53
  s_mov_b64 exec, s[78:79]
  ds_read_b128 v[36:39], v3 offset:20480
  ds_read_b128 v[40:43], v3 offset:20992
  s_mov_b64 exec, -1
  v_exp_f32 v56, v56
  v_exp_f32 v57, v57
  v_cvt_pk_bf16_f32 v137, v54, v55
  v_exp_f32 v58, v58
  v_exp_f32 v59, v59
  v_cvt_pk_bf16_f32 v138, v56, v57
  v_cvt_pk_bf16_f32 v139, v58, v59
  ds_read_b128 v[12:15], v2 offset:17408
  s_waitcnt lgkmcnt(3)
  v_mfma_f32_32x32x16_bf16 v[44:59], v[24:27], v[8:11], v[92:107]
  v_exp_f32 v76, v76
  v_exp_f32 v77, v77
  v_exp_f32 v78, v78
  v_exp_f32 v79, v79
  v_cvt_pk_bf16_f32 v124, v76, v77
  v_exp_f32 v80, v80
  v_mfma_f32_32x32x16_bf16 v[108:123], v[28:31], v[132:135], v[108:123]
  v_exp_f32 v81, v81
  v_cvt_pk_bf16_f32 v125, v78, v79
  v_exp_f32 v82, v82
  v_exp_f32 v83, v83
  v_cvt_pk_bf16_f32 v126, v80, v81
  v_exp_f32 v84, v84
  v_exp_f32 v85, v85
  v_cvt_pk_bf16_f32 v127, v82, v83
  v_exp_f32 v86, v86
  v_mfma_f32_32x32x16_bf16 v[108:123], v[32:35], v[136:139], v[108:123]
  v_exp_f32 v87, v87
  v_cvt_pk_bf16_f32 v128, v84, v85
  s_mov_b64 exec, s[78:79]
  ds_read_b128 v[28:31], v3 offset:19456
  ds_read_b128 v[32:35], v3 offset:19968
  s_mov_b64 exec, -1
  v_exp_f32 v88, v88
  v_exp_f32 v89, v89
  v_cvt_pk_bf16_f32 v129, v86, v87
  v_exp_f32 v90, v90
  v_exp_f32 v91, v91
  v_cvt_pk_bf16_f32 v130, v88, v89
  v_cvt_pk_bf16_f32 v131, v90, v91
  s_waitcnt lgkmcnt(2)
  v_mfma_f32_32x32x16_bf16 v[76:91], v[12:15], v[8:11], v[92:107]
  v_exp_f32 v60, v60
  v_exp_f32 v61, v61
  v_exp_f32 v62, v62
  v_exp_f32 v63, v63
  v_cvt_pk_bf16_f32 v132, v60, v61
  v_exp_f32 v64, v64
  v_mfma_f32_32x32x16_bf16 v[108:123], v[36:39], v[124:127], v[108:123]
  v_exp_f32 v65, v65
  v_cvt_pk_bf16_f32 v133, v62, v63
  v_exp_f32 v66, v66
  v_exp_f32 v67, v67
  v_cvt_pk_bf16_f32 v134, v64, v65
  v_exp_f32 v68, v68
  v_exp_f32 v69, v69
  v_cvt_pk_bf16_f32 v135, v66, v67
  v_exp_f32 v70, v70
  v_mfma_f32_32x32x16_bf16 v[108:123], v[40:43], v[128:131], v[108:123]
  v_exp_f32 v71, v71
  v_cvt_pk_bf16_f32 v136, v68, v69
  s_mov_b64 exec, s[78:79]
  ds_read_b128 v[36:39], v3 offset:18432
  ds_read_b128 v[40:43], v3 offset:18944
  s_mov_b64 exec, -1
  v_exp_f32 v72, v72
  v_exp_f32 v73, v73
  v_cvt_pk_bf16_f32 v137, v70, v71
  v_exp_f32 v74, v74
  v_exp_f32 v75, v75
  v_cvt_pk_bf16_f32 v138, v72, v73
  v_cvt_pk_bf16_f32 v139, v74, v75
  v_exp_f32 v44, v44
  v_exp_f32 v45, v45
  v_exp_f32 v46, v46
  v_exp_f32 v47, v47
  v_cvt_pk_bf16_f32 v124, v44, v45
  v_exp_f32 v48, v48
  s_waitcnt lgkmcnt(3)
  v_mfma_f32_32x32x16_bf16 v[108:123], v[28:31], v[132:135], v[108:123]
  v_exp_f32 v49, v49
  v_cvt_pk_bf16_f32 v125, v46, v47
  v_exp_f32 v50, v50
  v_exp_f32 v51, v51
  v_cvt_pk_bf16_f32 v126, v48, v49
  v_exp_f32 v52, v52
  v_exp_f32 v53, v53
  v_cvt_pk_bf16_f32 v127, v50, v51
  v_exp_f32 v54, v54
  s_waitcnt lgkmcnt(2)
  v_mfma_f32_32x32x16_bf16 v[108:123], v[32:35], v[136:139], v[108:123]
  v_exp_f32 v55, v55
  v_cvt_pk_bf16_f32 v128, v52, v53
  s_mov_b64 exec, s[78:79]
  ds_read_b128 v[28:31], v3 offset:17408
  ds_read_b128 v[32:35], v3 offset:17920
  s_mov_b64 exec, -1
  v_exp_f32 v56, v56
  v_exp_f32 v57, v57
  v_cvt_pk_bf16_f32 v129, v54, v55
  v_exp_f32 v58, v58
  v_exp_f32 v59, v59
  v_cvt_pk_bf16_f32 v130, v56, v57
  v_cvt_pk_bf16_f32 v131, v58, v59
  v_exp_f32 v76, v76
  v_exp_f32 v77, v77
  v_exp_f32 v78, v78
  v_exp_f32 v79, v79
  v_cvt_pk_bf16_f32 v132, v76, v77
  v_exp_f32 v80, v80
  s_waitcnt lgkmcnt(3)
  v_mfma_f32_32x32x16_bf16 v[108:123], v[36:39], v[124:127], v[108:123]
  v_exp_f32 v81, v81
  v_cvt_pk_bf16_f32 v133, v78, v79
  v_exp_f32 v82, v82
  v_exp_f32 v83, v83
  v_cvt_pk_bf16_f32 v134, v80, v81
  v_exp_f32 v84, v84
  v_exp_f32 v85, v85
  v_cvt_pk_bf16_f32 v135, v82, v83
  v_exp_f32 v86, v86
  s_waitcnt lgkmcnt(2)
  v_mfma_f32_32x32x16_bf16 v[108:123], v[40:43], v[128:131], v[108:123]
  v_exp_f32 v87, v87
  v_cvt_pk_bf16_f32 v136, v84, v85
  v_exp_f32 v88, v88
  v_exp_f32 v89, v89
  v_cvt_pk_bf16_f32 v137, v86, v87
  v_exp_f32 v90, v90
  v_exp_f32 v91, v91
  v_cvt_pk_bf16_f32 v138, v88, v89
  v_cvt_pk_bf16_f32 v139, v90, v91
  s_waitcnt lgkmcnt(1)
  v_mfma_f32_32x32x16_bf16 v[108:123], v[28:31], v[132:135], v[108:123]
  s_waitcnt lgkmcnt(0)
  v_mfma_f32_32x32x16_bf16 v[108:123], v[32:35], v[136:139], v[108:123]
  s_nop 11
  v_rcp_f32 v156, v116
  s_nop 0
  v_mul_f32 v108, v108, v156
  v_mul_f32 v109, v109, v156
  v_mul_f32 v110, v110, v156
  v_mul_f32 v111, v111, v156
  v_mul_f32 v112, v112, v156
  v_mul_f32 v113, v113, v156
  v_mul_f32 v114, v114, v156
  v_mul_f32 v115, v115, v156
  v_cvt_pk_bf16_f32 v144, v108, v109
  v_cvt_pk_bf16_f32 v145, v110, v111
  v_cvt_pk_bf16_f32 v146, v112, v113
  v_cvt_pk_bf16_f32 v147, v114, v115
  buffer_store_dwordx4 v[144:147], v1, s[36:39], s40 offen offset:1024 sc1
  s_branch gm_AC_fin
gm_AC_gen:
  s_waitcnt lgkmcnt(0)
  s_nop 10
  ds_read_b128 v[12:15], v2 offset:8192
  ds_read_b128 v[16:19], v2 offset:0
  ds_read_b128 v[20:23], v2 offset:7168
  ds_read_b128 v[24:27], v2 offset:6144
  s_waitcnt lgkmcnt(3)
  v_mfma_f32_32x32x16_bf16 v[44:59], v[12:15], v[4:7], 0
  s_waitcnt lgkmcnt(2)
  v_mfma_f32_32x32x16_bf16 v[60:75], v[16:19], v[4:7], 0
  s_waitcnt lgkmcnt(1)
  v_mfma_f32_32x32x16_bf16 v[76:91], v[20:23], v[4:7], 0
  ds_read_b128 v[12:15], v2 offset:5120
  ds_read_b128 v[16:19], v2 offset:4096
  s_waitcnt lgkmcnt(2)
  v_mfma_f32_32x32x16_bf16 v[92:107], v[24:27], v[4:7], 0
  ds_read_b128 v[20:23], v2 offset:3072
  ds_read_b128 v[24:27], v2 offset:2048
  s_nop 1
  v_cndmask_b32 v44, v44, v158, s[44:45]
  v_cndmask_b32 v45, v45, v158, s[46:47]
  v_cndmask_b32 v46, v46, v158, s[48:49]
  v_cndmask_b32 v47, v47, v158, s[50:51]
  v_cndmask_b32 v48, v48, v158, s[52:53]
  v_cndmask_b32 v49, v49, v158, s[54:55]
  v_cndmask_b32 v50, v50, v158, s[56:57]
  v_cndmask_b32 v51, v51, v158, s[58:59]
  v_cndmask_b32 v52, v52, v158, s[60:61]
  v_cndmask_b32 v53, v53, v158, s[62:63]
  v_cndmask_b32 v54, v54, v158, s[64:65]
  v_cndmask_b32 v55, v55, v158, s[66:67]
  v_cndmask_b32 v56, v56, v158, s[68:69]
  v_cndmask_b32 v57, v57, v158, s[70:71]
  v_cndmask_b32 v58, v58, v158, s[72:73]
  v_cndmask_b32 v59, v59, v158, s[74:75]
  s_waitcnt lgkmcnt(3)
  v_mfma_f32_32x32x16_bf16 v[108:123], v[12:15], v[4:7], 0
  ds_read_b128 v[12:15], v2 offset:1024
  v_max3_f32 v156, v44, v45, v46
  v_max3_f32 v157, v47, v48, v49
  v_max3_f32 v156, v50, v51, v156
  v_max3_f32 v157, v52, v53, v157
  v_max3_f32 v156, v54, v55, v156
  v_max3_f32 v157, v56, v57, v157
  v_max3_f32 v156, v58, v59, v156
  s_cmp_gt_i32 s41, 7
  s_cbranch_scc1 gm_AC_g0_p1done
  s_waitcnt lgkmcnt(3)
  v_mfma_f32_32x32x16_bf16 v[60:75], v[16:19], v[4:7], 0
  v_max3_f32 v156, v76, v77, v156
  v_max3_f32 v157, v78, v79, v157
  v_max3_f32 v156, v80, v81, v156
  v_max3_f32 v157, v82, v83, v157
  v_max3_f32 v156, v84, v85, v156
  v_max3_f32 v157, v86, v87, v157
  v_max3_f32 v156, v88, v89, v156
  v_max3_f32 v157, v90, v91, v157
  s_cmp_gt_i32 s41, 6
  s_cbranch_scc1 gm_AC_g0_p1done
  s_waitcnt lgkmcnt(2)
  v_mfma_f32_32x32x16_bf16 v[44:59], v[20:23], v[4:7], 0
  v_max3_f32 v156, v92, v93, v156
  v_max3_f32 v157, v94, v95, v157
  v_max3_f32 v156, v96, v97, v156
  v_max3_f32 v157, v98, v99, v157
  v_max3_f32 v156, v100, v101, v156
  v_max3_f32 v157, v102, v103, v157
  v_max3_f32 v156, v104, v105, v156
  v_max3_f32 v157, v106, v107, v157
  s_cmp_gt_i32 s41, 5
  s_cbranch_scc1 gm_AC_g0_p1done
  s_waitcnt lgkmcnt(1)
  v_mfma_f32_32x32x16_bf16 v[76:91], v[24:27], v[4:7], 0
  v_max3_f32 v156, v108, v109, v156
  v_max3_f32 v157, v110, v111, v157
  v_max3_f32 v156, v112, v113, v156
  v_max3_f32 v157, v114, v115, v157
  v_max3_f32 v156, v116, v117, v156
  v_max3_f32 v157, v118, v119, v157
  v_max3_f32 v156, v120, v121, v156
  v_max3_f32 v157, v122, v123, v157
  s_cmp_gt_i32 s41, 4
  s_cbranch_scc1 gm_AC_g0_p1done
  s_waitcnt lgkmcnt(0)
  v_mfma_f32_32x32x16_bf16 v[92:107], v[12:15], v[4:7], 0
  v_max3_f32 v156, v60, v61, v156
  v_max3_f32 v157, v62, v63, v157
  v_max3_f32 v156, v64, v65, v156
  v_max3_f32 v157, v66, v67, v157
  v_max3_f32 v156, v68, v69, v156
  v_max3_f32 v157, v70, v71, v157
  v_max3_f32 v156, v72, v73, v156
  v_max3_f32 v157, v74, v75, v157
  s_cmp_gt_i32 s41, 3
  s_cbranch_scc1 gm_AC_g0_p1done
  v_max3_f32 v156, v44, v45, v156
  v_max3_f32 v157, v46, v47, v157
  v_max3_f32 v156, v48, v49, v156
  v_max3_f32 v157, v50, v51, v157
  v_max3_f32 v156, v52, v53, v156
  v_max3_f32 v157, v54, v55, v157
  v_max3_f32 v156, v56, v57, v156
  v_max3_f32 v157, v58, v59, v157
  s_cmp_gt_i32 s41, 2
  s_cbranch_scc1 gm_AC_g0_p1done
  v_max3_f32 v156, v76, v77, v156
  v_max3_f32 v157, v78, v79, v157
  v_max3_f32 v156, v80, v81, v156
  v_max3_f32 v157, v82, v83, v157
  v_max3_f32 v156, v84, v85, v156
  v_max3_f32 v157, v86, v87, v157
  v_max3_f32 v156, v88, v89, v156
  v_max3_f32 v157, v90, v91, v157
  s_cmp_gt_i32 s41, 1
  s_cbranch_scc1 gm_AC_g0_p1done
  v_max3_f32 v156, v92, v93, v156
  v_max3_f32 v157, v94, v95, v157
  v_max3_f32 v156, v96, v97, v156
  v_max3_f32 v157, v98, v99, v157
  v_max3_f32 v156, v100, v101, v156
  v_max3_f32 v157, v102, v103, v157
  v_max3_f32 v156, v104, v105, v156
  v_max3_f32 v157, v106, v107, v157
gm_AC_g0_p1done:
  s_waitcnt lgkmcnt(0)
  s_nop 10
  ds_read_b128 v[12:15], v2 offset:8192
  ds_read_b128 v[16:19], v2 offset:0
  ds_read_b128 v[20:23], v2 offset:7168
  v_max_f32 v156, v156, v157
  v_mov_b32 v157, v156
  s_nop 1
  v_permlane32_swap_b32 v156, v157
  v_max_f32 v156, v156, v157
  v_sub_f32 v92, 0, v156
  v_sub_f32 v93, 0, v156
  v_sub_f32 v94, 0, v156
  v_sub_f32 v95, 0, v156
  v_sub_f32 v96, 0, v156
  v_sub_f32 v97, 0, v156
  v_sub_f32 v98, 0, v156
  v_sub_f32 v99, 0, v156
  v_sub_f32 v100, 0, v156
  v_sub_f32 v101, 0, v156
  v_sub_f32 v102, 0, v156
  v_sub_f32 v103, 0, v156
  v_sub_f32 v104, 0, v156
  v_sub_f32 v105, 0, v156
  v_sub_f32 v106, 0, v156
  v_sub_f32 v107, 0, v156
  s_waitcnt lgkmcnt(2)
  s_nop 0
  v_mfma_f32_32x32x16_bf16 v[44:59], v[12:15], v[4:7], v[92:107]
  s_waitcnt lgkmcnt(0)
  v_mfma_f32_32x32x16_bf16 v[76:91], v[20:23], v[4:7], v[92:107]
  ds_read_b128 v[24:27], v2 offset:6144
  s_mov_b64 exec, s[78:79]
  ds_read_b128 v[28:31], v3 offset:8192
  ds_read_b128 v[32:35], v3 offset:8704
  s_mov_b64 exec, -1
  ds_read_b128 v[12:15], v2 offset:5120
  s_waitcnt lgkmcnt(3)
  v_mfma_f32_32x32x16_bf16 v[60:75], v[24:27], v[4:7], v[92:107]
  s_nop 1
  v_exp_f32 v44, v44
  v_exp_f32 v45, v45
  v_exp_f32 v46, v46
  v_exp_f32 v47, v47
  v_cvt_pk_bf16_f32 v124, v44, v45
  v_exp_f32 v48, v48
  v_exp_f32 v49, v49
  v_cvt_pk_bf16_f32 v125, v46, v47
  v_exp_f32 v50, v50
  v_exp_f32 v51, v51
  v_cvt_pk_bf16_f32 v126, v48, v49
  v_exp_f32 v52, v52
  v_exp_f32 v53, v53
  v_cvt_pk_bf16_f32 v127, v50, v51
  v_exp_f32 v54, v54
  v_exp_f32 v55, v55
  v_cvt_pk_bf16_f32 v128, v52, v53
  v_exp_f32 v56, v56
  v_exp_f32 v57, v57
  v_cvt_pk_bf16_f32 v129, v54, v55
  v_exp_f32 v58, v58
  v_exp_f32 v59, v59
  v_cvt_pk_bf16_f32 v130, v56, v57
  v_cvt_pk_bf16_f32 v131, v58, v59
  v_and_b32 v140, v124, v148
  v_xor_b32 v124, v124, v140
  v_and_b32 v141, v125, v149
  v_xor_b32 v125, v125, v141
  v_and_b32 v142, v126, v150
  v_xor_b32 v126, v126, v142
  v_and_b32 v143, v127, v151
  v_xor_b32 v127, v127, v143
  v_and_b32 v144, v128, v152
  v_xor_b32 v128, v128, v144
  v_and_b32 v145, v129, v153
  v_xor_b32 v129, v129, v145
  v_and_b32 v146, v130, v154
  v_xor_b32 v130, v130, v146
  v_and_b32 v147, v131, v155
  v_xor_b32 v131, v131, v147
  s_waitcnt lgkmcnt(2)
  v_mfma_f32_32x32x16_bf16 v[108:123], v[28:31], v[124:127], 0
  s_waitcnt lgkmcnt(1)
  v_mfma_f32_32x32x16_bf16 v[108:123], v[32:35], v[128:131], v[108:123]
  s_mov_b64 exec, s[78:79]
  ds_read_b128 v[28:31], v3 offset:7168
  ds_read_b128 v[32:35], v3 offset:7680
  s_mov_b64 exec, -1
  s_mov_b64 exec, s[78:79]
  ds_read_b128 v[36:39], v3 offset:6144
  ds_read_b128 v[40:43], v3 offset:6656
  s_mov_b64 exec, -1
  s_cmp_gt_i32 s41, 7
  s_cbranch_scc1 gm_AC_g0_p2done
  ds_read_b128 v[16:19], v2 offset:4096
  s_waitcnt lgkmcnt(5)
  v_mfma_f32_32x32x16_bf16 v[44:59], v[12:15], v[4:7], v[92:107]
  v_exp_f32 v76, v76
  v_exp_f32 v77, v77
  v_exp_f32 v78, v78
  v_exp_f32 v79, v79
  v_cvt_pk_bf16_f32 v124, v76, v77
  v_exp_f32 v80, v80
  v_exp_f32 v81, v81
  v_cvt_pk_bf16_f32 v125, v78, v79
  v_exp_f32 v82, v82
  v_exp_f32 v83, v83
  v_cvt_pk_bf16_f32 v126, v80, v81
  v_exp_f32 v84, v84
  v_exp_f32 v85, v85
  v_cvt_pk_bf16_f32 v127, v82, v83
  v_exp_f32 v86, v86
  v_exp_f32 v87, v87
  v_cvt_pk_bf16_f32 v128, v84, v85
  v_exp_f32 v88, v88
  v_exp_f32 v89, v89
  v_cvt_pk_bf16_f32 v129, v86, v87
  v_exp_f32 v90, v90
  v_exp_f32 v91, v91
  v_cvt_pk_bf16_f32 v130, v88, v89
  v_cvt_pk_bf16_f32 v131, v90, v91
  s_waitcnt lgkmcnt(4)
  v_mfma_f32_32x32x16_bf16 v[108:123], v[28:31], v[124:127], v[108:123]
  s_waitcnt lgkmcnt(3)
  v_mfma_f32_32x32x16_bf16 v[108:123], v[32:35], v[128:131], v[108:123]
  s_mov_b64 exec, s[78:79]
  ds_read_b128 v[28:31], v3 offset:5120
  ds_read_b128 v[32:35], v3 offset:5632
  s_mov_b64 exec, -1
  s_cmp_gt_i32 s41, 6
  s_cbranch_scc1 gm_AC_g0_p2done
  ds_read_b128 v[20:23], v2 offset:3072
  s_waitcnt lgkmcnt(3)
  v_mfma_f32_32x32x16_bf16 v[76:91], v[16:19], v[4:7], v[92:107]
  v_exp_f32 v60, v60
  v_exp_f32 v61, v61
  v_exp_f32 v62, v62
  v_exp_f32 v63, v63
  v_cvt_pk_bf16_f32 v132, v60, v61
  v_exp_f32 v64, v64
  v_exp_f32 v65, v65
  v_cvt_pk_bf16_f32 v133, v62, v63
  v_exp_f32 v66, v66
  v_exp_f32 v67, v67
  v_cvt_pk_bf16_f32 v134, v64, v65
  v_exp_f32 v68, v68
  v_exp_f32 v69, v69
  v_cvt_pk_bf16_f32 v135, v66, v67
  v_exp_f32 v70, v70
  v_exp_f32 v71, v71
  v_cvt_pk_bf16_f32 v136, v68, v69
  v_exp_f32 v72, v72
  v_exp_f32 v73, v73
  v_cvt_pk_bf16_f32 v137, v70, v71
  v_exp_f32 v74, v74
  v_exp_f32 v75, v75
  v_cvt_pk_bf16_f32 v138, v72, v73
  v_cvt_pk_bf16_f32 v139, v74, v75
  v_mfma_f32_32x32x16_bf16 v[108:123], v[36:39], v[132:135], v[108:123]
  s_nop 0
  v_mfma_f32_32x32x16_bf16 v[108:123], v[40:43], v[136:139], v[108:123]
  s_mov_b64 exec, s[78:79]
  ds_read_b128 v[36:39], v3 offset:4096
  ds_read_b128 v[40:43], v3 offset:4608
  s_mov_b64 exec, -1
  s_cmp_gt_i32 s41, 5
  s_cbranch_scc1 gm_AC_g0_p2done
  ds_read_b128 v[24:27], v2 offset:2048
  s_waitcnt lgkmcnt(3)
  v_mfma_f32_32x32x16_bf16 v[60:75], v[20:23], v[4:7], v[92:107]
  v_exp_f32 v44, v44
  v_exp_f32 v45, v45
  v_exp_f32 v46, v46
  v_exp_f32 v47, v47
  v_cvt_pk_bf16_f32 v124, v44, v45
  v_exp_f32 v48, v48
  v_exp_f32 v49, v49
  v_cvt_pk_bf16_f32 v125, v46, v47
  v_exp_f32 v50, v50
  v_exp_f32 v51, v51
  v_cvt_pk_bf16_f32 v126, v48, v49
  v_exp_f32 v52, v52
  v_exp_f32 v53, v53
  v_cvt_pk_bf16_f32 v127, v50, v51
  v_exp_f32 v54, v54
  v_exp_f32 v55, v55
  v_cvt_pk_bf16_f32 v128, v52, v53
  v_exp_f32 v56, v56
  v_exp_f32 v57, v57
  v_cvt_pk_bf16_f32 v129, v54, v55
  v_exp_f32 v58, v58
  v_exp_f32 v59, v59
  v_cvt_pk_bf16_f32 v130, v56, v57
  v_cvt_pk_bf16_f32 v131, v58, v59
  v_mfma_f32_32x32x16_bf16 v[108:123], v[28:31], v[124:127], v[108:123]
  s_nop 0
  v_mfma_f32_32x32x16_bf16 v[108:123], v[32:35], v[128:131], v[108:123]
  s_mov_b64 exec, s[78:79]
  ds_read_b128 v[28:31], v3 offset:3072
  ds_read_b128 v[32:35], v3 offset:3584
  s_mov_b64 exec, -1
  s_cmp_gt_i32 s41, 4
  s_cbranch_scc1 gm_AC_g0_p2done
  ds_read_b128 v[12:15], v2 offset:1024
  s_waitcnt lgkmcnt(3)
  v_mfma_f32_32x32x16_bf16 v[44:59], v[24:27], v[4:7], v[92:107]
  v_exp_f32 v76, v76
  v_exp_f32 v77, v77
  v_exp_f32 v78, v78
  v_exp_f32 v79, v79
  v_cvt_pk_bf16_f32 v132, v76, v77
  v_exp_f32 v80, v80
  v_exp_f32 v81, v81
  v_cvt_pk_bf16_f32 v133, v78, v79
  v_exp_f32 v82, v82
  v_exp_f32 v83, v83
  v_cvt_pk_bf16_f32 v134, v80, v81
  v_exp_f32 v84, v84
  v_exp_f32 v85, v85
  v_cvt_pk_bf16_f32 v135, v82, v83
  v_exp_f32 v86, v86
  v_exp_f32 v87, v87
  v_cvt_pk_bf16_f32 v136, v84, v85
  v_exp_f32 v88, v88
  v_exp_f32 v89, v89
  v_cvt_pk_bf16_f32 v137, v86, v87
  v_exp_f32 v90, v90
  v_exp_f32 v91, v91
  v_cvt_pk_bf16_f32 v138, v88, v89
  v_cvt_pk_bf16_f32 v139, v90, v91
  v_mfma_f32_32x32x16_bf16 v[108:123], v[36:39], v[132:135], v[108:123]
  s_nop 0
  v_mfma_f32_32x32x16_bf16 v[108:123], v[40:43], v[136:139], v[108:123]
  s_mov_b64 exec, s[78:79]
  ds_read_b128 v[36:39], v3 offset:2048
  ds_read_b128 v[40:43], v3 offset:2560
  s_mov_b64 exec, -1
  s_cmp_gt_i32 s41, 3
  s_cbranch_scc1 gm_AC_g0_p2done
  s_waitcnt lgkmcnt(2)
  v_mfma_f32_32x32x16_bf16 v[76:91], v[12:15], v[4:7], v[92:107]
  v_exp_f32 v60, v60
  v_exp_f32 v61, v61
  v_exp_f32 v62, v62
  v_exp_f32 v63, v63
  v_cvt_pk_bf16_f32 v124, v60, v61
  v_exp_f32 v64, v64
  v_exp_f32 v65, v65
  v_cvt_pk_bf16_f32 v125, v62, v63
  v_exp_f32 v66, v66
  v_exp_f32 v67, v67
  v_cvt_pk_bf16_f32 v126, v64, v65
  v_exp_f32 v68, v68
  v_exp_f32 v69, v69
  v_cvt_pk_bf16_f32 v127, v66, v67
  v_exp_f32 v70, v70
  v_exp_f32 v71, v71
  v_cvt_pk_bf16_f32 v128, v68, v69
  v_exp_f32 v72, v72
  v_exp_f32 v73, v73
  v_cvt_pk_bf16_f32 v129, v70, v71
  v_exp_f32 v74, v74
  v_exp_f32 v75, v75
  v_cvt_pk_bf16_f32 v130, v72, v73
  v_cvt_pk_bf16_f32 v131, v74, v75
  v_mfma_f32_32x32x16_bf16 v[108:123], v[28:31], v[124:127], v[108:123]
  s_nop 0
  v_mfma_f32_32x32x16_bf16 v[108:123], v[32:35], v[128:131], v[108:123]
  s_mov_b64 exec, s[78:79]
  ds_read_b128 v[28:31], v3 offset:1024
  ds_read_b128 v[32:35], v3 offset:1536
  s_mov_b64 exec, -1
  s_cmp_gt_i32 s41, 2
  s_cbranch_scc1 gm_AC_g0_p2done
  v_exp_f32 v44, v44
  v_exp_f32 v45, v45
  v_exp_f32 v46, v46
  v_exp_f32 v47, v47
  v_cvt_pk_bf16_f32 v132, v44, v45
  v_exp_f32 v48, v48
  v_exp_f32 v49, v49
  v_cvt_pk_bf16_f32 v133, v46, v47
  v_exp_f32 v50, v50
  v_exp_f32 v51, v51
  v_cvt_pk_bf16_f32 v134, v48, v49
  v_exp_f32 v52, v52
  v_exp_f32 v53, v53
  v_cvt_pk_bf16_f32 v135, v50, v51
  v_exp_f32 v54, v54
  v_exp_f32 v55, v55
  v_cvt_pk_bf16_f32 v136, v52, v53
  v_exp_f32 v56, v56
  v_exp_f32 v57, v57
  v_cvt_pk_bf16_f32 v137, v54, v55
  v_exp_f32 v58, v58
  v_exp_f32 v59, v59
  v_cvt_pk_bf16_f32 v138, v56, v57
  v_cvt_pk_bf16_f32 v139, v58, v59
  s_waitcnt lgkmcnt(3)
  v_mfma_f32_32x32x16_bf16 v[108:123], v[36:39], v[132:135], v[108:123]
  s_waitcnt lgkmcnt(2)
  v_mfma_f32_32x32x16_bf16 v[108:123], v[40:43], v[136:139], v[108:123]
  s_cmp_gt_i32 s41, 1
  s_cbranch_scc1 gm_AC_g0_p2done
  v_exp_f32 v76, v76
  v_exp_f32 v77, v77
  v_exp_f32 v78, v78
  v_exp_f32 v79, v79
  v_cvt_pk_bf16_f32 v124, v76, v77
  v_exp_f32 v80, v80
  v_exp_f32 v81, v81
  v_cvt_pk_bf16_f32 v125, v78, v79
  v_exp_f32 v82, v82
  v_exp_f32 v83, v83
  v_cvt_pk_bf16_f32 v126, v80, v81
  v_exp_f32 v84, v84
  v_exp_f32 v85, v85
  v_cvt_pk_bf16_f32 v127, v82, v83
  v_exp_f32 v86, v86
  v_exp_f32 v87, v87
  v_cvt_pk_bf16_f32 v128, v84, v85
  v_exp_f32 v88, v88
  v_exp_f32 v89, v89
  v_cvt_pk_bf16_f32 v129, v86, v87
  v_exp_f32 v90, v90
  v_exp_f32 v91, v91
  v_cvt_pk_bf16_f32 v130, v88, v89
  v_cvt_pk_bf16_f32 v131, v90, v91
  s_waitcnt lgkmcnt(1)
  v_mfma_f32_32x32x16_bf16 v[108:123], v[28:31], v[124:127], v[108:123]
  s_waitcnt lgkmcnt(0)
  v_mfma_f32_32x32x16_bf16 v[108:123], v[32:35], v[128:131], v[108:123]
gm_AC_g0_p2done:
  s_waitcnt lgkmcnt(0)
  s_nop 10
  v_rcp_f32 v156, v116
  s_nop 0
  v_mul_f32 v108, v108, v156
  v_mul_f32 v109, v109, v156
  v_mul_f32 v110, v110, v156
  v_mul_f32 v111, v111, v156
  v_mul_f32 v112, v112, v156
  v_mul_f32 v113, v113, v156
  v_mul_f32 v114, v114, v156
  v_mul_f32 v115, v115, v156
  v_cvt_pk_bf16_f32 v140, v108, v109
  v_cvt_pk_bf16_f32 v141, v110, v111
  v_cvt_pk_bf16_f32 v142, v112, v113
  v_cvt_pk_bf16_f32 v143, v114, v115
  buffer_store_dwordx4 v[140:143], v1, s[36:39], s40 offen offset:0 sc1
  ds_read_b128 v[12:15], v2 offset:24576
  ds_read_b128 v[16:19], v2 offset:16384
  ds_read_b128 v[20:23], v2 offset:23552
  ds_read_b128 v[24:27], v2 offset:22528
  s_waitcnt lgkmcnt(3)
  v_mfma_f32_32x32x16_bf16 v[44:59], v[12:15], v[8:11], 0
  s_waitcnt lgkmcnt(2)
  v_mfma_f32_32x32x16_bf16 v[60:75], v[16:19], v[8:11], 0
  s_waitcnt lgkmcnt(1)
  v_mfma_f32_32x32x16_bf16 v[76:91], v[20:23], v[8:11], 0
  ds_read_b128 v[12:15], v2 offset:21504
  ds_read_b128 v[16:19], v2 offset:20480
  s_waitcnt lgkmcnt(2)
  v_mfma_f32_32x32x16_bf16 v[92:107], v[24:27], v[8:11], 0
  ds_read_b128 v[20:23], v2 offset:19456
  ds_read_b128 v[24:27], v2 offset:18432
  s_nop 1
  v_cndmask_b32 v44, v44, v158, s[44:45]
  v_cndmask_b32 v45, v45, v158, s[46:47]
  v_cndmask_b32 v46, v46, v158, s[48:49]
  v_cndmask_b32 v47, v47, v158, s[50:51]
  v_cndmask_b32 v48, v48, v158, s[52:53]
  v_cndmask_b32 v49, v49, v158, s[54:55]
  v_cndmask_b32 v50, v50, v158, s[56:57]
  v_cndmask_b32 v51, v51, v158, s[58:59]
  v_cndmask_b32 v52, v52, v158, s[60:61]
  v_cndmask_b32 v53, v53, v158, s[62:63]
  v_cndmask_b32 v54, v54, v158, s[64:65]
  v_cndmask_b32 v55, v55, v158, s[66:67]
  v_cndmask_b32 v56, v56, v158, s[68:69]
  v_cndmask_b32 v57, v57, v158, s[70:71]
  v_cndmask_b32 v58, v58, v158, s[72:73]
  v_cndmask_b32 v59, v59, v158, s[74:75]
  s_waitcnt lgkmcnt(3)
  v_mfma_f32_32x32x16_bf16 v[108:123], v[12:15], v[8:11], 0
  ds_read_b128 v[12:15], v2 offset:17408
  v_max3_f32 v156, v44, v45, v46
  v_max3_f32 v157, v47, v48, v49
  v_max3_f32 v156, v50, v51, v156
  v_max3_f32 v157, v52, v53, v157
  v_max3_f32 v156, v54, v55, v156
  v_max3_f32 v157, v56, v57, v157
  v_max3_f32 v156, v58, v59, v156
  s_cmp_gt_i32 s41, 7
  s_cbranch_scc1 gm_AC_g1_p1done
  s_waitcnt lgkmcnt(3)
  v_mfma_f32_32x32x16_bf16 v[60:75], v[16:19], v[8:11], 0
  v_max3_f32 v156, v76, v77, v156
  v_max3_f32 v157, v78, v79, v157
  v_max3_f32 v156, v80, v81, v156
  v_max3_f32 v157, v82, v83, v157
  v_max3_f32 v156, v84, v85, v156
  v_max3_f32 v157, v86, v87, v157
  v_max3_f32 v156, v88, v89, v156
  v_max3_f32 v157, v90, v91, v157
  s_cmp_gt_i32 s41, 6
  s_cbranch_scc1 gm_AC_g1_p1done
  s_waitcnt lgkmcnt(2)
  v_mfma_f32_32x32x16_bf16 v[44:59], v[20:23], v[8:11], 0
  v_max3_f32 v156, v92, v93, v156
  v_max3_f32 v157, v94, v95, v157
  v_max3_f32 v156, v96, v97, v156
  v_max3_f32 v157, v98, v99, v157
  v_max3_f32 v156, v100, v101, v156
  v_max3_f32 v157, v102, v103, v157
  v_max3_f32 v156, v104, v105, v156
  v_max3_f32 v157, v106, v107, v157
  s_cmp_gt_i32 s41, 5
  s_cbranch_scc1 gm_AC_g1_p1done
  s_waitcnt lgkmcnt(1)
  v_mfma_f32_32x32x16_bf16 v[76:91], v[24:27], v[8:11], 0
  v_max3_f32 v156, v108, v109, v156
  v_max3_f32 v157, v110, v111, v157
  v_max3_f32 v156, v112, v113, v156
  v_max3_f32 v157, v114, v115, v157
  v_max3_f32 v156, v116, v117, v156
  v_max3_f32 v157, v118, v119, v157
  v_max3_f32 v156, v120, v121, v156
  v_max3_f32 v157, v122, v123, v157
  s_cmp_gt_i32 s41, 4
  s_cbranch_scc1 gm_AC_g1_p1done
  s_waitcnt lgkmcnt(0)
  v_mfma_f32_32x32x16_bf16 v[92:107], v[12:15], v[8:11], 0
  v_max3_f32 v156, v60, v61, v156
  v_max3_f32 v157, v62, v63, v157
  v_max3_f32 v156, v64, v65, v156
  v_max3_f32 v157, v66, v67, v157
  v_max3_f32 v156, v68, v69, v156
  v_max3_f32 v157, v70, v71, v157
  v_max3_f32 v156, v72, v73, v156
  v_max3_f32 v157, v74, v75, v157
  s_cmp_gt_i32 s41, 3
  s_cbranch_scc1 gm_AC_g1_p1done
  v_max3_f32 v156, v44, v45, v156
  v_max3_f32 v157, v46, v47, v157
  v_max3_f32 v156, v48, v49, v156
  v_max3_f32 v157, v50, v51, v157
  v_max3_f32 v156, v52, v53, v156
  v_max3_f32 v157, v54, v55, v157
  v_max3_f32 v156, v56, v57, v156
  v_max3_f32 v157, v58, v59, v157
  s_cmp_gt_i32 s41, 2
  s_cbranch_scc1 gm_AC_g1_p1done
  v_max3_f32 v156, v76, v77, v156
  v_max3_f32 v157, v78, v79, v157
  v_max3_f32 v156, v80, v81, v156
  v_max3_f32 v157, v82, v83, v157
  v_max3_f32 v156, v84, v85, v156
  v_max3_f32 v157, v86, v87, v157
  v_max3_f32 v156, v88, v89, v156
  v_max3_f32 v157, v90, v91, v157
  s_cmp_gt_i32 s41, 1
  s_cbranch_scc1 gm_AC_g1_p1done
  v_max3_f32 v156, v92, v93, v156
  v_max3_f32 v157, v94, v95, v157
  v_max3_f32 v156, v96, v97, v156
  v_max3_f32 v157, v98, v99, v157
  v_max3_f32 v156, v100, v101, v156
  v_max3_f32 v157, v102, v103, v157
  v_max3_f32 v156, v104, v105, v156
  v_max3_f32 v157, v106, v107, v157
gm_AC_g1_p1done:
  s_waitcnt lgkmcnt(0)
  s_nop 10
  ds_read_b128 v[12:15], v2 offset:24576
  ds_read_b128 v[16:19], v2 offset:16384
  ds_read_b128 v[20:23], v2 offset:23552
  v_max_f32 v156, v156, v157
  v_mov_b32 v157, v156
  s_nop 1
  v_permlane32_swap_b32 v156, v157
  v_max_f32 v156, v156, v157
  v_sub_f32 v92, 0, v156
  v_sub_f32 v93, 0, v156
  v_sub_f32 v94, 0, v156
  v_sub_f32 v95, 0, v156
  v_sub_f32 v96, 0, v156
  v_sub_f32 v97, 0, v156
  v_sub_f32 v98, 0, v156
  v_sub_f32 v99, 0, v156
  v_sub_f32 v100, 0, v156
  v_sub_f32 v101, 0, v156
  v_sub_f32 v102, 0, v156
  v_sub_f32 v103, 0, v156
  v_sub_f32 v104, 0, v156
  v_sub_f32 v105, 0, v156
  v_sub_f32 v106, 0, v156
  v_sub_f32 v107, 0, v156
  s_waitcnt lgkmcnt(2)
  s_nop 0
  v_mfma_f32_32x32x16_bf16 v[44:59], v[12:15], v[8:11], v[92:107]
  s_waitcnt lgkmcnt(0)
  v_mfma_f32_32x32x16_bf16 v[76:91], v[20:23], v[8:11], v[92:107]
  ds_read_b128 v[24:27], v2 offset:22528
  s_mov_b64 exec, s[78:79]
  ds_read_b128 v[28:31], v3 offset:24576
  ds_read_b128 v[32:35], v3 offset:25088
  s_mov_b64 exec, -1
  ds_read_b128 v[12:15], v2 offset:21504
  s_waitcnt lgkmcnt(3)
  v_mfma_f32_32x32x16_bf16 v[60:75], v[24:27], v[8:11], v[92:107]
  s_nop 1
  v_exp_f32 v44, v44
  v_exp_f32 v45, v45
  v_exp_f32 v46, v46
  v_exp_f32 v47, v47
  v_cvt_pk_bf16_f32 v124, v44, v45
  v_exp_f32 v48, v48
  v_exp_f32 v49, v49
  v_cvt_pk_bf16_f32 v125, v46, v47
  v_exp_f32 v50, v50
  v_exp_f32 v51, v51
  v_cvt_pk_bf16_f32 v126, v48, v49
  v_exp_f32 v52, v52
  v_exp_f32 v53, v53
  v_cvt_pk_bf16_f32 v127, v50, v51
  v_exp_f32 v54, v54
  v_exp_f32 v55, v55
  v_cvt_pk_bf16_f32 v128, v52, v53
  v_exp_f32 v56, v56
  v_exp_f32 v57, v57
  v_cvt_pk_bf16_f32 v129, v54, v55
  v_exp_f32 v58, v58
  v_exp_f32 v59, v59
  v_cvt_pk_bf16_f32 v130, v56, v57
  v_cvt_pk_bf16_f32 v131, v58, v59
  v_and_b32 v140, v124, v148
  v_xor_b32 v124, v124, v140
  v_and_b32 v141, v125, v149
  v_xor_b32 v125, v125, v141
  v_and_b32 v142, v126, v150
  v_xor_b32 v126, v126, v142
  v_and_b32 v143, v127, v151
  v_xor_b32 v127, v127, v143
  v_and_b32 v144, v128, v152
  v_xor_b32 v128, v128, v144
  v_and_b32 v145, v129, v153
  v_xor_b32 v129, v129, v145
  v_and_b32 v146, v130, v154
  v_xor_b32 v130, v130, v146
  v_and_b32 v147, v131, v155
  v_xor_b32 v131, v131, v147
  s_waitcnt lgkmcnt(2)
  v_mfma_f32_32x32x16_bf16 v[108:123], v[28:31], v[124:127], 0
  s_waitcnt lgkmcnt(1)
  v_mfma_f32_32x32x16_bf16 v[108:123], v[32:35], v[128:131], v[108:123]
  s_mov_b64 exec, s[78:79]
  ds_read_b128 v[28:31], v3 offset:23552
  ds_read_b128 v[32:35], v3 offset:24064
  s_mov_b64 exec, -1
  s_mov_b64 exec, s[78:79]
  ds_read_b128 v[36:39], v3 offset:22528
  ds_read_b128 v[40:43], v3 offset:23040
  s_mov_b64 exec, -1
  s_cmp_gt_i32 s41, 7
  s_cbranch_scc1 gm_AC_g1_p2done
  ds_read_b128 v[16:19], v2 offset:20480
  s_waitcnt lgkmcnt(5)
  v_mfma_f32_32x32x16_bf16 v[44:59], v[12:15], v[8:11], v[92:107]
  v_exp_f32 v76, v76
  v_exp_f32 v77, v77
  v_exp_f32 v78, v78
  v_exp_f32 v79, v79
  v_cvt_pk_bf16_f32 v124, v76, v77
  v_exp_f32 v80, v80
  v_exp_f32 v81, v81
  v_cvt_pk_bf16_f32 v125, v78, v79
  v_exp_f32 v82, v82
  v_exp_f32 v83, v83
  v_cvt_pk_bf16_f32 v126, v80, v81
  v_exp_f32 v84, v84
  v_exp_f32 v85, v85
  v_cvt_pk_bf16_f32 v127, v82, v83
  v_exp_f32 v86, v86
  v_exp_f32 v87, v87
  v_cvt_pk_bf16_f32 v128, v84, v85
  v_exp_f32 v88, v88
  v_exp_f32 v89, v89
  v_cvt_pk_bf16_f32 v129, v86, v87
  v_exp_f32 v90, v90
  v_exp_f32 v91, v91
  v_cvt_pk_bf16_f32 v130, v88, v89
  v_cvt_pk_bf16_f32 v131, v90, v91
  s_waitcnt lgkmcnt(4)
  v_mfma_f32_32x32x16_bf16 v[108:123], v[28:31], v[124:127], v[108:123]
  s_waitcnt lgkmcnt(3)
  v_mfma_f32_32x32x16_bf16 v[108:123], v[32:35], v[128:131], v[108:123]
  s_mov_b64 exec, s[78:79]
  ds_read_b128 v[28:31], v3 offset:21504
  ds_read_b128 v[32:35], v3 offset:22016
  s_mov_b64 exec, -1
  s_cmp_gt_i32 s41, 6
  s_cbranch_scc1 gm_AC_g1_p2done
  ds_read_b128 v[20:23], v2 offset:19456
  s_waitcnt lgkmcnt(3)
  v_mfma_f32_32x32x16_bf16 v[76:91], v[16:19], v[8:11], v[92:107]
  v_exp_f32 v60, v60
  v_exp_f32 v61, v61
  v_exp_f32 v62, v62
  v_exp_f32 v63, v63
  v_cvt_pk_bf16_f32 v132, v60, v61
  v_exp_f32 v64, v64
  v_exp_f32 v65, v65
  v_cvt_pk_bf16_f32 v133, v62, v63
  v_exp_f32 v66, v66
  v_exp_f32 v67, v67
  v_cvt_pk_bf16_f32 v134, v64, v65
  v_exp_f32 v68, v68
  v_exp_f32 v69, v69
  v_cvt_pk_bf16_f32 v135, v66, v67
  v_exp_f32 v70, v70
  v_exp_f32 v71, v71
  v_cvt_pk_bf16_f32 v136, v68, v69
  v_exp_f32 v72, v72
  v_exp_f32 v73, v73
  v_cvt_pk_bf16_f32 v137, v70, v71
  v_exp_f32 v74, v74
  v_exp_f32 v75, v75
  v_cvt_pk_bf16_f32 v138, v72, v73
  v_cvt_pk_bf16_f32 v139, v74, v75
  v_mfma_f32_32x32x16_bf16 v[108:123], v[36:39], v[132:135], v[108:123]
  s_nop 0
  v_mfma_f32_32x32x16_bf16 v[108:123], v[40:43], v[136:139], v[108:123]
  s_mov_b64 exec, s[78:79]
  ds_read_b128 v[36:39], v3 offset:20480
  ds_read_b128 v[40:43], v3 offset:20992
  s_mov_b64 exec, -1
  s_cmp_gt_i32 s41, 5
  s_cbranch_scc1 gm_AC_g1_p2done
  ds_read_b128 v[24:27], v2 offset:18432
  s_waitcnt lgkmcnt(3)
  v_mfma_f32_32x32x16_bf16 v[60:75], v[20:23], v[8:11], v[92:107]
  v_exp_f32 v44, v44
  v_exp_f32 v45, v45
  v_exp_f32 v46, v46
  v_exp_f32 v47, v47
  v_cvt_pk_bf16_f32 v124, v44, v45
  v_exp_f32 v48, v48
  v_exp_f32 v49, v49
  v_cvt_pk_bf16_f32 v125, v46, v47
  v_exp_f32 v50, v50
  v_exp_f32 v51, v51
  v_cvt_pk_bf16_f32 v126, v48, v49
  v_exp_f32 v52, v52
  v_exp_f32 v53, v53
  v_cvt_pk_bf16_f32 v127, v50, v51
  v_exp_f32 v54, v54
  v_exp_f32 v55, v55
  v_cvt_pk_bf16_f32 v128, v52, v53
  v_exp_f32 v56, v56
  v_exp_f32 v57, v57
  v_cvt_pk_bf16_f32 v129, v54, v55
  v_exp_f32 v58, v58
  v_exp_f32 v59, v59
  v_cvt_pk_bf16_f32 v130, v56, v57
  v_cvt_pk_bf16_f32 v131, v58, v59
  v_mfma_f32_32x32x16_bf16 v[108:123], v[28:31], v[124:127], v[108:123]
  s_nop 0
  v_mfma_f32_32x32x16_bf16 v[108:123], v[32:35], v[128:131], v[108:123]
  s_mov_b64 exec, s[78:79]
  ds_read_b128 v[28:31], v3 offset:19456
  ds_read_b128 v[32:35], v3 offset:19968
  s_mov_b64 exec, -1
  s_cmp_gt_i32 s41, 4
  s_cbranch_scc1 gm_AC_g1_p2done
  ds_read_b128 v[12:15], v2 offset:17408
  s_waitcnt lgkmcnt(3)
  v_mfma_f32_32x32x16_bf16 v[44:59], v[24:27], v[8:11], v[92:107]
  v_exp_f32 v76, v76
  v_exp_f32 v77, v77
  v_exp_f32 v78, v78
  v_exp_f32 v79, v79
  v_cvt_pk_bf16_f32 v132, v76, v77
  v_exp_f32 v80, v80
  v_exp_f32 v81, v81
  v_cvt_pk_bf16_f32 v133, v78, v79
  v_exp_f32 v82, v82
  v_exp_f32 v83, v83
  v_cvt_pk_bf16_f32 v134, v80, v81
  v_exp_f32 v84, v84
  v_exp_f32 v85, v85
  v_cvt_pk_bf16_f32 v135, v82, v83
  v_exp_f32 v86, v86
  v_exp_f32 v87, v87
  v_cvt_pk_bf16_f32 v136, v84, v85
  v_exp_f32 v88, v88
  v_exp_f32 v89, v89
  v_cvt_pk_bf16_f32 v137, v86, v87
  v_exp_f32 v90, v90
  v_exp_f32 v91, v91
  v_cvt_pk_bf16_f32 v138, v88, v89
  v_cvt_pk_bf16_f32 v139, v90, v91
  v_mfma_f32_32x32x16_bf16 v[108:123], v[36:39], v[132:135], v[108:123]
  s_nop 0
  v_mfma_f32_32x32x16_bf16 v[108:123], v[40:43], v[136:139], v[108:123]
  s_mov_b64 exec, s[78:79]
  ds_read_b128 v[36:39], v3 offset:18432
  ds_read_b128 v[40:43], v3 offset:18944
  s_mov_b64 exec, -1
  s_cmp_gt_i32 s41, 3
  s_cbranch_scc1 gm_AC_g1_p2done
  s_waitcnt lgkmcnt(2)
  v_mfma_f32_32x32x16_bf16 v[76:91], v[12:15], v[8:11], v[92:107]
  v_exp_f32 v60, v60
  v_exp_f32 v61, v61
  v_exp_f32 v62, v62
  v_exp_f32 v63, v63
  v_cvt_pk_bf16_f32 v124, v60, v61
  v_exp_f32 v64, v64
  v_exp_f32 v65, v65
  v_cvt_pk_bf16_f32 v125, v62, v63
  v_exp_f32 v66, v66
  v_exp_f32 v67, v67
  v_cvt_pk_bf16_f32 v126, v64, v65
  v_exp_f32 v68, v68
  v_exp_f32 v69, v69
  v_cvt_pk_bf16_f32 v127, v66, v67
  v_exp_f32 v70, v70
  v_exp_f32 v71, v71
  v_cvt_pk_bf16_f32 v128, v68, v69
  v_exp_f32 v72, v72
  v_exp_f32 v73, v73
  v_cvt_pk_bf16_f32 v129, v70, v71
  v_exp_f32 v74, v74
  v_exp_f32 v75, v75
  v_cvt_pk_bf16_f32 v130, v72, v73
  v_cvt_pk_bf16_f32 v131, v74, v75
  v_mfma_f32_32x32x16_bf16 v[108:123], v[28:31], v[124:127], v[108:123]
  s_nop 0
  v_mfma_f32_32x32x16_bf16 v[108:123], v[32:35], v[128:131], v[108:123]
  s_mov_b64 exec, s[78:79]
  ds_read_b128 v[28:31], v3 offset:17408
  ds_read_b128 v[32:35], v3 offset:17920
  s_mov_b64 exec, -1
  s_cmp_gt_i32 s41, 2
  s_cbranch_scc1 gm_AC_g1_p2done
  v_exp_f32 v44, v44
  v_exp_f32 v45, v45
  v_exp_f32 v46, v46
  v_exp_f32 v47, v47
  v_cvt_pk_bf16_f32 v132, v44, v45
  v_exp_f32 v48, v48
  v_exp_f32 v49, v49
  v_cvt_pk_bf16_f32 v133, v46, v47
  v_exp_f32 v50, v50
  v_exp_f32 v51, v51
  v_cvt_pk_bf16_f32 v134, v48, v49
  v_exp_f32 v52, v52
  v_exp_f32 v53, v53
  v_cvt_pk_bf16_f32 v135, v50, v51
  v_exp_f32 v54, v54
  v_exp_f32 v55, v55
  v_cvt_pk_bf16_f32 v136, v52, v53
  v_exp_f32 v56, v56
  v_exp_f32 v57, v57
  v_cvt_pk_bf16_f32 v137, v54, v55
  v_exp_f32 v58, v58
  v_exp_f32 v59, v59
  v_cvt_pk_bf16_f32 v138, v56, v57
  v_cvt_pk_bf16_f32 v139, v58, v59
  s_waitcnt lgkmcnt(3)
  v_mfma_f32_32x32x16_bf16 v[108:123], v[36:39], v[132:135], v[108:123]
  s_waitcnt lgkmcnt(2)
  v_mfma_f32_32x32x16_bf16 v[108:123], v[40:43], v[136:139], v[108:123]
  s_cmp_gt_i32 s41, 1
  s_cbranch_scc1 gm_AC_g1_p2done
  v_exp_f32 v76, v76
  v_exp_f32 v77, v77
  v_exp_f32 v78, v78
  v_exp_f32 v79, v79
  v_cvt_pk_bf16_f32 v124, v76, v77
  v_exp_f32 v80, v80
  v_exp_f32 v81, v81
  v_cvt_pk_bf16_f32 v125, v78, v79
  v_exp_f32 v82, v82
  v_exp_f32 v83, v83
  v_cvt_pk_bf16_f32 v126, v80, v81
  v_exp_f32 v84, v84
  v_exp_f32 v85, v85
  v_cvt_pk_bf16_f32 v127, v82, v83
  v_exp_f32 v86, v86
  v_exp_f32 v87, v87
  v_cvt_pk_bf16_f32 v128, v84, v85
  v_exp_f32 v88, v88
  v_exp_f32 v89, v89
  v_cvt_pk_bf16_f32 v129, v86, v87
  v_exp_f32 v90, v90
  v_exp_f32 v91, v91
  v_cvt_pk_bf16_f32 v130, v88, v89
  v_cvt_pk_bf16_f32 v131, v90, v91
  s_waitcnt lgkmcnt(1)
  v_mfma_f32_32x32x16_bf16 v[108:123], v[28:31], v[124:127], v[108:123]
  s_waitcnt lgkmcnt(0)
  v_mfma_f32_32x32x16_bf16 v[108:123], v[32:35], v[128:131], v[108:123]
gm_AC_g1_p2done:
  s_waitcnt lgkmcnt(0)
  s_nop 10
  v_rcp_f32 v156, v116
  s_nop 0
  v_mul_f32 v108, v108, v156
  v_mul_f32 v109, v109, v156
  v_mul_f32 v110, v110, v156
  v_mul_f32 v111, v111, v156
  v_mul_f32 v112, v112, v156
  v_mul_f32 v113, v113, v156
  v_mul_f32 v114, v114, v156
  v_mul_f32 v115, v115, v156
  v_cvt_pk_bf16_f32 v144, v108, v109
  v_cvt_pk_bf16_f32 v145, v110, v111
  v_cvt_pk_bf16_f32 v146, v112, v113
  v_cvt_pk_bf16_f32 v147, v114, v115
  buffer_store_dwordx4 v[144:147], v1, s[36:39], s40 offen offset:1024 sc1
gm_AC_fin:
  s_waitcnt lgkmcnt(0)
  s_nop 10
  s_lshl_b32 s44, s4, 1
  s_and_b32 s33, s6, 1
  s_add_u32 s44, s44, s33
  s_lshr_b32 s45, s6, 1
  s_lshl_b32 s48, s44, 2
  s_lshr_b32 s33, s3, 1
  s_add_u32 s48, s48, s33
  s_lshl_b32 s49, s45, 1
  s_and_b32 s34, s3, 1
  s_add_u32 s49, s49, s34
  v_lshrrev_b32 v8, 5, v0
  v_lshlrev_b32 v8, 8, v8
  v_bfe_u32 v9, v0, 2, 2
  v_lshl_add_u32 v8, v9, 6, v8
  v_bfe_u32 v9, v0, 4, 1
  v_lshl_add_u32 v8, v9, 5, v8
  v_and_b32 v9, 3, v0
  v_lshl_add_u32 v8, v9, 3, v8
  s_lshl_b32 s34, s34, 14
  s_add_u32 s33, s34, 0x10000
  v_add_u32 v8, s33, v8
  s_lshl_b32 s55, s48, 15
  s_add_u32 s55, s55, s34
  s_add_u32 s55, s55, 0xb00000
  s_lshl_b32 s34, s3, 12
  s_add_u32 s33, s34, 0x20000
  v_add_u32 v2, s33, v1
  s_xor_b32 s33, s33, 0x1000
  v_add_u32 v3, s33, v1
  v_and_b32 v4, 31, v0
  v_lshlrev_b32 v5, 2, v4
  s_lshl_b32 s54, s48, 7
  s_add_u32 s54, s54, 0xa00000
  s_lshr_b32 s33, s44, 1
  s_lshl_b32 s33, s33, 2
  s_lshr_b32 s34, s45, 1
  s_add_u32 s33, s33, s34
  s_lshl_b32 s33, s33, 3
  s_bfe_u32 s34, s48, 0x20001
  s_lshl_b32 s34, s34, 1
  s_add_u32 s33, s33, s34
  s_and_b32 s34, s45, 1
  s_add_u32 s33, s33, s34
  s_lshl_b32 s33, s33, 9
  s_add_u32 s33, s33, 0x1640000
  v_and_b32 v10, 3, v0
  v_lshlrev_b32 v10, 7, v10
  v_add_u32 v10, s33, v10
  s_mov_b32 s56, s26
  s_mov_b32 s57, s27
  s_mov_b32 s58, 0x200000
  s_mov_b32 s59, 0x20000
  v_lshlrev_b32 v4, 10, v4
  v_lshrrev_b32 v6, 5, v0
  v_lshl_add_u32 v4, v6, 4, v4
  s_lshl_b32 s33, s48, 15
  s_lshl_b32 s34, s49, 6
  s_add_u32 s53, s33, s34
  s_waitcnt vmcnt(0)
  v_mov_b32 v12, s90
  v_mov_b32 v13, 0
  s_mov_b64 exec, 1
  buffer_store_dword v12, v13, s[36:39], s43 offen sc1
  s_mov_b64 exec, -1
  s_lshl_b32 s33, s4, 1
  s_and_b32 s34, s3, 1
  s_add_u32 s33, s33, s34
  s_lshl_b32 s33, s33, 6
  s_and_b32 s34, s48, 7
  s_add_u32 s33, s33, s34
  s_lshl_b32 s33, s33, 7
  s_add_u32 s33, s33, 0x1660000
  v_and_b32 v7, 7, v0
  v_lshlrev_b32 v7, 10, v7
  v_add_u32 v7, s33, v7
  s_barrier
  s_mov_b32 s88, 0x8000
poll6:
  buffer_load_dword v11, v7, s[36:39], 0 offen sc1
  s_waitcnt vmcnt(0)
  v_cmp_ne_u32 s[86:87], s90, v11
  s_nop 3
  s_cmp_eq_u64 s[86:87], 0
  s_cbranch_scc1 poll6_ok
  s_sleep 3
  s_sub_u32 s88, s88, 1
  s_cmp_lg_u32 s88, 0
  s_cbranch_scc1 poll6
poll6_ok:
  buffer_load_dwordx4 v[64:67], v1, s[36:39], s55 offen offset:0 sc1
  buffer_load_dwordx4 v[68:71], v1, s[36:39], s55 offen offset:1024 sc1
  buffer_load_dwordx4 v[72:75], v1, s[36:39], s55 offen offset:2048 sc1
  buffer_load_dwordx4 v[76:79], v1, s[36:39], s55 offen offset:3072 sc1
  s_add_u32 s55, s55, 0x1000
  buffer_load_dwordx4 v[80:83], v1, s[36:39], s55 offen offset:0 sc1
  buffer_load_dwordx4 v[84:87], v1, s[36:39], s55 offen offset:1024 sc1
  buffer_load_dwordx4 v[88:91], v1, s[36:39], s55 offen offset:2048 sc1
  buffer_load_dwordx4 v[92:95], v1, s[36:39], s55 offen offset:3072 sc1
  s_add_u32 s55, s55, 0x1000
  buffer_load_dwordx4 v[96:99], v1, s[36:39], s55 offen offset:0 sc1
  buffer_load_dwordx4 v[100:103], v1, s[36:39], s55 offen offset:1024 sc1
  buffer_load_dwordx4 v[104:107], v1, s[36:39], s55 offen offset:2048 sc1
  buffer_load_dwordx4 v[108:111], v1, s[36:39], s55 offen offset:3072 sc1
  s_add_u32 s55, s55, 0x1000
  buffer_load_dwordx4 v[112:115], v1, s[36:39], s55 offen offset:0 sc1
  buffer_load_dwordx4 v[116:119], v1, s[36:39], s55 offen offset:1024 sc1
  buffer_load_dwordx4 v[120:123], v1, s[36:39], s55 offen offset:2048 sc1
  buffer_load_dwordx4 v[124:127], v1, s[36:39], s55 offen offset:3072 sc1
  ds_read_b64_tr_b16 v[128:129], v8 offset:0
  ds_read_b64_tr_b16 v[130:131], v8 offset:512
  ds_read_b64_tr_b16 v[132:133], v8 offset:32768
  ds_read_b64_tr_b16 v[134:135], v8 offset:33280
  ds_read_b64_tr_b16 v[136:137], v8 offset:1024
  ds_read_b64_tr_b16 v[138:139], v8 offset:1536
  ds_read_b64_tr_b16 v[140:141], v8 offset:33792
  ds_read_b64_tr_b16 v[142:143], v8 offset:34304
  ds_read_b64_tr_b16 v[144:145], v8 offset:2048
  ds_read_b64_tr_b16 v[146:147], v8 offset:2560
  ds_read_b64_tr_b16 v[148:149], v8 offset:34816
  ds_read_b64_tr_b16 v[150:151], v8 offset:35328
  s_waitcnt vmcnt(15) lgkmcnt(10)
  v_mfma_f32_32x32x16_bf16 v[16:31], v[128:131], v[64:67], 0
  ds_read_b64_tr_b16 v[152:153], v8 offset:3072
  ds_read_b64_tr_b16 v[154:155], v8 offset:3584
  s_waitcnt lgkmcnt(10)
  v_mfma_f32_32x32x16_bf16 v[32:47], v[132:135], v[64:67], 0
  ds_read_b64_tr_b16 v[156:157], v8 offset:35840
  ds_read_b64_tr_b16 v[158:159], v8 offset:36352
  s_waitcnt vmcnt(14) lgkmcnt(10)
  v_mfma_f32_32x32x16_bf16 v[16:31], v[136:139], v[68:71], v[16:31]
  ds_read_b64_tr_b16 v[128:129], v8 offset:4096
  ds_read_b64_tr_b16 v[130:131], v8 offset:4608
  s_waitcnt lgkmcnt(10)
  v_mfma_f32_32x32x16_bf16 v[32:47], v[140:143], v[68:71], v[32:47]
  ds_read_b64_tr_b16 v[132:133], v8 offset:36864
  ds_read_b64_tr_b16 v[134:135], v8 offset:37376
  s_waitcnt vmcnt(13) lgkmcnt(10)
  v_mfma_f32_32x32x16_bf16 v[16:31], v[144:147], v[72:75], v[16:31]
  ds_read_b64_tr_b16 v[136:137], v8 offset:5120
  ds_read_b64_tr_b16 v[138:139], v8 offset:5632
  s_waitcnt lgkmcnt(10)
  v_mfma_f32_32x32x16_bf16 v[32:47], v[148:151], v[72:75], v[32:47]
  ds_read_b64_tr_b16 v[140:141], v8 offset:37888
  ds_read_b64_tr_b16 v[142:143], v8 offset:38400
  s_waitcnt vmcnt(12) lgkmcnt(10)
  v_mfma_f32_32x32x16_bf16 v[16:31], v[152:155], v[76:79], v[16:31]
  ds_read_b64_tr_b16 v[144:145], v8 offset:6144
  ds_read_b64_tr_b16 v[146:147], v8 offset:6656
  s_waitcnt lgkmcnt(10)
  v_mfma_f32_32x32x16_bf16 v[32:47], v[156:159], v[76:79], v[32:47]
  ds_read_b64_tr_b16 v[148:149], v8 offset:38912
  ds_read_b64_tr_b16 v[150:151], v8 offset:39424
  s_waitcnt vmcnt(11) lgkmcnt(10)
  v_mfma_f32_32x32x16_bf16 v[16:31], v[128:131], v[80:83], v[16:31]
  ds_read_b64_tr_b16 v[152:153], v8 offset:7168
  ds_read_b64_tr_b16 v[154:155], v8 offset:7680
  s_waitcnt lgkmcnt(10)
  v_mfma_f32_32x32x16_bf16 v[32:47], v[132:135], v[80:83], v[32:47]
  ds_read_b64_tr_b16 v[156:157], v8 offset:39936
  ds_read_b64_tr_b16 v[158:159], v8 offset:40448
  s_waitcnt vmcnt(10) lgkmcnt(10)
  v_mfma_f32_32x32x16_bf16 v[16:31], v[136:139], v[84:87], v[16:31]
  ds_read_b64_tr_b16 v[128:129], v8 offset:8192
  ds_read_b64_tr_b16 v[130:131], v8 offset:8704
  s_waitcnt lgkmcnt(10)
  v_mfma_f32_32x32x16_bf16 v[32:47], v[140:143], v[84:87], v[32:47]
  ds_read_b64_tr_b16 v[132:133], v8 offset:40960
  ds_read_b64_tr_b16 v[134:135], v8 offset:41472
  s_waitcnt vmcnt(9) lgkmcnt(10)
  v_mfma_f32_32x32x16_bf16 v[16:31], v[144:147], v[88:91], v[16:31]
  ds_read_b64_tr_b16 v[136:137], v8 offset:9216
  ds_read_b64_tr_b16 v[138:139], v8 offset:9728
  s_waitcnt lgkmcnt(10)
  v_mfma_f32_32x32x16_bf16 v[32:47], v[148:151], v[88:91], v[32:47]
  ds_read_b64_tr_b16 v[140:141], v8 offset:41984
  ds_read_b64_tr_b16 v[142:143], v8 offset:42496
  s_waitcnt vmcnt(8) lgkmcnt(10)
  v_mfma_f32_32x32x16_bf16 v[16:31], v[152:155], v[92:95], v[16:31]
  ds_read_b64_tr_b16 v[144:145], v8 offset:10240
  ds_read_b64_tr_b16 v[146:147], v8 offset:10752
  s_waitcnt lgkmcnt(10)
  v_mfma_f32_32x32x16_bf16 v[32:47], v[156:159], v[92:95], v[32:47]
  ds_read_b64_tr_b16 v[148:149], v8 offset:43008
  ds_read_b64_tr_b16 v[150:151], v8 offset:43520
  s_waitcnt vmcnt(7) lgkmcnt(10)
  v_mfma_f32_32x32x16_bf16 v[16:31], v[128:131], v[96:99], v[16:31]
  ds_read_b64_tr_b16 v[152:153], v8 offset:11264
  ds_read_b64_tr_b16 v[154:155], v8 offset:11776
  s_waitcnt lgkmcnt(10)
  v_mfma_f32_32x32x16_bf16 v[32:47], v[132:135], v[96:99], v[32:47]
  ds_read_b64_tr_b16 v[156:157], v8 offset:44032
  ds_read_b64_tr_b16 v[158:159], v8 offset:44544
  s_waitcnt vmcnt(6) lgkmcnt(10)
  v_mfma_f32_32x32x16_bf16 v[16:31], v[136:139], v[100:103], v[16:31]
  ds_read_b64_tr_b16 v[128:129], v8 offset:12288
  ds_read_b64_tr_b16 v[130:131], v8 offset:12800
  s_waitcnt lgkmcnt(10)
  v_mfma_f32_32x32x16_bf16 v[32:47], v[140:143], v[100:103], v[32:47]
  ds_read_b64_tr_b16 v[132:133], v8 offset:45056
  ds_read_b64_tr_b16 v[134:135], v8 offset:45568
  s_waitcnt vmcnt(5) lgkmcnt(10)
  v_mfma_f32_32x32x16_bf16 v[16:31], v[144:147], v[104:107], v[16:31]
  ds_read_b64_tr_b16 v[136:137], v8 offset:13312
  ds_read_b64_tr_b16 v[138:139], v8 offset:13824
  s_waitcnt lgkmcnt(10)
  v_mfma_f32_32x32x16_bf16 v[32:47], v[148:151], v[104:107], v[32:47]
  ds_read_b64_tr_b16 v[140:141], v8 offset:46080
  ds_read_b64_tr_b16 v[142:143], v8 offset:46592
  s_waitcnt vmcnt(4) lgkmcnt(10)
  v_mfma_f32_32x32x16_bf16 v[16:31], v[152:155], v[108:111], v[16:31]
  ds_read_b64_tr_b16 v[144:145], v8 offset:14336
  ds_read_b64_tr_b16 v[146:147], v8 offset:14848
  s_waitcnt lgkmcnt(10)
  v_mfma_f32_32x32x16_bf16 v[32:47], v[156:159], v[108:111], v[32:47]
  ds_read_b64_tr_b16 v[148:149], v8 offset:47104
  ds_read_b64_tr_b16 v[150:151], v8 offset:47616
  s_waitcnt vmcnt(3) lgkmcnt(10)
  v_mfma_f32_32x32x16_bf16 v[16:31], v[128:131], v[112:115], v[16:31]
  ds_read_b64_tr_b16 v[152:153], v8 offset:15360
  ds_read_b64_tr_b16 v[154:155], v8 offset:15872
  s_waitcnt lgkmcnt(10)
  v_mfma_f32_32x32x16_bf16 v[32:47], v[132:135], v[112:115], v[32:47]
  ds_read_b64_tr_b16 v[156:157], v8 offset:48128
  ds_read_b64_tr_b16 v[158:159], v8 offset:48640
  s_waitcnt vmcnt(2) lgkmcnt(10)
  v_mfma_f32_32x32x16_bf16 v[16:31], v[136:139], v[116:119], v[16:31]
  s_waitcnt lgkmcnt(8)
  v_mfma_f32_32x32x16_bf16 v[32:47], v[140:143], v[116:119], v[32:47]
  s_waitcnt vmcnt(1) lgkmcnt(6)
  v_mfma_f32_32x32x16_bf16 v[16:31], v[144:147], v[120:123], v[16:31]
  s_waitcnt lgkmcnt(4)
  v_mfma_f32_32x32x16_bf16 v[32:47], v[148:151], v[120:123], v[32:47]
  s_waitcnt vmcnt(0) lgkmcnt(2)
  v_mfma_f32_32x32x16_bf16 v[16:31], v[152:155], v[124:127], v[16:31]
  s_waitcnt lgkmcnt(0)
  v_mfma_f32_32x32x16_bf16 v[32:47], v[156:159], v[124:127], v[32:47]
  buffer_load_dword v11, v10, s[36:39], 0 offen sc1
  s_bitcmp1_b32 s3, 0
  s_cbranch_scc1 gm_AC_x1
  s_nop 11
  ds_write_b128 v3, v[32:35] offset:0
  ds_write_b128 v3, v[36:39] offset:1024
  ds_write_b128 v3, v[40:43] offset:2048
  ds_write_b128 v3, v[44:47] offset:3072
  s_branch gm_AC_x2
gm_AC_x1:
  s_nop 11
  ds_write_b128 v3, v[16:19] offset:0
  ds_write_b128 v3, v[20:23] offset:1024
  ds_write_b128 v3, v[24:27] offset:2048
  ds_write_b128 v3, v[28:31] offset:3072
  v_mov_b32 v16, v32
  v_mov_b32 v17, v33
  v_mov_b32 v18, v34
  v_mov_b32 v19, v35
  v_mov_b32 v20, v36
  v_mov_b32 v21, v37
  v_mov_b32 v22, v38
  v_mov_b32 v23, v39
  v_mov_b32 v24, v40
  v_mov_b32 v25, v41
  v_mov_b32 v26, v42
  v_mov_b32 v27, v43
  v_mov_b32 v28, v44
  v_mov_b32 v29, v45
  v_mov_b32 v30, v46
  v_mov_b32 v31, v47
gm_AC_x2:
  s_waitcnt lgkmcnt(0)
  s_barrier
  s_waitcnt vmcnt(0)
  v_cmp_ne_u32 s[86:87], s90, v11
  s_nop 3
  s_cmp_eq_u64 s[86:87], 0
  s_cbranch_scc1 gm_AC_f2ok
  s_mov_b32 s88, 0x8000
poll7:
  buffer_load_dword v11, v10, s[36:39], 0 offen sc1
  s_waitcnt vmcnt(0)
  v_cmp_ne_u32 s[86:87], s90, v11
  s_nop 3
  s_cmp_eq_u64 s[86:87], 0
  s_cbranch_scc1 poll7_ok
  s_sleep 3
  s_sub_u32 s88, s88, 1
  s_cmp_lg_u32 s88, 0
  s_cbranch_scc1 poll7
poll7_ok:
gm_AC_f2ok:
  buffer_load_dword v6, v5, s[36:39], s54 offen sc1
  s_add_u32 s33, s42, 0x0
  buffer_load_dwordx4 v[64:67], v1, s[36:39], s33 offen sc1
  buffer_load_dwordx4 v[68:71], v1, s[36:39], s33 offen offset:1024 sc1
  s_add_u32 s33, s42, 0x200000
  buffer_load_dwordx4 v[72:75], v1, s[36:39], s33 offen sc1
  buffer_load_dwordx4 v[76:79], v1, s[36:39], s33 offen offset:1024 sc1
  s_add_u32 s33, s42, 0x400000
  buffer_load_dwordx4 v[80:83], v1, s[36:39], s33 offen sc1
  buffer_load_dwordx4 v[84:87], v1, s[36:39], s33 offen offset:1024 sc1
  s_add_u32 s33, s42, 0x600000
  buffer_load_dwordx4 v[88:91], v1, s[36:39], s33 offen sc1
  buffer_load_dwordx4 v[92:95], v1, s[36:39], s33 offen offset:1024 sc1
  ds_read_b128 v[104:107], v2 offset:0
  ds_read_b128 v[108:111], v2 offset:1024
  ds_read_b128 v[112:115], v2 offset:2048
  ds_read_b128 v[116:119], v2 offset:3072
  s_waitcnt lgkmcnt(3)
  v_add_f32 v16, v16, v104
  v_add_f32 v17, v17, v105
  v_add_f32 v18, v18, v106
  v_add_f32 v19, v19, v107
  s_waitcnt lgkmcnt(2)
  v_add_f32 v20, v20, v108
  v_add_f32 v21, v21, v109
  v_add_f32 v22, v22, v110
  v_add_f32 v23, v23, v111
  s_waitcnt lgkmcnt(1)
  v_add_f32 v24, v24, v112
  v_add_f32 v25, v25, v113
  v_add_f32 v26, v26, v114
  v_add_f32 v27, v27, v115
  s_waitcnt lgkmcnt(0)
  v_add_f32 v28, v28, v116
  v_add_f32 v29, v29, v117
  v_add_f32 v30, v30, v118
  v_add_f32 v31, v31, v119
  s_waitcnt vmcnt(8)
  v_sub_f32 v12, 1.0, v6
  v_cvt_pk_bf16_f32 v12, v12, v12
  v_lshlrev_b32 v12, 16, v12
  v_mul_f32 v16, v16, v6
  v_mul_f32 v17, v17, v6
  v_mul_f32 v18, v18, v6
  v_mul_f32 v19, v19, v6
  v_mul_f32 v20, v20, v6
  v_mul_f32 v21, v21, v6
  v_mul_f32 v22, v22, v6
  v_mul_f32 v23, v23, v6
  v_mul_f32 v24, v24, v6
  v_mul_f32 v25, v25, v6
  v_mul_f32 v26, v26, v6
  v_mul_f32 v27, v27, v6
  v_mul_f32 v28, v28, v6
  v_mul_f32 v29, v29, v6
  v_mul_f32 v30, v30, v6
  v_mul_f32 v31, v31, v6
  s_waitcnt vmcnt(7)
  v_lshlrev_b32 v120, 16, v64
  v_and_b32 v121, 0xffff0000, v64
  v_lshlrev_b32 v122, 16, v65
  v_and_b32 v123, 0xffff0000, v65
  v_lshlrev_b32 v124, 16, v66
  v_and_b32 v125, 0xffff0000, v66
  v_lshlrev_b32 v126, 16, v67
  v_and_b32 v127, 0xffff0000, v67
  s_waitcnt vmcnt(6)
  v_lshlrev_b32 v128, 16, v68
  v_and_b32 v129, 0xffff0000, v68
  v_lshlrev_b32 v130, 16, v69
  v_and_b32 v131, 0xffff0000, v69
  v_lshlrev_b32 v132, 16, v70
  v_and_b32 v133, 0xffff0000, v70
  v_lshlrev_b32 v134, 16, v71
  v_and_b32 v135, 0xffff0000, v71
  s_waitcnt vmcnt(5)
  v_lshlrev_b32 v10, 16, v72
  v_and_b32 v11, 0xffff0000, v72
  v_add_f32 v120, v120, v10
  v_add_f32 v121, v121, v11
  v_lshlrev_b32 v10, 16, v73
  v_and_b32 v11, 0xffff0000, v73
  v_add_f32 v122, v122, v10
  v_add_f32 v123, v123, v11
  v_lshlrev_b32 v10, 16, v74
  v_and_b32 v11, 0xffff0000, v74
  v_add_f32 v124, v124, v10
  v_add_f32 v125, v125, v11
  v_lshlrev_b32 v10, 16, v75
  v_and_b32 v11, 0xffff0000, v75
  v_add_f32 v126, v126, v10
  v_add_f32 v127, v127, v11
  s_waitcnt vmcnt(4)
  v_lshlrev_b32 v10, 16, v76
  v_and_b32 v11, 0xffff0000, v76
  v_add_f32 v128, v128, v10
  v_add_f32 v129, v129, v11
  v_lshlrev_b32 v10, 16, v77
  v_and_b32 v11, 0xffff0000, v77
  v_add_f32 v130, v130, v10
  v_add_f32 v131, v131, v11
  v_lshlrev_b32 v10, 16, v78
  v_and_b32 v11, 0xffff0000, v78
  v_add_f32 v132, v132, v10
  v_add_f32 v133, v133, v11
  v_lshlrev_b32 v10, 16, v79
  v_and_b32 v11, 0xffff0000, v79
  v_add_f32 v134, v134, v10
  v_add_f32 v135, v135, v11
  s_waitcnt vmcnt(3)
  v_lshlrev_b32 v10, 16, v80
  v_and_b32 v11, 0xffff0000, v80
  v_add_f32 v120, v120, v10
  v_add_f32 v121, v121, v11
  v_lshlrev_b32 v10, 16, v81
  v_and_b32 v11, 0xffff0000, v81
  v_add_f32 v122, v122, v10
  v_add_f32 v123, v123, v11
  v_lshlrev_b32 v10, 16, v82
  v_and_b32 v11, 0xffff0000, v82
  v_add_f32 v124, v124, v10
  v_add_f32 v125, v125, v11
  v_lshlrev_b32 v10, 16, v83
  v_and_b32 v11, 0xffff0000, v83
  v_add_f32 v126, v126, v10
  v_add_f32 v127, v127, v11
  s_waitcnt vmcnt(2)
  v_lshlrev_b32 v10, 16, v84
  v_and_b32 v11, 0xffff0000, v84
  v_add_f32 v128, v128, v10
  v_add_f32 v129, v129, v11
  v_lshlrev_b32 v10, 16, v85
  v_and_b32 v11, 0xffff0000, v85
  v_add_f32 v130, v130, v10
  v_add_f32 v131, v131, v11
  v_lshlrev_b32 v10, 16, v86
  v_and_b32 v11, 0xffff0000, v86
  v_add_f32 v132, v132, v10
  v_add_f32 v133, v133, v11
  v_lshlrev_b32 v10, 16, v87
  v_and_b32 v11, 0xffff0000, v87
  v_add_f32 v134, v134, v10
  v_add_f32 v135, v135, v11
  s_waitcnt vmcnt(1)
  v_lshlrev_b32 v10, 16, v88
  v_and_b32 v11, 0xffff0000, v88
  v_add_f32 v120, v120, v10
  v_add_f32 v121, v121, v11
  v_lshlrev_b32 v10, 16, v89
  v_and_b32 v11, 0xffff0000, v89
  v_add_f32 v122, v122, v10
  v_add_f32 v123, v123, v11
  v_lshlrev_b32 v10, 16, v90
  v_and_b32 v11, 0xffff0000, v90
  v_add_f32 v124, v124, v10
  v_add_f32 v125, v125, v11
  v_lshlrev_b32 v10, 16, v91
  v_and_b32 v11, 0xffff0000, v91
  v_add_f32 v126, v126, v10
  v_add_f32 v127, v127, v11
  s_waitcnt vmcnt(0)
  v_lshlrev_b32 v10, 16, v92
  v_and_b32 v11, 0xffff0000, v92
  v_add_f32 v128, v128, v10
  v_add_f32 v129, v129, v11
  v_lshlrev_b32 v10, 16, v93
  v_and_b32 v11, 0xffff0000, v93
  v_add_f32 v130, v130, v10
  v_add_f32 v131, v131, v11
  v_lshlrev_b32 v10, 16, v94
  v_and_b32 v11, 0xffff0000, v94
  v_add_f32 v132, v132, v10
  v_add_f32 v133, v133, v11
  v_lshlrev_b32 v10, 16, v95
  v_and_b32 v11, 0xffff0000, v95
  v_add_f32 v134, v134, v10
  v_add_f32 v135, v135, v11
  v_fmac_f32 v16, v120, v12
  v_fmac_f32 v17, v121, v12
  v_fmac_f32 v18, v122, v12
  v_fmac_f32 v19, v123, v12
  v_fmac_f32 v20, v124, v12
  v_fmac_f32 v21, v125, v12
  v_fmac_f32 v22, v126, v12
  v_fmac_f32 v23, v127, v12
  v_fmac_f32 v24, v128, v12
  v_fmac_f32 v25, v129, v12
  v_fmac_f32 v26, v130, v12
  v_fmac_f32 v27, v131, v12
  v_fmac_f32 v28, v132, v12
  v_fmac_f32 v29, v133, v12
  v_fmac_f32 v30, v134, v12
  v_fmac_f32 v31, v135, v12
  v_cvt_pk_bf16_f32 v64, v16, v17
  v_cvt_pk_bf16_f32 v65, v18, v19
  v_cvt_pk_bf16_f32 v66, v20, v21
  v_cvt_pk_bf16_f32 v67, v22, v23
  v_cvt_pk_bf16_f32 v68, v24, v25
  v_cvt_pk_bf16_f32 v69, v26, v27
  v_cvt_pk_bf16_f32 v70, v28, v29
  v_cvt_pk_bf16_f32 v71, v30, v31
  v_permlane32_swap_b32 v64, v66
  v_permlane32_swap_b32 v65, v67
  v_permlane32_swap_b32 v68, v70
  v_permlane32_swap_b32 v69, v71
  buffer_store_dwordx4 v[64:67], v4, s[56:59], s53 offen
  buffer_store_dwordx4 v[68:71], v4, s[56:59], s53 offen offset:32
  s_endpgm
gm_AL:
  s_sub_u32 s3, s3, 8
  s_setprio 3
  v_lshrrev_b32 v2, 3, v0
  v_lshrrev_b32 v4, 4, v0
  s_and_b32 s33, s3, 1
  s_lshl_b32 s33, s33, 2
  v_or_b32 v4, s33, v4
  v_and_b32 v5, 7, v0
  v_xor_b32 v4, v4, v5
  s_lshl_b32 s33, s3, 3
  v_add_u32 v2, s33, v2
  v_lshlrev_b32 v2, 10, v2
  v_lshl_add_u32 v2, v4, 4, v2
  v_lshrrev_b32 v3, 2, v0
  s_lshl_b32 s33, s3, 4
  v_add_u32 v3, s33, v3
  v_mul_u32_u24 v3, 3072, v3
  v_and_b32 v4, 3, v0
  v_lshl_add_u32 v3, v4, 4, v3
  s_lshl_b32 s34, s3, 10
  s_and_b32 s77, s4, 3
  s_lshr_b32 s78, s4, 2
  s_lshl_b32 s83, s77, 1
  s_and_b32 s33, s6, 1
  s_add_u32 s83, s83, s33
  s_lshl_b32 s82, s78, 3
  s_lshr_b32 s33, s6, 1
  s_add_u32 s82, s82, s33
  s_lshl_b32 s33, s82, 6
  s_sub_u32 s32, 0x180000, s33
  s_waitcnt lgkmcnt(0)
  s_add_u32 s48, s10, s33
  s_addc_u32 s49, s11, 0
  s_mov_b32 s50, s32
  s_mov_b32 s51, 0x20000
  s_mov_b32 s40, s8
  s_mov_b32 s41, s9
  s_mov_b32 s42, 0x200000
  s_mov_b32 s43, 0x20000
  s_lshl_b32 s44, s83, 18
  s_sub_u32 s45, s44, 0x40000
  s_add_u32 s33, s44, 0x0
  s_add_u32 m0, s34, 0x0
  s_nop 0
  buffer_load_dwordx4 v2, s[40:43], s33 offen lds
  s_add_u32 s33, s44, 0x8000
  s_add_u32 m0, s34, 0x1000
  s_nop 0
  buffer_load_dwordx4 v2, s[40:43], s33 offen lds
  s_add_u32 s33, s44, 0x10000
  s_add_u32 m0, s34, 0x2000
  s_nop 0
  buffer_load_dwordx4 v2, s[40:43], s33 offen lds
  s_add_u32 s33, s44, 0x18000
  s_add_u32 m0, s34, 0x3000
  s_nop 0
  buffer_load_dwordx4 v2, s[40:43], s33 offen lds
  s_add_u32 s33, s44, 0x20000
  s_add_u32 m0, s34, 0x4000
  s_nop 0
  buffer_load_dwordx4 v2, s[40:43], s33 offen lds
  s_add_u32 s33, s44, 0x28000
  s_add_u32 m0, s34, 0x5000
  s_nop 0
  buffer_load_dwordx4 v2, s[40:43], s33 offen lds
  s_add_u32 s33, s44, 0x30000
  s_add_u32 m0, s34, 0x6000
  s_nop 0
  buffer_load_dwordx4 v2, s[40:43], s33 offen lds
  s_add_u32 s33, s44, 0x38000
  s_add_u32 m0, s34, 0x7000
  s_nop 0
  buffer_load_dwordx4 v2, s[40:43], s33 offen lds
  s_mov_b32 s33, 0x400
  s_add_u32 m0, s34, 0x8000
  s_nop 0
  buffer_load_dwordx4 v3, s[48:51], s33 offen lds
  s_mov_b32 s33, 0x800
  s_add_u32 m0, s34, 0x9000
  s_nop 0
  buffer_load_dwordx4 v3, s[48:51], s33 offen lds
  s_mov_b32 s33, 0x0
  s_add_u32 m0, s34, 0xa000
  s_nop 0
  buffer_load_dwordx4 v3, s[48:51], s33 offen lds
  s_add_u32 s33, s44, 0x80
  s_add_u32 m0, s34, 0xb000
  s_nop 0
  buffer_load_dwordx4 v2, s[40:43], s33 offen lds
  s_add_u32 s33, s44, 0x8080
  s_add_u32 m0, s34, 0xc000
  s_nop 0
  buffer_load_dwordx4 v2, s[40:43], s33 offen lds
  s_add_u32 s33, s44, 0x10080
  s_add_u32 m0, s34, 0xd000
  s_nop 0
  buffer_load_dwordx4 v2, s[40:43], s33 offen lds
  s_add_u32 s33, s44, 0x18080
  s_add_u32 m0, s34, 0xe000
  s_nop 0
  buffer_load_dwordx4 v2, s[40:43], s33 offen lds
  s_add_u32 s33, s44, 0x20080
  s_add_u32 m0, s34, 0xf000
  s_nop 0
  buffer_load_dwordx4 v2, s[40:43], s33 offen lds
  s_add_u32 s33, s44, 0x28080
  s_add_u32 m0, s34, 0x10000
  s_nop 0
  buffer_load_dwordx4 v2, s[40:43], s33 offen lds
  s_add_u32 s33, s44, 0x30080
  s_add_u32 m0, s34, 0x11000
  s_nop 0
  buffer_load_dwordx4 v2, s[40:43], s33 offen lds
  s_add_u32 s33, s44, 0x38080
  s_add_u32 m0, s34, 0x12000
  s_nop 0
  buffer_load_dwordx4 v2, s[40:43], s33 offen lds
  s_mov_b32 s33, 0x30400
  s_add_u32 m0, s34, 0x13000
  s_nop 0
  buffer_load_dwordx4 v3, s[48:51], s33 offen lds
  s_mov_b32 s33, 0x30800
  s_add_u32 m0, s34, 0x14000
  s_nop 0
  buffer_load_dwordx4 v3, s[48:51], s33 offen lds
  s_mov_b32 s33, 0x30000
  s_add_u32 m0, s34, 0x15000
  s_nop 0
  buffer_load_dwordx4 v3, s[48:51], s33 offen lds
  s_mov_b32 s36, s30
  s_mov_b32 s37, s31
  s_mov_b32 s38, 0x1700000
  s_mov_b32 s39, 0x20000
  s_add_u32 s84, s30, 0x1600000
  s_addc_u32 s85, s31, 0
  s_load_dword s90, s[84:85], 0
  s_waitcnt lgkmcnt(0)
  s_add_u32 s90, s90, 1
  s_waitcnt vmcnt(11)
  s_barrier
  s_add_u32 s33, s44, 0x100
  s_add_u32 m0, s34, 0x16000
  s_nop 0
  buffer_load_dwordx4 v2, s[40:43], s33 offen lds
  s_add_u32 s33, s44, 0x8100
  s_add_u32 m0, s34, 0x17000
  s_nop 0
  buffer_load_dwordx4 v2, s[40:43], s33 offen lds
  s_add_u32 s33, s44, 0x10100
  s_add_u32 m0, s34, 0x18000
  s_nop 0
  buffer_load_dwordx4 v2, s[40:43], s33 offen lds
  s_add_u32 s33, s44, 0x18100
  s_add_u32 m0, s34, 0x19000
  s_nop 0
  buffer_load_dwordx4 v2, s[40:43], s33 offen lds
  s_add_u32 s33, s44, 0x20100
  s_add_u32 m0, s34, 0x1a000
  s_nop 0
  buffer_load_dwordx4 v2, s[40:43], s33 offen lds
  s_add_u32 s33, s44, 0x28100
  s_add_u32 m0, s34, 0x1b000
  s_nop 0
  buffer_load_dwordx4 v2, s[40:43], s33 offen lds
  s_add_u32 s33, s44, 0x30100
  s_add_u32 m0, s34, 0x1c000
  s_nop 0
  buffer_load_dwordx4 v2, s[40:43], s33 offen lds
  s_add_u32 s33, s44, 0x38100
  s_add_u32 m0, s34, 0x1d000
  s_nop 0
  buffer_load_dwordx4 v2, s[40:43], s33 offen lds
  s_mov_b32 s33, 0x60400
  s_add_u32 m0, s34, 0x1e000
  s_nop 0
  buffer_load_dwordx4 v3, s[48:51], s33 offen lds
  s_mov_b32 s33, 0x60800
  s_add_u32 m0, s34, 0x1f000
  s_nop 0
  buffer_load_dwordx4 v3, s[48:51], s33 offen lds
  s_mov_b32 s33, 0x60000
  s_add_u32 m0, s34, 0x20000
  s_nop 0
  buffer_load_dwordx4 v3, s[48:51], s33 offen lds
  s_lshl_b32 s46, s83, 8
  s_lshl_b32 s33, s82, 4
  s_add_u32 s46, s46, s33
  s_lshl_b32 s33, s3, 2
  s_add_u32 s46, s46, s33
  s_lshl_b32 s33, s46, 10
  buffer_load_dwordx4 v[60:63], v1, s[40:43], s33 offen offset:0
  buffer_load_dwordx4 v[64:67], v1, s[40:43], s33 offen offset:1024
  buffer_load_dwordx4 v[68:71], v1, s[40:43], s33 offen offset:2048
  buffer_load_dwordx4 v[72:75], v1, s[40:43], s33 offen offset:3072
  s_mov_b32 s52, s24
  s_mov_b32 s53, s25
  s_mov_b32 s54, 0x400
  s_mov_b32 s55, 0x20000
  buffer_load_dwordx4 v[16:19], v1, s[52:55], 0 offen
  s_and_b32 s32, s4, 1
  s_lshl_b32 s33, s32, 4
  s_add_u32 s33, s33, s6
  s_lshr_b32 s60, s33, 2
  s_lshl_b32 s33, s33, 2
  s_add_u32 s33, s33, s3
  s_lshl_b32 s33, s33, 16
  s_bfe_u32 s32, s4, 0x10001
  s_lshl_b32 s32, s32, 11
  s_add_u32 s61, s33, s32
  s_cmp_eq_u32 s78, 0
  s_cselect_b32 s56, s16, s18
  s_cselect_b32 s57, s17, s19
  s_mov_b32 s58, 0x800000
  s_mov_b32 s59, 0x20000
  v_and_b32 v8, 15, v0
  v_lshlrev_b32 v8, 12, v8
  v_lshrrev_b32 v11, 4, v0
  v_add_u32 v11, s60, v11
  s_waitcnt vmcnt(16)
  s_barrier
  s_add_u32 s33, s44, 0x180
  s_add_u32 m0, s34, 0x0
  s_nop 0
  buffer_load_dwordx4 v2, s[40:43], s33 offen lds
  s_add_u32 s33, s44, 0x8180
  s_add_u32 m0, s34, 0x1000
  s_nop 0
  buffer_load_dwordx4 v2, s[40:43], s33 offen lds
  s_add_u32 s33, s44, 0x10180
  s_add_u32 m0, s34, 0x2000
  s_nop 0
  buffer_load_dwordx4 v2, s[40:43], s33 offen lds
  s_add_u32 s33, s44, 0x18180
  s_add_u32 m0, s34, 0x3000
  s_nop 0
  buffer_load_dwordx4 v2, s[40:43], s33 offen lds
  s_add_u32 s33, s44, 0x20180
  s_add_u32 m0, s34, 0x4000
  s_nop 0
  buffer_load_dwordx4 v2, s[40:43], s33 offen lds
  s_add_u32 s33, s44, 0x28180
  s_add_u32 m0, s34, 0x5000
  s_nop 0
  buffer_load_dwordx4 v2, s[40:43], s33 offen lds
  s_add_u32 s33, s44, 0x30180
  s_add_u32 m0, s34, 0x6000
  s_nop 0
  buffer_load_dwordx4 v2, s[40:43], s33 offen lds
  s_add_u32 s33, s44, 0x38180
  s_add_u32 m0, s34, 0x7000
  s_nop 0
  buffer_load_dwordx4 v2, s[40:43], s33 offen lds
  s_mov_b32 s33, 0x90400
  s_add_u32 m0, s34, 0x8000
  s_nop 0
  buffer_load_dwordx4 v3, s[48:51], s33 offen lds
  s_mov_b32 s33, 0x90800
  s_add_u32 m0, s34, 0x9000
  s_nop 0
  buffer_load_dwordx4 v3, s[48:51], s33 offen lds
  s_mov_b32 s33, 0x90000
  s_add_u32 m0, s34, 0xa000
  s_nop 0
  buffer_load_dwordx4 v3, s[48:51], s33 offen lds
  s_waitcnt vmcnt(16)
  s_barrier
  s_add_u32 s33, s44, 0x200
  s_add_u32 m0, s34, 0xb000
  s_nop 0
  buffer_load_dwordx4 v2, s[40:43], s33 offen lds
  s_add_u32 s33, s44, 0x8200
  s_add_u32 m0, s34, 0xc000
  s_nop 0
  buffer_load_dwordx4 v2, s[40:43], s33 offen lds
  s_add_u32 s33, s44, 0x10200
  s_add_u32 m0, s34, 0xd000
  s_nop 0
  buffer_load_dwordx4 v2, s[40:43], s33 offen lds
  s_add_u32 s33, s44, 0x18200
  s_add_u32 m0, s34, 0xe000
  s_nop 0
  buffer_load_dwordx4 v2, s[40:43], s33 offen lds
  s_add_u32 s33, s44, 0x20200
  s_add_u32 m0, s34, 0xf000
  s_nop 0
  buffer_load_dwordx4 v2, s[40:43], s33 offen lds
  s_add_u32 s33, s44, 0x28200
  s_add_u32 m0, s34, 0x10000
  s_nop 0
  buffer_load_dwordx4 v2, s[40:43], s33 offen lds
  s_add_u32 s33, s44, 0x30200
  s_add_u32 m0, s34, 0x11000
  s_nop 0
  buffer_load_dwordx4 v2, s[40:43], s33 offen lds
  s_add_u32 s33, s44, 0x38200
  s_add_u32 m0, s34, 0x12000
  s_nop 0
  buffer_load_dwordx4 v2, s[40:43], s33 offen lds
  s_mov_b32 s33, 0xc0400
  s_add_u32 m0, s34, 0x13000
  s_nop 0
  buffer_load_dwordx4 v3, s[48:51], s33 offen lds
  s_mov_b32 s33, 0xc0800
  s_add_u32 m0, s34, 0x14000
  s_nop 0
  buffer_load_dwordx4 v3, s[48:51], s33 offen lds
  s_mov_b32 s33, 0xc0000
  s_add_u32 m0, s34, 0x15000
  s_nop 0
  buffer_load_dwordx4 v3, s[48:51], s33 offen lds
  s_add_u32 s84, s60, 0
  s_and_b32 s84, s84, 3
  s_xor_b32 s86, s60, 4
  s_and_b32 s86, s86, 4
  s_or_b32 s84, s84, s86
  s_add_u32 s85, s60, 2
  s_and_b32 s85, s85, 3
  s_xor_b32 s86, s60, 0
  s_and_b32 s86, s86, 4
  s_or_b32 s85, s85, s86
  v_mov_b32 v12, s84
  v_mov_b32 v13, s85
  s_mov_b32 s86, 0
  s_mov_b32 s87, -1
  v_cndmask_b32 v12, v12, v13, s[86:87]
  v_bfe_u32 v13, v0, 4, 1
  v_lshl_add_u32 v12, v12, 1, v13
  v_lshl_add_u32 v12, v12, 7, v8
  buffer_load_dword v45, v12, s[56:59], s61 offen
  s_waitcnt vmcnt(23)
  v_lshlrev_b32 v20, 16, v16
  v_and_b32 v21, 0xffff0000, v16
  v_lshlrev_b32 v22, 16, v17
  v_and_b32 v23, 0xffff0000, v17
  v_lshlrev_b32 v24, 16, v18
  v_and_b32 v25, 0xffff0000, v18
  v_lshlrev_b32 v26, 16, v19
  v_and_b32 v27, 0xffff0000, v19
  v_mov_b32 v32, 0
  v_mov_b32 v41, 0
  v_lshlrev_b32 v28, 16, v60
  v_and_b32 v29, 0xffff0000, v60
  v_mul_f32 v28, v28, v20
  v_mul_f32 v29, v29, v21
  v_cvt_pk_bf16_f32 v30, v28, v29
  v_lshlrev_b32 v28, 16, v30
  v_and_b32 v29, 0xffff0000, v30
  v_add_f32 v41, v41, v28
  v_add_f32 v41, v41, v29
  v_lshlrev_b32 v28, 16, v61
  v_and_b32 v29, 0xffff0000, v61
  v_mul_f32 v28, v28, v22
  v_mul_f32 v29, v29, v23
  v_cvt_pk_bf16_f32 v30, v28, v29
  v_lshlrev_b32 v28, 16, v30
  v_and_b32 v29, 0xffff0000, v30
  v_add_f32 v41, v41, v28
  v_add_f32 v41, v41, v29
  v_lshlrev_b32 v28, 16, v62
  v_and_b32 v29, 0xffff0000, v62
  v_mul_f32 v28, v28, v24
  v_mul_f32 v29, v29, v25
  v_cvt_pk_bf16_f32 v30, v28, v29
  v_lshlrev_b32 v28, 16, v30
  v_and_b32 v29, 0xffff0000, v30
  v_add_f32 v41, v41, v28
  v_add_f32 v41, v41, v29
  v_lshlrev_b32 v28, 16, v63
  v_and_b32 v29, 0xffff0000, v63
  v_mul_f32 v28, v28, v26
  v_mul_f32 v29, v29, v27
  v_cvt_pk_bf16_f32 v30, v28, v29
  v_lshlrev_b32 v28, 16, v30
  v_and_b32 v29, 0xffff0000, v30
  v_add_f32 v41, v41, v28
  v_add_f32 v41, v41, v29
  s_nop 1
  v_add_f32_dpp v41, v41, v41 row_shr:1 row_mask:0xf bank_mask:0xf bound_ctrl:0
  s_nop 1
  v_add_f32_dpp v41, v41, v41 row_shr:2 row_mask:0xf bank_mask:0xf bound_ctrl:0
  s_nop 1
  v_add_f32_dpp v41, v41, v41 row_shr:4 row_mask:0xf bank_mask:0xf bound_ctrl:0
  s_nop 1
  v_add_f32_dpp v41, v41, v41 row_shr:8 row_mask:0xf bank_mask:0xf bound_ctrl:0
  s_nop 1
  v_add_f32_dpp v41, v41, v41 row_bcast:15 row_mask:0xa bank_mask:0xf
  s_nop 1
  v_add_f32_dpp v41, v41, v41 row_bcast:31 row_mask:0xc bank_mask:0xf
  s_nop 0
  v_readlane_b32 s64, v41, 63
  v_cmp_eq_u32 s[66:67], 0, v0
  s_nop 0
  v_mov_b32 v29, s64
  v_cndmask_b32 v32, v32, v29, s[66:67]
  s_waitcnt vmcnt(12)
  s_barrier
  s_add_u32 s33, s44, 0x280
  s_add_u32 m0, s34, 0x16000
  s_nop 0
  buffer_load_dwordx4 v2, s[40:43], s33 offen lds
  s_add_u32 s33, s44, 0x8280
  s_add_u32 m0, s34, 0x17000
  s_nop 0
  buffer_load_dwordx4 v2, s[40:43], s33 offen lds
  s_add_u32 s33, s44, 0x10280
  s_add_u32 m0, s34, 0x18000
  s_nop 0
  buffer_load_dwordx4 v2, s[40:43], s33 offen lds
  s_add_u32 s33, s44, 0x18280
  s_add_u32 m0, s34, 0x19000
  s_nop 0
  buffer_load_dwordx4 v2, s[40:43], s33 offen lds
  s_add_u32 s33, s44, 0x20280
  s_add_u32 m0, s34, 0x1a000
  s_nop 0
  buffer_load_dwordx4 v2, s[40:43], s33 offen lds
  s_add_u32 s33, s44, 0x28280
  s_add_u32 m0, s34, 0x1b000
  s_nop 0
  buffer_load_dwordx4 v2, s[40:43], s33 offen lds
  s_add_u32 s33, s44, 0x30280
  s_add_u32 m0, s34, 0x1c000
  s_nop 0
  buffer_load_dwordx4 v2, s[40:43], s33 offen lds
  s_add_u32 s33, s44, 0x38280
  s_add_u32 m0, s34, 0x1d000
  s_nop 0
  buffer_load_dwordx4 v2, s[40:43], s33 offen lds
  s_mov_b32 s33, 0xf0400
  s_add_u32 m0, s34, 0x1e000
  s_nop 0
  buffer_load_dwordx4 v3, s[48:51], s33 offen lds
  s_mov_b32 s33, 0xf0800
  s_add_u32 m0, s34, 0x1f000
  s_nop 0
  buffer_load_dwordx4 v3, s[48:51], s33 offen lds
  s_mov_b32 s33, 0xf0000
  s_add_u32 m0, s34, 0x20000
  s_nop 0
  buffer_load_dwordx4 v3, s[48:51], s33 offen lds
  v_mov_b32 v41, 0
  v_lshlrev_b32 v28, 16, v64
  v_and_b32 v29, 0xffff0000, v64
  v_mul_f32 v28, v28, v20
  v_mul_f32 v29, v29, v21
  v_cvt_pk_bf16_f32 v30, v28, v29
  v_lshlrev_b32 v28, 16, v30
  v_and_b32 v29, 0xffff0000, v30
  v_add_f32 v41, v41, v28
  v_add_f32 v41, v41, v29
  v_lshlrev_b32 v28, 16, v65
  v_and_b32 v29, 0xffff0000, v65
  v_mul_f32 v28, v28, v22
  v_mul_f32 v29, v29, v23
  v_cvt_pk_bf16_f32 v30, v28, v29
  v_lshlrev_b32 v28, 16, v30
  v_and_b32 v29, 0xffff0000, v30
  v_add_f32 v41, v41, v28
  v_add_f32 v41, v41, v29
  v_lshlrev_b32 v28, 16, v66
  v_and_b32 v29, 0xffff0000, v66
  v_mul_f32 v28, v28, v24
  v_mul_f32 v29, v29, v25
  v_cvt_pk_bf16_f32 v30, v28, v29
  v_lshlrev_b32 v28, 16, v30
  v_and_b32 v29, 0xffff0000, v30
  v_add_f32 v41, v41, v28
  v_add_f32 v41, v41, v29
  v_lshlrev_b32 v28, 16, v67
  v_and_b32 v29, 0xffff0000, v67
  v_mul_f32 v28, v28, v26
  v_mul_f32 v29, v29, v27
  v_cvt_pk_bf16_f32 v30, v28, v29
  v_lshlrev_b32 v28, 16, v30
  v_and_b32 v29, 0xffff0000, v30
  v_add_f32 v41, v41, v28
  v_add_f32 v41, v41, v29
  s_nop 1
  v_add_f32_dpp v41, v41, v41 row_shr:1 row_mask:0xf bank_mask:0xf bound_ctrl:0
  s_nop 1
  v_add_f32_dpp v41, v41, v41 row_shr:2 row_mask:0xf bank_mask:0xf bound_ctrl:0
  s_nop 1
  v_add_f32_dpp v41, v41, v41 row_shr:4 row_mask:0xf bank_mask:0xf bound_ctrl:0
  s_nop 1
  v_add_f32_dpp v41, v41, v41 row_shr:8 row_mask:0xf bank_mask:0xf bound_ctrl:0
  s_nop 1
  v_add_f32_dpp v41, v41, v41 row_bcast:15 row_mask:0xa bank_mask:0xf
  s_nop 1
  v_add_f32_dpp v41, v41, v41 row_bcast:31 row_mask:0xc bank_mask:0xf
  s_nop 0
  v_readlane_b32 s64, v41, 63
  v_cmp_eq_u32 s[66:67], 1, v0
  s_nop 0
  v_mov_b32 v29, s64
  v_cndmask_b32 v32, v32, v29, s[66:67]
  s_waitcnt vmcnt(12)
  s_barrier
  s_add_u32 s33, s44, 0x300
  s_add_u32 m0, s34, 0x0
  s_nop 0
  buffer_load_dwordx4 v2, s[40:43], s33 offen lds
  s_add_u32 s33, s44, 0x8300
  s_add_u32 m0, s34, 0x1000
  s_nop 0
  buffer_load_dwordx4 v2, s[40:43], s33 offen lds
  s_add_u32 s33, s44, 0x10300
  s_add_u32 m0, s34, 0x2000
  s_nop 0
  buffer_load_dwordx4 v2, s[40:43], s33 offen lds
  s_add_u32 s33, s44, 0x18300
  s_add_u32 m0, s34, 0x3000
  s_nop 0
  buffer_load_dwordx4 v2, s[40:43], s33 offen lds
  s_add_u32 s33, s44, 0x20300
  s_add_u32 m0, s34, 0x4000
  s_nop 0
  buffer_load_dwordx4 v2, s[40:43], s33 offen lds
  s_add_u32 s33, s44, 0x28300
  s_add_u32 m0, s34, 0x5000
  s_nop 0
  buffer_load_dwordx4 v2, s[40:43], s33 offen lds
  s_add_u32 s33, s44, 0x30300
  s_add_u32 m0, s34, 0x6000
  s_nop 0
  buffer_load_dwordx4 v2, s[40:43], s33 offen lds
  s_add_u32 s33, s44, 0x38300
  s_add_u32 m0, s34, 0x7000
  s_nop 0
  buffer_load_dwordx4 v2, s[40:43], s33 offen lds
  s_mov_b32 s33, 0x120400
  s_add_u32 m0, s34, 0x8000
  s_nop 0
  buffer_load_dwordx4 v3, s[48:51], s33 offen lds
  s_mov_b32 s33, 0x120800
  s_add_u32 m0, s34, 0x9000
  s_nop 0
  buffer_load_dwordx4 v3, s[48:51], s33 offen lds
  s_mov_b32 s33, 0x120000
  s_add_u32 m0, s34, 0xa000
  s_nop 0
  buffer_load_dwordx4 v3, s[48:51], s33 offen lds
  v_mov_b32 v41, 0
  v_lshlrev_b32 v28, 16, v68
  v_and_b32 v29, 0xffff0000, v68
  v_mul_f32 v28, v28, v20
  v_mul_f32 v29, v29, v21
  v_cvt_pk_bf16_f32 v30, v28, v29
  v_lshlrev_b32 v28, 16, v30
  v_and_b32 v29, 0xffff0000, v30
  v_add_f32 v41, v41, v28
  v_add_f32 v41, v41, v29
  v_lshlrev_b32 v28, 16, v69
  v_and_b32 v29, 0xffff0000, v69
  v_mul_f32 v28, v28, v22
  v_mul_f32 v29, v29, v23
  v_cvt_pk_bf16_f32 v30, v28, v29
  v_lshlrev_b32 v28, 16, v30
  v_and_b32 v29, 0xffff0000, v30
  v_add_f32 v41, v41, v28
  v_add_f32 v41, v41, v29
  v_lshlrev_b32 v28, 16, v70
  v_and_b32 v29, 0xffff0000, v70
  v_mul_f32 v28, v28, v24
  v_mul_f32 v29, v29, v25
  v_cvt_pk_bf16_f32 v30, v28, v29
  v_lshlrev_b32 v28, 16, v30
  v_and_b32 v29, 0xffff0000, v30
  v_add_f32 v41, v41, v28
  v_add_f32 v41, v41, v29
  v_lshlrev_b32 v28, 16, v71
  v_and_b32 v29, 0xffff0000, v71
  v_mul_f32 v28, v28, v26
  v_mul_f32 v29, v29, v27
  v_cvt_pk_bf16_f32 v30, v28, v29
  v_lshlrev_b32 v28, 16, v30
  v_and_b32 v29, 0xffff0000, v30
  v_add_f32 v41, v41, v28
  v_add_f32 v41, v41, v29
  s_nop 1
  v_add_f32_dpp v41, v41, v41 row_shr:1 row_mask:0xf bank_mask:0xf bound_ctrl:0
  s_nop 1
  v_add_f32_dpp v41, v41, v41 row_shr:2 row_mask:0xf bank_mask:0xf bound_ctrl:0
  s_nop 1
  v_add_f32_dpp v41, v41, v41 row_shr:4 row_mask:0xf bank_mask:0xf bound_ctrl:0
  s_nop 1
  v_add_f32_dpp v41, v41, v41 row_shr:8 row_mask:0xf bank_mask:0xf bound_ctrl:0
  s_nop 1
  v_add_f32_dpp v41, v41, v41 row_bcast:15 row_mask:0xa bank_mask:0xf
  s_nop 1
  v_add_f32_dpp v41, v41, v41 row_bcast:31 row_mask:0xc bank_mask:0xf
  s_nop 0
  v_readlane_b32 s64, v41, 63
  v_cmp_eq_u32 s[66:67], 2, v0
  s_nop 0
  v_mov_b32 v29, s64
  v_cndmask_b32 v32, v32, v29, s[66:67]
  s_waitcnt vmcnt(11)
  s_barrier
  s_add_u32 s33, s44, 0x380
  s_add_u32 m0, s34, 0xb000
  s_nop 0
  buffer_load_dwordx4 v2, s[40:43], s33 offen lds
  s_add_u32 s33, s44, 0x8380
  s_add_u32 m0, s34, 0xc000
  s_nop 0
  buffer_load_dwordx4 v2, s[40:43], s33 offen lds
  s_add_u32 s33, s44, 0x10380
  s_add_u32 m0, s34, 0xd000
  s_nop 0
  buffer_load_dwordx4 v2, s[40:43], s33 offen lds
  s_add_u32 s33, s44, 0x18380
  s_add_u32 m0, s34, 0xe000
  s_nop 0
  buffer_load_dwordx4 v2, s[40:43], s33 offen lds
  s_add_u32 s33, s44, 0x20380
  s_add_u32 m0, s34, 0xf000
  s_nop 0
  buffer_load_dwordx4 v2, s[40:43], s33 offen lds
  s_add_u32 s33, s44, 0x28380
  s_add_u32 m0, s34, 0x10000
  s_nop 0
  buffer_load_dwordx4 v2, s[40:43], s33 offen lds
  s_add_u32 s33, s44, 0x30380
  s_add_u32 m0, s34, 0x11000
  s_nop 0
  buffer_load_dwordx4 v2, s[40:43], s33 offen lds
  s_add_u32 s33, s44, 0x38380
  s_add_u32 m0, s34, 0x12000
  s_nop 0
  buffer_load_dwordx4 v2, s[40:43], s33 offen lds
  s_mov_b32 s33, 0x150400
  s_add_u32 m0, s34, 0x13000
  s_nop 0
  buffer_load_dwordx4 v3, s[48:51], s33 offen lds
  s_mov_b32 s33, 0x150800
  s_add_u32 m0, s34, 0x14000
  s_nop 0
  buffer_load_dwordx4 v3, s[48:51], s33 offen lds
  s_mov_b32 s33, 0x150000
  s_add_u32 m0, s34, 0x15000
  s_nop 0
  buffer_load_dwordx4 v3, s[48:51], s33 offen lds
  v_mov_b32 v41, 0
  v_lshlrev_b32 v28, 16, v72
  v_and_b32 v29, 0xffff0000, v72
  v_mul_f32 v28, v28, v20
  v_mul_f32 v29, v29, v21
  v_cvt_pk_bf16_f32 v30, v28, v29
  v_lshlrev_b32 v28, 16, v30
  v_and_b32 v29, 0xffff0000, v30
  v_add_f32 v41, v41, v28
  v_add_f32 v41, v41, v29
  v_lshlrev_b32 v28, 16, v73
  v_and_b32 v29, 0xffff0000, v73
  v_mul_f32 v28, v28, v22
  v_mul_f32 v29, v29, v23
  v_cvt_pk_bf16_f32 v30, v28, v29
  v_lshlrev_b32 v28, 16, v30
  v_and_b32 v29, 0xffff0000, v30
  v_add_f32 v41, v41, v28
  v_add_f32 v41, v41, v29
  v_lshlrev_b32 v28, 16, v74
  v_and_b32 v29, 0xffff0000, v74
  v_mul_f32 v28, v28, v24
  v_mul_f32 v29, v29, v25
  v_cvt_pk_bf16_f32 v30, v28, v29
  v_lshlrev_b32 v28, 16, v30
  v_and_b32 v29, 0xffff0000, v30
  v_add_f32 v41, v41, v28
  v_add_f32 v41, v41, v29
  v_lshlrev_b32 v28, 16, v75
  v_and_b32 v29, 0xffff0000, v75
  v_mul_f32 v28, v28, v26
  v_mul_f32 v29, v29, v27
  v_cvt_pk_bf16_f32 v30, v28, v29
  v_lshlrev_b32 v28, 16, v30
  v_and_b32 v29, 0xffff0000, v30
  v_add_f32 v41, v41, v28
  v_add_f32 v41, v41, v29
  s_nop 1
  v_add_f32_dpp v41, v41, v41 row_shr:1 row_mask:0xf bank_mask:0xf bound_ctrl:0
  s_nop 1
  v_add_f32_dpp v41, v41, v41 row_shr:2 row_mask:0xf bank_mask:0xf bound_ctrl:0
  s_nop 1
  v_add_f32_dpp v41, v41, v41 row_shr:4 row_mask:0xf bank_mask:0xf bound_ctrl:0
  s_nop 1
  v_add_f32_dpp v41, v41, v41 row_shr:8 row_mask:0xf bank_mask:0xf bound_ctrl:0
  s_nop 1
  v_add_f32_dpp v41, v41, v41 row_bcast:15 row_mask:0xa bank_mask:0xf
  s_nop 1
  v_add_f32_dpp v41, v41, v41 row_bcast:31 row_mask:0xc bank_mask:0xf
  s_nop 0
  v_readlane_b32 s64, v41, 63
  v_cmp_eq_u32 s[66:67], 3, v0
  s_nop 0
  v_mov_b32 v29, s64
  v_cndmask_b32 v32, v32, v29, s[66:67]
  v_cvt_pk_bf16_f32 v28, v32, v32
  v_lshlrev_b32 v28, 16, v28
  v_mul_f32 v28, 0xbfb8aa3b, v28
  v_exp_f32 v28, v28
  s_nop 0
  v_add_f32 v28, 1.0, v28
  v_rcp_f32 v28, v28
  s_nop 0
  v_cvt_pk_bf16_f32 v28, v28, v28
  v_lshlrev_b32 v28, 16, v28
  s_lshl_b32 s33, s46, 2
  s_add_u32 s33, s33, 0xa00000
  v_lshlrev_b32 v29, 2, v0
  s_mov_b64 exec, 15
  buffer_store_dword v28, v29, s[36:39], s33 offen sc1
  s_mov_b64 exec, -1
  s_waitcnt vmcnt(12)
  s_barrier
  s_waitcnt vmcnt(1)
  s_barrier
  s_lshr_b32 s33, s6, 1
  s_lshl_b32 s33, s33, 7
  s_sub_u32 s32, 0x80000, s33
  s_add_u32 s72, s12, s33
  s_addc_u32 s73, s13, 0
  s_mov_b32 s74, s32
  s_mov_b32 s75, 0x20000
  v_lshrrev_b32 v9, 2, v0
  v_lshlrev_b32 v9, 10, v9
  v_and_b32 v10, 3, v0
  v_lshl_add_u32 v9, v10, 4, v9
  s_lshl_b32 s68, s3, 17
  s_lshl_b32 s63, s3, 13
  s_getpc_b64 s[84:85]
gm_AL_pc2:
  s_sub_u32 s84, s84, gm_AL_pc2-gm_AC_att
  s_subb_u32 s85, s85, 0
  s_mov_b32 s86, gm_AL-gm_AC_att
  s_mov_b32 s87, 0x20000
  v_lshlrev_b32 v13, 11, v0
  s_lshl_b32 s33, s6, 7
  s_lshl_b32 s32, s3, 14
  s_add_u32 s33, s33, s32
  s_mov_b64 exec, 0xff
  buffer_load_dword v52, v13, s[84:87], s33 offen
  s_mov_b64 exec, -1
  s_barrier
  s_waitcnt vmcnt(0)
  s_barrier
  s_cmp_eq_u32 s83, 0
  s_cbranch_scc1 gm_AL_nh
  s_sub_u32 s33, s83, 1
  s_lshl_b32 s33, s33, 4
  s_add_u32 s33, s33, s82
  s_lshl_b32 s69, s33, 15
  s_add_u32 s69, s69, s63
  s_lshl_b32 s33, s33, 10
  s_add_u32 s33, s33, 0x1680000
  v_and_b32 v13, 7, v0
  v_lshlrev_b32 v13, 7, v13
  v_add_u32 v13, s33, v13
  s_mov_b32 s88, 0x8000
poll8:
  buffer_load_dword v14, v13, s[36:39], 0 offen sc1
  s_waitcnt vmcnt(0)
  v_cmp_ne_u32 s[86:87], s90, v14
  s_nop 3
  s_cmp_eq_u64 s[86:87], 0
  s_cbranch_scc1 poll8_ok
  s_sleep 3
  s_sub_u32 s88, s88, 1
  s_cmp_lg_u32 s88, 0
  s_cbranch_scc1 poll8
poll8_ok:
  s_lshl_b32 s70, s3, 14
  s_add_u32 m0, s70, 0x0
  s_add_u32 s33, s69, 0x0
  buffer_load_dwordx4 v1, s[36:39], s33 offen offset:0 sc1 lds
  buffer_load_dwordx4 v1, s[36:39], s33 offen offset:1024 sc1 lds
  buffer_load_dwordx4 v1, s[36:39], s33 offen offset:2048 sc1 lds
  buffer_load_dwordx4 v1, s[36:39], s33 offen offset:3072 sc1 lds
  s_add_u32 m0, s70, 0x1000
  s_add_u32 s33, s69, 0x1000
  buffer_load_dwordx4 v1, s[36:39], s33 offen offset:0 sc1 lds
  buffer_load_dwordx4 v1, s[36:39], s33 offen offset:1024 sc1 lds
  buffer_load_dwordx4 v1, s[36:39], s33 offen offset:2048 sc1 lds
  buffer_load_dwordx4 v1, s[36:39], s33 offen offset:3072 sc1 lds
  s_waitcnt vmcnt(0)
gm_AL_nh:
  s_barrier
  s_add_u32 m0, s63, 0x10000
  s_add_u32 s33, s68, 0x0
  buffer_load_dwordx4 v9, s[72:75], s33 offen lds
  s_add_u32 m0, s63, 0x10400
  s_add_u32 s33, s68, 0x4000
  buffer_load_dwordx4 v9, s[72:75], s33 offen lds
  s_add_u32 m0, s63, 0x10800
  s_add_u32 s33, s68, 0x8000
  buffer_load_dwordx4 v9, s[72:75], s33 offen lds
  s_add_u32 m0, s63, 0x10c00
  s_add_u32 s33, s68, 0xc000
  buffer_load_dwordx4 v9, s[72:75], s33 offen lds
  s_add_u32 m0, s63, 0x11000
  s_add_u32 s33, s68, 0x10000
  buffer_load_dwordx4 v9, s[72:75], s33 offen lds
  s_add_u32 m0, s63, 0x11400
  s_add_u32 s33, s68, 0x14000
  buffer_load_dwordx4 v9, s[72:75], s33 offen lds
  s_add_u32 m0, s63, 0x11800
  s_add_u32 s33, s68, 0x18000
  buffer_load_dwordx4 v9, s[72:75], s33 offen lds
  s_add_u32 m0, s63, 0x11c00
  s_add_u32 s33, s68, 0x1c000
  buffer_load_dwordx4 v9, s[72:75], s33 offen lds
  s_add_u32 m0, s63, 0x18000
  s_add_u32 s33, s68, 0x40
  buffer_load_dwordx4 v9, s[72:75], s33 offen lds
  s_add_u32 m0, s63, 0x18400
  s_add_u32 s33, s68, 0x4040
  buffer_load_dwordx4 v9, s[72:75], s33 offen lds
  s_add_u32 m0, s63, 0x18800
  s_add_u32 s33, s68, 0x8040
  buffer_load_dwordx4 v9, s[72:75], s33 offen lds
  s_add_u32 m0, s63, 0x18c00
  s_add_u32 s33, s68, 0xc040
  buffer_load_dwordx4 v9, s[72:75], s33 offen lds
  s_add_u32 m0, s63, 0x19000
  s_add_u32 s33, s68, 0x10040
  buffer_load_dwordx4 v9, s[72:75], s33 offen lds
  s_add_u32 m0, s63, 0x19400
  s_add_u32 s33, s68, 0x14040
  buffer_load_dwordx4 v9, s[72:75], s33 offen lds
  s_add_u32 m0, s63, 0x19800
  s_add_u32 s33, s68, 0x18040
  buffer_load_dwordx4 v9, s[72:75], s33 offen lds
  s_add_u32 m0, s63, 0x19c00
  s_add_u32 s33, s68, 0x1c040
  buffer_load_dwordx4 v9, s[72:75], s33 offen lds
  s_add_u32 s84, s60, 3
  s_and_b32 s84, s84, 3
  s_xor_b32 s86, s60, 0
  s_and_b32 s86, s86, 4
  s_or_b32 s84, s84, s86
  s_add_u32 s85, s60, 1
  s_and_b32 s85, s85, 3
  s_xor_b32 s86, s60, 4
  s_and_b32 s86, s86, 4
  s_or_b32 s85, s85, s86
  v_mov_b32 v12, s84
  v_mov_b32 v13, s85
  s_mov_b32 s86, 0
  s_mov_b32 s87, -1
  v_cndmask_b32 v12, v12, v13, s[86:87]
  v_bfe_u32 v13, v0, 4, 1
  v_lshl_add_u32 v12, v12, 1, v13
  v_lshl_add_u32 v12, v12, 7, v8
  buffer_load_dword v46, v12, s[56:59], s61 offen
  s_add_u32 s84, s60, 2
  s_and_b32 s84, s84, 3
  s_xor_b32 s86, s60, 4
  s_and_b32 s86, s86, 4
  s_or_b32 s84, s84, s86
  s_add_u32 s85, s60, 3
  s_and_b32 s85, s85, 3
  s_xor_b32 s86, s60, 4
  s_and_b32 s86, s86, 4
  s_or_b32 s85, s85, s86
  v_mov_b32 v12, s84
  v_mov_b32 v13, s85
  s_mov_b32 s86, 0
  s_mov_b32 s87, -1
  v_cndmask_b32 v12, v12, v13, s[86:87]
  v_bfe_u32 v13, v0, 4, 1
  v_lshl_add_u32 v12, v12, 1, v13
  v_lshl_add_u32 v12, v12, 7, v8
  buffer_load_dword v47, v12, s[56:59], s61 offen
  s_waitcnt vmcnt(2)
  s_barrier
  s_endpgm
gm_end:
  s_endpgm
CODE_END:
.section .rodata,"a"
.p2align 6
.amdhsa_kernel gated_mix__sliding_block__spectral_fnet__prompt_kernel
  .amdhsa_next_free_vgpr 168
  .amdhsa_next_free_sgpr 102
  .amdhsa_accum_offset 168
  .amdhsa_group_segment_fixed_size 0
  .amdhsa_kernarg_size 96
  .amdhsa_user_sgpr_count 2
  .amdhsa_user_sgpr_kernarg_segment_ptr 1
  .amdhsa_system_sgpr_workgroup_id_x 1
.end_amdhsa_kernel
```
